```python
import torch

def _softmax(x, axis=-1):
    return torch.softmax(x, dim=axis)

def _gelu(x):
    return torch.nn.functional.gelu(x, approximate='tanh')

def _silu(x):
    return torch.nn.functional.silu(x)

def _sigmoid(x):
    return torch.sigmoid(x)

def _layernorm(x, axis=-1, eps=1e-05):
    m = x.mean(dim=axis, keepdim=True)
    v = x.var(dim=axis, keepdim=True, unbiased=False)
    return (x - m) / torch.sqrt(v + eps)

def _scatter_add(tgt, idx, src, axis=0):
    return tgt.clone().index_add_(axis, idx, src)

def _segment_sum(src, seg, n):
    out = torch.zeros((n,) + src.shape[1:], dtype=src.dtype)
    return out.index_add_(0, seg, src)

def _pad(x, pw):
    flat = tuple((v for pair in reversed(pw) for v in pair))
    return torch.nn.functional.pad(x, flat)
kernel_name = 'gated_mix__memory_aug_recurrent_mem_tr__glu_gated_swiglu__prompt'

def setup_inputs():

    _w = lambda a: (lambda t: t.to(torch.bfloat16) if t.is_floating_point() else t)(torch.as_tensor(a))

    def _A_setup():
        B, S, Dm = (1, 2048, 1024)
        H, Dh = (32, 128)
        M, seg = (8, 32)
        seg = min(seg, S)
        S = S // seg * seg
        return {'x': _w((lambda *s: torch.randn(*s, dtype=torch.bfloat16) * 0.05)(B, S, Dm)), 'mem0': _w((lambda *s: torch.randn(*s, dtype=torch.bfloat16) * 0.4)(B, M, Dm)), 'Wq': _w((lambda *s: torch.randn(*s, dtype=torch.bfloat16) * 6.4)(Dm, H, Dh) * Dm ** (-0.5)), 'Wk': _w((lambda *s: torch.randn(*s, dtype=torch.bfloat16) * 6.4)(Dm, H, Dh) * Dm ** (-0.5)), 'Wv': _w((lambda *s: torch.randn(*s, dtype=torch.bfloat16) * 0.4)(Dm, H, Dh) * Dm ** (-0.5)), 'Wo': _w((lambda *s: torch.randn(*s, dtype=torch.bfloat16) * 0.4)(H, Dh, Dm) * (H * Dh) ** (-0.5)), 'seg_len': seg}
    _A_in = _A_setup()

    def _B_setup():
        B, S, D, F = (1, 2048, 1024, 3584)
        return {'x': _w((lambda *s: torch.randn(*s, dtype=torch.bfloat16) * 0.05)(B, S, D)), 'w1': _w((lambda *s: torch.randn(*s, dtype=torch.bfloat16) * 1.6)(D, F) * (2.0 / D) ** 0.5), 'w3': _w((lambda *s: torch.randn(*s, dtype=torch.bfloat16) * 1.6)(D, F) * (2.0 / D) ** 0.5), 'w2': _w((lambda *s: torch.randn(*s, dtype=torch.bfloat16) * 1.6)(F, D) * (2.0 / F) ** 0.5)}
    _B_in = _B_setup()
    return {'A_x': _A_in['x'], 'A_mem0': _A_in['mem0'], 'A_Wq': _A_in['Wq'], 'A_Wk': _A_in['Wk'], 'A_Wv': _A_in['Wv'], 'A_Wo': _A_in['Wo'], 'A_seg_len': _A_in['seg_len'], 'B_x': _B_in['x'], 'B_w1': _B_in['w1'], 'B_w3': _B_in['w3'], 'B_w2': _B_in['w2'], 'gate_w': _w((lambda *s: torch.randn(*s, dtype=torch.bfloat16) * 0.05)(1024) * 16.0)}

def reference(A_x, A_mem0, A_Wq, A_Wk, A_Wv, A_Wo, A_seg_len, B_x, B_w1, B_w3, B_w2, gate_w):

    def _A_ref(x, mem0, Wq, Wk, Wv, Wo, seg_len):
        B, S, Dm = x.shape
        H, Dh = (Wq.shape[1], Wq.shape[2])
        M = mem0.shape[1]
        scale = Dh ** (-0.5)
        n_seg = S // seg_len
        L = M + seg_len
        idx = torch.arange(L)
        mask = (idx[:, None] < M) | (idx[:, None] >= idx[None, :])
        mem = mem0
        outs = []
        for s in range(n_seg):
            xs = x[:, s * seg_len:(s + 1) * seg_len, :].clone()
            h = torch.concatenate([mem, xs], axis=1)
            q = torch.einsum('btd,dhe->bhte', h, Wq)
            k = torch.einsum('btd,dhe->bhte', h, Wk)
            v = torch.einsum('btd,dhe->bhte', h, Wv)
            scores = torch.einsum('bhqe,bhke->bhqk', q, k) * scale
            scores = torch.where(mask[None, None], scores, -1000000000.0)
            p = _softmax(scores, axis=-1)
            o = torch.einsum('bhqk,bhke->bhqe', p, v)
            o = torch.einsum('bhte,hed->btd', o, Wo)
            mem = o[:, :M, :].clone()
            outs.append(o[:, M:, :])
        return torch.concatenate(outs, axis=1)

    def _B_ref(x, w1, w3, w2):
        gate = torch.einsum('bsd,df->bsf', x, w1)
        up = torch.einsum('bsd,df->bsf', x, w3)
        h = _silu(gate) * up
        out = torch.einsum('bsf,fd->bsd', h, w2)
        return out
    x = A_x
    g = _sigmoid((x * gate_w).sum(-1, keepdims=True))
    a = _A_ref(x, A_mem0, A_Wq, A_Wk, A_Wv, A_Wo, A_seg_len)
    b = _B_ref(x, B_w1, B_w3, B_w2)
    return g * a + (1 - g) * b
```

```asm
; @launch grid=(256,1,1) block=(256,1,1) lds=163840
.amdgcn_target "amdgcn-amd-amdhsa--gfx950"
.text
.globl gated_mix__memory_aug_recurrent_mem_tr__glu_gated_swiglu__prompt_kernel
.p2align 8
.type gated_mix__memory_aug_recurrent_mem_tr__glu_gated_swiglu__prompt_kernel,@function
gated_mix__memory_aug_recurrent_mem_tr__glu_gated_swiglu__prompt_kernel:
s_cmp_ge_u32 s2,256
s_cbranch_scc1 L_exit
s_load_dwordx2 s[4:5],s[0:1],112
s_load_dwordx2 s[6:7],s[0:1],104
s_getpc_b64 s[16:17]
L_entry_pc:
s_lshr_b32 s54,s2,3
s_and_b32 s54,s54,3
s_lshl_b32 s54,s54,15
v_lshl_add_u32 v24,v0,7,s54
v_min_u32 v24,L_code_end-L_entry_pc-4,v24
global_load_dword v28,v24,s[16:17]
v_lshrrev_b32 v24,6,v0
s_getreg_b32 s12,hwreg(HW_REG_XCC_ID)
v_readfirstlane_b32 s14,v24
s_and_b32 s12,s12,7
v_mov_b32 v25,1
s_mov_b32 s15,0
v_mov_b32 v27,0
s_waitcnt lgkmcnt(0)
s_cmp_eq_u32 s14,0
s_cbranch_scc0 L_en_w1
s_lshr_b32 s54,s2,7
s_bfe_u32 s55,s2,0x20005
s_and_b32 s56,s2,31
s_lshl_b32 s57,s54,22
s_lshl_b32 s59,s55,19
s_add_u32 s57,s57,s59
s_lshl_b32 s59,s56,13
s_add_u32 s57,s57,s59
s_add_u32 s57,s57,92274688
v_lshl_add_u32 v24,v0,4,s57
v_add_u32 v26,4096,v24
v_mov_b32 v32,-1
v_mov_b32 v33,-1
v_mov_b32 v34,-1
v_mov_b32 v35,-1
global_store_dwordx4 v24,v[32:35],s[4:5] offset:0 sc1
global_store_dwordx4 v24,v[32:35],s[4:5] offset:1024 sc1
global_store_dwordx4 v24,v[32:35],s[4:5] offset:2048 sc1
global_store_dwordx4 v24,v[32:35],s[4:5] offset:3072 sc1
global_store_dwordx4 v26,v[32:35],s[4:5] offset:0 sc1
global_store_dwordx4 v26,v[32:35],s[4:5] offset:1024 sc1
global_store_dwordx4 v26,v[32:35],s[4:5] offset:2048 sc1
global_store_dwordx4 v26,v[32:35],s[4:5] offset:3072 sc1
s_lshl_b32 s54,s2,7
s_add_u32 s54,s54,94371840
v_lshl_add_u32 v24,v0,16,s54
s_mov_b64 exec,3
global_store_dword v24,v27,s[4:5] sc1
s_waitcnt vmcnt(0)
s_mov_b64 exec,1
s_mov_b32 s13,s12
L_en_try:
s_and_b32 s54,s13,3
s_lshr_b32 s55,s13,2
s_lshl_b32 s54,s54,2
s_lshl_b32 s59,s55,7
s_add_u32 s54,s54,s59
v_mov_b32 v24,s54
global_atomic_add v26,v24,v25,s[6:7] offset:32 sc0
s_waitcnt vmcnt(0)
v_readfirstlane_b32 s11,v26
s_nop 0
s_cmp_lt_u32 s11,32
s_cbranch_scc1 L_en_got
s_add_u32 s13,s13,1
s_and_b32 s13,s13,7
s_cmp_lg_u32 s13,s12
s_cbranch_scc1 L_en_try
L_en_got:
s_min_u32 s11,s11,255
s_lshl_b32 s54,s13,8
s_or_b32 s54,s54,s11
v_mov_b32 v26,s54
ds_write_b32 v27,v26
s_mov_b64 exec,-1
s_branch L_en_j
L_en_w1:
L_en_j:
s_waitcnt lgkmcnt(0)
s_barrier
ds_read_b32 v26,v27
s_waitcnt lgkmcnt(0)
v_readfirstlane_b32 s54,v26
s_barrier
s_and_b32 s11,s54,255
s_lshr_b32 s10,s54,8
s_cmp_ge_u32 s11,32
s_cbranch_scc1 L_exit
s_cmp_lt_u32 s10,4
s_cbranch_scc1 L_chain
s_sub_u32 s10,s10,4
s_branch L_bulk
L_exit:
s_endpgm
L_bulk:
s_load_dwordx2 s[4:5],s[0:1],112
s_load_dwordx2 s[6:7],s[0:1],104
s_load_dwordx2 s[64:65],s[0:1],0
s_load_dwordx2 s[66:67],s[0:1],16
s_load_dwordx2 s[68:69],s[0:1],24
s_load_dwordx2 s[70:71],s[0:1],32
s_load_dwordx2 s[72:73],s[0:1],64
s_load_dwordx2 s[74:75],s[0:1],72
s_load_dwordx2 s[76:77],s[0:1],80
s_load_dwordx2 s[60:61],s[0:1],40
s_load_dwordx2 s[62:63],s[0:1],96
s_load_dwordx2 s[46:47],s[0:1],88
v_lshrrev_b32 v2,6,v0
s_mov_b32 s40,0x200000
v_readfirstlane_b32 s14,v2
s_getpc_b64 s[78:79]
L_bulk_pc:
s_add_u32 s78,s78,L_table-L_bulk_pc
s_addc_u32 s79,s79,0
s_mul_i32 s54,s10,1280
s_mul_i32 s59,s11,40
s_add_u32 s54,s54,s59
s_add_u32 s78,s78,s54
s_addc_u32 s79,s79,0
s_load_dwordx2 s[26:27],s[78:79],0
s_lshl_b32 s23,s14,12
s_waitcnt lgkmcnt(0)
s_cmp_ge_u32 s10,4
s_cbranch_scc1 L_bulk_nx
v_bfe_u32 v31,v0,0,6
v_lshlrev_b32 v40,5,v31
global_load_dwordx4 v[160:163],v40,s[46:47]
global_load_dwordx4 v[164:167],v40,s[46:47] offset:16
s_lshl_b32 s13,s11,2
s_add_u32 s13,s13,s10
s_lshl_b32 s54,s13,15
s_lshl_b32 s59,s14,13
s_add_u32 s54,s54,s59
s_add_u32 s56,s64,s54
s_addc_u32 s57,s65,0
global_load_dwordx4 v[128:131],v40,s[56:57] offset:0
global_load_dwordx4 v[132:135],v40,s[56:57] offset:16
global_load_dwordx4 v[136:139],v40,s[56:57] offset:2048
global_load_dwordx4 v[140:143],v40,s[56:57] offset:2064
s_add_u32 s56,s56,4096
s_addc_u32 s57,s57,0
global_load_dwordx4 v[144:147],v40,s[56:57] offset:0
global_load_dwordx4 v[148:151],v40,s[56:57] offset:16
global_load_dwordx4 v[152:155],v40,s[56:57] offset:2048
global_load_dwordx4 v[156:159],v40,s[56:57] offset:2064
L_bulk_nx:
v_bfe_u32 v31,v0,0,6
v_lshlrev_b32 v2,4,v31
v_add_u32 v3,4096,v2
v_bfe_u32 v31,v0,0,6
v_lshlrev_b32 v192,4,v31
v_bfe_u32 v31,v0,6,2
v_lshl_add_u32 v192,v31,17,v192
v_add_u32 v193,31744,v192
v_add_u32 v194,63488,v192
v_add_u32 v195,95232,v192
v_bfe_u32 v31,v0,0,6
v_lshlrev_b32 v196,4,v31
v_bfe_u32 v31,v0,6,2
s_mov_b32 s59,458752
v_mad_u32_u24 v196,v31,s59,v196
v_bfe_u32 v31,v0,0,6
v_lshlrev_b32 v213,4,v31
v_bfe_u32 v31,v0,7,1
v_lshl_add_u32 v213,v31,13,v213
v_bfe_u32 v31,v0,0,4
v_lshlrev_b32 v214,11,v31
v_bfe_u32 v31,v0,4,1
v_lshl_add_u32 v214,v31,5,v214
v_bfe_u32 v31,v0,5,1
v_lshl_add_u32 v214,v31,4,v214
v_bfe_u32 v31,v0,7,1
v_lshl_add_u32 v214,v31,17,v214
v_bfe_u32 v31,v0,6,1
v_lshl_add_u32 v214,v31,7,v214
v_bfe_u32 v24,v0,4,2
v_lshlrev_b32 v24,1,v24
v_xor_b32 v24,v24,v0
v_and_b32 v24,15,v24
v_lshlrev_b32 v24,4,v24
v_xor_b32 v25,128,v24
v_bfe_u32 v31,v0,4,2
v_lshlrev_b32 v26,13,v31
v_bfe_u32 v31,v0,6,1
v_lshl_add_u32 v26,v31,15,v26
v_add_u32 v200,v26,v24
v_add_u32 v25,v26,v25
v_add_u32 v201,64512,v25
v_add_u32 v202,129024,v200
v_add_u32 v203,193536,v25
v_bfe_u32 v24,v0,4,2
v_lshlrev_b32 v24,1,v24
v_xor_b32 v24,v24,v0
v_and_b32 v24,15,v24
v_lshlrev_b32 v24,4,v24
v_xor_b32 v25,128,v24
v_bfe_u32 v31,v0,4,2
v_mul_u32_u24 v26,7168,v31
v_bfe_u32 v31,v0,6,1
s_mov_b32 s59,28672
v_mad_u32_u24 v26,v31,s59,v26
v_add_u32 v204,v26,v24
v_add_u32 v25,v26,v25
v_add_u32 v205,56320,v25
v_add_u32 v206,112640,v204
v_add_u32 v207,168960,v25
v_bfe_u32 v24,v0,4,2
v_lshlrev_b32 v24,1,v24
v_xor_b32 v24,v24,v0
v_and_b32 v24,15,v24
v_lshlrev_b32 v24,4,v24
v_xor_b32 v25,128,v24
v_bfe_u32 v31,v0,4,2
v_lshlrev_b32 v26,11,v31
v_bfe_u32 v31,v0,6,1
v_lshl_add_u32 v26,v31,15,v26
v_add_u32 v208,v26,v24
v_add_u32 v25,v26,v25
v_add_u32 v209,7168,v25
v_add_u32 v210,14336,v208
v_add_u32 v211,21504,v25
v_bfe_u32 v31,v0,2,3
v_lshlrev_b32 v24,5,v31
v_bfe_u32 v31,v0,2,4
v_lshlrev_b32 v25,8,v31
v_bfe_u32 v31,v0,0,2
v_lshl_add_u32 v25,v31,3,v25
v_bfe_u32 v31,v0,6,1
v_lshl_add_u32 v25,v31,13,v25
v_add_u32 v25,65536,v25
v_xor_b32 v26,0,v24
v_add_u32 v216,v25,v26
v_xor_b32 v26,32,v24
v_add_u32 v217,v25,v26
v_xor_b32 v26,64,v24
v_add_u32 v218,v25,v26
v_xor_b32 v26,96,v24
v_add_u32 v219,v25,v26
v_xor_b32 v26,128,v24
v_add_u32 v220,v25,v26
v_xor_b32 v26,160,v24
v_add_u32 v221,v25,v26
v_xor_b32 v26,192,v24
v_add_u32 v222,v25,v26
v_xor_b32 v26,224,v24
v_add_u32 v223,v25,v26
v_bfe_u32 v31,v0,2,3
v_lshlrev_b32 v24,5,v31
v_bfe_u32 v31,v0,6,1
v_lshlrev_b32 v26,7,v31
v_xor_b32 v24,v24,v26
v_bfe_u32 v31,v0,2,4
v_lshlrev_b32 v25,8,v31
v_bfe_u32 v31,v0,0,2
v_lshl_add_u32 v25,v31,3,v25
v_add_u32 v25,65536,v25
v_xor_b32 v26,0,v24
v_add_u32 v224,v25,v26
v_add_u32 v228,8192,v224
v_xor_b32 v26,32,v24
v_add_u32 v225,v25,v26
v_add_u32 v229,8192,v225
v_xor_b32 v26,64,v24
v_add_u32 v226,v25,v26
v_add_u32 v230,8192,v226
v_xor_b32 v26,96,v24
v_add_u32 v227,v25,v26
v_add_u32 v231,8192,v227
v_mov_b32 v234,1
v_mov_b32 v252,1
v_mov_b32 v235,0
v_mov_b32 v233,94445440
v_bfe_u32 v31,v0,0,4
v_lshlrev_b32 v237,3,v31
v_bfe_u32 v31,v0,7,1
v_lshl_add_u32 v237,v31,9,v237
v_add_u32 v237,95420416,v237
v_bfe_u32 v31,v0,6,2
v_lshlrev_b32 v239,2,v31
v_add_u32 v239,131072,v239
v_mov_b32 v15,131072
s_mov_b32 s28,0
s_lshr_b32 s41,s10,2
s_mov_b32 s42,-1
s_mov_b32 s43,0
v_mov_b32 v215,0
s_mov_b32 s24,0
s_mov_b32 s25,0
s_mov_b32 s3,0
s_mov_b32 s39,0
s_mov_b32 s29,0
s_cmp_eq_u32 s14,0
s_cselect_b32 s38,1,0
s_waitcnt lgkmcnt(0)
s_mov_b64 s[48:49],s[72:73]
s_mov_b64 s[8:9],s[72:73]
s_mov_b64 s[44:45],s[64:65]
s_mov_b64 s[16:17],s[64:65]
s_mov_b64 s[18:19],s[64:65]
s_mov_b64 s[30:31],s[64:65]
s_mov_b64 s[50:51],s[64:65]
s_mov_b64 s[52:53],s[64:65]
s_mov_b64 s[56:57],s[64:65]
v_mov_b32 v4,0
v_mov_b32 v5,0
v_mov_b32 v6,0
v_mov_b32 v7,0
v_mov_b32 v8,0
v_mov_b32 v9,0
v_mov_b32 v10,0
v_mov_b32 v11,0
v_mov_b32 v238,0
s_cmp_ge_u32 s10,4
s_cbranch_scc1 L_bulk_nx2
s_waitcnt vmcnt(0)
v_bfe_u32 v31,v0,0,6
v_lshlrev_b32 v24,9,v31
v_bfe_u32 v31,v0,6,2
v_lshl_add_u32 v24,v31,6,v24
v_add_u32 v24,131072,v24
ds_write_b128 v24,v[128:131] offset:0
ds_write_b128 v24,v[132:135] offset:256
ds_write_b128 v24,v[136:139] offset:16
ds_write_b128 v24,v[140:143] offset:272
ds_write_b128 v24,v[144:147] offset:32
ds_write_b128 v24,v[148:151] offset:288
ds_write_b128 v24,v[152:155] offset:48
ds_write_b128 v24,v[156:159] offset:304
s_waitcnt lgkmcnt(0)
s_barrier
v_bfe_u32 v31,v0,0,6
v_lshlrev_b32 v28,4,v31
v_bfe_u32 v31,v0,6,2
v_lshl_add_u32 v28,v31,13,v28
v_add_u32 v24,131072,v28
ds_read_b128 v[64:67],v24 offset:0
ds_read_b128 v[68:71],v24 offset:1024
ds_read_b128 v[72:75],v24 offset:2048
ds_read_b128 v[76:79],v24 offset:3072
ds_read_b128 v[80:83],v24 offset:4096
ds_read_b128 v[84:87],v24 offset:5120
ds_read_b128 v[88:91],v24 offset:6144
ds_read_b128 v[92:95],v24 offset:7168
s_lshl_b32 s54,s13,15
s_add_u32 s54,s54,104857600
s_add_u32 s56,s4,s54
s_addc_u32 s57,s5,0
v_add_u32 v29,4096,v28
s_waitcnt lgkmcnt(0)
global_store_dwordx4 v28,v[64:67],s[56:57] offset:0 sc1
global_store_dwordx4 v28,v[68:71],s[56:57] offset:1024 sc1
global_store_dwordx4 v28,v[72:75],s[56:57] offset:2048 sc1
global_store_dwordx4 v28,v[76:79],s[56:57] offset:3072 sc1
global_store_dwordx4 v29,v[80:83],s[56:57] offset:0 sc1
global_store_dwordx4 v29,v[84:87],s[56:57] offset:1024 sc1
global_store_dwordx4 v29,v[88:91],s[56:57] offset:2048 sc1
global_store_dwordx4 v29,v[92:95],s[56:57] offset:3072 sc1
v_lshlrev_b32 v104,16,v160
v_and_b32 v105,0xffff0000,v160
v_lshlrev_b32 v106,16,v161
v_and_b32 v107,0xffff0000,v161
v_lshlrev_b32 v108,16,v162
v_and_b32 v109,0xffff0000,v162
v_lshlrev_b32 v110,16,v163
v_and_b32 v111,0xffff0000,v163
v_lshlrev_b32 v112,16,v164
v_and_b32 v113,0xffff0000,v164
v_lshlrev_b32 v114,16,v165
v_and_b32 v115,0xffff0000,v165
v_lshlrev_b32 v116,16,v166
v_and_b32 v117,0xffff0000,v166
v_lshlrev_b32 v118,16,v167
v_and_b32 v119,0xffff0000,v167
v_lshlrev_b32 v24,16,v128
v_and_b32 v25,0xffff0000,v128
v_pk_mul_f32 v[24:25],v[24:25],v[104:105]
v_cvt_pk_bf16_f32 v26,v24,v25
v_lshlrev_b32 v120,16,v26
v_and_b32 v121,0xffff0000,v26
v_lshlrev_b32 v24,16,v129
v_and_b32 v25,0xffff0000,v129
v_pk_mul_f32 v[24:25],v[24:25],v[106:107]
v_cvt_pk_bf16_f32 v26,v24,v25
v_lshlrev_b32 v24,16,v26
v_and_b32 v25,0xffff0000,v26
v_pk_add_f32 v[120:121],v[120:121],v[24:25]
v_lshlrev_b32 v24,16,v130
v_and_b32 v25,0xffff0000,v130
v_pk_mul_f32 v[24:25],v[24:25],v[108:109]
v_cvt_pk_bf16_f32 v26,v24,v25
v_lshlrev_b32 v24,16,v26
v_and_b32 v25,0xffff0000,v26
v_pk_add_f32 v[120:121],v[120:121],v[24:25]
v_lshlrev_b32 v24,16,v131
v_and_b32 v25,0xffff0000,v131
v_pk_mul_f32 v[24:25],v[24:25],v[110:111]
v_cvt_pk_bf16_f32 v26,v24,v25
v_lshlrev_b32 v24,16,v26
v_and_b32 v25,0xffff0000,v26
v_pk_add_f32 v[120:121],v[120:121],v[24:25]
v_lshlrev_b32 v24,16,v132
v_and_b32 v25,0xffff0000,v132
v_pk_mul_f32 v[24:25],v[24:25],v[112:113]
v_cvt_pk_bf16_f32 v26,v24,v25
v_lshlrev_b32 v24,16,v26
v_and_b32 v25,0xffff0000,v26
v_pk_add_f32 v[120:121],v[120:121],v[24:25]
v_lshlrev_b32 v24,16,v133
v_and_b32 v25,0xffff0000,v133
v_pk_mul_f32 v[24:25],v[24:25],v[114:115]
v_cvt_pk_bf16_f32 v26,v24,v25
v_lshlrev_b32 v24,16,v26
v_and_b32 v25,0xffff0000,v26
v_pk_add_f32 v[120:121],v[120:121],v[24:25]
v_lshlrev_b32 v24,16,v134
v_and_b32 v25,0xffff0000,v134
v_pk_mul_f32 v[24:25],v[24:25],v[116:117]
v_cvt_pk_bf16_f32 v26,v24,v25
v_lshlrev_b32 v24,16,v26
v_and_b32 v25,0xffff0000,v26
v_pk_add_f32 v[120:121],v[120:121],v[24:25]
v_lshlrev_b32 v24,16,v135
v_and_b32 v25,0xffff0000,v135
v_pk_mul_f32 v[24:25],v[24:25],v[118:119]
v_cvt_pk_bf16_f32 v26,v24,v25
v_lshlrev_b32 v24,16,v26
v_and_b32 v25,0xffff0000,v26
v_pk_add_f32 v[120:121],v[120:121],v[24:25]
v_add_f32 v120,v120,v121
v_lshlrev_b32 v24,16,v136
v_and_b32 v25,0xffff0000,v136
v_pk_mul_f32 v[24:25],v[24:25],v[104:105]
v_cvt_pk_bf16_f32 v26,v24,v25
v_lshlrev_b32 v122,16,v26
v_and_b32 v123,0xffff0000,v26
v_lshlrev_b32 v24,16,v137
v_and_b32 v25,0xffff0000,v137
v_pk_mul_f32 v[24:25],v[24:25],v[106:107]
v_cvt_pk_bf16_f32 v26,v24,v25
v_lshlrev_b32 v24,16,v26
v_and_b32 v25,0xffff0000,v26
v_pk_add_f32 v[122:123],v[122:123],v[24:25]
v_lshlrev_b32 v24,16,v138
v_and_b32 v25,0xffff0000,v138
v_pk_mul_f32 v[24:25],v[24:25],v[108:109]
v_cvt_pk_bf16_f32 v26,v24,v25
v_lshlrev_b32 v24,16,v26
v_and_b32 v25,0xffff0000,v26
v_pk_add_f32 v[122:123],v[122:123],v[24:25]
v_lshlrev_b32 v24,16,v139
v_and_b32 v25,0xffff0000,v139
v_pk_mul_f32 v[24:25],v[24:25],v[110:111]
v_cvt_pk_bf16_f32 v26,v24,v25
v_lshlrev_b32 v24,16,v26
v_and_b32 v25,0xffff0000,v26
v_pk_add_f32 v[122:123],v[122:123],v[24:25]
v_lshlrev_b32 v24,16,v140
v_and_b32 v25,0xffff0000,v140
v_pk_mul_f32 v[24:25],v[24:25],v[112:113]
v_cvt_pk_bf16_f32 v26,v24,v25
v_lshlrev_b32 v24,16,v26
v_and_b32 v25,0xffff0000,v26
v_pk_add_f32 v[122:123],v[122:123],v[24:25]
v_lshlrev_b32 v24,16,v141
v_and_b32 v25,0xffff0000,v141
v_pk_mul_f32 v[24:25],v[24:25],v[114:115]
v_cvt_pk_bf16_f32 v26,v24,v25
v_lshlrev_b32 v24,16,v26
v_and_b32 v25,0xffff0000,v26
v_pk_add_f32 v[122:123],v[122:123],v[24:25]
v_lshlrev_b32 v24,16,v142
v_and_b32 v25,0xffff0000,v142
v_pk_mul_f32 v[24:25],v[24:25],v[116:117]
v_cvt_pk_bf16_f32 v26,v24,v25
v_lshlrev_b32 v24,16,v26
v_and_b32 v25,0xffff0000,v26
v_pk_add_f32 v[122:123],v[122:123],v[24:25]
v_lshlrev_b32 v24,16,v143
v_and_b32 v25,0xffff0000,v143
v_pk_mul_f32 v[24:25],v[24:25],v[118:119]
v_cvt_pk_bf16_f32 v26,v24,v25
v_lshlrev_b32 v24,16,v26
v_and_b32 v25,0xffff0000,v26
v_pk_add_f32 v[122:123],v[122:123],v[24:25]
v_add_f32 v122,v122,v123
v_lshlrev_b32 v24,16,v144
v_and_b32 v25,0xffff0000,v144
v_pk_mul_f32 v[24:25],v[24:25],v[104:105]
v_cvt_pk_bf16_f32 v26,v24,v25
v_lshlrev_b32 v124,16,v26
v_and_b32 v125,0xffff0000,v26
v_lshlrev_b32 v24,16,v145
v_and_b32 v25,0xffff0000,v145
v_pk_mul_f32 v[24:25],v[24:25],v[106:107]
v_cvt_pk_bf16_f32 v26,v24,v25
v_lshlrev_b32 v24,16,v26
v_and_b32 v25,0xffff0000,v26
v_pk_add_f32 v[124:125],v[124:125],v[24:25]
v_lshlrev_b32 v24,16,v146
v_and_b32 v25,0xffff0000,v146
v_pk_mul_f32 v[24:25],v[24:25],v[108:109]
v_cvt_pk_bf16_f32 v26,v24,v25
v_lshlrev_b32 v24,16,v26
v_and_b32 v25,0xffff0000,v26
v_pk_add_f32 v[124:125],v[124:125],v[24:25]
v_lshlrev_b32 v24,16,v147
v_and_b32 v25,0xffff0000,v147
v_pk_mul_f32 v[24:25],v[24:25],v[110:111]
v_cvt_pk_bf16_f32 v26,v24,v25
v_lshlrev_b32 v24,16,v26
v_and_b32 v25,0xffff0000,v26
v_pk_add_f32 v[124:125],v[124:125],v[24:25]
v_lshlrev_b32 v24,16,v148
v_and_b32 v25,0xffff0000,v148
v_pk_mul_f32 v[24:25],v[24:25],v[112:113]
v_cvt_pk_bf16_f32 v26,v24,v25
v_lshlrev_b32 v24,16,v26
v_and_b32 v25,0xffff0000,v26
v_pk_add_f32 v[124:125],v[124:125],v[24:25]
v_lshlrev_b32 v24,16,v149
v_and_b32 v25,0xffff0000,v149
v_pk_mul_f32 v[24:25],v[24:25],v[114:115]
v_cvt_pk_bf16_f32 v26,v24,v25
v_lshlrev_b32 v24,16,v26
v_and_b32 v25,0xffff0000,v26
v_pk_add_f32 v[124:125],v[124:125],v[24:25]
v_lshlrev_b32 v24,16,v150
v_and_b32 v25,0xffff0000,v150
v_pk_mul_f32 v[24:25],v[24:25],v[116:117]
v_cvt_pk_bf16_f32 v26,v24,v25
v_lshlrev_b32 v24,16,v26
v_and_b32 v25,0xffff0000,v26
v_pk_add_f32 v[124:125],v[124:125],v[24:25]
v_lshlrev_b32 v24,16,v151
v_and_b32 v25,0xffff0000,v151
v_pk_mul_f32 v[24:25],v[24:25],v[118:119]
v_cvt_pk_bf16_f32 v26,v24,v25
v_lshlrev_b32 v24,16,v26
v_and_b32 v25,0xffff0000,v26
v_pk_add_f32 v[124:125],v[124:125],v[24:25]
v_add_f32 v124,v124,v125
v_lshlrev_b32 v24,16,v152
v_and_b32 v25,0xffff0000,v152
v_pk_mul_f32 v[24:25],v[24:25],v[104:105]
v_cvt_pk_bf16_f32 v26,v24,v25
v_lshlrev_b32 v126,16,v26
v_and_b32 v127,0xffff0000,v26
v_lshlrev_b32 v24,16,v153
v_and_b32 v25,0xffff0000,v153
v_pk_mul_f32 v[24:25],v[24:25],v[106:107]
v_cvt_pk_bf16_f32 v26,v24,v25
v_lshlrev_b32 v24,16,v26
v_and_b32 v25,0xffff0000,v26
v_pk_add_f32 v[126:127],v[126:127],v[24:25]
v_lshlrev_b32 v24,16,v154
v_and_b32 v25,0xffff0000,v154
v_pk_mul_f32 v[24:25],v[24:25],v[108:109]
v_cvt_pk_bf16_f32 v26,v24,v25
v_lshlrev_b32 v24,16,v26
v_and_b32 v25,0xffff0000,v26
v_pk_add_f32 v[126:127],v[126:127],v[24:25]
v_lshlrev_b32 v24,16,v155
v_and_b32 v25,0xffff0000,v155
v_pk_mul_f32 v[24:25],v[24:25],v[110:111]
v_cvt_pk_bf16_f32 v26,v24,v25
v_lshlrev_b32 v24,16,v26
v_and_b32 v25,0xffff0000,v26
v_pk_add_f32 v[126:127],v[126:127],v[24:25]
v_lshlrev_b32 v24,16,v156
v_and_b32 v25,0xffff0000,v156
v_pk_mul_f32 v[24:25],v[24:25],v[112:113]
v_cvt_pk_bf16_f32 v26,v24,v25
v_lshlrev_b32 v24,16,v26
v_and_b32 v25,0xffff0000,v26
v_pk_add_f32 v[126:127],v[126:127],v[24:25]
v_lshlrev_b32 v24,16,v157
v_and_b32 v25,0xffff0000,v157
v_pk_mul_f32 v[24:25],v[24:25],v[114:115]
v_cvt_pk_bf16_f32 v26,v24,v25
v_lshlrev_b32 v24,16,v26
v_and_b32 v25,0xffff0000,v26
v_pk_add_f32 v[126:127],v[126:127],v[24:25]
v_lshlrev_b32 v24,16,v158
v_and_b32 v25,0xffff0000,v158
v_pk_mul_f32 v[24:25],v[24:25],v[116:117]
v_cvt_pk_bf16_f32 v26,v24,v25
v_lshlrev_b32 v24,16,v26
v_and_b32 v25,0xffff0000,v26
v_pk_add_f32 v[126:127],v[126:127],v[24:25]
v_lshlrev_b32 v24,16,v159
v_and_b32 v25,0xffff0000,v159
v_pk_mul_f32 v[24:25],v[24:25],v[118:119]
v_cvt_pk_bf16_f32 v26,v24,v25
v_lshlrev_b32 v24,16,v26
v_and_b32 v25,0xffff0000,v26
v_pk_add_f32 v[126:127],v[126:127],v[24:25]
v_add_f32 v126,v126,v127
v_add_f32_dpp v120,v120,v120 quad_perm:[1,0,3,2] row_mask:0xf bank_mask:0xf
v_add_f32_dpp v122,v122,v122 quad_perm:[1,0,3,2] row_mask:0xf bank_mask:0xf
v_add_f32_dpp v124,v124,v124 quad_perm:[1,0,3,2] row_mask:0xf bank_mask:0xf
v_add_f32_dpp v126,v126,v126 quad_perm:[1,0,3,2] row_mask:0xf bank_mask:0xf
v_add_f32_dpp v120,v120,v120 quad_perm:[2,3,0,1] row_mask:0xf bank_mask:0xf
v_add_f32_dpp v122,v122,v122 quad_perm:[2,3,0,1] row_mask:0xf bank_mask:0xf
v_add_f32_dpp v124,v124,v124 quad_perm:[2,3,0,1] row_mask:0xf bank_mask:0xf
v_add_f32_dpp v126,v126,v126 quad_perm:[2,3,0,1] row_mask:0xf bank_mask:0xf
v_add_f32_dpp v120,v120,v120 row_half_mirror row_mask:0xf bank_mask:0xf
v_add_f32_dpp v122,v122,v122 row_half_mirror row_mask:0xf bank_mask:0xf
v_add_f32_dpp v124,v124,v124 row_half_mirror row_mask:0xf bank_mask:0xf
v_add_f32_dpp v126,v126,v126 row_half_mirror row_mask:0xf bank_mask:0xf
v_add_f32_dpp v120,v120,v120 row_mirror row_mask:0xf bank_mask:0xf
v_add_f32_dpp v122,v122,v122 row_mirror row_mask:0xf bank_mask:0xf
v_add_f32_dpp v124,v124,v124 row_mirror row_mask:0xf bank_mask:0xf
v_add_f32_dpp v126,v126,v126 row_mirror row_mask:0xf bank_mask:0xf
v_mov_b32 v121,v120
v_mov_b32 v123,v122
v_mov_b32 v125,v124
v_mov_b32 v127,v126
v_permlane16_swap_b32 v120,v121
v_permlane16_swap_b32 v122,v123
v_permlane16_swap_b32 v124,v125
v_permlane16_swap_b32 v126,v127
v_add_f32 v120,v120,v121
v_add_f32 v122,v122,v123
v_add_f32 v124,v124,v125
v_add_f32 v126,v126,v127
v_mov_b32 v121,v120
v_mov_b32 v123,v122
v_mov_b32 v125,v124
v_mov_b32 v127,v126
v_permlane32_swap_b32 v120,v121
v_permlane32_swap_b32 v122,v123
v_permlane32_swap_b32 v124,v125
v_permlane32_swap_b32 v126,v127
v_add_f32 v120,v120,v121
v_add_f32 v122,v122,v123
v_add_f32 v124,v124,v125
v_add_f32 v126,v126,v127
s_mov_b32 s54,0xbfb8aa3b
v_cvt_pk_bf16_f32 v120,v120,v120
v_and_b32 v120,0xffff0000,v120
v_mul_f32 v120,s54,v120
v_exp_f32 v120,v120
s_nop 0
v_add_f32 v120,1.0,v120
v_rcp_f32 v120,v120
s_nop 0
v_cvt_pk_bf16_f32 v120,v120,v120
v_and_b32 v120,0xffff0000,v120
v_sub_f32 v121,1.0,v120
v_cvt_pk_bf16_f32 v121,v121,v121
v_and_b32 v121,0xffff0000,v121
v_cvt_pk_bf16_f32 v122,v122,v122
v_and_b32 v122,0xffff0000,v122
v_mul_f32 v122,s54,v122
v_exp_f32 v122,v122
s_nop 0
v_add_f32 v122,1.0,v122
v_rcp_f32 v122,v122
s_nop 0
v_cvt_pk_bf16_f32 v122,v122,v122
v_and_b32 v122,0xffff0000,v122
v_sub_f32 v123,1.0,v122
v_cvt_pk_bf16_f32 v123,v123,v123
v_and_b32 v123,0xffff0000,v123
v_cvt_pk_bf16_f32 v124,v124,v124
v_and_b32 v124,0xffff0000,v124
v_mul_f32 v124,s54,v124
v_exp_f32 v124,v124
s_nop 0
v_add_f32 v124,1.0,v124
v_rcp_f32 v124,v124
s_nop 0
v_cvt_pk_bf16_f32 v124,v124,v124
v_and_b32 v124,0xffff0000,v124
v_sub_f32 v125,1.0,v124
v_cvt_pk_bf16_f32 v125,v125,v125
v_and_b32 v125,0xffff0000,v125
v_cvt_pk_bf16_f32 v126,v126,v126
v_and_b32 v126,0xffff0000,v126
v_mul_f32 v126,s54,v126
v_exp_f32 v126,v126
s_nop 0
v_add_f32 v126,1.0,v126
v_rcp_f32 v126,v126
s_nop 0
v_cvt_pk_bf16_f32 v126,v126,v126
v_and_b32 v126,0xffff0000,v126
v_sub_f32 v127,1.0,v126
v_cvt_pk_bf16_f32 v127,v127,v127
v_and_b32 v127,0xffff0000,v127
s_lshl_b32 s54,s13,7
s_lshl_b32 s59,s14,5
s_add_u32 s54,s54,s59
s_add_u32 s54,s54,95420416
v_mov_b32 v24,s54
s_mov_b64 exec,1
global_store_dwordx4 v24,v[120:123],s[4:5] sc1
global_store_dwordx4 v24,v[124:127],s[4:5] offset:16 sc1
s_mov_b64 exec,-1
s_lshr_b32 s54,s13,4
s_lshl_b32 s54,s54,7
s_add_u32 s54,s54,94443520
v_mov_b32 v233,s54
s_mov_b32 s39,s38
v_bfe_u32 v31,v0,0,2
v_lshlrev_b32 v24,2,v31
v_bfe_u32 v31,v0,2,1
v_lshl_add_u32 v24,v31,7,v24
s_cmp_lg_u32 s14,0
s_cbranch_scc1 L_bulk_tk_ok
L_bulk_tk:
global_load_dword v236,v24,s[6:7] offset:32 sc1
s_sub_u32 s40,s40,1
s_cbranch_scc1 L_bulk_bail
s_waitcnt vmcnt(0)
v_cmp_gt_u32 vcc,32,v236
s_cbranch_vccz L_bulk_tk_ok
s_sleep 1
s_branch L_bulk_tk
L_bulk_tk_ok:
L_bulk_nx2:
L_bulk_item:
s_and_b32 s33,s26,15
s_bfe_u32 s34,s26,0x40004
s_bfe_u32 s35,s26,0x60008
s_cmp_eq_u32 s33,0
s_cbranch_scc1 L_bulk_end
s_cmp_lg_u32 s28,0
s_cbranch_scc1 L_bulk_go
s_waitcnt vmcnt(0)
s_barrier
s_cmp_eq_u32 s39,0
s_cbranch_scc1 L_sig1
s_mov_b32 s39,0
s_mov_b64 exec,1
global_atomic_add v233,v252,s[4:5]
s_mov_b64 exec,-1
v_mov_b32 v252,1
L_sig1:
s_nop 0
s_bfe_u32 s54,s26,0x6000e
s_bfe_u32 s37,s26,0x60014
s_lshl_b32 s54,s54,7
s_add_u32 s54,s54,94437376
v_mov_b32 v32,s54
s_sub_u32 s54,s33,6
s_cmp_lt_u32 s54,3
s_cbranch_scc0 L_bulk_nd
s_lshl_b32 s37,s34,2
s_add_u32 s37,s37,4
s_bfe_u32 s54,s35,0x20003
s_cmp_eq_u32 s33,7
s_cselect_b32 s54,s54,s14
s_lshl_b32 s54,s54,12
s_add_u32 s54,s54,94371840
v_bfe_u32 v31,v0,0,5
v_lshlrev_b32 v32,7,v31
v_add_u32 v32,s54,v32
L_bulk_nd:
global_load_dword v236,v32,s[4:5] sc1
s_lshr_b32 s55,s14,1
s_mov_b32 s24,-1
s_cmp_eq_u32 s33,5
s_cbranch_scc1 L_sd0_d8
s_cmp_eq_u32 s33,8
s_cbranch_scc1 L_sd0_d4
s_cmp_eq_u32 s33,12
s_cbranch_scc1 L_sd0_d4
s_sub_u32 s54,s33,6
s_cmp_lt_u32 s54,2
s_cbranch_scc1 L_sd0_db
s_lshl_b32 s54,s34,19
s_add_u32 s54,s54,104857600
s_add_u32 s16,s4,s54
s_addc_u32 s17,s5,0
s_mov_b32 s20,1024
v_mov_b32 v4,v192
v_mov_b32 v5,v193
v_mov_b32 v6,v194
v_mov_b32 v7,v195
s_cmp_lt_u32 s33,9
s_cbranch_scc1 L_sd0_big
s_lshl_b32 s54,s34,18
s_lshl_b32 s59,s14,16
s_add_u32 s54,s54,s59
s_add_u32 s54,s54,104857600
s_add_u32 s16,s4,s54
s_addc_u32 s17,s5,0
v_mov_b32 v4,v2
v_add_u32 v5,31744,v2
v_mov_b32 v6,0
v_mov_b32 v7,0
L_sd0_big:
s_cmp_eq_u32 s33,4
s_cbranch_scc1 L_sd0_up
s_cmp_eq_u32 s33,1
s_cselect_b64 s[56:57],s[66:67],s[68:69]
s_cmp_eq_u32 s33,3
s_cselect_b64 s[56:57],s[70:71],s[56:57]
s_cmp_eq_u32 s33,11
s_cselect_b64 s[56:57],s[70:71],s[56:57]
s_cmp_eq_u32 s33,9
s_cselect_b64 s[56:57],s[66:67],s[56:57]
s_lshl_b32 s54,s35,9
s_lshl_b32 s59,s55,8
s_add_u32 s54,s54,s59
s_add_u32 s18,s56,s54
s_addc_u32 s19,s57,0
s_mov_b32 s21,262144
v_mov_b32 v8,v200
v_mov_b32 v9,v201
v_mov_b32 v10,v202
v_mov_b32 v11,v203
s_branch L_sd0_e
L_sd0_up:
s_cmp_eq_u32 s55,1
s_cselect_b64 s[56:57],s[74:75],s[72:73]
s_and_b32 s54,s35,31
s_lshl_b32 s54,s54,8
s_add_u32 s18,s56,s54
s_addc_u32 s19,s57,0
s_mov_b32 s21,229376
v_mov_b32 v8,v204
v_mov_b32 v9,v205
v_mov_b32 v10,v206
v_mov_b32 v11,v207
s_bitcmp1_b32 s35,5
s_cbranch_scc0 L_sd0_e
s_and_b32 s54,s34,3
s_mul_i32 s24,s54,2
s_mul_i32 s25,s20,32
s_mul_i32 s3,s21,32
s_lshl_b32 s54,s24,2
s_mul_i32 s57,s54,s20
s_add_u32 s16,s16,s57
s_addc_u32 s17,s17,0
s_mul_i32 s57,s54,s21
s_add_u32 s18,s18,s57
s_addc_u32 s19,s19,0
s_branch L_sd0_e
L_sd0_d8:
s_mul_i32 s54,s34,1835008
s_add_u32 s54,s54,50331648
s_add_u32 s16,s4,s54
s_addc_u32 s17,s5,0
s_mov_b32 s20,1024
s_and_b32 s54,s35,31
s_lshl_b32 s54,s54,9
s_lshl_b32 s59,s55,8
s_add_u32 s54,s54,s59
s_add_u32 s18,s76,s54
s_addc_u32 s19,s77,0
s_mov_b32 s21,65536
v_mov_b32 v4,v196
v_add_u32 v5,113664,v196
v_add_u32 v6,227328,v196
v_add_u32 v7,340992,v196
v_mov_b32 v8,v208
v_mov_b32 v9,v209
v_mov_b32 v10,v210
v_mov_b32 v11,v211
s_bitcmp1_b32 s35,5
s_cbranch_scc0 L_sd0_e
s_and_b32 s54,s34,3
s_mul_i32 s24,s54,7
s_mul_i32 s25,s20,112
s_mul_i32 s3,s21,112
s_lshl_b32 s54,s24,2
s_mul_i32 s57,s54,s20
s_add_u32 s16,s16,s57
s_addc_u32 s17,s17,0
s_mul_i32 s57,s54,s21
s_add_u32 s18,s18,s57
s_addc_u32 s19,s19,0
s_branch L_sd0_e
L_sd0_d4:
s_lshl_b32 s54,s34,20
s_lshl_b32 s59,s14,18
s_add_u32 s54,s54,s59
s_add_u32 s54,s54,67108864
s_mul_i32 s58,s34,917504
s_mul_i32 s59,s14,229376
s_add_u32 s58,s58,s59
s_add_u32 s58,s58,50331648
s_cmp_eq_u32 s33,8
s_cselect_b32 s54,s54,s58
s_cselect_b32 s58,16,0
s_cselect_b64 s[56:57],s[60:61],s[76:77]
s_add_u32 s16,s4,s54
s_addc_u32 s17,s5,0
s_mov_b32 s20,1024
s_lshl_b32 s54,s35,9
s_lshl_b32 s59,s55,8
s_add_u32 s54,s54,s59
s_add_u32 s18,s56,s54
s_addc_u32 s19,s57,0
s_mov_b32 s21,65536
v_mov_b32 v4,v2
s_lshl_b32 s58,s58,10
s_add_u32 s58,s58,113664
v_add_u32 v5,s58,v2
v_mov_b32 v6,0
v_mov_b32 v7,0
v_mov_b32 v8,v208
v_mov_b32 v9,v209
v_mov_b32 v10,v210
v_mov_b32 v11,v211
s_branch L_sd0_e
L_sd0_db:
s_lshr_b32 s57,s35,3
s_lshl_b32 s54,s34,20
s_lshl_b32 s59,s57,15
s_add_u32 s54,s54,s59
s_add_u32 s54,s54,67106816
s_and_b32 s12,s35,7
s_lshl_b32 s12,s12,8
s_lshl_b32 s59,s55,16
s_add_u32 s12,s12,s59
s_lshl_b32 s59,s57,21
s_add_u32 s12,s12,s59
s_add_u32 s16,s4,s54
s_addc_u32 s17,s5,0
s_mov_b32 s20,2048
s_add_u32 s18,s60,s12
s_addc_u32 s19,s61,0
s_mov_b32 s21,131072
s_lshl_b32 s54,s14,1
s_add_u32 s54,s54,s57
s_and_b32 s54,s54,3
s_lshl_b32 s54,s54,17
s_lshl_b32 s59,s55,19
s_add_u32 s54,s54,s59
s_add_u32 s54,s54,2048
v_add_u32 v4,s54,v2
v_mov_b32 v5,v4
s_lshl_b32 s54,s14,1
s_add_u32 s54,s54,s57
s_add_u32 s54,s54,1
s_and_b32 s54,s54,3
s_lshl_b32 s54,s54,17
s_lshl_b32 s59,s55,19
s_add_u32 s54,s54,s59
v_add_u32 v6,s54,v2
v_mov_b32 v7,v6
v_mov_b32 v8,v208
v_mov_b32 v9,v209
v_mov_b32 v10,v210
v_mov_b32 v11,v211
L_sd0_e:
s_add_u32 m0,s23,65536
s_nop 0
global_load_lds_dwordx4 v8,s[18:19] offset:0
global_load_lds_dwordx4 v9,s[18:19] offset:1024
global_load_lds_dwordx4 v10,s[18:19] offset:2048
global_load_lds_dwordx4 v11,s[18:19] offset:3072
s_add_u32 s18,s18,s21
s_addc_u32 s19,s19,0
s_add_u32 m0,s23,81920
s_nop 0
global_load_lds_dwordx4 v8,s[18:19] offset:0
global_load_lds_dwordx4 v9,s[18:19] offset:1024
global_load_lds_dwordx4 v10,s[18:19] offset:2048
global_load_lds_dwordx4 v11,s[18:19] offset:3072
s_add_u32 s18,s18,s21
s_addc_u32 s19,s19,0
s_add_u32 m0,s23,98304
s_nop 0
global_load_lds_dwordx4 v8,s[18:19] offset:0
global_load_lds_dwordx4 v9,s[18:19] offset:1024
global_load_lds_dwordx4 v10,s[18:19] offset:2048
global_load_lds_dwordx4 v11,s[18:19] offset:3072
s_add_u32 s18,s18,s21
s_addc_u32 s19,s19,0
s_add_u32 m0,s23,114688
s_nop 0
global_load_lds_dwordx4 v8,s[18:19] offset:0
global_load_lds_dwordx4 v9,s[18:19] offset:1024
global_load_lds_dwordx4 v10,s[18:19] offset:2048
global_load_lds_dwordx4 v11,s[18:19] offset:3072
s_add_u32 s18,s18,s21
s_addc_u32 s19,s19,0
s_waitcnt vmcnt(16)
v_cmp_gt_u32 vcc,s37,v236
s_cbranch_vccz L_bulk_dep_ok
s_cmp_eq_u32 s33,7
s_cbranch_scc0 L_bulk_nw
s_lshr_b32 s55,s35,3
s_and_b32 s56,s35,7
s_and_b32 s57,s34,3
s_lshl_b32 s54,s55,21
s_lshl_b32 s59,s56,8
s_add_u32 s54,s54,s59
s_lshl_b32 s59,s57,19
s_add_u32 s54,s54,s59
v_bfe_u32 v31,v0,1,7
v_lshlrev_b32 v24,11,v31
v_bfe_u32 v31,v0,0,1
v_lshl_add_u32 v24,v31,7,v24
v_add_u32 v24,s54,v24
global_load_dword v232,v24,s[60:61]
v_add_u32 v24,262144,v24
global_load_dword v232,v24,s[60:61]
L_bulk_nw:
s_cmp_eq_u32 s33,6
s_cbranch_scc1 L_bulk_dep
s_cmp_eq_u32 s33,8
s_cbranch_scc1 L_bulk_dep
s_cmp_lg_u32 s14,0
s_cbranch_scc1 L_bulk_dep_ok
L_bulk_dep:
global_load_dword v236,v32,s[4:5] offset:0 sc1
s_sub_u32 s40,s40,1
s_cbranch_scc1 L_bulk_bail
s_waitcnt vmcnt(0)
v_cmp_gt_u32 vcc,s37,v236
s_cbranch_vccz L_bulk_dep_ok
s_sleep 1
s_branch L_bulk_dep
L_bulk_dep_ok:
s_barrier
s_cmp_ge_u32 s33,8
s_cbranch_scc1 L_bulk_first
s_add_u32 m0,s23,0
s_nop 0
global_load_lds_dwordx4 v4,s[16:17] offset:0 sc1
global_load_lds_dwordx4 v5,s[16:17] offset:1024 sc1
global_load_lds_dwordx4 v6,s[16:17] offset:2048 sc1
global_load_lds_dwordx4 v7,s[16:17] offset:3072 sc1
s_add_u32 s16,s16,s20
s_addc_u32 s17,s17,0
s_add_u32 m0,s23,16384
s_nop 0
global_load_lds_dwordx4 v4,s[16:17] offset:0 sc1
global_load_lds_dwordx4 v5,s[16:17] offset:1024 sc1
global_load_lds_dwordx4 v6,s[16:17] offset:2048 sc1
global_load_lds_dwordx4 v7,s[16:17] offset:3072 sc1
s_add_u32 s16,s16,s20
s_addc_u32 s17,s17,0
s_add_u32 m0,s23,32768
s_nop 0
global_load_lds_dwordx4 v4,s[16:17] offset:0 sc1
global_load_lds_dwordx4 v5,s[16:17] offset:1024 sc1
global_load_lds_dwordx4 v6,s[16:17] offset:2048 sc1
global_load_lds_dwordx4 v7,s[16:17] offset:3072 sc1
s_add_u32 s16,s16,s20
s_addc_u32 s17,s17,0
s_add_u32 m0,s23,49152
s_nop 0
global_load_lds_dwordx4 v4,s[16:17] offset:0 sc1
global_load_lds_dwordx4 v5,s[16:17] offset:1024 sc1
global_load_lds_dwordx4 v6,s[16:17] offset:2048 sc1
global_load_lds_dwordx4 v7,s[16:17] offset:3072 sc1
s_add_u32 s16,s16,s20
s_addc_u32 s17,s17,0
s_branch L_bulk_p2
L_bulk_first:
s_add_u32 m0,s23,0
s_nop 0
global_load_lds_dwordx4 v4,s[16:17] offset:0 sc1
global_load_lds_dwordx4 v5,s[16:17] offset:1024 sc1
s_add_u32 s16,s16,s20
s_addc_u32 s17,s17,0
s_add_u32 m0,s23,16384
s_nop 0
global_load_lds_dwordx4 v4,s[16:17] offset:0 sc1
global_load_lds_dwordx4 v5,s[16:17] offset:1024 sc1
s_add_u32 s16,s16,s20
s_addc_u32 s17,s17,0
s_add_u32 m0,s23,32768
s_nop 0
global_load_lds_dwordx4 v4,s[16:17] offset:0 sc1
global_load_lds_dwordx4 v5,s[16:17] offset:1024 sc1
s_add_u32 s16,s16,s20
s_addc_u32 s17,s17,0
s_add_u32 m0,s23,49152
s_nop 0
global_load_lds_dwordx4 v4,s[16:17] offset:0 sc1
global_load_lds_dwordx4 v5,s[16:17] offset:1024 sc1
s_add_u32 s16,s16,s20
s_addc_u32 s17,s17,0
L_bulk_p2:
s_sub_u32 s54,s33,6
s_cmp_lt_u32 s54,7
s_cbranch_scc1 L_bulk_go
s_waitcnt vmcnt(0)
L_bulk_go:
s_bfe_u32 s54,s27,0x6000e
s_lshl_b32 s54,s54,7
s_add_u32 s54,s54,94437376
v_mov_b32 v238,s54
s_lshr_b32 s32,s26,26
s_lshr_b32 s55,s14,1
s_and_b32 s56,s14,1
s_and_b32 s35,s35,31
s_sub_u32 s54,s33,6
s_cmp_lt_u32 s54,2
s_cbranch_scc1 L_g_db
v_mov_b32 v12,v213
s_mov_b32 s22,6
s_cmp_eq_u32 s33,4
s_cbranch_scc1 L_g_up
v_mov_b32 v16,v216
v_mov_b32 v17,v217
v_mov_b32 v18,v218
v_mov_b32 v19,v219
v_mov_b32 v20,v220
v_mov_b32 v21,v221
v_mov_b32 v22,v222
v_mov_b32 v23,v223
s_cmp_ge_u32 s33,8
s_cbranch_scc1 L_g_small
s_cmp_eq_u32 s33,5
s_cbranch_scc0 L_g_qkv
s_mov_b32 s22,26
s_lshl_b32 s54,s34,19
s_lshl_b32 s59,s55,18
s_add_u32 s54,s54,s59
s_lshl_b32 s59,s35,13
s_add_u32 s54,s54,s59
s_lshl_b32 s59,s56,12
s_add_u32 s54,s54,s59
s_add_u32 s54,s54,100663296
s_add_u32 s30,s4,s54
s_addc_u32 s31,s5,0
s_lshl_b32 s54,s34,11
s_lshl_b32 s59,s55,9
s_add_u32 s54,s54,s59
s_add_u32 s44,s4,s54
s_addc_u32 s45,s5,0
s_branch L_g_tr
L_g_qkv:
s_sub_u32 s57,s33,1
s_lshl_b32 s54,s57,24
s_lshl_b32 s59,s34,16
s_add_u32 s54,s54,s59
s_lshl_b32 s59,s55,15
s_add_u32 s54,s54,s59
s_lshl_b32 s59,s35,20
s_add_u32 s54,s54,s59
s_lshl_b32 s59,s56,19
s_add_u32 s54,s54,s59
s_add_u32 s30,s4,s54
s_addc_u32 s31,s5,0
s_cmp_eq_u32 s33,3
s_cbranch_scc1 L_g_v
s_branch L_g_tr
L_g_up:
v_mov_b32 v16,v224
v_mov_b32 v17,v225
v_mov_b32 v18,v226
v_mov_b32 v19,v227
v_mov_b32 v20,v228
v_mov_b32 v21,v229
v_mov_b32 v22,v230
v_mov_b32 v23,v231
s_mul_i32 s54,s34,1835008
s_mul_i32 s59,s55,917504
s_add_u32 s54,s54,s59
s_lshl_b32 s59,s35,12
s_add_u32 s54,s54,s59
s_lshl_b32 s59,s56,11
s_add_u32 s54,s54,s59
s_add_u32 s54,s54,50331648
s_add_u32 s30,s4,s54
s_addc_u32 s31,s5,0
L_g_tr:
s_barrier
ds_read_b128 v[64:67],v12 offset:0
ds_read_b64_tr_b16 v[96:97],v16 offset:0
ds_read_b64_tr_b16 v[98:99],v16 offset:4096
ds_read_b128 v[68:71],v12 offset:1024
ds_read_b64_tr_b16 v[100:101],v17 offset:0
ds_read_b64_tr_b16 v[102:103],v17 offset:4096
ds_read_b128 v[72:75],v12 offset:2048
ds_read_b64_tr_b16 v[104:105],v18 offset:0
ds_read_b64_tr_b16 v[106:107],v18 offset:4096
ds_read_b128 v[76:79],v12 offset:3072
ds_read_b64_tr_b16 v[108:109],v19 offset:0
ds_read_b64_tr_b16 v[110:111],v19 offset:4096
ds_read_b128 v[80:83],v12 offset:4096
ds_read_b64_tr_b16 v[112:113],v20 offset:0
ds_read_b64_tr_b16 v[114:115],v20 offset:4096
ds_read_b128 v[84:87],v12 offset:5120
ds_read_b64_tr_b16 v[116:117],v21 offset:0
ds_read_b64_tr_b16 v[118:119],v21 offset:4096
ds_read_b128 v[88:91],v12 offset:6144
ds_read_b64_tr_b16 v[120:121],v22 offset:0
ds_read_b64_tr_b16 v[122:123],v22 offset:4096
ds_read_b128 v[92:95],v12 offset:7168
ds_read_b64_tr_b16 v[124:125],v23 offset:0
ds_read_b64_tr_b16 v[126:127],v23 offset:4096
s_waitcnt vmcnt(63) lgkmcnt(0)
s_barrier
v_mfma_f32_16x16x32_bf16 a[0:3],v[96:99],v[64:67],0
ds_read_b128 v[128:131],v12 offset:16384
v_mfma_f32_16x16x32_bf16 a[4:7],v[100:103],v[64:67],0
s_add_u32 m0,s23,0
v_mfma_f32_16x16x32_bf16 a[8:11],v[104:107],v[64:67],0
ds_read_b64_tr_b16 v[160:161],v16 offset:16384
v_mfma_f32_16x16x32_bf16 a[12:15],v[108:111],v[64:67],0
global_load_lds_dwordx4 v4,s[16:17] offset:0 sc1
v_mfma_f32_16x16x32_bf16 a[16:19],v[112:115],v[64:67],0
ds_read_b64_tr_b16 v[162:163],v16 offset:20480
v_mfma_f32_16x16x32_bf16 a[20:23],v[116:119],v[64:67],0
v_mfma_f32_16x16x32_bf16 a[24:27],v[120:123],v[64:67],0
ds_read_b128 v[132:135],v12 offset:17408
v_mfma_f32_16x16x32_bf16 a[28:31],v[124:127],v[64:67],0
global_load_lds_dwordx4 v5,s[16:17] offset:1024 sc1
v_mfma_f32_16x16x32_bf16 a[32:35],v[96:99],v[68:71],0
ds_read_b64_tr_b16 v[164:165],v17 offset:16384
v_mfma_f32_16x16x32_bf16 a[36:39],v[100:103],v[68:71],0
v_mfma_f32_16x16x32_bf16 a[40:43],v[104:107],v[68:71],0
ds_read_b64_tr_b16 v[166:167],v17 offset:20480
v_mfma_f32_16x16x32_bf16 a[44:47],v[108:111],v[68:71],0
global_load_lds_dwordx4 v6,s[16:17] offset:2048 sc1
v_mfma_f32_16x16x32_bf16 a[48:51],v[112:115],v[68:71],0
ds_read_b128 v[136:139],v12 offset:18432
v_mfma_f32_16x16x32_bf16 a[52:55],v[116:119],v[68:71],0
v_mfma_f32_16x16x32_bf16 a[56:59],v[120:123],v[68:71],0
ds_read_b64_tr_b16 v[168:169],v18 offset:16384
v_mfma_f32_16x16x32_bf16 a[60:63],v[124:127],v[68:71],0
global_load_lds_dwordx4 v7,s[16:17] offset:3072 sc1
v_mfma_f32_16x16x32_bf16 a[64:67],v[96:99],v[72:75],0
ds_read_b64_tr_b16 v[170:171],v18 offset:20480
v_mfma_f32_16x16x32_bf16 a[68:71],v[100:103],v[72:75],0
v_mfma_f32_16x16x32_bf16 a[72:75],v[104:107],v[72:75],0
ds_read_b128 v[140:143],v12 offset:19456
v_mfma_f32_16x16x32_bf16 a[76:79],v[108:111],v[72:75],0
s_add_u32 m0,s23,65536
v_mfma_f32_16x16x32_bf16 a[80:83],v[112:115],v[72:75],0
ds_read_b64_tr_b16 v[172:173],v19 offset:16384
v_mfma_f32_16x16x32_bf16 a[84:87],v[116:119],v[72:75],0
s_add_u32 s16,s16,s20
v_mfma_f32_16x16x32_bf16 a[88:91],v[120:123],v[72:75],0
ds_read_b64_tr_b16 v[174:175],v19 offset:20480
v_mfma_f32_16x16x32_bf16 a[92:95],v[124:127],v[72:75],0
s_addc_u32 s17,s17,0
v_mfma_f32_16x16x32_bf16 a[96:99],v[96:99],v[76:79],0
ds_read_b128 v[144:147],v12 offset:20480
v_mfma_f32_16x16x32_bf16 a[100:103],v[100:103],v[76:79],0
global_load_lds_dwordx4 v8,s[18:19] offset:0
v_mfma_f32_16x16x32_bf16 a[104:107],v[104:107],v[76:79],0
ds_read_b64_tr_b16 v[176:177],v20 offset:16384
v_mfma_f32_16x16x32_bf16 a[108:111],v[108:111],v[76:79],0
v_mfma_f32_16x16x32_bf16 a[112:115],v[112:115],v[76:79],0
ds_read_b64_tr_b16 v[178:179],v20 offset:20480
v_mfma_f32_16x16x32_bf16 a[116:119],v[116:119],v[76:79],0
global_load_lds_dwordx4 v9,s[18:19] offset:1024
v_mfma_f32_16x16x32_bf16 a[120:123],v[120:123],v[76:79],0
ds_read_b128 v[148:151],v12 offset:21504
v_mfma_f32_16x16x32_bf16 a[124:127],v[124:127],v[76:79],0
v_mfma_f32_16x16x32_bf16 a[128:131],v[96:99],v[80:83],0
ds_read_b64_tr_b16 v[180:181],v21 offset:16384
v_mfma_f32_16x16x32_bf16 a[132:135],v[100:103],v[80:83],0
global_load_lds_dwordx4 v10,s[18:19] offset:2048
v_mfma_f32_16x16x32_bf16 a[136:139],v[104:107],v[80:83],0
ds_read_b64_tr_b16 v[182:183],v21 offset:20480
v_mfma_f32_16x16x32_bf16 a[140:143],v[108:111],v[80:83],0
v_mfma_f32_16x16x32_bf16 a[144:147],v[112:115],v[80:83],0
ds_read_b128 v[152:155],v12 offset:22528
v_mfma_f32_16x16x32_bf16 a[148:151],v[116:119],v[80:83],0
global_load_lds_dwordx4 v11,s[18:19] offset:3072
v_mfma_f32_16x16x32_bf16 a[152:155],v[120:123],v[80:83],0
ds_read_b64_tr_b16 v[184:185],v22 offset:16384
v_mfma_f32_16x16x32_bf16 a[156:159],v[124:127],v[80:83],0
v_mfma_f32_16x16x32_bf16 a[160:163],v[96:99],v[84:87],0
ds_read_b64_tr_b16 v[186:187],v22 offset:20480
v_mfma_f32_16x16x32_bf16 a[164:167],v[100:103],v[84:87],0
s_add_u32 s18,s18,s21
v_mfma_f32_16x16x32_bf16 a[168:171],v[104:107],v[84:87],0
ds_read_b128 v[156:159],v12 offset:23552
v_mfma_f32_16x16x32_bf16 a[172:175],v[108:111],v[84:87],0
s_addc_u32 s19,s19,0
v_mfma_f32_16x16x32_bf16 a[176:179],v[112:115],v[84:87],0
ds_read_b64_tr_b16 v[188:189],v23 offset:16384
v_mfma_f32_16x16x32_bf16 a[180:183],v[116:119],v[84:87],0
v_mfma_f32_16x16x32_bf16 a[184:187],v[120:123],v[84:87],0
ds_read_b64_tr_b16 v[190:191],v23 offset:20480
v_mfma_f32_16x16x32_bf16 a[188:191],v[124:127],v[84:87],0
v_mfma_f32_16x16x32_bf16 a[192:195],v[96:99],v[88:91],0
v_mfma_f32_16x16x32_bf16 a[196:199],v[100:103],v[88:91],0
v_mfma_f32_16x16x32_bf16 a[200:203],v[104:107],v[88:91],0
v_mfma_f32_16x16x32_bf16 a[204:207],v[108:111],v[88:91],0
v_mfma_f32_16x16x32_bf16 a[208:211],v[112:115],v[88:91],0
v_mfma_f32_16x16x32_bf16 a[212:215],v[116:119],v[88:91],0
v_mfma_f32_16x16x32_bf16 a[216:219],v[120:123],v[88:91],0
v_mfma_f32_16x16x32_bf16 a[220:223],v[124:127],v[88:91],0
v_mfma_f32_16x16x32_bf16 a[224:227],v[96:99],v[92:95],0
v_mfma_f32_16x16x32_bf16 a[228:231],v[100:103],v[92:95],0
v_mfma_f32_16x16x32_bf16 a[232:235],v[104:107],v[92:95],0
v_mfma_f32_16x16x32_bf16 a[236:239],v[108:111],v[92:95],0
v_mfma_f32_16x16x32_bf16 a[240:243],v[112:115],v[92:95],0
v_mfma_f32_16x16x32_bf16 a[244:247],v[116:119],v[92:95],0
v_mfma_f32_16x16x32_bf16 a[248:251],v[120:123],v[92:95],0
v_mfma_f32_16x16x32_bf16 a[252:255],v[124:127],v[92:95],0
s_waitcnt vmcnt(63) lgkmcnt(0)
s_barrier
v_mfma_f32_16x16x32_bf16 a[0:3],v[160:163],v[128:131],a[0:3]
ds_read_b128 v[64:67],v12 offset:32768
v_mfma_f32_16x16x32_bf16 a[4:7],v[164:167],v[128:131],a[4:7]
s_add_u32 m0,s23,16384
v_mfma_f32_16x16x32_bf16 a[8:11],v[168:171],v[128:131],a[8:11]
ds_read_b64_tr_b16 v[96:97],v16 offset:32768
v_mfma_f32_16x16x32_bf16 a[12:15],v[172:175],v[128:131],a[12:15]
global_load_lds_dwordx4 v4,s[16:17] offset:0 sc1
v_mfma_f32_16x16x32_bf16 a[16:19],v[176:179],v[128:131],a[16:19]
ds_read_b64_tr_b16 v[98:99],v16 offset:36864
v_mfma_f32_16x16x32_bf16 a[20:23],v[180:183],v[128:131],a[20:23]
v_mfma_f32_16x16x32_bf16 a[24:27],v[184:187],v[128:131],a[24:27]
ds_read_b128 v[68:71],v12 offset:33792
v_mfma_f32_16x16x32_bf16 a[28:31],v[188:191],v[128:131],a[28:31]
global_load_lds_dwordx4 v5,s[16:17] offset:1024 sc1
v_mfma_f32_16x16x32_bf16 a[32:35],v[160:163],v[132:135],a[32:35]
ds_read_b64_tr_b16 v[100:101],v17 offset:32768
v_mfma_f32_16x16x32_bf16 a[36:39],v[164:167],v[132:135],a[36:39]
v_mfma_f32_16x16x32_bf16 a[40:43],v[168:171],v[132:135],a[40:43]
ds_read_b64_tr_b16 v[102:103],v17 offset:36864
v_mfma_f32_16x16x32_bf16 a[44:47],v[172:175],v[132:135],a[44:47]
global_load_lds_dwordx4 v6,s[16:17] offset:2048 sc1
v_mfma_f32_16x16x32_bf16 a[48:51],v[176:179],v[132:135],a[48:51]
ds_read_b128 v[72:75],v12 offset:34816
v_mfma_f32_16x16x32_bf16 a[52:55],v[180:183],v[132:135],a[52:55]
v_mfma_f32_16x16x32_bf16 a[56:59],v[184:187],v[132:135],a[56:59]
ds_read_b64_tr_b16 v[104:105],v18 offset:32768
v_mfma_f32_16x16x32_bf16 a[60:63],v[188:191],v[132:135],a[60:63]
global_load_lds_dwordx4 v7,s[16:17] offset:3072 sc1
v_mfma_f32_16x16x32_bf16 a[64:67],v[160:163],v[136:139],a[64:67]
ds_read_b64_tr_b16 v[106:107],v18 offset:36864
v_mfma_f32_16x16x32_bf16 a[68:71],v[164:167],v[136:139],a[68:71]
v_mfma_f32_16x16x32_bf16 a[72:75],v[168:171],v[136:139],a[72:75]
ds_read_b128 v[76:79],v12 offset:35840
v_mfma_f32_16x16x32_bf16 a[76:79],v[172:175],v[136:139],a[76:79]
s_add_u32 m0,s23,81920
v_mfma_f32_16x16x32_bf16 a[80:83],v[176:179],v[136:139],a[80:83]
ds_read_b64_tr_b16 v[108:109],v19 offset:32768
v_mfma_f32_16x16x32_bf16 a[84:87],v[180:183],v[136:139],a[84:87]
s_add_u32 s16,s16,s20
v_mfma_f32_16x16x32_bf16 a[88:91],v[184:187],v[136:139],a[88:91]
ds_read_b64_tr_b16 v[110:111],v19 offset:36864
v_mfma_f32_16x16x32_bf16 a[92:95],v[188:191],v[136:139],a[92:95]
s_addc_u32 s17,s17,0
v_mfma_f32_16x16x32_bf16 a[96:99],v[160:163],v[140:143],a[96:99]
ds_read_b128 v[80:83],v12 offset:36864
v_mfma_f32_16x16x32_bf16 a[100:103],v[164:167],v[140:143],a[100:103]
global_load_lds_dwordx4 v8,s[18:19] offset:0
v_mfma_f32_16x16x32_bf16 a[104:107],v[168:171],v[140:143],a[104:107]
ds_read_b64_tr_b16 v[112:113],v20 offset:32768
v_mfma_f32_16x16x32_bf16 a[108:111],v[172:175],v[140:143],a[108:111]
v_mfma_f32_16x16x32_bf16 a[112:115],v[176:179],v[140:143],a[112:115]
ds_read_b64_tr_b16 v[114:115],v20 offset:36864
v_mfma_f32_16x16x32_bf16 a[116:119],v[180:183],v[140:143],a[116:119]
global_load_lds_dwordx4 v9,s[18:19] offset:1024
v_mfma_f32_16x16x32_bf16 a[120:123],v[184:187],v[140:143],a[120:123]
ds_read_b128 v[84:87],v12 offset:37888
v_mfma_f32_16x16x32_bf16 a[124:127],v[188:191],v[140:143],a[124:127]
v_mfma_f32_16x16x32_bf16 a[128:131],v[160:163],v[144:147],a[128:131]
ds_read_b64_tr_b16 v[116:117],v21 offset:32768
v_mfma_f32_16x16x32_bf16 a[132:135],v[164:167],v[144:147],a[132:135]
global_load_lds_dwordx4 v10,s[18:19] offset:2048
v_mfma_f32_16x16x32_bf16 a[136:139],v[168:171],v[144:147],a[136:139]
ds_read_b64_tr_b16 v[118:119],v21 offset:36864
v_mfma_f32_16x16x32_bf16 a[140:143],v[172:175],v[144:147],a[140:143]
v_mfma_f32_16x16x32_bf16 a[144:147],v[176:179],v[144:147],a[144:147]
ds_read_b128 v[88:91],v12 offset:38912
v_mfma_f32_16x16x32_bf16 a[148:151],v[180:183],v[144:147],a[148:151]
global_load_lds_dwordx4 v11,s[18:19] offset:3072
v_mfma_f32_16x16x32_bf16 a[152:155],v[184:187],v[144:147],a[152:155]
ds_read_b64_tr_b16 v[120:121],v22 offset:32768
v_mfma_f32_16x16x32_bf16 a[156:159],v[188:191],v[144:147],a[156:159]
v_mfma_f32_16x16x32_bf16 a[160:163],v[160:163],v[148:151],a[160:163]
ds_read_b64_tr_b16 v[122:123],v22 offset:36864
v_mfma_f32_16x16x32_bf16 a[164:167],v[164:167],v[148:151],a[164:167]
s_add_u32 s18,s18,s21
v_mfma_f32_16x16x32_bf16 a[168:171],v[168:171],v[148:151],a[168:171]
ds_read_b128 v[92:95],v12 offset:39936
v_mfma_f32_16x16x32_bf16 a[172:175],v[172:175],v[148:151],a[172:175]
s_addc_u32 s19,s19,0
v_mfma_f32_16x16x32_bf16 a[176:179],v[176:179],v[148:151],a[176:179]
ds_read_b64_tr_b16 v[124:125],v23 offset:32768
v_mfma_f32_16x16x32_bf16 a[180:183],v[180:183],v[148:151],a[180:183]
v_mfma_f32_16x16x32_bf16 a[184:187],v[184:187],v[148:151],a[184:187]
ds_read_b64_tr_b16 v[126:127],v23 offset:36864
v_mfma_f32_16x16x32_bf16 a[188:191],v[188:191],v[148:151],a[188:191]
v_mfma_f32_16x16x32_bf16 a[192:195],v[160:163],v[152:155],a[192:195]
v_mfma_f32_16x16x32_bf16 a[196:199],v[164:167],v[152:155],a[196:199]
v_mfma_f32_16x16x32_bf16 a[200:203],v[168:171],v[152:155],a[200:203]
v_mfma_f32_16x16x32_bf16 a[204:207],v[172:175],v[152:155],a[204:207]
v_mfma_f32_16x16x32_bf16 a[208:211],v[176:179],v[152:155],a[208:211]
v_mfma_f32_16x16x32_bf16 a[212:215],v[180:183],v[152:155],a[212:215]
v_mfma_f32_16x16x32_bf16 a[216:219],v[184:187],v[152:155],a[216:219]
v_mfma_f32_16x16x32_bf16 a[220:223],v[188:191],v[152:155],a[220:223]
v_mfma_f32_16x16x32_bf16 a[224:227],v[160:163],v[156:159],a[224:227]
v_mfma_f32_16x16x32_bf16 a[228:231],v[164:167],v[156:159],a[228:231]
v_mfma_f32_16x16x32_bf16 a[232:235],v[168:171],v[156:159],a[232:235]
v_mfma_f32_16x16x32_bf16 a[236:239],v[172:175],v[156:159],a[236:239]
v_mfma_f32_16x16x32_bf16 a[240:243],v[176:179],v[156:159],a[240:243]
v_mfma_f32_16x16x32_bf16 a[244:247],v[180:183],v[156:159],a[244:247]
v_mfma_f32_16x16x32_bf16 a[248:251],v[184:187],v[156:159],a[248:251]
v_mfma_f32_16x16x32_bf16 a[252:255],v[188:191],v[156:159],a[252:255]
s_waitcnt vmcnt(63) lgkmcnt(0)
s_barrier
v_mfma_f32_16x16x32_bf16 a[0:3],v[96:99],v[64:67],a[0:3]
ds_read_b128 v[128:131],v12 offset:49152
v_mfma_f32_16x16x32_bf16 a[4:7],v[100:103],v[64:67],a[4:7]
s_add_u32 m0,s23,32768
v_mfma_f32_16x16x32_bf16 a[8:11],v[104:107],v[64:67],a[8:11]
ds_read_b64_tr_b16 v[160:161],v16 offset:49152
v_mfma_f32_16x16x32_bf16 a[12:15],v[108:111],v[64:67],a[12:15]
global_load_lds_dwordx4 v4,s[16:17] offset:0 sc1
v_mfma_f32_16x16x32_bf16 a[16:19],v[112:115],v[64:67],a[16:19]
ds_read_b64_tr_b16 v[162:163],v16 offset:53248
v_mfma_f32_16x16x32_bf16 a[20:23],v[116:119],v[64:67],a[20:23]
v_mfma_f32_16x16x32_bf16 a[24:27],v[120:123],v[64:67],a[24:27]
ds_read_b128 v[132:135],v12 offset:50176
v_mfma_f32_16x16x32_bf16 a[28:31],v[124:127],v[64:67],a[28:31]
global_load_lds_dwordx4 v5,s[16:17] offset:1024 sc1
v_mfma_f32_16x16x32_bf16 a[32:35],v[96:99],v[68:71],a[32:35]
ds_read_b64_tr_b16 v[164:165],v17 offset:49152
v_mfma_f32_16x16x32_bf16 a[36:39],v[100:103],v[68:71],a[36:39]
v_mfma_f32_16x16x32_bf16 a[40:43],v[104:107],v[68:71],a[40:43]
ds_read_b64_tr_b16 v[166:167],v17 offset:53248
v_mfma_f32_16x16x32_bf16 a[44:47],v[108:111],v[68:71],a[44:47]
global_load_lds_dwordx4 v6,s[16:17] offset:2048 sc1
v_mfma_f32_16x16x32_bf16 a[48:51],v[112:115],v[68:71],a[48:51]
ds_read_b128 v[136:139],v12 offset:51200
v_mfma_f32_16x16x32_bf16 a[52:55],v[116:119],v[68:71],a[52:55]
v_mfma_f32_16x16x32_bf16 a[56:59],v[120:123],v[68:71],a[56:59]
ds_read_b64_tr_b16 v[168:169],v18 offset:49152
v_mfma_f32_16x16x32_bf16 a[60:63],v[124:127],v[68:71],a[60:63]
global_load_lds_dwordx4 v7,s[16:17] offset:3072 sc1
v_mfma_f32_16x16x32_bf16 a[64:67],v[96:99],v[72:75],a[64:67]
ds_read_b64_tr_b16 v[170:171],v18 offset:53248
v_mfma_f32_16x16x32_bf16 a[68:71],v[100:103],v[72:75],a[68:71]
v_mfma_f32_16x16x32_bf16 a[72:75],v[104:107],v[72:75],a[72:75]
ds_read_b128 v[140:143],v12 offset:52224
v_mfma_f32_16x16x32_bf16 a[76:79],v[108:111],v[72:75],a[76:79]
s_add_u32 m0,s23,98304
v_mfma_f32_16x16x32_bf16 a[80:83],v[112:115],v[72:75],a[80:83]
ds_read_b64_tr_b16 v[172:173],v19 offset:49152
v_mfma_f32_16x16x32_bf16 a[84:87],v[116:119],v[72:75],a[84:87]
s_add_u32 s16,s16,s20
v_mfma_f32_16x16x32_bf16 a[88:91],v[120:123],v[72:75],a[88:91]
ds_read_b64_tr_b16 v[174:175],v19 offset:53248
v_mfma_f32_16x16x32_bf16 a[92:95],v[124:127],v[72:75],a[92:95]
s_addc_u32 s17,s17,0
v_mfma_f32_16x16x32_bf16 a[96:99],v[96:99],v[76:79],a[96:99]
ds_read_b128 v[144:147],v12 offset:53248
v_mfma_f32_16x16x32_bf16 a[100:103],v[100:103],v[76:79],a[100:103]
global_load_lds_dwordx4 v8,s[18:19] offset:0
v_mfma_f32_16x16x32_bf16 a[104:107],v[104:107],v[76:79],a[104:107]
ds_read_b64_tr_b16 v[176:177],v20 offset:49152
v_mfma_f32_16x16x32_bf16 a[108:111],v[108:111],v[76:79],a[108:111]
v_mfma_f32_16x16x32_bf16 a[112:115],v[112:115],v[76:79],a[112:115]
ds_read_b64_tr_b16 v[178:179],v20 offset:53248
v_mfma_f32_16x16x32_bf16 a[116:119],v[116:119],v[76:79],a[116:119]
global_load_lds_dwordx4 v9,s[18:19] offset:1024
v_mfma_f32_16x16x32_bf16 a[120:123],v[120:123],v[76:79],a[120:123]
ds_read_b128 v[148:151],v12 offset:54272
v_mfma_f32_16x16x32_bf16 a[124:127],v[124:127],v[76:79],a[124:127]
v_mfma_f32_16x16x32_bf16 a[128:131],v[96:99],v[80:83],a[128:131]
ds_read_b64_tr_b16 v[180:181],v21 offset:49152
v_mfma_f32_16x16x32_bf16 a[132:135],v[100:103],v[80:83],a[132:135]
global_load_lds_dwordx4 v10,s[18:19] offset:2048
v_mfma_f32_16x16x32_bf16 a[136:139],v[104:107],v[80:83],a[136:139]
ds_read_b64_tr_b16 v[182:183],v21 offset:53248
v_mfma_f32_16x16x32_bf16 a[140:143],v[108:111],v[80:83],a[140:143]
v_mfma_f32_16x16x32_bf16 a[144:147],v[112:115],v[80:83],a[144:147]
ds_read_b128 v[152:155],v12 offset:55296
v_mfma_f32_16x16x32_bf16 a[148:151],v[116:119],v[80:83],a[148:151]
global_load_lds_dwordx4 v11,s[18:19] offset:3072
v_mfma_f32_16x16x32_bf16 a[152:155],v[120:123],v[80:83],a[152:155]
ds_read_b64_tr_b16 v[184:185],v22 offset:49152
v_mfma_f32_16x16x32_bf16 a[156:159],v[124:127],v[80:83],a[156:159]
v_mfma_f32_16x16x32_bf16 a[160:163],v[96:99],v[84:87],a[160:163]
ds_read_b64_tr_b16 v[186:187],v22 offset:53248
v_mfma_f32_16x16x32_bf16 a[164:167],v[100:103],v[84:87],a[164:167]
s_add_u32 s18,s18,s21
v_mfma_f32_16x16x32_bf16 a[168:171],v[104:107],v[84:87],a[168:171]
ds_read_b128 v[156:159],v12 offset:56320
v_mfma_f32_16x16x32_bf16 a[172:175],v[108:111],v[84:87],a[172:175]
s_addc_u32 s19,s19,0
v_mfma_f32_16x16x32_bf16 a[176:179],v[112:115],v[84:87],a[176:179]
ds_read_b64_tr_b16 v[188:189],v23 offset:49152
v_mfma_f32_16x16x32_bf16 a[180:183],v[116:119],v[84:87],a[180:183]
v_mfma_f32_16x16x32_bf16 a[184:187],v[120:123],v[84:87],a[184:187]
ds_read_b64_tr_b16 v[190:191],v23 offset:53248
v_mfma_f32_16x16x32_bf16 a[188:191],v[124:127],v[84:87],a[188:191]
v_mfma_f32_16x16x32_bf16 a[192:195],v[96:99],v[88:91],a[192:195]
v_mfma_f32_16x16x32_bf16 a[196:199],v[100:103],v[88:91],a[196:199]
v_mfma_f32_16x16x32_bf16 a[200:203],v[104:107],v[88:91],a[200:203]
v_mfma_f32_16x16x32_bf16 a[204:207],v[108:111],v[88:91],a[204:207]
v_mfma_f32_16x16x32_bf16 a[208:211],v[112:115],v[88:91],a[208:211]
v_mfma_f32_16x16x32_bf16 a[212:215],v[116:119],v[88:91],a[212:215]
v_mfma_f32_16x16x32_bf16 a[216:219],v[120:123],v[88:91],a[216:219]
v_mfma_f32_16x16x32_bf16 a[220:223],v[124:127],v[88:91],a[220:223]
v_mfma_f32_16x16x32_bf16 a[224:227],v[96:99],v[92:95],a[224:227]
v_mfma_f32_16x16x32_bf16 a[228:231],v[100:103],v[92:95],a[228:231]
v_mfma_f32_16x16x32_bf16 a[232:235],v[104:107],v[92:95],a[232:235]
v_mfma_f32_16x16x32_bf16 a[236:239],v[108:111],v[92:95],a[236:239]
v_mfma_f32_16x16x32_bf16 a[240:243],v[112:115],v[92:95],a[240:243]
v_mfma_f32_16x16x32_bf16 a[244:247],v[116:119],v[92:95],a[244:247]
v_mfma_f32_16x16x32_bf16 a[248:251],v[120:123],v[92:95],a[248:251]
v_mfma_f32_16x16x32_bf16 a[252:255],v[124:127],v[92:95],a[252:255]
s_waitcnt vmcnt(16) lgkmcnt(0)
s_barrier
v_mfma_f32_16x16x32_bf16 a[0:3],v[160:163],v[128:131],a[0:3]
ds_read_b128 v[64:67],v12 offset:0
v_mfma_f32_16x16x32_bf16 a[4:7],v[164:167],v[128:131],a[4:7]
s_add_u32 m0,s23,49152
v_mfma_f32_16x16x32_bf16 a[8:11],v[168:171],v[128:131],a[8:11]
ds_read_b64_tr_b16 v[96:97],v16 offset:0
v_mfma_f32_16x16x32_bf16 a[12:15],v[172:175],v[128:131],a[12:15]
global_load_lds_dwordx4 v4,s[16:17] offset:0 sc1
v_mfma_f32_16x16x32_bf16 a[16:19],v[176:179],v[128:131],a[16:19]
ds_read_b64_tr_b16 v[98:99],v16 offset:4096
v_mfma_f32_16x16x32_bf16 a[20:23],v[180:183],v[128:131],a[20:23]
v_mfma_f32_16x16x32_bf16 a[24:27],v[184:187],v[128:131],a[24:27]
ds_read_b128 v[68:71],v12 offset:1024
v_mfma_f32_16x16x32_bf16 a[28:31],v[188:191],v[128:131],a[28:31]
global_load_lds_dwordx4 v5,s[16:17] offset:1024 sc1
v_mfma_f32_16x16x32_bf16 a[32:35],v[160:163],v[132:135],a[32:35]
ds_read_b64_tr_b16 v[100:101],v17 offset:0
v_mfma_f32_16x16x32_bf16 a[36:39],v[164:167],v[132:135],a[36:39]
v_mfma_f32_16x16x32_bf16 a[40:43],v[168:171],v[132:135],a[40:43]
ds_read_b64_tr_b16 v[102:103],v17 offset:4096
v_mfma_f32_16x16x32_bf16 a[44:47],v[172:175],v[132:135],a[44:47]
global_load_lds_dwordx4 v6,s[16:17] offset:2048 sc1
v_mfma_f32_16x16x32_bf16 a[48:51],v[176:179],v[132:135],a[48:51]
ds_read_b128 v[72:75],v12 offset:2048
v_mfma_f32_16x16x32_bf16 a[52:55],v[180:183],v[132:135],a[52:55]
v_mfma_f32_16x16x32_bf16 a[56:59],v[184:187],v[132:135],a[56:59]
ds_read_b64_tr_b16 v[104:105],v18 offset:0
v_mfma_f32_16x16x32_bf16 a[60:63],v[188:191],v[132:135],a[60:63]
global_load_lds_dwordx4 v7,s[16:17] offset:3072 sc1
v_mfma_f32_16x16x32_bf16 a[64:67],v[160:163],v[136:139],a[64:67]
ds_read_b64_tr_b16 v[106:107],v18 offset:4096
v_mfma_f32_16x16x32_bf16 a[68:71],v[164:167],v[136:139],a[68:71]
v_mfma_f32_16x16x32_bf16 a[72:75],v[168:171],v[136:139],a[72:75]
ds_read_b128 v[76:79],v12 offset:3072
v_mfma_f32_16x16x32_bf16 a[76:79],v[172:175],v[136:139],a[76:79]
s_add_u32 m0,s23,114688
v_mfma_f32_16x16x32_bf16 a[80:83],v[176:179],v[136:139],a[80:83]
ds_read_b64_tr_b16 v[108:109],v19 offset:0
v_mfma_f32_16x16x32_bf16 a[84:87],v[180:183],v[136:139],a[84:87]
s_add_u32 s16,s16,s20
v_mfma_f32_16x16x32_bf16 a[88:91],v[184:187],v[136:139],a[88:91]
ds_read_b64_tr_b16 v[110:111],v19 offset:4096
v_mfma_f32_16x16x32_bf16 a[92:95],v[188:191],v[136:139],a[92:95]
s_addc_u32 s17,s17,0
v_mfma_f32_16x16x32_bf16 a[96:99],v[160:163],v[140:143],a[96:99]
ds_read_b128 v[80:83],v12 offset:4096
v_mfma_f32_16x16x32_bf16 a[100:103],v[164:167],v[140:143],a[100:103]
global_load_lds_dwordx4 v8,s[18:19] offset:0
v_mfma_f32_16x16x32_bf16 a[104:107],v[168:171],v[140:143],a[104:107]
ds_read_b64_tr_b16 v[112:113],v20 offset:0
v_mfma_f32_16x16x32_bf16 a[108:111],v[172:175],v[140:143],a[108:111]
v_mfma_f32_16x16x32_bf16 a[112:115],v[176:179],v[140:143],a[112:115]
ds_read_b64_tr_b16 v[114:115],v20 offset:4096
v_mfma_f32_16x16x32_bf16 a[116:119],v[180:183],v[140:143],a[116:119]
global_load_lds_dwordx4 v9,s[18:19] offset:1024
v_mfma_f32_16x16x32_bf16 a[120:123],v[184:187],v[140:143],a[120:123]
ds_read_b128 v[84:87],v12 offset:5120
v_mfma_f32_16x16x32_bf16 a[124:127],v[188:191],v[140:143],a[124:127]
v_mfma_f32_16x16x32_bf16 a[128:131],v[160:163],v[144:147],a[128:131]
ds_read_b64_tr_b16 v[116:117],v21 offset:0
v_mfma_f32_16x16x32_bf16 a[132:135],v[164:167],v[144:147],a[132:135]
global_load_lds_dwordx4 v10,s[18:19] offset:2048
v_mfma_f32_16x16x32_bf16 a[136:139],v[168:171],v[144:147],a[136:139]
ds_read_b64_tr_b16 v[118:119],v21 offset:4096
v_mfma_f32_16x16x32_bf16 a[140:143],v[172:175],v[144:147],a[140:143]
v_mfma_f32_16x16x32_bf16 a[144:147],v[176:179],v[144:147],a[144:147]
ds_read_b128 v[88:91],v12 offset:6144
v_mfma_f32_16x16x32_bf16 a[148:151],v[180:183],v[144:147],a[148:151]
global_load_lds_dwordx4 v11,s[18:19] offset:3072
v_mfma_f32_16x16x32_bf16 a[152:155],v[184:187],v[144:147],a[152:155]
ds_read_b64_tr_b16 v[120:121],v22 offset:0
v_mfma_f32_16x16x32_bf16 a[156:159],v[188:191],v[144:147],a[156:159]
v_mfma_f32_16x16x32_bf16 a[160:163],v[160:163],v[148:151],a[160:163]
ds_read_b64_tr_b16 v[122:123],v22 offset:4096
v_mfma_f32_16x16x32_bf16 a[164:167],v[164:167],v[148:151],a[164:167]
s_add_u32 s18,s18,s21
v_mfma_f32_16x16x32_bf16 a[168:171],v[168:171],v[148:151],a[168:171]
ds_read_b128 v[92:95],v12 offset:7168
v_mfma_f32_16x16x32_bf16 a[172:175],v[172:175],v[148:151],a[172:175]
s_addc_u32 s19,s19,0
v_mfma_f32_16x16x32_bf16 a[176:179],v[176:179],v[148:151],a[176:179]
ds_read_b64_tr_b16 v[124:125],v23 offset:0
v_mfma_f32_16x16x32_bf16 a[180:183],v[180:183],v[148:151],a[180:183]
s_cmp_eq_u32 s39,0
s_cbranch_scc1 L_sig2
s_mov_b32 s39,0
s_mov_b64 exec,1
global_atomic_add v233,v252,s[4:5]
s_mov_b64 exec,-1
v_mov_b32 v252,1
L_sig2:
s_nop 0
v_mfma_f32_16x16x32_bf16 a[184:187],v[184:187],v[148:151],a[184:187]
ds_read_b64_tr_b16 v[126:127],v23 offset:4096
v_mfma_f32_16x16x32_bf16 a[188:191],v[188:191],v[148:151],a[188:191]
global_load_dword v236,v238,s[4:5] sc1
v_mfma_f32_16x16x32_bf16 a[192:195],v[160:163],v[152:155],a[192:195]
v_mfma_f32_16x16x32_bf16 a[196:199],v[164:167],v[152:155],a[196:199]
v_mfma_f32_16x16x32_bf16 a[200:203],v[168:171],v[152:155],a[200:203]
v_mfma_f32_16x16x32_bf16 a[204:207],v[172:175],v[152:155],a[204:207]
v_mfma_f32_16x16x32_bf16 a[208:211],v[176:179],v[152:155],a[208:211]
v_mfma_f32_16x16x32_bf16 a[212:215],v[180:183],v[152:155],a[212:215]
v_mfma_f32_16x16x32_bf16 a[216:219],v[184:187],v[152:155],a[216:219]
v_mfma_f32_16x16x32_bf16 a[220:223],v[188:191],v[152:155],a[220:223]
v_mfma_f32_16x16x32_bf16 a[224:227],v[160:163],v[156:159],a[224:227]
v_mfma_f32_16x16x32_bf16 a[228:231],v[164:167],v[156:159],a[228:231]
v_mfma_f32_16x16x32_bf16 a[232:235],v[168:171],v[156:159],a[232:235]
v_mfma_f32_16x16x32_bf16 a[236:239],v[172:175],v[156:159],a[236:239]
v_mfma_f32_16x16x32_bf16 a[240:243],v[176:179],v[156:159],a[240:243]
v_mfma_f32_16x16x32_bf16 a[244:247],v[180:183],v[156:159],a[244:247]
v_mfma_f32_16x16x32_bf16 a[248:251],v[184:187],v[156:159],a[248:251]
v_mfma_f32_16x16x32_bf16 a[252:255],v[188:191],v[156:159],a[252:255]
L_g_tr_mid:
s_cmp_lg_u32 s22,s24
s_cbranch_scc1 L_g_tr_nwr
s_sub_u32 s16,s16,s25
s_subb_u32 s17,s17,0
s_sub_u32 s18,s18,s3
s_subb_u32 s19,s19,0
L_g_tr_nwr:
s_waitcnt vmcnt(16) lgkmcnt(0)
s_barrier
v_mfma_f32_16x16x32_bf16 a[0:3],v[96:99],v[64:67],a[0:3]
ds_read_b128 v[128:131],v12 offset:16384
v_mfma_f32_16x16x32_bf16 a[4:7],v[100:103],v[64:67],a[4:7]
s_add_u32 m0,s23,0
v_mfma_f32_16x16x32_bf16 a[8:11],v[104:107],v[64:67],a[8:11]
ds_read_b64_tr_b16 v[160:161],v16 offset:16384
v_mfma_f32_16x16x32_bf16 a[12:15],v[108:111],v[64:67],a[12:15]
global_load_lds_dwordx4 v4,s[16:17] offset:0 sc1
v_mfma_f32_16x16x32_bf16 a[16:19],v[112:115],v[64:67],a[16:19]
ds_read_b64_tr_b16 v[162:163],v16 offset:20480
v_mfma_f32_16x16x32_bf16 a[20:23],v[116:119],v[64:67],a[20:23]
v_mfma_f32_16x16x32_bf16 a[24:27],v[120:123],v[64:67],a[24:27]
ds_read_b128 v[132:135],v12 offset:17408
v_mfma_f32_16x16x32_bf16 a[28:31],v[124:127],v[64:67],a[28:31]
global_load_lds_dwordx4 v5,s[16:17] offset:1024 sc1
v_mfma_f32_16x16x32_bf16 a[32:35],v[96:99],v[68:71],a[32:35]
ds_read_b64_tr_b16 v[164:165],v17 offset:16384
v_mfma_f32_16x16x32_bf16 a[36:39],v[100:103],v[68:71],a[36:39]
v_mfma_f32_16x16x32_bf16 a[40:43],v[104:107],v[68:71],a[40:43]
ds_read_b64_tr_b16 v[166:167],v17 offset:20480
v_mfma_f32_16x16x32_bf16 a[44:47],v[108:111],v[68:71],a[44:47]
global_load_lds_dwordx4 v6,s[16:17] offset:2048 sc1
v_mfma_f32_16x16x32_bf16 a[48:51],v[112:115],v[68:71],a[48:51]
ds_read_b128 v[136:139],v12 offset:18432
v_mfma_f32_16x16x32_bf16 a[52:55],v[116:119],v[68:71],a[52:55]
v_mfma_f32_16x16x32_bf16 a[56:59],v[120:123],v[68:71],a[56:59]
ds_read_b64_tr_b16 v[168:169],v18 offset:16384
v_mfma_f32_16x16x32_bf16 a[60:63],v[124:127],v[68:71],a[60:63]
global_load_lds_dwordx4 v7,s[16:17] offset:3072 sc1
v_mfma_f32_16x16x32_bf16 a[64:67],v[96:99],v[72:75],a[64:67]
ds_read_b64_tr_b16 v[170:171],v18 offset:20480
v_mfma_f32_16x16x32_bf16 a[68:71],v[100:103],v[72:75],a[68:71]
v_mfma_f32_16x16x32_bf16 a[72:75],v[104:107],v[72:75],a[72:75]
ds_read_b128 v[140:143],v12 offset:19456
v_mfma_f32_16x16x32_bf16 a[76:79],v[108:111],v[72:75],a[76:79]
s_add_u32 m0,s23,65536
v_mfma_f32_16x16x32_bf16 a[80:83],v[112:115],v[72:75],a[80:83]
ds_read_b64_tr_b16 v[172:173],v19 offset:16384
v_mfma_f32_16x16x32_bf16 a[84:87],v[116:119],v[72:75],a[84:87]
s_add_u32 s16,s16,s20
v_mfma_f32_16x16x32_bf16 a[88:91],v[120:123],v[72:75],a[88:91]
ds_read_b64_tr_b16 v[174:175],v19 offset:20480
v_mfma_f32_16x16x32_bf16 a[92:95],v[124:127],v[72:75],a[92:95]
s_addc_u32 s17,s17,0
v_mfma_f32_16x16x32_bf16 a[96:99],v[96:99],v[76:79],a[96:99]
ds_read_b128 v[144:147],v12 offset:20480
v_mfma_f32_16x16x32_bf16 a[100:103],v[100:103],v[76:79],a[100:103]
global_load_lds_dwordx4 v8,s[18:19] offset:0
v_mfma_f32_16x16x32_bf16 a[104:107],v[104:107],v[76:79],a[104:107]
ds_read_b64_tr_b16 v[176:177],v20 offset:16384
v_mfma_f32_16x16x32_bf16 a[108:111],v[108:111],v[76:79],a[108:111]
v_mfma_f32_16x16x32_bf16 a[112:115],v[112:115],v[76:79],a[112:115]
ds_read_b64_tr_b16 v[178:179],v20 offset:20480
v_mfma_f32_16x16x32_bf16 a[116:119],v[116:119],v[76:79],a[116:119]
global_load_lds_dwordx4 v9,s[18:19] offset:1024
v_mfma_f32_16x16x32_bf16 a[120:123],v[120:123],v[76:79],a[120:123]
ds_read_b128 v[148:151],v12 offset:21504
v_mfma_f32_16x16x32_bf16 a[124:127],v[124:127],v[76:79],a[124:127]
v_mfma_f32_16x16x32_bf16 a[128:131],v[96:99],v[80:83],a[128:131]
ds_read_b64_tr_b16 v[180:181],v21 offset:16384
v_mfma_f32_16x16x32_bf16 a[132:135],v[100:103],v[80:83],a[132:135]
global_load_lds_dwordx4 v10,s[18:19] offset:2048
v_mfma_f32_16x16x32_bf16 a[136:139],v[104:107],v[80:83],a[136:139]
ds_read_b64_tr_b16 v[182:183],v21 offset:20480
v_mfma_f32_16x16x32_bf16 a[140:143],v[108:111],v[80:83],a[140:143]
v_mfma_f32_16x16x32_bf16 a[144:147],v[112:115],v[80:83],a[144:147]
ds_read_b128 v[152:155],v12 offset:22528
v_mfma_f32_16x16x32_bf16 a[148:151],v[116:119],v[80:83],a[148:151]
global_load_lds_dwordx4 v11,s[18:19] offset:3072
v_mfma_f32_16x16x32_bf16 a[152:155],v[120:123],v[80:83],a[152:155]
ds_read_b64_tr_b16 v[184:185],v22 offset:16384
v_mfma_f32_16x16x32_bf16 a[156:159],v[124:127],v[80:83],a[156:159]
v_mfma_f32_16x16x32_bf16 a[160:163],v[96:99],v[84:87],a[160:163]
ds_read_b64_tr_b16 v[186:187],v22 offset:20480
v_mfma_f32_16x16x32_bf16 a[164:167],v[100:103],v[84:87],a[164:167]
s_add_u32 s18,s18,s21
v_mfma_f32_16x16x32_bf16 a[168:171],v[104:107],v[84:87],a[168:171]
ds_read_b128 v[156:159],v12 offset:23552
v_mfma_f32_16x16x32_bf16 a[172:175],v[108:111],v[84:87],a[172:175]
s_addc_u32 s19,s19,0
v_mfma_f32_16x16x32_bf16 a[176:179],v[112:115],v[84:87],a[176:179]
ds_read_b64_tr_b16 v[188:189],v23 offset:16384
v_mfma_f32_16x16x32_bf16 a[180:183],v[116:119],v[84:87],a[180:183]
v_mfma_f32_16x16x32_bf16 a[184:187],v[120:123],v[84:87],a[184:187]
ds_read_b64_tr_b16 v[190:191],v23 offset:20480
v_mfma_f32_16x16x32_bf16 a[188:191],v[124:127],v[84:87],a[188:191]
v_mfma_f32_16x16x32_bf16 a[192:195],v[96:99],v[88:91],a[192:195]
v_mfma_f32_16x16x32_bf16 a[196:199],v[100:103],v[88:91],a[196:199]
v_mfma_f32_16x16x32_bf16 a[200:203],v[104:107],v[88:91],a[200:203]
v_mfma_f32_16x16x32_bf16 a[204:207],v[108:111],v[88:91],a[204:207]
v_mfma_f32_16x16x32_bf16 a[208:211],v[112:115],v[88:91],a[208:211]
v_mfma_f32_16x16x32_bf16 a[212:215],v[116:119],v[88:91],a[212:215]
v_mfma_f32_16x16x32_bf16 a[216:219],v[120:123],v[88:91],a[216:219]
v_mfma_f32_16x16x32_bf16 a[220:223],v[124:127],v[88:91],a[220:223]
v_mfma_f32_16x16x32_bf16 a[224:227],v[96:99],v[92:95],a[224:227]
v_mfma_f32_16x16x32_bf16 a[228:231],v[100:103],v[92:95],a[228:231]
v_mfma_f32_16x16x32_bf16 a[232:235],v[104:107],v[92:95],a[232:235]
v_mfma_f32_16x16x32_bf16 a[236:239],v[108:111],v[92:95],a[236:239]
v_mfma_f32_16x16x32_bf16 a[240:243],v[112:115],v[92:95],a[240:243]
v_mfma_f32_16x16x32_bf16 a[244:247],v[116:119],v[92:95],a[244:247]
v_mfma_f32_16x16x32_bf16 a[248:251],v[120:123],v[92:95],a[248:251]
v_mfma_f32_16x16x32_bf16 a[252:255],v[124:127],v[92:95],a[252:255]
s_waitcnt vmcnt(16) lgkmcnt(0)
s_barrier
v_mfma_f32_16x16x32_bf16 a[0:3],v[160:163],v[128:131],a[0:3]
ds_read_b128 v[64:67],v12 offset:32768
v_mfma_f32_16x16x32_bf16 a[4:7],v[164:167],v[128:131],a[4:7]
s_add_u32 m0,s23,16384
v_mfma_f32_16x16x32_bf16 a[8:11],v[168:171],v[128:131],a[8:11]
ds_read_b64_tr_b16 v[96:97],v16 offset:32768
v_mfma_f32_16x16x32_bf16 a[12:15],v[172:175],v[128:131],a[12:15]
global_load_lds_dwordx4 v4,s[16:17] offset:0 sc1
v_mfma_f32_16x16x32_bf16 a[16:19],v[176:179],v[128:131],a[16:19]
ds_read_b64_tr_b16 v[98:99],v16 offset:36864
v_mfma_f32_16x16x32_bf16 a[20:23],v[180:183],v[128:131],a[20:23]
v_mfma_f32_16x16x32_bf16 a[24:27],v[184:187],v[128:131],a[24:27]
ds_read_b128 v[68:71],v12 offset:33792
v_mfma_f32_16x16x32_bf16 a[28:31],v[188:191],v[128:131],a[28:31]
global_load_lds_dwordx4 v5,s[16:17] offset:1024 sc1
v_mfma_f32_16x16x32_bf16 a[32:35],v[160:163],v[132:135],a[32:35]
ds_read_b64_tr_b16 v[100:101],v17 offset:32768
v_mfma_f32_16x16x32_bf16 a[36:39],v[164:167],v[132:135],a[36:39]
v_mfma_f32_16x16x32_bf16 a[40:43],v[168:171],v[132:135],a[40:43]
ds_read_b64_tr_b16 v[102:103],v17 offset:36864
v_mfma_f32_16x16x32_bf16 a[44:47],v[172:175],v[132:135],a[44:47]
global_load_lds_dwordx4 v6,s[16:17] offset:2048 sc1
v_mfma_f32_16x16x32_bf16 a[48:51],v[176:179],v[132:135],a[48:51]
ds_read_b128 v[72:75],v12 offset:34816
v_mfma_f32_16x16x32_bf16 a[52:55],v[180:183],v[132:135],a[52:55]
v_mfma_f32_16x16x32_bf16 a[56:59],v[184:187],v[132:135],a[56:59]
ds_read_b64_tr_b16 v[104:105],v18 offset:32768
v_mfma_f32_16x16x32_bf16 a[60:63],v[188:191],v[132:135],a[60:63]
global_load_lds_dwordx4 v7,s[16:17] offset:3072 sc1
v_mfma_f32_16x16x32_bf16 a[64:67],v[160:163],v[136:139],a[64:67]
ds_read_b64_tr_b16 v[106:107],v18 offset:36864
v_mfma_f32_16x16x32_bf16 a[68:71],v[164:167],v[136:139],a[68:71]
v_mfma_f32_16x16x32_bf16 a[72:75],v[168:171],v[136:139],a[72:75]
ds_read_b128 v[76:79],v12 offset:35840
v_mfma_f32_16x16x32_bf16 a[76:79],v[172:175],v[136:139],a[76:79]
s_add_u32 m0,s23,81920
v_mfma_f32_16x16x32_bf16 a[80:83],v[176:179],v[136:139],a[80:83]
ds_read_b64_tr_b16 v[108:109],v19 offset:32768
v_mfma_f32_16x16x32_bf16 a[84:87],v[180:183],v[136:139],a[84:87]
s_add_u32 s16,s16,s20
v_mfma_f32_16x16x32_bf16 a[88:91],v[184:187],v[136:139],a[88:91]
ds_read_b64_tr_b16 v[110:111],v19 offset:36864
v_mfma_f32_16x16x32_bf16 a[92:95],v[188:191],v[136:139],a[92:95]
s_addc_u32 s17,s17,0
v_mfma_f32_16x16x32_bf16 a[96:99],v[160:163],v[140:143],a[96:99]
ds_read_b128 v[80:83],v12 offset:36864
v_mfma_f32_16x16x32_bf16 a[100:103],v[164:167],v[140:143],a[100:103]
global_load_lds_dwordx4 v8,s[18:19] offset:0
v_mfma_f32_16x16x32_bf16 a[104:107],v[168:171],v[140:143],a[104:107]
ds_read_b64_tr_b16 v[112:113],v20 offset:32768
v_mfma_f32_16x16x32_bf16 a[108:111],v[172:175],v[140:143],a[108:111]
v_mfma_f32_16x16x32_bf16 a[112:115],v[176:179],v[140:143],a[112:115]
ds_read_b64_tr_b16 v[114:115],v20 offset:36864
v_mfma_f32_16x16x32_bf16 a[116:119],v[180:183],v[140:143],a[116:119]
global_load_lds_dwordx4 v9,s[18:19] offset:1024
v_mfma_f32_16x16x32_bf16 a[120:123],v[184:187],v[140:143],a[120:123]
ds_read_b128 v[84:87],v12 offset:37888
v_mfma_f32_16x16x32_bf16 a[124:127],v[188:191],v[140:143],a[124:127]
v_mfma_f32_16x16x32_bf16 a[128:131],v[160:163],v[144:147],a[128:131]
ds_read_b64_tr_b16 v[116:117],v21 offset:32768
v_mfma_f32_16x16x32_bf16 a[132:135],v[164:167],v[144:147],a[132:135]
global_load_lds_dwordx4 v10,s[18:19] offset:2048
v_mfma_f32_16x16x32_bf16 a[136:139],v[168:171],v[144:147],a[136:139]
ds_read_b64_tr_b16 v[118:119],v21 offset:36864
v_mfma_f32_16x16x32_bf16 a[140:143],v[172:175],v[144:147],a[140:143]
v_mfma_f32_16x16x32_bf16 a[144:147],v[176:179],v[144:147],a[144:147]
ds_read_b128 v[88:91],v12 offset:38912
v_mfma_f32_16x16x32_bf16 a[148:151],v[180:183],v[144:147],a[148:151]
global_load_lds_dwordx4 v11,s[18:19] offset:3072
v_mfma_f32_16x16x32_bf16 a[152:155],v[184:187],v[144:147],a[152:155]
ds_read_b64_tr_b16 v[120:121],v22 offset:32768
v_mfma_f32_16x16x32_bf16 a[156:159],v[188:191],v[144:147],a[156:159]
v_mfma_f32_16x16x32_bf16 a[160:163],v[160:163],v[148:151],a[160:163]
ds_read_b64_tr_b16 v[122:123],v22 offset:36864
v_mfma_f32_16x16x32_bf16 a[164:167],v[164:167],v[148:151],a[164:167]
s_add_u32 s18,s18,s21
v_mfma_f32_16x16x32_bf16 a[168:171],v[168:171],v[148:151],a[168:171]
ds_read_b128 v[92:95],v12 offset:39936
v_mfma_f32_16x16x32_bf16 a[172:175],v[172:175],v[148:151],a[172:175]
s_addc_u32 s19,s19,0
v_mfma_f32_16x16x32_bf16 a[176:179],v[176:179],v[148:151],a[176:179]
ds_read_b64_tr_b16 v[124:125],v23 offset:32768
v_mfma_f32_16x16x32_bf16 a[180:183],v[180:183],v[148:151],a[180:183]
v_mfma_f32_16x16x32_bf16 a[184:187],v[184:187],v[148:151],a[184:187]
ds_read_b64_tr_b16 v[126:127],v23 offset:36864
v_mfma_f32_16x16x32_bf16 a[188:191],v[188:191],v[148:151],a[188:191]
v_mfma_f32_16x16x32_bf16 a[192:195],v[160:163],v[152:155],a[192:195]
v_mfma_f32_16x16x32_bf16 a[196:199],v[164:167],v[152:155],a[196:199]
v_mfma_f32_16x16x32_bf16 a[200:203],v[168:171],v[152:155],a[200:203]
v_mfma_f32_16x16x32_bf16 a[204:207],v[172:175],v[152:155],a[204:207]
v_mfma_f32_16x16x32_bf16 a[208:211],v[176:179],v[152:155],a[208:211]
v_mfma_f32_16x16x32_bf16 a[212:215],v[180:183],v[152:155],a[212:215]
v_mfma_f32_16x16x32_bf16 a[216:219],v[184:187],v[152:155],a[216:219]
v_mfma_f32_16x16x32_bf16 a[220:223],v[188:191],v[152:155],a[220:223]
v_mfma_f32_16x16x32_bf16 a[224:227],v[160:163],v[156:159],a[224:227]
v_mfma_f32_16x16x32_bf16 a[228:231],v[164:167],v[156:159],a[228:231]
v_mfma_f32_16x16x32_bf16 a[232:235],v[168:171],v[156:159],a[232:235]
v_mfma_f32_16x16x32_bf16 a[236:239],v[172:175],v[156:159],a[236:239]
v_mfma_f32_16x16x32_bf16 a[240:243],v[176:179],v[156:159],a[240:243]
v_mfma_f32_16x16x32_bf16 a[244:247],v[180:183],v[156:159],a[244:247]
v_mfma_f32_16x16x32_bf16 a[248:251],v[184:187],v[156:159],a[248:251]
v_mfma_f32_16x16x32_bf16 a[252:255],v[188:191],v[156:159],a[252:255]
s_waitcnt vmcnt(16) lgkmcnt(0)
s_barrier
v_mfma_f32_16x16x32_bf16 a[0:3],v[96:99],v[64:67],a[0:3]
ds_read_b128 v[128:131],v12 offset:49152
v_mfma_f32_16x16x32_bf16 a[4:7],v[100:103],v[64:67],a[4:7]
s_add_u32 m0,s23,32768
v_mfma_f32_16x16x32_bf16 a[8:11],v[104:107],v[64:67],a[8:11]
ds_read_b64_tr_b16 v[160:161],v16 offset:49152
v_mfma_f32_16x16x32_bf16 a[12:15],v[108:111],v[64:67],a[12:15]
global_load_lds_dwordx4 v4,s[16:17] offset:0 sc1
v_mfma_f32_16x16x32_bf16 a[16:19],v[112:115],v[64:67],a[16:19]
ds_read_b64_tr_b16 v[162:163],v16 offset:53248
v_mfma_f32_16x16x32_bf16 a[20:23],v[116:119],v[64:67],a[20:23]
v_mfma_f32_16x16x32_bf16 a[24:27],v[120:123],v[64:67],a[24:27]
ds_read_b128 v[132:135],v12 offset:50176
v_mfma_f32_16x16x32_bf16 a[28:31],v[124:127],v[64:67],a[28:31]
global_load_lds_dwordx4 v5,s[16:17] offset:1024 sc1
v_mfma_f32_16x16x32_bf16 a[32:35],v[96:99],v[68:71],a[32:35]
ds_read_b64_tr_b16 v[164:165],v17 offset:49152
v_mfma_f32_16x16x32_bf16 a[36:39],v[100:103],v[68:71],a[36:39]
v_mfma_f32_16x16x32_bf16 a[40:43],v[104:107],v[68:71],a[40:43]
ds_read_b64_tr_b16 v[166:167],v17 offset:53248
v_mfma_f32_16x16x32_bf16 a[44:47],v[108:111],v[68:71],a[44:47]
global_load_lds_dwordx4 v6,s[16:17] offset:2048 sc1
v_mfma_f32_16x16x32_bf16 a[48:51],v[112:115],v[68:71],a[48:51]
ds_read_b128 v[136:139],v12 offset:51200
v_mfma_f32_16x16x32_bf16 a[52:55],v[116:119],v[68:71],a[52:55]
v_mfma_f32_16x16x32_bf16 a[56:59],v[120:123],v[68:71],a[56:59]
ds_read_b64_tr_b16 v[168:169],v18 offset:49152
v_mfma_f32_16x16x32_bf16 a[60:63],v[124:127],v[68:71],a[60:63]
global_load_lds_dwordx4 v7,s[16:17] offset:3072 sc1
v_mfma_f32_16x16x32_bf16 a[64:67],v[96:99],v[72:75],a[64:67]
ds_read_b64_tr_b16 v[170:171],v18 offset:53248
v_mfma_f32_16x16x32_bf16 a[68:71],v[100:103],v[72:75],a[68:71]
v_mfma_f32_16x16x32_bf16 a[72:75],v[104:107],v[72:75],a[72:75]
ds_read_b128 v[140:143],v12 offset:52224
v_mfma_f32_16x16x32_bf16 a[76:79],v[108:111],v[72:75],a[76:79]
s_add_u32 m0,s23,98304
v_mfma_f32_16x16x32_bf16 a[80:83],v[112:115],v[72:75],a[80:83]
ds_read_b64_tr_b16 v[172:173],v19 offset:49152
v_mfma_f32_16x16x32_bf16 a[84:87],v[116:119],v[72:75],a[84:87]
s_add_u32 s16,s16,s20
v_mfma_f32_16x16x32_bf16 a[88:91],v[120:123],v[72:75],a[88:91]
ds_read_b64_tr_b16 v[174:175],v19 offset:53248
v_mfma_f32_16x16x32_bf16 a[92:95],v[124:127],v[72:75],a[92:95]
s_addc_u32 s17,s17,0
v_mfma_f32_16x16x32_bf16 a[96:99],v[96:99],v[76:79],a[96:99]
ds_read_b128 v[144:147],v12 offset:53248
v_mfma_f32_16x16x32_bf16 a[100:103],v[100:103],v[76:79],a[100:103]
global_load_lds_dwordx4 v8,s[18:19] offset:0
v_mfma_f32_16x16x32_bf16 a[104:107],v[104:107],v[76:79],a[104:107]
ds_read_b64_tr_b16 v[176:177],v20 offset:49152
v_mfma_f32_16x16x32_bf16 a[108:111],v[108:111],v[76:79],a[108:111]
v_mfma_f32_16x16x32_bf16 a[112:115],v[112:115],v[76:79],a[112:115]
ds_read_b64_tr_b16 v[178:179],v20 offset:53248
v_mfma_f32_16x16x32_bf16 a[116:119],v[116:119],v[76:79],a[116:119]
global_load_lds_dwordx4 v9,s[18:19] offset:1024
v_mfma_f32_16x16x32_bf16 a[120:123],v[120:123],v[76:79],a[120:123]
ds_read_b128 v[148:151],v12 offset:54272
v_mfma_f32_16x16x32_bf16 a[124:127],v[124:127],v[76:79],a[124:127]
v_mfma_f32_16x16x32_bf16 a[128:131],v[96:99],v[80:83],a[128:131]
ds_read_b64_tr_b16 v[180:181],v21 offset:49152
v_mfma_f32_16x16x32_bf16 a[132:135],v[100:103],v[80:83],a[132:135]
global_load_lds_dwordx4 v10,s[18:19] offset:2048
v_mfma_f32_16x16x32_bf16 a[136:139],v[104:107],v[80:83],a[136:139]
ds_read_b64_tr_b16 v[182:183],v21 offset:53248
v_mfma_f32_16x16x32_bf16 a[140:143],v[108:111],v[80:83],a[140:143]
v_mfma_f32_16x16x32_bf16 a[144:147],v[112:115],v[80:83],a[144:147]
ds_read_b128 v[152:155],v12 offset:55296
v_mfma_f32_16x16x32_bf16 a[148:151],v[116:119],v[80:83],a[148:151]
global_load_lds_dwordx4 v11,s[18:19] offset:3072
v_mfma_f32_16x16x32_bf16 a[152:155],v[120:123],v[80:83],a[152:155]
ds_read_b64_tr_b16 v[184:185],v22 offset:49152
v_mfma_f32_16x16x32_bf16 a[156:159],v[124:127],v[80:83],a[156:159]
v_mfma_f32_16x16x32_bf16 a[160:163],v[96:99],v[84:87],a[160:163]
ds_read_b64_tr_b16 v[186:187],v22 offset:53248
v_mfma_f32_16x16x32_bf16 a[164:167],v[100:103],v[84:87],a[164:167]
s_add_u32 s18,s18,s21
v_mfma_f32_16x16x32_bf16 a[168:171],v[104:107],v[84:87],a[168:171]
ds_read_b128 v[156:159],v12 offset:56320
v_mfma_f32_16x16x32_bf16 a[172:175],v[108:111],v[84:87],a[172:175]
s_addc_u32 s19,s19,0
v_mfma_f32_16x16x32_bf16 a[176:179],v[112:115],v[84:87],a[176:179]
ds_read_b64_tr_b16 v[188:189],v23 offset:49152
v_mfma_f32_16x16x32_bf16 a[180:183],v[116:119],v[84:87],a[180:183]
ds_write_b32 v239,v236
v_mfma_f32_16x16x32_bf16 a[184:187],v[120:123],v[84:87],a[184:187]
ds_read_b64_tr_b16 v[190:191],v23 offset:53248
v_mfma_f32_16x16x32_bf16 a[188:191],v[124:127],v[84:87],a[188:191]
v_mfma_f32_16x16x32_bf16 a[192:195],v[96:99],v[88:91],a[192:195]
v_mfma_f32_16x16x32_bf16 a[196:199],v[100:103],v[88:91],a[196:199]
v_mfma_f32_16x16x32_bf16 a[200:203],v[104:107],v[88:91],a[200:203]
v_mfma_f32_16x16x32_bf16 a[204:207],v[108:111],v[88:91],a[204:207]
v_mfma_f32_16x16x32_bf16 a[208:211],v[112:115],v[88:91],a[208:211]
v_mfma_f32_16x16x32_bf16 a[212:215],v[116:119],v[88:91],a[212:215]
v_mfma_f32_16x16x32_bf16 a[216:219],v[120:123],v[88:91],a[216:219]
v_mfma_f32_16x16x32_bf16 a[220:223],v[124:127],v[88:91],a[220:223]
v_mfma_f32_16x16x32_bf16 a[224:227],v[96:99],v[92:95],a[224:227]
v_mfma_f32_16x16x32_bf16 a[228:231],v[100:103],v[92:95],a[228:231]
v_mfma_f32_16x16x32_bf16 a[232:235],v[104:107],v[92:95],a[232:235]
v_mfma_f32_16x16x32_bf16 a[236:239],v[108:111],v[92:95],a[236:239]
v_mfma_f32_16x16x32_bf16 a[240:243],v[112:115],v[92:95],a[240:243]
v_mfma_f32_16x16x32_bf16 a[244:247],v[116:119],v[92:95],a[244:247]
v_mfma_f32_16x16x32_bf16 a[248:251],v[120:123],v[92:95],a[248:251]
v_mfma_f32_16x16x32_bf16 a[252:255],v[124:127],v[92:95],a[252:255]
s_waitcnt vmcnt(16) lgkmcnt(0)
s_barrier
v_mfma_f32_16x16x32_bf16 a[0:3],v[160:163],v[128:131],a[0:3]
ds_read_b128 v[64:67],v12 offset:0
v_mfma_f32_16x16x32_bf16 a[4:7],v[164:167],v[128:131],a[4:7]
s_add_u32 m0,s23,49152
v_mfma_f32_16x16x32_bf16 a[8:11],v[168:171],v[128:131],a[8:11]
ds_read_b64_tr_b16 v[96:97],v16 offset:0
v_mfma_f32_16x16x32_bf16 a[12:15],v[172:175],v[128:131],a[12:15]
global_load_lds_dwordx4 v4,s[16:17] offset:0 sc1
v_mfma_f32_16x16x32_bf16 a[16:19],v[176:179],v[128:131],a[16:19]
ds_read_b64_tr_b16 v[98:99],v16 offset:4096
v_mfma_f32_16x16x32_bf16 a[20:23],v[180:183],v[128:131],a[20:23]
v_mfma_f32_16x16x32_bf16 a[24:27],v[184:187],v[128:131],a[24:27]
ds_read_b128 v[68:71],v12 offset:1024
v_mfma_f32_16x16x32_bf16 a[28:31],v[188:191],v[128:131],a[28:31]
global_load_lds_dwordx4 v5,s[16:17] offset:1024 sc1
v_mfma_f32_16x16x32_bf16 a[32:35],v[160:163],v[132:135],a[32:35]
ds_read_b64_tr_b16 v[100:101],v17 offset:0
v_mfma_f32_16x16x32_bf16 a[36:39],v[164:167],v[132:135],a[36:39]
v_mfma_f32_16x16x32_bf16 a[40:43],v[168:171],v[132:135],a[40:43]
ds_read_b64_tr_b16 v[102:103],v17 offset:4096
v_mfma_f32_16x16x32_bf16 a[44:47],v[172:175],v[132:135],a[44:47]
global_load_lds_dwordx4 v6,s[16:17] offset:2048 sc1
v_mfma_f32_16x16x32_bf16 a[48:51],v[176:179],v[132:135],a[48:51]
ds_read_b128 v[72:75],v12 offset:2048
v_mfma_f32_16x16x32_bf16 a[52:55],v[180:183],v[132:135],a[52:55]
v_mfma_f32_16x16x32_bf16 a[56:59],v[184:187],v[132:135],a[56:59]
ds_read_b64_tr_b16 v[104:105],v18 offset:0
v_mfma_f32_16x16x32_bf16 a[60:63],v[188:191],v[132:135],a[60:63]
global_load_lds_dwordx4 v7,s[16:17] offset:3072 sc1
v_mfma_f32_16x16x32_bf16 a[64:67],v[160:163],v[136:139],a[64:67]
ds_read_b64_tr_b16 v[106:107],v18 offset:4096
v_mfma_f32_16x16x32_bf16 a[68:71],v[164:167],v[136:139],a[68:71]
v_mfma_f32_16x16x32_bf16 a[72:75],v[168:171],v[136:139],a[72:75]
ds_read_b128 v[76:79],v12 offset:3072
v_mfma_f32_16x16x32_bf16 a[76:79],v[172:175],v[136:139],a[76:79]
s_add_u32 m0,s23,114688
v_mfma_f32_16x16x32_bf16 a[80:83],v[176:179],v[136:139],a[80:83]
ds_read_b64_tr_b16 v[108:109],v19 offset:0
v_mfma_f32_16x16x32_bf16 a[84:87],v[180:183],v[136:139],a[84:87]
s_add_u32 s16,s16,s20
v_mfma_f32_16x16x32_bf16 a[88:91],v[184:187],v[136:139],a[88:91]
ds_read_b64_tr_b16 v[110:111],v19 offset:4096
v_mfma_f32_16x16x32_bf16 a[92:95],v[188:191],v[136:139],a[92:95]
s_addc_u32 s17,s17,0
v_mfma_f32_16x16x32_bf16 a[96:99],v[160:163],v[140:143],a[96:99]
ds_read_b128 v[80:83],v12 offset:4096
v_mfma_f32_16x16x32_bf16 a[100:103],v[164:167],v[140:143],a[100:103]
global_load_lds_dwordx4 v8,s[18:19] offset:0
v_mfma_f32_16x16x32_bf16 a[104:107],v[168:171],v[140:143],a[104:107]
ds_read_b64_tr_b16 v[112:113],v20 offset:0
v_mfma_f32_16x16x32_bf16 a[108:111],v[172:175],v[140:143],a[108:111]
v_mfma_f32_16x16x32_bf16 a[112:115],v[176:179],v[140:143],a[112:115]
ds_read_b64_tr_b16 v[114:115],v20 offset:4096
v_mfma_f32_16x16x32_bf16 a[116:119],v[180:183],v[140:143],a[116:119]
global_load_lds_dwordx4 v9,s[18:19] offset:1024
v_mfma_f32_16x16x32_bf16 a[120:123],v[184:187],v[140:143],a[120:123]
ds_read_b128 v[84:87],v12 offset:5120
v_mfma_f32_16x16x32_bf16 a[124:127],v[188:191],v[140:143],a[124:127]
v_mfma_f32_16x16x32_bf16 a[128:131],v[160:163],v[144:147],a[128:131]
ds_read_b64_tr_b16 v[116:117],v21 offset:0
v_mfma_f32_16x16x32_bf16 a[132:135],v[164:167],v[144:147],a[132:135]
global_load_lds_dwordx4 v10,s[18:19] offset:2048
v_mfma_f32_16x16x32_bf16 a[136:139],v[168:171],v[144:147],a[136:139]
ds_read_b64_tr_b16 v[118:119],v21 offset:4096
v_mfma_f32_16x16x32_bf16 a[140:143],v[172:175],v[144:147],a[140:143]
v_mfma_f32_16x16x32_bf16 a[144:147],v[176:179],v[144:147],a[144:147]
ds_read_b128 v[88:91],v12 offset:6144
v_mfma_f32_16x16x32_bf16 a[148:151],v[180:183],v[144:147],a[148:151]
global_load_lds_dwordx4 v11,s[18:19] offset:3072
v_mfma_f32_16x16x32_bf16 a[152:155],v[184:187],v[144:147],a[152:155]
ds_read_b64_tr_b16 v[120:121],v22 offset:0
v_mfma_f32_16x16x32_bf16 a[156:159],v[188:191],v[144:147],a[156:159]
v_mfma_f32_16x16x32_bf16 a[160:163],v[160:163],v[148:151],a[160:163]
ds_read_b64_tr_b16 v[122:123],v22 offset:4096
v_mfma_f32_16x16x32_bf16 a[164:167],v[164:167],v[148:151],a[164:167]
s_add_u32 s18,s18,s21
v_mfma_f32_16x16x32_bf16 a[168:171],v[168:171],v[148:151],a[168:171]
ds_read_b128 v[92:95],v12 offset:7168
v_mfma_f32_16x16x32_bf16 a[172:175],v[172:175],v[148:151],a[172:175]
s_addc_u32 s19,s19,0
v_mfma_f32_16x16x32_bf16 a[176:179],v[176:179],v[148:151],a[176:179]
ds_read_b64_tr_b16 v[124:125],v23 offset:0
v_mfma_f32_16x16x32_bf16 a[180:183],v[180:183],v[148:151],a[180:183]
global_load_dword v236,v238,s[4:5] sc1
v_mfma_f32_16x16x32_bf16 a[184:187],v[184:187],v[148:151],a[184:187]
ds_read_b64_tr_b16 v[126:127],v23 offset:4096
v_mfma_f32_16x16x32_bf16 a[188:191],v[188:191],v[148:151],a[188:191]
v_mfma_f32_16x16x32_bf16 a[192:195],v[160:163],v[152:155],a[192:195]
v_mfma_f32_16x16x32_bf16 a[196:199],v[164:167],v[152:155],a[196:199]
v_mfma_f32_16x16x32_bf16 a[200:203],v[168:171],v[152:155],a[200:203]
v_mfma_f32_16x16x32_bf16 a[204:207],v[172:175],v[152:155],a[204:207]
v_mfma_f32_16x16x32_bf16 a[208:211],v[176:179],v[152:155],a[208:211]
v_mfma_f32_16x16x32_bf16 a[212:215],v[180:183],v[152:155],a[212:215]
v_mfma_f32_16x16x32_bf16 a[216:219],v[184:187],v[152:155],a[216:219]
v_mfma_f32_16x16x32_bf16 a[220:223],v[188:191],v[152:155],a[220:223]
v_mfma_f32_16x16x32_bf16 a[224:227],v[160:163],v[156:159],a[224:227]
v_mfma_f32_16x16x32_bf16 a[228:231],v[164:167],v[156:159],a[228:231]
v_mfma_f32_16x16x32_bf16 a[232:235],v[168:171],v[156:159],a[232:235]
v_mfma_f32_16x16x32_bf16 a[236:239],v[172:175],v[156:159],a[236:239]
v_mfma_f32_16x16x32_bf16 a[240:243],v[176:179],v[156:159],a[240:243]
v_mfma_f32_16x16x32_bf16 a[244:247],v[180:183],v[156:159],a[244:247]
v_mfma_f32_16x16x32_bf16 a[248:251],v[184:187],v[156:159],a[248:251]
v_mfma_f32_16x16x32_bf16 a[252:255],v[188:191],v[156:159],a[252:255]
s_sub_u32 s22,s22,1
s_cmp_lg_u32 s22,0
s_cbranch_scc1 L_g_tr_mid
s_mov_b32 s36,s33
s_and_b32 s33,s27,15
s_bfe_u32 s34,s27,0x40004
s_bfe_u32 s35,s27,0x60008
s_mov_b32 s28,1
s_sub_u32 s54,s33,1
s_cmp_lt_u32 s54,5
s_cbranch_scc1 L_g_tr_h_ck
s_sub_u32 s54,s33,9
s_cmp_lt_u32 s54,4
s_cbranch_scc0 L_g_tr_h_no
L_g_tr_h_ck:
ds_read_b128 v[24:27],v15
s_bfe_u32 s55,s27,0x60014
s_waitcnt lgkmcnt(0)
v_min3_u32 v24,v24,v25,v26
v_min_u32 v24,v24,v27
s_nop 0
v_readfirstlane_b32 s54,v24
s_nop 0
s_cmp_ge_u32 s54,s55
s_cbranch_scc1 L_g_tr_h_pf
L_g_tr_h_no:
s_mov_b32 s28,0
s_mov_b32 s33,1
s_mov_b32 s34,0
s_mov_b32 s35,0
L_g_tr_h_pf:
s_lshr_b32 s55,s14,1
s_mov_b32 s24,-1
s_cmp_eq_u32 s33,5
s_cbranch_scc1 L_g_tr_h_sd_d8
s_cmp_eq_u32 s33,8
s_cbranch_scc1 L_g_tr_h_sd_d4
s_cmp_eq_u32 s33,12
s_cbranch_scc1 L_g_tr_h_sd_d4
s_sub_u32 s54,s33,6
s_cmp_lt_u32 s54,2
s_cbranch_scc1 L_g_tr_h_sd_db
s_lshl_b32 s54,s34,19
s_add_u32 s54,s54,104857600
s_add_u32 s16,s4,s54
s_addc_u32 s17,s5,0
s_mov_b32 s20,1024
v_mov_b32 v4,v192
v_mov_b32 v5,v193
v_mov_b32 v6,v194
v_mov_b32 v7,v195
s_cmp_lt_u32 s33,9
s_cbranch_scc1 L_g_tr_h_sd_big
s_lshl_b32 s54,s34,18
s_lshl_b32 s59,s14,16
s_add_u32 s54,s54,s59
s_add_u32 s54,s54,104857600
s_add_u32 s16,s4,s54
s_addc_u32 s17,s5,0
v_mov_b32 v4,v2
v_add_u32 v5,31744,v2
v_mov_b32 v6,0
v_mov_b32 v7,0
L_g_tr_h_sd_big:
s_cmp_eq_u32 s33,4
s_cbranch_scc1 L_g_tr_h_sd_up
s_cmp_eq_u32 s33,1
s_cselect_b64 s[56:57],s[66:67],s[68:69]
s_cmp_eq_u32 s33,3
s_cselect_b64 s[56:57],s[70:71],s[56:57]
s_cmp_eq_u32 s33,11
s_cselect_b64 s[56:57],s[70:71],s[56:57]
s_cmp_eq_u32 s33,9
s_cselect_b64 s[56:57],s[66:67],s[56:57]
s_lshl_b32 s54,s35,9
s_lshl_b32 s59,s55,8
s_add_u32 s54,s54,s59
s_add_u32 s18,s56,s54
s_addc_u32 s19,s57,0
s_mov_b32 s21,262144
v_mov_b32 v8,v200
v_mov_b32 v9,v201
v_mov_b32 v10,v202
v_mov_b32 v11,v203
s_branch L_g_tr_h_sd_e
L_g_tr_h_sd_up:
s_cmp_eq_u32 s55,1
s_cselect_b64 s[56:57],s[74:75],s[72:73]
s_and_b32 s54,s35,31
s_lshl_b32 s54,s54,8
s_add_u32 s18,s56,s54
s_addc_u32 s19,s57,0
s_mov_b32 s21,229376
v_mov_b32 v8,v204
v_mov_b32 v9,v205
v_mov_b32 v10,v206
v_mov_b32 v11,v207
s_bitcmp1_b32 s35,5
s_cbranch_scc0 L_g_tr_h_sd_e
s_and_b32 s54,s34,3
s_mul_i32 s24,s54,2
s_mul_i32 s25,s20,32
s_mul_i32 s3,s21,32
s_lshl_b32 s54,s24,2
s_mul_i32 s57,s54,s20
s_add_u32 s16,s16,s57
s_addc_u32 s17,s17,0
s_mul_i32 s57,s54,s21
s_add_u32 s18,s18,s57
s_addc_u32 s19,s19,0
s_branch L_g_tr_h_sd_e
L_g_tr_h_sd_d8:
s_mul_i32 s54,s34,1835008
s_add_u32 s54,s54,50331648
s_add_u32 s16,s4,s54
s_addc_u32 s17,s5,0
s_mov_b32 s20,1024
s_and_b32 s54,s35,31
s_lshl_b32 s54,s54,9
s_lshl_b32 s59,s55,8
s_add_u32 s54,s54,s59
s_add_u32 s18,s76,s54
s_addc_u32 s19,s77,0
s_mov_b32 s21,65536
v_mov_b32 v4,v196
v_add_u32 v5,113664,v196
v_add_u32 v6,227328,v196
v_add_u32 v7,340992,v196
v_mov_b32 v8,v208
v_mov_b32 v9,v209
v_mov_b32 v10,v210
v_mov_b32 v11,v211
s_bitcmp1_b32 s35,5
s_cbranch_scc0 L_g_tr_h_sd_e
s_and_b32 s54,s34,3
s_mul_i32 s24,s54,7
s_mul_i32 s25,s20,112
s_mul_i32 s3,s21,112
s_lshl_b32 s54,s24,2
s_mul_i32 s57,s54,s20
s_add_u32 s16,s16,s57
s_addc_u32 s17,s17,0
s_mul_i32 s57,s54,s21
s_add_u32 s18,s18,s57
s_addc_u32 s19,s19,0
s_branch L_g_tr_h_sd_e
L_g_tr_h_sd_d4:
s_lshl_b32 s54,s34,20
s_lshl_b32 s59,s14,18
s_add_u32 s54,s54,s59
s_add_u32 s54,s54,67108864
s_mul_i32 s58,s34,917504
s_mul_i32 s59,s14,229376
s_add_u32 s58,s58,s59
s_add_u32 s58,s58,50331648
s_cmp_eq_u32 s33,8
s_cselect_b32 s54,s54,s58
s_cselect_b32 s58,16,0
s_cselect_b64 s[56:57],s[60:61],s[76:77]
s_add_u32 s16,s4,s54
s_addc_u32 s17,s5,0
s_mov_b32 s20,1024
s_lshl_b32 s54,s35,9
s_lshl_b32 s59,s55,8
s_add_u32 s54,s54,s59
s_add_u32 s18,s56,s54
s_addc_u32 s19,s57,0
s_mov_b32 s21,65536
v_mov_b32 v4,v2
s_lshl_b32 s58,s58,10
s_add_u32 s58,s58,113664
v_add_u32 v5,s58,v2
v_mov_b32 v6,0
v_mov_b32 v7,0
v_mov_b32 v8,v208
v_mov_b32 v9,v209
v_mov_b32 v10,v210
v_mov_b32 v11,v211
s_branch L_g_tr_h_sd_e
L_g_tr_h_sd_db:
s_lshr_b32 s57,s35,3
s_lshl_b32 s54,s34,20
s_lshl_b32 s59,s57,15
s_add_u32 s54,s54,s59
s_add_u32 s54,s54,67106816
s_and_b32 s12,s35,7
s_lshl_b32 s12,s12,8
s_lshl_b32 s59,s55,16
s_add_u32 s12,s12,s59
s_lshl_b32 s59,s57,21
s_add_u32 s12,s12,s59
s_add_u32 s16,s4,s54
s_addc_u32 s17,s5,0
s_mov_b32 s20,2048
s_add_u32 s18,s60,s12
s_addc_u32 s19,s61,0
s_mov_b32 s21,131072
s_lshl_b32 s54,s14,1
s_add_u32 s54,s54,s57
s_and_b32 s54,s54,3
s_lshl_b32 s54,s54,17
s_lshl_b32 s59,s55,19
s_add_u32 s54,s54,s59
s_add_u32 s54,s54,2048
v_add_u32 v4,s54,v2
v_mov_b32 v5,v4
s_lshl_b32 s54,s14,1
s_add_u32 s54,s54,s57
s_add_u32 s54,s54,1
s_and_b32 s54,s54,3
s_lshl_b32 s54,s54,17
s_lshl_b32 s59,s55,19
s_add_u32 s54,s54,s59
v_add_u32 v6,s54,v2
v_mov_b32 v7,v6
v_mov_b32 v8,v208
v_mov_b32 v9,v209
v_mov_b32 v10,v210
v_mov_b32 v11,v211
L_g_tr_h_sd_e:
s_cmp_eq_u32 s28,0
s_cselect_b64 s[16:17],s[64:65],s[16:17]
s_cselect_b32 s54,0,-1
s_and_b32 s21,s21,s54
v_and_b32 v4,s54,v4
v_and_b32 v5,s54,v5
v_and_b32 v6,s54,v6
v_and_b32 v7,s54,v7
v_and_b32 v8,s54,v8
v_and_b32 v9,s54,v9
v_and_b32 v10,s54,v10
v_and_b32 v11,s54,v11
s_waitcnt vmcnt(16) lgkmcnt(0)
s_barrier
v_mfma_f32_16x16x32_bf16 a[0:3],v[96:99],v[64:67],a[0:3]
ds_read_b128 v[128:131],v12 offset:16384
v_mfma_f32_16x16x32_bf16 a[4:7],v[100:103],v[64:67],a[4:7]
s_add_u32 m0,s23,0
v_mfma_f32_16x16x32_bf16 a[8:11],v[104:107],v[64:67],a[8:11]
ds_read_b64_tr_b16 v[160:161],v16 offset:16384
v_mfma_f32_16x16x32_bf16 a[12:15],v[108:111],v[64:67],a[12:15]
global_load_lds_dwordx4 v4,s[16:17] offset:0 sc1
v_mfma_f32_16x16x32_bf16 a[16:19],v[112:115],v[64:67],a[16:19]
ds_read_b64_tr_b16 v[162:163],v16 offset:20480
v_mfma_f32_16x16x32_bf16 a[20:23],v[116:119],v[64:67],a[20:23]
v_mfma_f32_16x16x32_bf16 a[24:27],v[120:123],v[64:67],a[24:27]
ds_read_b128 v[132:135],v12 offset:17408
v_mfma_f32_16x16x32_bf16 a[28:31],v[124:127],v[64:67],a[28:31]
global_load_lds_dwordx4 v5,s[16:17] offset:1024 sc1
v_mfma_f32_16x16x32_bf16 a[32:35],v[96:99],v[68:71],a[32:35]
ds_read_b64_tr_b16 v[164:165],v17 offset:16384
v_mfma_f32_16x16x32_bf16 a[36:39],v[100:103],v[68:71],a[36:39]
v_mfma_f32_16x16x32_bf16 a[40:43],v[104:107],v[68:71],a[40:43]
ds_read_b64_tr_b16 v[166:167],v17 offset:20480
v_mfma_f32_16x16x32_bf16 a[44:47],v[108:111],v[68:71],a[44:47]
global_load_lds_dwordx4 v6,s[16:17] offset:2048 sc1
v_mfma_f32_16x16x32_bf16 a[48:51],v[112:115],v[68:71],a[48:51]
ds_read_b128 v[136:139],v12 offset:18432
v_mfma_f32_16x16x32_bf16 a[52:55],v[116:119],v[68:71],a[52:55]
v_mfma_f32_16x16x32_bf16 a[56:59],v[120:123],v[68:71],a[56:59]
ds_read_b64_tr_b16 v[168:169],v18 offset:16384
v_mfma_f32_16x16x32_bf16 a[60:63],v[124:127],v[68:71],a[60:63]
global_load_lds_dwordx4 v7,s[16:17] offset:3072 sc1
v_mfma_f32_16x16x32_bf16 a[64:67],v[96:99],v[72:75],a[64:67]
ds_read_b64_tr_b16 v[170:171],v18 offset:20480
v_mfma_f32_16x16x32_bf16 a[68:71],v[100:103],v[72:75],a[68:71]
v_mfma_f32_16x16x32_bf16 a[72:75],v[104:107],v[72:75],a[72:75]
ds_read_b128 v[140:143],v12 offset:19456
v_mfma_f32_16x16x32_bf16 a[76:79],v[108:111],v[72:75],a[76:79]
s_add_u32 m0,s23,65536
v_mfma_f32_16x16x32_bf16 a[80:83],v[112:115],v[72:75],a[80:83]
ds_read_b64_tr_b16 v[172:173],v19 offset:16384
v_mfma_f32_16x16x32_bf16 a[84:87],v[116:119],v[72:75],a[84:87]
s_add_u32 s16,s16,s20
v_mfma_f32_16x16x32_bf16 a[88:91],v[120:123],v[72:75],a[88:91]
ds_read_b64_tr_b16 v[174:175],v19 offset:20480
v_mfma_f32_16x16x32_bf16 a[92:95],v[124:127],v[72:75],a[92:95]
s_addc_u32 s17,s17,0
v_mfma_f32_16x16x32_bf16 a[96:99],v[96:99],v[76:79],a[96:99]
ds_read_b128 v[144:147],v12 offset:20480
v_mfma_f32_16x16x32_bf16 a[100:103],v[100:103],v[76:79],a[100:103]
global_load_lds_dwordx4 v8,s[18:19] offset:0
v_mfma_f32_16x16x32_bf16 a[104:107],v[104:107],v[76:79],a[104:107]
ds_read_b64_tr_b16 v[176:177],v20 offset:16384
v_mfma_f32_16x16x32_bf16 a[108:111],v[108:111],v[76:79],a[108:111]
v_mfma_f32_16x16x32_bf16 a[112:115],v[112:115],v[76:79],a[112:115]
ds_read_b64_tr_b16 v[178:179],v20 offset:20480
v_mfma_f32_16x16x32_bf16 a[116:119],v[116:119],v[76:79],a[116:119]
global_load_lds_dwordx4 v9,s[18:19] offset:1024
v_mfma_f32_16x16x32_bf16 a[120:123],v[120:123],v[76:79],a[120:123]
ds_read_b128 v[148:151],v12 offset:21504
v_mfma_f32_16x16x32_bf16 a[124:127],v[124:127],v[76:79],a[124:127]
v_mfma_f32_16x16x32_bf16 a[128:131],v[96:99],v[80:83],a[128:131]
ds_read_b64_tr_b16 v[180:181],v21 offset:16384
v_mfma_f32_16x16x32_bf16 a[132:135],v[100:103],v[80:83],a[132:135]
global_load_lds_dwordx4 v10,s[18:19] offset:2048
v_mfma_f32_16x16x32_bf16 a[136:139],v[104:107],v[80:83],a[136:139]
ds_read_b64_tr_b16 v[182:183],v21 offset:20480
v_mfma_f32_16x16x32_bf16 a[140:143],v[108:111],v[80:83],a[140:143]
v_mfma_f32_16x16x32_bf16 a[144:147],v[112:115],v[80:83],a[144:147]
ds_read_b128 v[152:155],v12 offset:22528
v_mfma_f32_16x16x32_bf16 a[148:151],v[116:119],v[80:83],a[148:151]
global_load_lds_dwordx4 v11,s[18:19] offset:3072
v_mfma_f32_16x16x32_bf16 a[152:155],v[120:123],v[80:83],a[152:155]
ds_read_b64_tr_b16 v[184:185],v22 offset:16384
v_mfma_f32_16x16x32_bf16 a[156:159],v[124:127],v[80:83],a[156:159]
v_mfma_f32_16x16x32_bf16 a[160:163],v[96:99],v[84:87],a[160:163]
ds_read_b64_tr_b16 v[186:187],v22 offset:20480
v_mfma_f32_16x16x32_bf16 a[164:167],v[100:103],v[84:87],a[164:167]
s_add_u32 s18,s18,s21
v_mfma_f32_16x16x32_bf16 a[168:171],v[104:107],v[84:87],a[168:171]
ds_read_b128 v[156:159],v12 offset:23552
v_mfma_f32_16x16x32_bf16 a[172:175],v[108:111],v[84:87],a[172:175]
s_addc_u32 s19,s19,0
v_mfma_f32_16x16x32_bf16 a[176:179],v[112:115],v[84:87],a[176:179]
ds_read_b64_tr_b16 v[188:189],v23 offset:16384
v_mfma_f32_16x16x32_bf16 a[180:183],v[116:119],v[84:87],a[180:183]
v_mfma_f32_16x16x32_bf16 a[184:187],v[120:123],v[84:87],a[184:187]
ds_read_b64_tr_b16 v[190:191],v23 offset:20480
v_mfma_f32_16x16x32_bf16 a[188:191],v[124:127],v[84:87],a[188:191]
v_mfma_f32_16x16x32_bf16 a[192:195],v[96:99],v[88:91],a[192:195]
v_mfma_f32_16x16x32_bf16 a[196:199],v[100:103],v[88:91],a[196:199]
v_mfma_f32_16x16x32_bf16 a[200:203],v[104:107],v[88:91],a[200:203]
v_mfma_f32_16x16x32_bf16 a[204:207],v[108:111],v[88:91],a[204:207]
v_mfma_f32_16x16x32_bf16 a[208:211],v[112:115],v[88:91],a[208:211]
v_mfma_f32_16x16x32_bf16 a[212:215],v[116:119],v[88:91],a[212:215]
v_mfma_f32_16x16x32_bf16 a[216:219],v[120:123],v[88:91],a[216:219]
v_mfma_f32_16x16x32_bf16 a[220:223],v[124:127],v[88:91],a[220:223]
v_mfma_f32_16x16x32_bf16 a[224:227],v[96:99],v[92:95],a[224:227]
v_mfma_f32_16x16x32_bf16 a[228:231],v[100:103],v[92:95],a[228:231]
v_mfma_f32_16x16x32_bf16 a[232:235],v[104:107],v[92:95],a[232:235]
v_mfma_f32_16x16x32_bf16 a[236:239],v[108:111],v[92:95],a[236:239]
v_mfma_f32_16x16x32_bf16 a[240:243],v[112:115],v[92:95],a[240:243]
v_mfma_f32_16x16x32_bf16 a[244:247],v[116:119],v[92:95],a[244:247]
v_mfma_f32_16x16x32_bf16 a[248:251],v[120:123],v[92:95],a[248:251]
v_mfma_f32_16x16x32_bf16 a[252:255],v[124:127],v[92:95],a[252:255]
s_waitcnt vmcnt(16) lgkmcnt(0)
s_barrier
v_mfma_f32_16x16x32_bf16 a[0:3],v[160:163],v[128:131],a[0:3]
ds_read_b128 v[64:67],v12 offset:32768
v_mfma_f32_16x16x32_bf16 a[4:7],v[164:167],v[128:131],a[4:7]
s_add_u32 m0,s23,16384
v_mfma_f32_16x16x32_bf16 a[8:11],v[168:171],v[128:131],a[8:11]
ds_read_b64_tr_b16 v[96:97],v16 offset:32768
v_mfma_f32_16x16x32_bf16 a[12:15],v[172:175],v[128:131],a[12:15]
global_load_lds_dwordx4 v4,s[16:17] offset:0 sc1
v_mfma_f32_16x16x32_bf16 a[16:19],v[176:179],v[128:131],a[16:19]
ds_read_b64_tr_b16 v[98:99],v16 offset:36864
v_mfma_f32_16x16x32_bf16 a[20:23],v[180:183],v[128:131],a[20:23]
v_mfma_f32_16x16x32_bf16 a[24:27],v[184:187],v[128:131],a[24:27]
ds_read_b128 v[68:71],v12 offset:33792
v_mfma_f32_16x16x32_bf16 a[28:31],v[188:191],v[128:131],a[28:31]
global_load_lds_dwordx4 v5,s[16:17] offset:1024 sc1
v_mfma_f32_16x16x32_bf16 a[32:35],v[160:163],v[132:135],a[32:35]
ds_read_b64_tr_b16 v[100:101],v17 offset:32768
v_mfma_f32_16x16x32_bf16 a[36:39],v[164:167],v[132:135],a[36:39]
v_mfma_f32_16x16x32_bf16 a[40:43],v[168:171],v[132:135],a[40:43]
ds_read_b64_tr_b16 v[102:103],v17 offset:36864
v_mfma_f32_16x16x32_bf16 a[44:47],v[172:175],v[132:135],a[44:47]
global_load_lds_dwordx4 v6,s[16:17] offset:2048 sc1
v_mfma_f32_16x16x32_bf16 a[48:51],v[176:179],v[132:135],a[48:51]
ds_read_b128 v[72:75],v12 offset:34816
v_mfma_f32_16x16x32_bf16 a[52:55],v[180:183],v[132:135],a[52:55]
v_mfma_f32_16x16x32_bf16 a[56:59],v[184:187],v[132:135],a[56:59]
ds_read_b64_tr_b16 v[104:105],v18 offset:32768
v_mfma_f32_16x16x32_bf16 a[60:63],v[188:191],v[132:135],a[60:63]
global_load_lds_dwordx4 v7,s[16:17] offset:3072 sc1
v_mfma_f32_16x16x32_bf16 a[64:67],v[160:163],v[136:139],a[64:67]
ds_read_b64_tr_b16 v[106:107],v18 offset:36864
v_mfma_f32_16x16x32_bf16 a[68:71],v[164:167],v[136:139],a[68:71]
v_mfma_f32_16x16x32_bf16 a[72:75],v[168:171],v[136:139],a[72:75]
ds_read_b128 v[76:79],v12 offset:35840
v_mfma_f32_16x16x32_bf16 a[76:79],v[172:175],v[136:139],a[76:79]
s_add_u32 m0,s23,81920
v_mfma_f32_16x16x32_bf16 a[80:83],v[176:179],v[136:139],a[80:83]
ds_read_b64_tr_b16 v[108:109],v19 offset:32768
v_mfma_f32_16x16x32_bf16 a[84:87],v[180:183],v[136:139],a[84:87]
s_add_u32 s16,s16,s20
v_mfma_f32_16x16x32_bf16 a[88:91],v[184:187],v[136:139],a[88:91]
ds_read_b64_tr_b16 v[110:111],v19 offset:36864
v_mfma_f32_16x16x32_bf16 a[92:95],v[188:191],v[136:139],a[92:95]
s_addc_u32 s17,s17,0
v_mfma_f32_16x16x32_bf16 a[96:99],v[160:163],v[140:143],a[96:99]
ds_read_b128 v[80:83],v12 offset:36864
v_mfma_f32_16x16x32_bf16 a[100:103],v[164:167],v[140:143],a[100:103]
global_load_lds_dwordx4 v8,s[18:19] offset:0
v_mfma_f32_16x16x32_bf16 a[104:107],v[168:171],v[140:143],a[104:107]
ds_read_b64_tr_b16 v[112:113],v20 offset:32768
v_mfma_f32_16x16x32_bf16 a[108:111],v[172:175],v[140:143],a[108:111]
v_mfma_f32_16x16x32_bf16 a[112:115],v[176:179],v[140:143],a[112:115]
ds_read_b64_tr_b16 v[114:115],v20 offset:36864
v_mfma_f32_16x16x32_bf16 a[116:119],v[180:183],v[140:143],a[116:119]
global_load_lds_dwordx4 v9,s[18:19] offset:1024
v_mfma_f32_16x16x32_bf16 a[120:123],v[184:187],v[140:143],a[120:123]
ds_read_b128 v[84:87],v12 offset:37888
v_mfma_f32_16x16x32_bf16 a[124:127],v[188:191],v[140:143],a[124:127]
v_mfma_f32_16x16x32_bf16 a[128:131],v[160:163],v[144:147],a[128:131]
ds_read_b64_tr_b16 v[116:117],v21 offset:32768
v_mfma_f32_16x16x32_bf16 a[132:135],v[164:167],v[144:147],a[132:135]
global_load_lds_dwordx4 v10,s[18:19] offset:2048
v_mfma_f32_16x16x32_bf16 a[136:139],v[168:171],v[144:147],a[136:139]
ds_read_b64_tr_b16 v[118:119],v21 offset:36864
v_mfma_f32_16x16x32_bf16 a[140:143],v[172:175],v[144:147],a[140:143]
v_mfma_f32_16x16x32_bf16 a[144:147],v[176:179],v[144:147],a[144:147]
ds_read_b128 v[88:91],v12 offset:38912
v_mfma_f32_16x16x32_bf16 a[148:151],v[180:183],v[144:147],a[148:151]
global_load_lds_dwordx4 v11,s[18:19] offset:3072
v_mfma_f32_16x16x32_bf16 a[152:155],v[184:187],v[144:147],a[152:155]
ds_read_b64_tr_b16 v[120:121],v22 offset:32768
v_mfma_f32_16x16x32_bf16 a[156:159],v[188:191],v[144:147],a[156:159]
v_mfma_f32_16x16x32_bf16 a[160:163],v[160:163],v[148:151],a[160:163]
ds_read_b64_tr_b16 v[122:123],v22 offset:36864
v_mfma_f32_16x16x32_bf16 a[164:167],v[164:167],v[148:151],a[164:167]
s_add_u32 s18,s18,s21
v_mfma_f32_16x16x32_bf16 a[168:171],v[168:171],v[148:151],a[168:171]
ds_read_b128 v[92:95],v12 offset:39936
v_mfma_f32_16x16x32_bf16 a[172:175],v[172:175],v[148:151],a[172:175]
s_addc_u32 s19,s19,0
v_mfma_f32_16x16x32_bf16 a[176:179],v[176:179],v[148:151],a[176:179]
ds_read_b64_tr_b16 v[124:125],v23 offset:32768
v_mfma_f32_16x16x32_bf16 a[180:183],v[180:183],v[148:151],a[180:183]
v_mfma_f32_16x16x32_bf16 a[184:187],v[184:187],v[148:151],a[184:187]
ds_read_b64_tr_b16 v[126:127],v23 offset:36864
v_mfma_f32_16x16x32_bf16 a[188:191],v[188:191],v[148:151],a[188:191]
v_mfma_f32_16x16x32_bf16 a[192:195],v[160:163],v[152:155],a[192:195]
v_mfma_f32_16x16x32_bf16 a[196:199],v[164:167],v[152:155],a[196:199]
v_mfma_f32_16x16x32_bf16 a[200:203],v[168:171],v[152:155],a[200:203]
v_mfma_f32_16x16x32_bf16 a[204:207],v[172:175],v[152:155],a[204:207]
v_mfma_f32_16x16x32_bf16 a[208:211],v[176:179],v[152:155],a[208:211]
v_mfma_f32_16x16x32_bf16 a[212:215],v[180:183],v[152:155],a[212:215]
v_mfma_f32_16x16x32_bf16 a[216:219],v[184:187],v[152:155],a[216:219]
v_mfma_f32_16x16x32_bf16 a[220:223],v[188:191],v[152:155],a[220:223]
v_mfma_f32_16x16x32_bf16 a[224:227],v[160:163],v[156:159],a[224:227]
v_mfma_f32_16x16x32_bf16 a[228:231],v[164:167],v[156:159],a[228:231]
v_mfma_f32_16x16x32_bf16 a[232:235],v[168:171],v[156:159],a[232:235]
v_mfma_f32_16x16x32_bf16 a[236:239],v[172:175],v[156:159],a[236:239]
v_mfma_f32_16x16x32_bf16 a[240:243],v[176:179],v[156:159],a[240:243]
v_mfma_f32_16x16x32_bf16 a[244:247],v[180:183],v[156:159],a[244:247]
v_mfma_f32_16x16x32_bf16 a[248:251],v[184:187],v[156:159],a[248:251]
v_mfma_f32_16x16x32_bf16 a[252:255],v[188:191],v[156:159],a[252:255]
s_waitcnt vmcnt(16) lgkmcnt(0)
s_barrier
v_mfma_f32_16x16x32_bf16 a[0:3],v[96:99],v[64:67],a[0:3]
ds_read_b128 v[128:131],v12 offset:49152
v_mfma_f32_16x16x32_bf16 a[4:7],v[100:103],v[64:67],a[4:7]
s_add_u32 m0,s23,32768
v_mfma_f32_16x16x32_bf16 a[8:11],v[104:107],v[64:67],a[8:11]
ds_read_b64_tr_b16 v[160:161],v16 offset:49152
v_mfma_f32_16x16x32_bf16 a[12:15],v[108:111],v[64:67],a[12:15]
global_load_lds_dwordx4 v4,s[16:17] offset:0 sc1
v_mfma_f32_16x16x32_bf16 a[16:19],v[112:115],v[64:67],a[16:19]
ds_read_b64_tr_b16 v[162:163],v16 offset:53248
v_mfma_f32_16x16x32_bf16 a[20:23],v[116:119],v[64:67],a[20:23]
v_mfma_f32_16x16x32_bf16 a[24:27],v[120:123],v[64:67],a[24:27]
ds_read_b128 v[132:135],v12 offset:50176
v_mfma_f32_16x16x32_bf16 a[28:31],v[124:127],v[64:67],a[28:31]
global_load_lds_dwordx4 v5,s[16:17] offset:1024 sc1
v_mfma_f32_16x16x32_bf16 a[32:35],v[96:99],v[68:71],a[32:35]
ds_read_b64_tr_b16 v[164:165],v17 offset:49152
v_mfma_f32_16x16x32_bf16 a[36:39],v[100:103],v[68:71],a[36:39]
v_mfma_f32_16x16x32_bf16 a[40:43],v[104:107],v[68:71],a[40:43]
ds_read_b64_tr_b16 v[166:167],v17 offset:53248
v_mfma_f32_16x16x32_bf16 a[44:47],v[108:111],v[68:71],a[44:47]
global_load_lds_dwordx4 v6,s[16:17] offset:2048 sc1
v_mfma_f32_16x16x32_bf16 a[48:51],v[112:115],v[68:71],a[48:51]
ds_read_b128 v[136:139],v12 offset:51200
v_mfma_f32_16x16x32_bf16 a[52:55],v[116:119],v[68:71],a[52:55]
v_mfma_f32_16x16x32_bf16 a[56:59],v[120:123],v[68:71],a[56:59]
ds_read_b64_tr_b16 v[168:169],v18 offset:49152
v_mfma_f32_16x16x32_bf16 a[60:63],v[124:127],v[68:71],a[60:63]
global_load_lds_dwordx4 v7,s[16:17] offset:3072 sc1
v_mfma_f32_16x16x32_bf16 a[64:67],v[96:99],v[72:75],a[64:67]
ds_read_b64_tr_b16 v[170:171],v18 offset:53248
v_mfma_f32_16x16x32_bf16 a[68:71],v[100:103],v[72:75],a[68:71]
v_mfma_f32_16x16x32_bf16 a[72:75],v[104:107],v[72:75],a[72:75]
ds_read_b128 v[140:143],v12 offset:52224
v_mfma_f32_16x16x32_bf16 a[76:79],v[108:111],v[72:75],a[76:79]
s_add_u32 m0,s23,98304
v_mfma_f32_16x16x32_bf16 a[80:83],v[112:115],v[72:75],a[80:83]
ds_read_b64_tr_b16 v[172:173],v19 offset:49152
v_mfma_f32_16x16x32_bf16 a[84:87],v[116:119],v[72:75],a[84:87]
s_add_u32 s16,s16,s20
v_mfma_f32_16x16x32_bf16 a[88:91],v[120:123],v[72:75],a[88:91]
ds_read_b64_tr_b16 v[174:175],v19 offset:53248
v_mfma_f32_16x16x32_bf16 a[92:95],v[124:127],v[72:75],a[92:95]
s_addc_u32 s17,s17,0
v_mfma_f32_16x16x32_bf16 a[96:99],v[96:99],v[76:79],a[96:99]
ds_read_b128 v[144:147],v12 offset:53248
v_mfma_f32_16x16x32_bf16 a[100:103],v[100:103],v[76:79],a[100:103]
global_load_lds_dwordx4 v8,s[18:19] offset:0
v_mfma_f32_16x16x32_bf16 a[104:107],v[104:107],v[76:79],a[104:107]
ds_read_b64_tr_b16 v[176:177],v20 offset:49152
v_mfma_f32_16x16x32_bf16 a[108:111],v[108:111],v[76:79],a[108:111]
v_mfma_f32_16x16x32_bf16 a[112:115],v[112:115],v[76:79],a[112:115]
ds_read_b64_tr_b16 v[178:179],v20 offset:53248
v_mfma_f32_16x16x32_bf16 a[116:119],v[116:119],v[76:79],a[116:119]
global_load_lds_dwordx4 v9,s[18:19] offset:1024
v_mfma_f32_16x16x32_bf16 a[120:123],v[120:123],v[76:79],a[120:123]
ds_read_b128 v[148:151],v12 offset:54272
v_mfma_f32_16x16x32_bf16 a[124:127],v[124:127],v[76:79],a[124:127]
v_mfma_f32_16x16x32_bf16 a[128:131],v[96:99],v[80:83],a[128:131]
ds_read_b64_tr_b16 v[180:181],v21 offset:49152
v_mfma_f32_16x16x32_bf16 a[132:135],v[100:103],v[80:83],a[132:135]
global_load_lds_dwordx4 v10,s[18:19] offset:2048
v_mfma_f32_16x16x32_bf16 a[136:139],v[104:107],v[80:83],a[136:139]
ds_read_b64_tr_b16 v[182:183],v21 offset:53248
v_mfma_f32_16x16x32_bf16 a[140:143],v[108:111],v[80:83],a[140:143]
v_mfma_f32_16x16x32_bf16 a[144:147],v[112:115],v[80:83],a[144:147]
ds_read_b128 v[152:155],v12 offset:55296
v_mfma_f32_16x16x32_bf16 a[148:151],v[116:119],v[80:83],a[148:151]
global_load_lds_dwordx4 v11,s[18:19] offset:3072
v_mfma_f32_16x16x32_bf16 a[152:155],v[120:123],v[80:83],a[152:155]
ds_read_b64_tr_b16 v[184:185],v22 offset:49152
v_mfma_f32_16x16x32_bf16 a[156:159],v[124:127],v[80:83],a[156:159]
v_mfma_f32_16x16x32_bf16 a[160:163],v[96:99],v[84:87],a[160:163]
ds_read_b64_tr_b16 v[186:187],v22 offset:53248
v_mfma_f32_16x16x32_bf16 a[164:167],v[100:103],v[84:87],a[164:167]
s_add_u32 s18,s18,s21
v_mfma_f32_16x16x32_bf16 a[168:171],v[104:107],v[84:87],a[168:171]
ds_read_b128 v[156:159],v12 offset:56320
v_mfma_f32_16x16x32_bf16 a[172:175],v[108:111],v[84:87],a[172:175]
s_addc_u32 s19,s19,0
v_mfma_f32_16x16x32_bf16 a[176:179],v[112:115],v[84:87],a[176:179]
ds_read_b64_tr_b16 v[188:189],v23 offset:49152
v_mfma_f32_16x16x32_bf16 a[180:183],v[116:119],v[84:87],a[180:183]
v_mfma_f32_16x16x32_bf16 a[184:187],v[120:123],v[84:87],a[184:187]
ds_read_b64_tr_b16 v[190:191],v23 offset:53248
v_mfma_f32_16x16x32_bf16 a[188:191],v[124:127],v[84:87],a[188:191]
v_mfma_f32_16x16x32_bf16 a[192:195],v[96:99],v[88:91],a[192:195]
v_mfma_f32_16x16x32_bf16 a[196:199],v[100:103],v[88:91],a[196:199]
v_mfma_f32_16x16x32_bf16 a[200:203],v[104:107],v[88:91],a[200:203]
v_mfma_f32_16x16x32_bf16 a[204:207],v[108:111],v[88:91],a[204:207]
v_mfma_f32_16x16x32_bf16 a[208:211],v[112:115],v[88:91],a[208:211]
v_mfma_f32_16x16x32_bf16 a[212:215],v[116:119],v[88:91],a[212:215]
v_mfma_f32_16x16x32_bf16 a[216:219],v[120:123],v[88:91],a[216:219]
v_mfma_f32_16x16x32_bf16 a[220:223],v[124:127],v[88:91],a[220:223]
v_mfma_f32_16x16x32_bf16 a[224:227],v[96:99],v[92:95],a[224:227]
v_mfma_f32_16x16x32_bf16 a[228:231],v[100:103],v[92:95],a[228:231]
v_mfma_f32_16x16x32_bf16 a[232:235],v[104:107],v[92:95],a[232:235]
v_mfma_f32_16x16x32_bf16 a[236:239],v[108:111],v[92:95],a[236:239]
v_mfma_f32_16x16x32_bf16 a[240:243],v[112:115],v[92:95],a[240:243]
v_mfma_f32_16x16x32_bf16 a[244:247],v[116:119],v[92:95],a[244:247]
v_mfma_f32_16x16x32_bf16 a[248:251],v[120:123],v[92:95],a[248:251]
v_mfma_f32_16x16x32_bf16 a[252:255],v[124:127],v[92:95],a[252:255]
s_waitcnt vmcnt(63) lgkmcnt(0)
s_barrier
v_mfma_f32_16x16x32_bf16 a[0:3],v[160:163],v[128:131],a[0:3]
v_mfma_f32_16x16x32_bf16 a[4:7],v[164:167],v[128:131],a[4:7]
s_add_u32 m0,s23,49152
v_mfma_f32_16x16x32_bf16 a[8:11],v[168:171],v[128:131],a[8:11]
v_mfma_f32_16x16x32_bf16 a[12:15],v[172:175],v[128:131],a[12:15]
global_load_lds_dwordx4 v4,s[16:17] offset:0 sc1
v_mfma_f32_16x16x32_bf16 a[16:19],v[176:179],v[128:131],a[16:19]
v_mfma_f32_16x16x32_bf16 a[20:23],v[180:183],v[128:131],a[20:23]
v_mfma_f32_16x16x32_bf16 a[24:27],v[184:187],v[128:131],a[24:27]
v_mfma_f32_16x16x32_bf16 a[28:31],v[188:191],v[128:131],a[28:31]
global_load_lds_dwordx4 v5,s[16:17] offset:1024 sc1
v_mfma_f32_16x16x32_bf16 a[32:35],v[160:163],v[132:135],a[32:35]
v_mfma_f32_16x16x32_bf16 a[36:39],v[164:167],v[132:135],a[36:39]
v_mfma_f32_16x16x32_bf16 a[40:43],v[168:171],v[132:135],a[40:43]
v_mfma_f32_16x16x32_bf16 a[44:47],v[172:175],v[132:135],a[44:47]
global_load_lds_dwordx4 v6,s[16:17] offset:2048 sc1
v_mfma_f32_16x16x32_bf16 a[48:51],v[176:179],v[132:135],a[48:51]
v_mfma_f32_16x16x32_bf16 a[52:55],v[180:183],v[132:135],a[52:55]
v_mfma_f32_16x16x32_bf16 a[56:59],v[184:187],v[132:135],a[56:59]
v_mfma_f32_16x16x32_bf16 a[60:63],v[188:191],v[132:135],a[60:63]
global_load_lds_dwordx4 v7,s[16:17] offset:3072 sc1
v_mfma_f32_16x16x32_bf16 a[64:67],v[160:163],v[136:139],a[64:67]
v_mfma_f32_16x16x32_bf16 a[68:71],v[164:167],v[136:139],a[68:71]
v_mfma_f32_16x16x32_bf16 a[72:75],v[168:171],v[136:139],a[72:75]
v_mfma_f32_16x16x32_bf16 a[76:79],v[172:175],v[136:139],a[76:79]
s_add_u32 m0,s23,114688
v_mfma_f32_16x16x32_bf16 a[80:83],v[176:179],v[136:139],a[80:83]
v_mfma_f32_16x16x32_bf16 a[84:87],v[180:183],v[136:139],a[84:87]
s_add_u32 s16,s16,s20
v_mfma_f32_16x16x32_bf16 a[88:91],v[184:187],v[136:139],a[88:91]
v_mfma_f32_16x16x32_bf16 a[92:95],v[188:191],v[136:139],a[92:95]
s_addc_u32 s17,s17,0
v_mfma_f32_16x16x32_bf16 a[96:99],v[160:163],v[140:143],a[96:99]
v_mfma_f32_16x16x32_bf16 a[100:103],v[164:167],v[140:143],a[100:103]
global_load_lds_dwordx4 v8,s[18:19] offset:0
v_mfma_f32_16x16x32_bf16 a[104:107],v[168:171],v[140:143],a[104:107]
v_mfma_f32_16x16x32_bf16 a[108:111],v[172:175],v[140:143],a[108:111]
v_mfma_f32_16x16x32_bf16 a[112:115],v[176:179],v[140:143],a[112:115]
v_mfma_f32_16x16x32_bf16 a[116:119],v[180:183],v[140:143],a[116:119]
global_load_lds_dwordx4 v9,s[18:19] offset:1024
v_mfma_f32_16x16x32_bf16 a[120:123],v[184:187],v[140:143],a[120:123]
v_mfma_f32_16x16x32_bf16 a[124:127],v[188:191],v[140:143],a[124:127]
v_mfma_f32_16x16x32_bf16 a[128:131],v[160:163],v[144:147],a[128:131]
v_mfma_f32_16x16x32_bf16 a[132:135],v[164:167],v[144:147],a[132:135]
global_load_lds_dwordx4 v10,s[18:19] offset:2048
v_mfma_f32_16x16x32_bf16 a[136:139],v[168:171],v[144:147],a[136:139]
v_mfma_f32_16x16x32_bf16 a[140:143],v[172:175],v[144:147],a[140:143]
v_mfma_f32_16x16x32_bf16 a[144:147],v[176:179],v[144:147],a[144:147]
v_mfma_f32_16x16x32_bf16 a[148:151],v[180:183],v[144:147],a[148:151]
global_load_lds_dwordx4 v11,s[18:19] offset:3072
v_mfma_f32_16x16x32_bf16 a[152:155],v[184:187],v[144:147],a[152:155]
v_mfma_f32_16x16x32_bf16 a[156:159],v[188:191],v[144:147],a[156:159]
v_mfma_f32_16x16x32_bf16 a[160:163],v[160:163],v[148:151],a[160:163]
v_mfma_f32_16x16x32_bf16 a[164:167],v[164:167],v[148:151],a[164:167]
s_add_u32 s18,s18,s21
v_mfma_f32_16x16x32_bf16 a[168:171],v[168:171],v[148:151],a[168:171]
v_mfma_f32_16x16x32_bf16 a[172:175],v[172:175],v[148:151],a[172:175]
s_addc_u32 s19,s19,0
v_mfma_f32_16x16x32_bf16 a[176:179],v[176:179],v[148:151],a[176:179]
v_mfma_f32_16x16x32_bf16 a[180:183],v[180:183],v[148:151],a[180:183]
v_mfma_f32_16x16x32_bf16 a[184:187],v[184:187],v[148:151],a[184:187]
v_mfma_f32_16x16x32_bf16 a[188:191],v[188:191],v[148:151],a[188:191]
v_mfma_f32_16x16x32_bf16 a[192:195],v[160:163],v[152:155],a[192:195]
v_mfma_f32_16x16x32_bf16 a[196:199],v[164:167],v[152:155],a[196:199]
v_mfma_f32_16x16x32_bf16 a[200:203],v[168:171],v[152:155],a[200:203]
v_mfma_f32_16x16x32_bf16 a[204:207],v[172:175],v[152:155],a[204:207]
v_mfma_f32_16x16x32_bf16 a[208:211],v[176:179],v[152:155],a[208:211]
v_mfma_f32_16x16x32_bf16 a[212:215],v[180:183],v[152:155],a[212:215]
v_mfma_f32_16x16x32_bf16 a[216:219],v[184:187],v[152:155],a[216:219]
v_mfma_f32_16x16x32_bf16 a[220:223],v[188:191],v[152:155],a[220:223]
v_mfma_f32_16x16x32_bf16 a[224:227],v[160:163],v[156:159],a[224:227]
v_mfma_f32_16x16x32_bf16 a[228:231],v[164:167],v[156:159],a[228:231]
v_mfma_f32_16x16x32_bf16 a[232:235],v[168:171],v[156:159],a[232:235]
v_mfma_f32_16x16x32_bf16 a[236:239],v[172:175],v[156:159],a[236:239]
v_mfma_f32_16x16x32_bf16 a[240:243],v[176:179],v[156:159],a[240:243]
v_mfma_f32_16x16x32_bf16 a[244:247],v[180:183],v[156:159],a[244:247]
v_mfma_f32_16x16x32_bf16 a[248:251],v[184:187],v[156:159],a[248:251]
v_mfma_f32_16x16x32_bf16 a[252:255],v[188:191],v[156:159],a[252:255]
s_cmp_eq_u32 s36,4
s_cbranch_scc1 L_e_up
s_cmp_eq_u32 s36,5
s_cbranch_scc1 L_e_db
v_accvgpr_read_b32 v32,a0
v_accvgpr_read_b32 v33,a1
v_accvgpr_read_b32 v34,a2
v_accvgpr_read_b32 v35,a3
v_accvgpr_read_b32 v36,a4
v_accvgpr_read_b32 v37,a5
v_accvgpr_read_b32 v38,a6
v_accvgpr_read_b32 v39,a7
v_cvt_pk_bf16_f32 v64,v32,v33
v_cvt_pk_bf16_f32 v65,v34,v35
v_cvt_pk_bf16_f32 v66,v36,v37
v_cvt_pk_bf16_f32 v67,v38,v39
global_store_dwordx4 v2,v[64:67],s[30:31] offset:0 sc1
v_accvgpr_read_b32 v24,a8
v_accvgpr_read_b32 v25,a9
v_accvgpr_read_b32 v26,a10
v_accvgpr_read_b32 v27,a11
v_accvgpr_read_b32 v28,a12
v_accvgpr_read_b32 v29,a13
v_accvgpr_read_b32 v30,a14
v_accvgpr_read_b32 v31,a15
v_cvt_pk_bf16_f32 v68,v24,v25
v_cvt_pk_bf16_f32 v69,v26,v27
v_cvt_pk_bf16_f32 v70,v28,v29
v_cvt_pk_bf16_f32 v71,v30,v31
global_store_dwordx4 v2,v[68:71],s[30:31] offset:1024 sc1
v_accvgpr_read_b32 v32,a16
v_accvgpr_read_b32 v33,a17
v_accvgpr_read_b32 v34,a18
v_accvgpr_read_b32 v35,a19
v_accvgpr_read_b32 v36,a20
v_accvgpr_read_b32 v37,a21
v_accvgpr_read_b32 v38,a22
v_accvgpr_read_b32 v39,a23
v_cvt_pk_bf16_f32 v72,v32,v33
v_cvt_pk_bf16_f32 v73,v34,v35
v_cvt_pk_bf16_f32 v74,v36,v37
v_cvt_pk_bf16_f32 v75,v38,v39
global_store_dwordx4 v2,v[72:75],s[30:31] offset:2048 sc1
v_accvgpr_read_b32 v24,a24
v_accvgpr_read_b32 v25,a25
v_accvgpr_read_b32 v26,a26
v_accvgpr_read_b32 v27,a27
v_accvgpr_read_b32 v28,a28
v_accvgpr_read_b32 v29,a29
v_accvgpr_read_b32 v30,a30
v_accvgpr_read_b32 v31,a31
v_cvt_pk_bf16_f32 v76,v24,v25
v_cvt_pk_bf16_f32 v77,v26,v27
v_cvt_pk_bf16_f32 v78,v28,v29
v_cvt_pk_bf16_f32 v79,v30,v31
global_store_dwordx4 v2,v[76:79],s[30:31] offset:3072 sc1
v_accvgpr_read_b32 v32,a32
v_accvgpr_read_b32 v33,a33
v_accvgpr_read_b32 v34,a34
v_accvgpr_read_b32 v35,a35
v_accvgpr_read_b32 v36,a36
v_accvgpr_read_b32 v37,a37
v_accvgpr_read_b32 v38,a38
v_accvgpr_read_b32 v39,a39
v_cvt_pk_bf16_f32 v80,v32,v33
v_cvt_pk_bf16_f32 v81,v34,v35
v_cvt_pk_bf16_f32 v82,v36,v37
v_cvt_pk_bf16_f32 v83,v38,v39
global_store_dwordx4 v3,v[80:83],s[30:31] offset:0 sc1
v_accvgpr_read_b32 v24,a40
v_accvgpr_read_b32 v25,a41
v_accvgpr_read_b32 v26,a42
v_accvgpr_read_b32 v27,a43
v_accvgpr_read_b32 v28,a44
v_accvgpr_read_b32 v29,a45
v_accvgpr_read_b32 v30,a46
v_accvgpr_read_b32 v31,a47
v_cvt_pk_bf16_f32 v84,v24,v25
v_cvt_pk_bf16_f32 v85,v26,v27
v_cvt_pk_bf16_f32 v86,v28,v29
v_cvt_pk_bf16_f32 v87,v30,v31
global_store_dwordx4 v3,v[84:87],s[30:31] offset:1024 sc1
v_accvgpr_read_b32 v32,a48
v_accvgpr_read_b32 v33,a49
v_accvgpr_read_b32 v34,a50
v_accvgpr_read_b32 v35,a51
v_accvgpr_read_b32 v36,a52
v_accvgpr_read_b32 v37,a53
v_accvgpr_read_b32 v38,a54
v_accvgpr_read_b32 v39,a55
v_cvt_pk_bf16_f32 v88,v32,v33
v_cvt_pk_bf16_f32 v89,v34,v35
v_cvt_pk_bf16_f32 v90,v36,v37
v_cvt_pk_bf16_f32 v91,v38,v39
global_store_dwordx4 v3,v[88:91],s[30:31] offset:2048 sc1
v_accvgpr_read_b32 v24,a56
v_accvgpr_read_b32 v25,a57
v_accvgpr_read_b32 v26,a58
v_accvgpr_read_b32 v27,a59
v_accvgpr_read_b32 v28,a60
v_accvgpr_read_b32 v29,a61
v_accvgpr_read_b32 v30,a62
v_accvgpr_read_b32 v31,a63
v_cvt_pk_bf16_f32 v92,v24,v25
v_cvt_pk_bf16_f32 v93,v26,v27
v_cvt_pk_bf16_f32 v94,v28,v29
v_cvt_pk_bf16_f32 v95,v30,v31
global_store_dwordx4 v3,v[92:95],s[30:31] offset:3072 sc1
s_add_u32 s30,s30,8192
s_addc_u32 s31,s31,0
v_accvgpr_read_b32 v32,a64
v_accvgpr_read_b32 v33,a65
v_accvgpr_read_b32 v34,a66
v_accvgpr_read_b32 v35,a67
v_accvgpr_read_b32 v36,a68
v_accvgpr_read_b32 v37,a69
v_accvgpr_read_b32 v38,a70
v_accvgpr_read_b32 v39,a71
v_cvt_pk_bf16_f32 v96,v32,v33
v_cvt_pk_bf16_f32 v97,v34,v35
v_cvt_pk_bf16_f32 v98,v36,v37
v_cvt_pk_bf16_f32 v99,v38,v39
global_store_dwordx4 v2,v[96:99],s[30:31] offset:0 sc1
v_accvgpr_read_b32 v24,a72
v_accvgpr_read_b32 v25,a73
v_accvgpr_read_b32 v26,a74
v_accvgpr_read_b32 v27,a75
v_accvgpr_read_b32 v28,a76
v_accvgpr_read_b32 v29,a77
v_accvgpr_read_b32 v30,a78
v_accvgpr_read_b32 v31,a79
v_cvt_pk_bf16_f32 v100,v24,v25
v_cvt_pk_bf16_f32 v101,v26,v27
v_cvt_pk_bf16_f32 v102,v28,v29
v_cvt_pk_bf16_f32 v103,v30,v31
global_store_dwordx4 v2,v[100:103],s[30:31] offset:1024 sc1
v_accvgpr_read_b32 v32,a80
v_accvgpr_read_b32 v33,a81
v_accvgpr_read_b32 v34,a82
v_accvgpr_read_b32 v35,a83
v_accvgpr_read_b32 v36,a84
v_accvgpr_read_b32 v37,a85
v_accvgpr_read_b32 v38,a86
v_accvgpr_read_b32 v39,a87
v_cvt_pk_bf16_f32 v104,v32,v33
v_cvt_pk_bf16_f32 v105,v34,v35
v_cvt_pk_bf16_f32 v106,v36,v37
v_cvt_pk_bf16_f32 v107,v38,v39
global_store_dwordx4 v2,v[104:107],s[30:31] offset:2048 sc1
v_accvgpr_read_b32 v24,a88
v_accvgpr_read_b32 v25,a89
v_accvgpr_read_b32 v26,a90
v_accvgpr_read_b32 v27,a91
v_accvgpr_read_b32 v28,a92
v_accvgpr_read_b32 v29,a93
v_accvgpr_read_b32 v30,a94
v_accvgpr_read_b32 v31,a95
v_cvt_pk_bf16_f32 v108,v24,v25
v_cvt_pk_bf16_f32 v109,v26,v27
v_cvt_pk_bf16_f32 v110,v28,v29
v_cvt_pk_bf16_f32 v111,v30,v31
global_store_dwordx4 v2,v[108:111],s[30:31] offset:3072 sc1
v_accvgpr_read_b32 v32,a96
v_accvgpr_read_b32 v33,a97
v_accvgpr_read_b32 v34,a98
v_accvgpr_read_b32 v35,a99
v_accvgpr_read_b32 v36,a100
v_accvgpr_read_b32 v37,a101
v_accvgpr_read_b32 v38,a102
v_accvgpr_read_b32 v39,a103
v_cvt_pk_bf16_f32 v112,v32,v33
v_cvt_pk_bf16_f32 v113,v34,v35
v_cvt_pk_bf16_f32 v114,v36,v37
v_cvt_pk_bf16_f32 v115,v38,v39
global_store_dwordx4 v3,v[112:115],s[30:31] offset:0 sc1
v_accvgpr_read_b32 v24,a104
v_accvgpr_read_b32 v25,a105
v_accvgpr_read_b32 v26,a106
v_accvgpr_read_b32 v27,a107
v_accvgpr_read_b32 v28,a108
v_accvgpr_read_b32 v29,a109
v_accvgpr_read_b32 v30,a110
v_accvgpr_read_b32 v31,a111
v_cvt_pk_bf16_f32 v116,v24,v25
v_cvt_pk_bf16_f32 v117,v26,v27
v_cvt_pk_bf16_f32 v118,v28,v29
v_cvt_pk_bf16_f32 v119,v30,v31
global_store_dwordx4 v3,v[116:119],s[30:31] offset:1024 sc1
v_accvgpr_read_b32 v32,a112
v_accvgpr_read_b32 v33,a113
v_accvgpr_read_b32 v34,a114
v_accvgpr_read_b32 v35,a115
v_accvgpr_read_b32 v36,a116
v_accvgpr_read_b32 v37,a117
v_accvgpr_read_b32 v38,a118
v_accvgpr_read_b32 v39,a119
v_cvt_pk_bf16_f32 v120,v32,v33
v_cvt_pk_bf16_f32 v121,v34,v35
v_cvt_pk_bf16_f32 v122,v36,v37
v_cvt_pk_bf16_f32 v123,v38,v39
global_store_dwordx4 v3,v[120:123],s[30:31] offset:2048 sc1
v_accvgpr_read_b32 v24,a120
v_accvgpr_read_b32 v25,a121
v_accvgpr_read_b32 v26,a122
v_accvgpr_read_b32 v27,a123
v_accvgpr_read_b32 v28,a124
v_accvgpr_read_b32 v29,a125
v_accvgpr_read_b32 v30,a126
v_accvgpr_read_b32 v31,a127
v_cvt_pk_bf16_f32 v124,v24,v25
v_cvt_pk_bf16_f32 v125,v26,v27
v_cvt_pk_bf16_f32 v126,v28,v29
v_cvt_pk_bf16_f32 v127,v30,v31
global_store_dwordx4 v3,v[124:127],s[30:31] offset:3072 sc1
s_add_u32 s30,s30,8192
s_addc_u32 s31,s31,0
v_accvgpr_read_b32 v32,a128
v_accvgpr_read_b32 v33,a129
v_accvgpr_read_b32 v34,a130
v_accvgpr_read_b32 v35,a131
v_accvgpr_read_b32 v36,a132
v_accvgpr_read_b32 v37,a133
v_accvgpr_read_b32 v38,a134
v_accvgpr_read_b32 v39,a135
v_cvt_pk_bf16_f32 v64,v32,v33
v_cvt_pk_bf16_f32 v65,v34,v35
v_cvt_pk_bf16_f32 v66,v36,v37
v_cvt_pk_bf16_f32 v67,v38,v39
global_store_dwordx4 v2,v[64:67],s[30:31] offset:0 sc1
v_accvgpr_read_b32 v24,a136
v_accvgpr_read_b32 v25,a137
v_accvgpr_read_b32 v26,a138
v_accvgpr_read_b32 v27,a139
v_accvgpr_read_b32 v28,a140
v_accvgpr_read_b32 v29,a141
v_accvgpr_read_b32 v30,a142
v_accvgpr_read_b32 v31,a143
v_cvt_pk_bf16_f32 v68,v24,v25
v_cvt_pk_bf16_f32 v69,v26,v27
v_cvt_pk_bf16_f32 v70,v28,v29
v_cvt_pk_bf16_f32 v71,v30,v31
global_store_dwordx4 v2,v[68:71],s[30:31] offset:1024 sc1
v_accvgpr_read_b32 v32,a144
v_accvgpr_read_b32 v33,a145
v_accvgpr_read_b32 v34,a146
v_accvgpr_read_b32 v35,a147
v_accvgpr_read_b32 v36,a148
v_accvgpr_read_b32 v37,a149
v_accvgpr_read_b32 v38,a150
v_accvgpr_read_b32 v39,a151
v_cvt_pk_bf16_f32 v72,v32,v33
v_cvt_pk_bf16_f32 v73,v34,v35
v_cvt_pk_bf16_f32 v74,v36,v37
v_cvt_pk_bf16_f32 v75,v38,v39
global_store_dwordx4 v2,v[72:75],s[30:31] offset:2048 sc1
v_accvgpr_read_b32 v24,a152
v_accvgpr_read_b32 v25,a153
v_accvgpr_read_b32 v26,a154
v_accvgpr_read_b32 v27,a155
v_accvgpr_read_b32 v28,a156
v_accvgpr_read_b32 v29,a157
v_accvgpr_read_b32 v30,a158
v_accvgpr_read_b32 v31,a159
v_cvt_pk_bf16_f32 v76,v24,v25
v_cvt_pk_bf16_f32 v77,v26,v27
v_cvt_pk_bf16_f32 v78,v28,v29
v_cvt_pk_bf16_f32 v79,v30,v31
global_store_dwordx4 v2,v[76:79],s[30:31] offset:3072 sc1
v_accvgpr_read_b32 v32,a160
v_accvgpr_read_b32 v33,a161
v_accvgpr_read_b32 v34,a162
v_accvgpr_read_b32 v35,a163
v_accvgpr_read_b32 v36,a164
v_accvgpr_read_b32 v37,a165
v_accvgpr_read_b32 v38,a166
v_accvgpr_read_b32 v39,a167
v_cvt_pk_bf16_f32 v80,v32,v33
v_cvt_pk_bf16_f32 v81,v34,v35
v_cvt_pk_bf16_f32 v82,v36,v37
v_cvt_pk_bf16_f32 v83,v38,v39
global_store_dwordx4 v3,v[80:83],s[30:31] offset:0 sc1
v_accvgpr_read_b32 v24,a168
v_accvgpr_read_b32 v25,a169
v_accvgpr_read_b32 v26,a170
v_accvgpr_read_b32 v27,a171
v_accvgpr_read_b32 v28,a172
v_accvgpr_read_b32 v29,a173
v_accvgpr_read_b32 v30,a174
v_accvgpr_read_b32 v31,a175
v_cvt_pk_bf16_f32 v84,v24,v25
v_cvt_pk_bf16_f32 v85,v26,v27
v_cvt_pk_bf16_f32 v86,v28,v29
v_cvt_pk_bf16_f32 v87,v30,v31
global_store_dwordx4 v3,v[84:87],s[30:31] offset:1024 sc1
v_accvgpr_read_b32 v32,a176
v_accvgpr_read_b32 v33,a177
v_accvgpr_read_b32 v34,a178
v_accvgpr_read_b32 v35,a179
v_accvgpr_read_b32 v36,a180
v_accvgpr_read_b32 v37,a181
v_accvgpr_read_b32 v38,a182
v_accvgpr_read_b32 v39,a183
v_cvt_pk_bf16_f32 v88,v32,v33
v_cvt_pk_bf16_f32 v89,v34,v35
v_cvt_pk_bf16_f32 v90,v36,v37
v_cvt_pk_bf16_f32 v91,v38,v39
global_store_dwordx4 v3,v[88:91],s[30:31] offset:2048 sc1
v_accvgpr_read_b32 v24,a184
v_accvgpr_read_b32 v25,a185
v_accvgpr_read_b32 v26,a186
v_accvgpr_read_b32 v27,a187
v_accvgpr_read_b32 v28,a188
v_accvgpr_read_b32 v29,a189
v_accvgpr_read_b32 v30,a190
v_accvgpr_read_b32 v31,a191
v_cvt_pk_bf16_f32 v92,v24,v25
v_cvt_pk_bf16_f32 v93,v26,v27
v_cvt_pk_bf16_f32 v94,v28,v29
v_cvt_pk_bf16_f32 v95,v30,v31
global_store_dwordx4 v3,v[92:95],s[30:31] offset:3072 sc1
s_add_u32 s30,s30,8192
s_addc_u32 s31,s31,0
v_accvgpr_read_b32 v32,a192
v_accvgpr_read_b32 v33,a193
v_accvgpr_read_b32 v34,a194
v_accvgpr_read_b32 v35,a195
v_accvgpr_read_b32 v36,a196
v_accvgpr_read_b32 v37,a197
v_accvgpr_read_b32 v38,a198
v_accvgpr_read_b32 v39,a199
v_cvt_pk_bf16_f32 v96,v32,v33
v_cvt_pk_bf16_f32 v97,v34,v35
v_cvt_pk_bf16_f32 v98,v36,v37
v_cvt_pk_bf16_f32 v99,v38,v39
global_store_dwordx4 v2,v[96:99],s[30:31] offset:0 sc1
v_accvgpr_read_b32 v24,a200
v_accvgpr_read_b32 v25,a201
v_accvgpr_read_b32 v26,a202
v_accvgpr_read_b32 v27,a203
v_accvgpr_read_b32 v28,a204
v_accvgpr_read_b32 v29,a205
v_accvgpr_read_b32 v30,a206
v_accvgpr_read_b32 v31,a207
v_cvt_pk_bf16_f32 v100,v24,v25
v_cvt_pk_bf16_f32 v101,v26,v27
v_cvt_pk_bf16_f32 v102,v28,v29
v_cvt_pk_bf16_f32 v103,v30,v31
global_store_dwordx4 v2,v[100:103],s[30:31] offset:1024 sc1
v_accvgpr_read_b32 v32,a208
v_accvgpr_read_b32 v33,a209
v_accvgpr_read_b32 v34,a210
v_accvgpr_read_b32 v35,a211
v_accvgpr_read_b32 v36,a212
v_accvgpr_read_b32 v37,a213
v_accvgpr_read_b32 v38,a214
v_accvgpr_read_b32 v39,a215
v_cvt_pk_bf16_f32 v104,v32,v33
v_cvt_pk_bf16_f32 v105,v34,v35
v_cvt_pk_bf16_f32 v106,v36,v37
v_cvt_pk_bf16_f32 v107,v38,v39
global_store_dwordx4 v2,v[104:107],s[30:31] offset:2048 sc1
v_accvgpr_read_b32 v24,a216
v_accvgpr_read_b32 v25,a217
v_accvgpr_read_b32 v26,a218
v_accvgpr_read_b32 v27,a219
v_accvgpr_read_b32 v28,a220
v_accvgpr_read_b32 v29,a221
v_accvgpr_read_b32 v30,a222
v_accvgpr_read_b32 v31,a223
v_cvt_pk_bf16_f32 v108,v24,v25
v_cvt_pk_bf16_f32 v109,v26,v27
v_cvt_pk_bf16_f32 v110,v28,v29
v_cvt_pk_bf16_f32 v111,v30,v31
global_store_dwordx4 v2,v[108:111],s[30:31] offset:3072 sc1
v_accvgpr_read_b32 v32,a224
v_accvgpr_read_b32 v33,a225
v_accvgpr_read_b32 v34,a226
v_accvgpr_read_b32 v35,a227
v_accvgpr_read_b32 v36,a228
v_accvgpr_read_b32 v37,a229
v_accvgpr_read_b32 v38,a230
v_accvgpr_read_b32 v39,a231
v_cvt_pk_bf16_f32 v112,v32,v33
v_cvt_pk_bf16_f32 v113,v34,v35
v_cvt_pk_bf16_f32 v114,v36,v37
v_cvt_pk_bf16_f32 v115,v38,v39
global_store_dwordx4 v3,v[112:115],s[30:31] offset:0 sc1
v_accvgpr_read_b32 v24,a232
v_accvgpr_read_b32 v25,a233
v_accvgpr_read_b32 v26,a234
v_accvgpr_read_b32 v27,a235
v_accvgpr_read_b32 v28,a236
v_accvgpr_read_b32 v29,a237
v_accvgpr_read_b32 v30,a238
v_accvgpr_read_b32 v31,a239
v_cvt_pk_bf16_f32 v116,v24,v25
v_cvt_pk_bf16_f32 v117,v26,v27
v_cvt_pk_bf16_f32 v118,v28,v29
v_cvt_pk_bf16_f32 v119,v30,v31
global_store_dwordx4 v3,v[116:119],s[30:31] offset:1024 sc1
v_accvgpr_read_b32 v32,a240
v_accvgpr_read_b32 v33,a241
v_accvgpr_read_b32 v34,a242
v_accvgpr_read_b32 v35,a243
v_accvgpr_read_b32 v36,a244
v_accvgpr_read_b32 v37,a245
v_accvgpr_read_b32 v38,a246
v_accvgpr_read_b32 v39,a247
v_cvt_pk_bf16_f32 v120,v32,v33
v_cvt_pk_bf16_f32 v121,v34,v35
v_cvt_pk_bf16_f32 v122,v36,v37
v_cvt_pk_bf16_f32 v123,v38,v39
global_store_dwordx4 v3,v[120:123],s[30:31] offset:2048 sc1
v_accvgpr_read_b32 v24,a248
v_accvgpr_read_b32 v25,a249
v_accvgpr_read_b32 v26,a250
v_accvgpr_read_b32 v27,a251
v_accvgpr_read_b32 v28,a252
v_accvgpr_read_b32 v29,a253
v_accvgpr_read_b32 v30,a254
v_accvgpr_read_b32 v31,a255
v_cvt_pk_bf16_f32 v124,v24,v25
v_cvt_pk_bf16_f32 v125,v26,v27
v_cvt_pk_bf16_f32 v126,v28,v29
v_cvt_pk_bf16_f32 v127,v30,v31
global_store_dwordx4 v3,v[124:127],s[30:31] offset:3072 sc1
s_lshl_b32 s54,s32,7
s_add_u32 s54,s54,94437376
v_mov_b32 v233,s54
s_cmp_eq_u32 s32,63
s_cselect_b32 s39,0,s38
s_cmp_le_u32 s36,3
s_cselect_b32 s54,2,1
s_cmp_eq_u32 s36,5
s_cselect_b32 s54,2,s54
v_mov_b32 v252,s54
s_waitcnt vmcnt(32)
s_branch L_bulk_adv
L_e_up:
v_mov_b32 v48,0xbfb8aa3b
v_mov_b32 v49,1.0
v_accvgpr_read_b32 v24,a0
v_accvgpr_read_b32 v25,a1
v_accvgpr_read_b32 v26,a2
v_accvgpr_read_b32 v27,a3
v_accvgpr_read_b32 v28,a4
v_accvgpr_read_b32 v29,a5
v_accvgpr_read_b32 v30,a6
v_accvgpr_read_b32 v31,a7
v_pk_mul_f32 v[40:41],v[24:25],v[48:49] op_sel_hi:[1,0]
v_pk_mul_f32 v[42:43],v[26:27],v[48:49] op_sel_hi:[1,0]
v_pk_mul_f32 v[44:45],v[28:29],v[48:49] op_sel_hi:[1,0]
v_pk_mul_f32 v[46:47],v[30:31],v[48:49] op_sel_hi:[1,0]
v_exp_f32 v40,v40
v_exp_f32 v41,v41
v_exp_f32 v42,v42
v_exp_f32 v43,v43
v_exp_f32 v44,v44
v_exp_f32 v45,v45
v_exp_f32 v46,v46
v_exp_f32 v47,v47
v_accvgpr_read_b32 v32,a16
v_accvgpr_read_b32 v33,a17
v_accvgpr_read_b32 v34,a18
v_accvgpr_read_b32 v35,a19
v_accvgpr_read_b32 v36,a20
v_accvgpr_read_b32 v37,a21
v_accvgpr_read_b32 v38,a22
v_accvgpr_read_b32 v39,a23
v_pk_add_f32 v[40:41],v[40:41],v[48:49] op_sel:[0,1] op_sel_hi:[1,1]
v_pk_add_f32 v[42:43],v[42:43],v[48:49] op_sel:[0,1] op_sel_hi:[1,1]
v_pk_add_f32 v[44:45],v[44:45],v[48:49] op_sel:[0,1] op_sel_hi:[1,1]
v_pk_add_f32 v[46:47],v[46:47],v[48:49] op_sel:[0,1] op_sel_hi:[1,1]
v_rcp_f32 v40,v40
v_rcp_f32 v41,v41
v_rcp_f32 v42,v42
v_rcp_f32 v43,v43
v_rcp_f32 v44,v44
v_rcp_f32 v45,v45
v_rcp_f32 v46,v46
v_rcp_f32 v47,v47
v_pk_mul_f32 v[24:25],v[24:25],v[40:41]
v_pk_mul_f32 v[26:27],v[26:27],v[42:43]
v_pk_mul_f32 v[28:29],v[28:29],v[44:45]
v_pk_mul_f32 v[30:31],v[30:31],v[46:47]
v_pk_mul_f32 v[24:25],v[24:25],v[32:33]
v_pk_mul_f32 v[26:27],v[26:27],v[34:35]
v_pk_mul_f32 v[28:29],v[28:29],v[36:37]
v_pk_mul_f32 v[30:31],v[30:31],v[38:39]
v_cvt_pk_bf16_f32 v64,v24,v25
v_cvt_pk_bf16_f32 v65,v26,v27
v_cvt_pk_bf16_f32 v66,v28,v29
v_cvt_pk_bf16_f32 v67,v30,v31
global_store_dwordx4 v2,v[64:67],s[30:31] offset:0 sc1
v_accvgpr_read_b32 v24,a8
v_accvgpr_read_b32 v25,a9
v_accvgpr_read_b32 v26,a10
v_accvgpr_read_b32 v27,a11
v_accvgpr_read_b32 v28,a12
v_accvgpr_read_b32 v29,a13
v_accvgpr_read_b32 v30,a14
v_accvgpr_read_b32 v31,a15
v_pk_mul_f32 v[40:41],v[24:25],v[48:49] op_sel_hi:[1,0]
v_pk_mul_f32 v[42:43],v[26:27],v[48:49] op_sel_hi:[1,0]
v_pk_mul_f32 v[44:45],v[28:29],v[48:49] op_sel_hi:[1,0]
v_pk_mul_f32 v[46:47],v[30:31],v[48:49] op_sel_hi:[1,0]
v_exp_f32 v40,v40
v_exp_f32 v41,v41
v_exp_f32 v42,v42
v_exp_f32 v43,v43
v_exp_f32 v44,v44
v_exp_f32 v45,v45
v_exp_f32 v46,v46
v_exp_f32 v47,v47
v_accvgpr_read_b32 v32,a24
v_accvgpr_read_b32 v33,a25
v_accvgpr_read_b32 v34,a26
v_accvgpr_read_b32 v35,a27
v_accvgpr_read_b32 v36,a28
v_accvgpr_read_b32 v37,a29
v_accvgpr_read_b32 v38,a30
v_accvgpr_read_b32 v39,a31
v_pk_add_f32 v[40:41],v[40:41],v[48:49] op_sel:[0,1] op_sel_hi:[1,1]
v_pk_add_f32 v[42:43],v[42:43],v[48:49] op_sel:[0,1] op_sel_hi:[1,1]
v_pk_add_f32 v[44:45],v[44:45],v[48:49] op_sel:[0,1] op_sel_hi:[1,1]
v_pk_add_f32 v[46:47],v[46:47],v[48:49] op_sel:[0,1] op_sel_hi:[1,1]
v_rcp_f32 v40,v40
v_rcp_f32 v41,v41
v_rcp_f32 v42,v42
v_rcp_f32 v43,v43
v_rcp_f32 v44,v44
v_rcp_f32 v45,v45
v_rcp_f32 v46,v46
v_rcp_f32 v47,v47
v_pk_mul_f32 v[24:25],v[24:25],v[40:41]
v_pk_mul_f32 v[26:27],v[26:27],v[42:43]
v_pk_mul_f32 v[28:29],v[28:29],v[44:45]
v_pk_mul_f32 v[30:31],v[30:31],v[46:47]
v_pk_mul_f32 v[24:25],v[24:25],v[32:33]
v_pk_mul_f32 v[26:27],v[26:27],v[34:35]
v_pk_mul_f32 v[28:29],v[28:29],v[36:37]
v_pk_mul_f32 v[30:31],v[30:31],v[38:39]
v_cvt_pk_bf16_f32 v68,v24,v25
v_cvt_pk_bf16_f32 v69,v26,v27
v_cvt_pk_bf16_f32 v70,v28,v29
v_cvt_pk_bf16_f32 v71,v30,v31
global_store_dwordx4 v2,v[68:71],s[30:31] offset:1024 sc1
s_add_u32 s30,s30,114688
s_addc_u32 s31,s31,0
v_accvgpr_read_b32 v24,a32
v_accvgpr_read_b32 v25,a33
v_accvgpr_read_b32 v26,a34
v_accvgpr_read_b32 v27,a35
v_accvgpr_read_b32 v28,a36
v_accvgpr_read_b32 v29,a37
v_accvgpr_read_b32 v30,a38
v_accvgpr_read_b32 v31,a39
v_pk_mul_f32 v[40:41],v[24:25],v[48:49] op_sel_hi:[1,0]
v_pk_mul_f32 v[42:43],v[26:27],v[48:49] op_sel_hi:[1,0]
v_pk_mul_f32 v[44:45],v[28:29],v[48:49] op_sel_hi:[1,0]
v_pk_mul_f32 v[46:47],v[30:31],v[48:49] op_sel_hi:[1,0]
v_exp_f32 v40,v40
v_exp_f32 v41,v41
v_exp_f32 v42,v42
v_exp_f32 v43,v43
v_exp_f32 v44,v44
v_exp_f32 v45,v45
v_exp_f32 v46,v46
v_exp_f32 v47,v47
v_accvgpr_read_b32 v32,a48
v_accvgpr_read_b32 v33,a49
v_accvgpr_read_b32 v34,a50
v_accvgpr_read_b32 v35,a51
v_accvgpr_read_b32 v36,a52
v_accvgpr_read_b32 v37,a53
v_accvgpr_read_b32 v38,a54
v_accvgpr_read_b32 v39,a55
v_pk_add_f32 v[40:41],v[40:41],v[48:49] op_sel:[0,1] op_sel_hi:[1,1]
v_pk_add_f32 v[42:43],v[42:43],v[48:49] op_sel:[0,1] op_sel_hi:[1,1]
v_pk_add_f32 v[44:45],v[44:45],v[48:49] op_sel:[0,1] op_sel_hi:[1,1]
v_pk_add_f32 v[46:47],v[46:47],v[48:49] op_sel:[0,1] op_sel_hi:[1,1]
v_rcp_f32 v40,v40
v_rcp_f32 v41,v41
v_rcp_f32 v42,v42
v_rcp_f32 v43,v43
v_rcp_f32 v44,v44
v_rcp_f32 v45,v45
v_rcp_f32 v46,v46
v_rcp_f32 v47,v47
v_pk_mul_f32 v[24:25],v[24:25],v[40:41]
v_pk_mul_f32 v[26:27],v[26:27],v[42:43]
v_pk_mul_f32 v[28:29],v[28:29],v[44:45]
v_pk_mul_f32 v[30:31],v[30:31],v[46:47]
v_pk_mul_f32 v[24:25],v[24:25],v[32:33]
v_pk_mul_f32 v[26:27],v[26:27],v[34:35]
v_pk_mul_f32 v[28:29],v[28:29],v[36:37]
v_pk_mul_f32 v[30:31],v[30:31],v[38:39]
v_cvt_pk_bf16_f32 v72,v24,v25
v_cvt_pk_bf16_f32 v73,v26,v27
v_cvt_pk_bf16_f32 v74,v28,v29
v_cvt_pk_bf16_f32 v75,v30,v31
global_store_dwordx4 v2,v[72:75],s[30:31] offset:0 sc1
v_accvgpr_read_b32 v24,a40
v_accvgpr_read_b32 v25,a41
v_accvgpr_read_b32 v26,a42
v_accvgpr_read_b32 v27,a43
v_accvgpr_read_b32 v28,a44
v_accvgpr_read_b32 v29,a45
v_accvgpr_read_b32 v30,a46
v_accvgpr_read_b32 v31,a47
v_pk_mul_f32 v[40:41],v[24:25],v[48:49] op_sel_hi:[1,0]
v_pk_mul_f32 v[42:43],v[26:27],v[48:49] op_sel_hi:[1,0]
v_pk_mul_f32 v[44:45],v[28:29],v[48:49] op_sel_hi:[1,0]
v_pk_mul_f32 v[46:47],v[30:31],v[48:49] op_sel_hi:[1,0]
v_exp_f32 v40,v40
v_exp_f32 v41,v41
v_exp_f32 v42,v42
v_exp_f32 v43,v43
v_exp_f32 v44,v44
v_exp_f32 v45,v45
v_exp_f32 v46,v46
v_exp_f32 v47,v47
v_accvgpr_read_b32 v32,a56
v_accvgpr_read_b32 v33,a57
v_accvgpr_read_b32 v34,a58
v_accvgpr_read_b32 v35,a59
v_accvgpr_read_b32 v36,a60
v_accvgpr_read_b32 v37,a61
v_accvgpr_read_b32 v38,a62
v_accvgpr_read_b32 v39,a63
v_pk_add_f32 v[40:41],v[40:41],v[48:49] op_sel:[0,1] op_sel_hi:[1,1]
v_pk_add_f32 v[42:43],v[42:43],v[48:49] op_sel:[0,1] op_sel_hi:[1,1]
v_pk_add_f32 v[44:45],v[44:45],v[48:49] op_sel:[0,1] op_sel_hi:[1,1]
v_pk_add_f32 v[46:47],v[46:47],v[48:49] op_sel:[0,1] op_sel_hi:[1,1]
v_rcp_f32 v40,v40
v_rcp_f32 v41,v41
v_rcp_f32 v42,v42
v_rcp_f32 v43,v43
v_rcp_f32 v44,v44
v_rcp_f32 v45,v45
v_rcp_f32 v46,v46
v_rcp_f32 v47,v47
v_pk_mul_f32 v[24:25],v[24:25],v[40:41]
v_pk_mul_f32 v[26:27],v[26:27],v[42:43]
v_pk_mul_f32 v[28:29],v[28:29],v[44:45]
v_pk_mul_f32 v[30:31],v[30:31],v[46:47]
v_pk_mul_f32 v[24:25],v[24:25],v[32:33]
v_pk_mul_f32 v[26:27],v[26:27],v[34:35]
v_pk_mul_f32 v[28:29],v[28:29],v[36:37]
v_pk_mul_f32 v[30:31],v[30:31],v[38:39]
v_cvt_pk_bf16_f32 v76,v24,v25
v_cvt_pk_bf16_f32 v77,v26,v27
v_cvt_pk_bf16_f32 v78,v28,v29
v_cvt_pk_bf16_f32 v79,v30,v31
global_store_dwordx4 v2,v[76:79],s[30:31] offset:1024 sc1
s_add_u32 s30,s30,114688
s_addc_u32 s31,s31,0
v_accvgpr_read_b32 v24,a64
v_accvgpr_read_b32 v25,a65
v_accvgpr_read_b32 v26,a66
v_accvgpr_read_b32 v27,a67
v_accvgpr_read_b32 v28,a68
v_accvgpr_read_b32 v29,a69
v_accvgpr_read_b32 v30,a70
v_accvgpr_read_b32 v31,a71
v_pk_mul_f32 v[40:41],v[24:25],v[48:49] op_sel_hi:[1,0]
v_pk_mul_f32 v[42:43],v[26:27],v[48:49] op_sel_hi:[1,0]
v_pk_mul_f32 v[44:45],v[28:29],v[48:49] op_sel_hi:[1,0]
v_pk_mul_f32 v[46:47],v[30:31],v[48:49] op_sel_hi:[1,0]
v_exp_f32 v40,v40
v_exp_f32 v41,v41
v_exp_f32 v42,v42
v_exp_f32 v43,v43
v_exp_f32 v44,v44
v_exp_f32 v45,v45
v_exp_f32 v46,v46
v_exp_f32 v47,v47
v_accvgpr_read_b32 v32,a80
v_accvgpr_read_b32 v33,a81
v_accvgpr_read_b32 v34,a82
v_accvgpr_read_b32 v35,a83
v_accvgpr_read_b32 v36,a84
v_accvgpr_read_b32 v37,a85
v_accvgpr_read_b32 v38,a86
v_accvgpr_read_b32 v39,a87
v_pk_add_f32 v[40:41],v[40:41],v[48:49] op_sel:[0,1] op_sel_hi:[1,1]
v_pk_add_f32 v[42:43],v[42:43],v[48:49] op_sel:[0,1] op_sel_hi:[1,1]
v_pk_add_f32 v[44:45],v[44:45],v[48:49] op_sel:[0,1] op_sel_hi:[1,1]
v_pk_add_f32 v[46:47],v[46:47],v[48:49] op_sel:[0,1] op_sel_hi:[1,1]
v_rcp_f32 v40,v40
v_rcp_f32 v41,v41
v_rcp_f32 v42,v42
v_rcp_f32 v43,v43
v_rcp_f32 v44,v44
v_rcp_f32 v45,v45
v_rcp_f32 v46,v46
v_rcp_f32 v47,v47
v_pk_mul_f32 v[24:25],v[24:25],v[40:41]
v_pk_mul_f32 v[26:27],v[26:27],v[42:43]
v_pk_mul_f32 v[28:29],v[28:29],v[44:45]
v_pk_mul_f32 v[30:31],v[30:31],v[46:47]
v_pk_mul_f32 v[24:25],v[24:25],v[32:33]
v_pk_mul_f32 v[26:27],v[26:27],v[34:35]
v_pk_mul_f32 v[28:29],v[28:29],v[36:37]
v_pk_mul_f32 v[30:31],v[30:31],v[38:39]
v_cvt_pk_bf16_f32 v80,v24,v25
v_cvt_pk_bf16_f32 v81,v26,v27
v_cvt_pk_bf16_f32 v82,v28,v29
v_cvt_pk_bf16_f32 v83,v30,v31
global_store_dwordx4 v2,v[80:83],s[30:31] offset:0 sc1
v_accvgpr_read_b32 v24,a72
v_accvgpr_read_b32 v25,a73
v_accvgpr_read_b32 v26,a74
v_accvgpr_read_b32 v27,a75
v_accvgpr_read_b32 v28,a76
v_accvgpr_read_b32 v29,a77
v_accvgpr_read_b32 v30,a78
v_accvgpr_read_b32 v31,a79
v_pk_mul_f32 v[40:41],v[24:25],v[48:49] op_sel_hi:[1,0]
v_pk_mul_f32 v[42:43],v[26:27],v[48:49] op_sel_hi:[1,0]
v_pk_mul_f32 v[44:45],v[28:29],v[48:49] op_sel_hi:[1,0]
v_pk_mul_f32 v[46:47],v[30:31],v[48:49] op_sel_hi:[1,0]
v_exp_f32 v40,v40
v_exp_f32 v41,v41
v_exp_f32 v42,v42
v_exp_f32 v43,v43
v_exp_f32 v44,v44
v_exp_f32 v45,v45
v_exp_f32 v46,v46
v_exp_f32 v47,v47
v_accvgpr_read_b32 v32,a88
v_accvgpr_read_b32 v33,a89
v_accvgpr_read_b32 v34,a90
v_accvgpr_read_b32 v35,a91
v_accvgpr_read_b32 v36,a92
v_accvgpr_read_b32 v37,a93
v_accvgpr_read_b32 v38,a94
v_accvgpr_read_b32 v39,a95
v_pk_add_f32 v[40:41],v[40:41],v[48:49] op_sel:[0,1] op_sel_hi:[1,1]
v_pk_add_f32 v[42:43],v[42:43],v[48:49] op_sel:[0,1] op_sel_hi:[1,1]
v_pk_add_f32 v[44:45],v[44:45],v[48:49] op_sel:[0,1] op_sel_hi:[1,1]
v_pk_add_f32 v[46:47],v[46:47],v[48:49] op_sel:[0,1] op_sel_hi:[1,1]
v_rcp_f32 v40,v40
v_rcp_f32 v41,v41
v_rcp_f32 v42,v42
v_rcp_f32 v43,v43
v_rcp_f32 v44,v44
v_rcp_f32 v45,v45
v_rcp_f32 v46,v46
v_rcp_f32 v47,v47
v_pk_mul_f32 v[24:25],v[24:25],v[40:41]
v_pk_mul_f32 v[26:27],v[26:27],v[42:43]
v_pk_mul_f32 v[28:29],v[28:29],v[44:45]
v_pk_mul_f32 v[30:31],v[30:31],v[46:47]
v_pk_mul_f32 v[24:25],v[24:25],v[32:33]
v_pk_mul_f32 v[26:27],v[26:27],v[34:35]
v_pk_mul_f32 v[28:29],v[28:29],v[36:37]
v_pk_mul_f32 v[30:31],v[30:31],v[38:39]
v_cvt_pk_bf16_f32 v84,v24,v25
v_cvt_pk_bf16_f32 v85,v26,v27
v_cvt_pk_bf16_f32 v86,v28,v29
v_cvt_pk_bf16_f32 v87,v30,v31
global_store_dwordx4 v2,v[84:87],s[30:31] offset:1024 sc1
s_add_u32 s30,s30,114688
s_addc_u32 s31,s31,0
v_accvgpr_read_b32 v24,a96
v_accvgpr_read_b32 v25,a97
v_accvgpr_read_b32 v26,a98
v_accvgpr_read_b32 v27,a99
v_accvgpr_read_b32 v28,a100
v_accvgpr_read_b32 v29,a101
v_accvgpr_read_b32 v30,a102
v_accvgpr_read_b32 v31,a103
v_pk_mul_f32 v[40:41],v[24:25],v[48:49] op_sel_hi:[1,0]
v_pk_mul_f32 v[42:43],v[26:27],v[48:49] op_sel_hi:[1,0]
v_pk_mul_f32 v[44:45],v[28:29],v[48:49] op_sel_hi:[1,0]
v_pk_mul_f32 v[46:47],v[30:31],v[48:49] op_sel_hi:[1,0]
v_exp_f32 v40,v40
v_exp_f32 v41,v41
v_exp_f32 v42,v42
v_exp_f32 v43,v43
v_exp_f32 v44,v44
v_exp_f32 v45,v45
v_exp_f32 v46,v46
v_exp_f32 v47,v47
v_accvgpr_read_b32 v32,a112
v_accvgpr_read_b32 v33,a113
v_accvgpr_read_b32 v34,a114
v_accvgpr_read_b32 v35,a115
v_accvgpr_read_b32 v36,a116
v_accvgpr_read_b32 v37,a117
v_accvgpr_read_b32 v38,a118
v_accvgpr_read_b32 v39,a119
v_pk_add_f32 v[40:41],v[40:41],v[48:49] op_sel:[0,1] op_sel_hi:[1,1]
v_pk_add_f32 v[42:43],v[42:43],v[48:49] op_sel:[0,1] op_sel_hi:[1,1]
v_pk_add_f32 v[44:45],v[44:45],v[48:49] op_sel:[0,1] op_sel_hi:[1,1]
v_pk_add_f32 v[46:47],v[46:47],v[48:49] op_sel:[0,1] op_sel_hi:[1,1]
v_rcp_f32 v40,v40
v_rcp_f32 v41,v41
v_rcp_f32 v42,v42
v_rcp_f32 v43,v43
v_rcp_f32 v44,v44
v_rcp_f32 v45,v45
v_rcp_f32 v46,v46
v_rcp_f32 v47,v47
v_pk_mul_f32 v[24:25],v[24:25],v[40:41]
v_pk_mul_f32 v[26:27],v[26:27],v[42:43]
v_pk_mul_f32 v[28:29],v[28:29],v[44:45]
v_pk_mul_f32 v[30:31],v[30:31],v[46:47]
v_pk_mul_f32 v[24:25],v[24:25],v[32:33]
v_pk_mul_f32 v[26:27],v[26:27],v[34:35]
v_pk_mul_f32 v[28:29],v[28:29],v[36:37]
v_pk_mul_f32 v[30:31],v[30:31],v[38:39]
v_cvt_pk_bf16_f32 v88,v24,v25
v_cvt_pk_bf16_f32 v89,v26,v27
v_cvt_pk_bf16_f32 v90,v28,v29
v_cvt_pk_bf16_f32 v91,v30,v31
global_store_dwordx4 v2,v[88:91],s[30:31] offset:0 sc1
v_accvgpr_read_b32 v24,a104
v_accvgpr_read_b32 v25,a105
v_accvgpr_read_b32 v26,a106
v_accvgpr_read_b32 v27,a107
v_accvgpr_read_b32 v28,a108
v_accvgpr_read_b32 v29,a109
v_accvgpr_read_b32 v30,a110
v_accvgpr_read_b32 v31,a111
v_pk_mul_f32 v[40:41],v[24:25],v[48:49] op_sel_hi:[1,0]
v_pk_mul_f32 v[42:43],v[26:27],v[48:49] op_sel_hi:[1,0]
v_pk_mul_f32 v[44:45],v[28:29],v[48:49] op_sel_hi:[1,0]
v_pk_mul_f32 v[46:47],v[30:31],v[48:49] op_sel_hi:[1,0]
v_exp_f32 v40,v40
v_exp_f32 v41,v41
v_exp_f32 v42,v42
v_exp_f32 v43,v43
v_exp_f32 v44,v44
v_exp_f32 v45,v45
v_exp_f32 v46,v46
v_exp_f32 v47,v47
v_accvgpr_read_b32 v32,a120
v_accvgpr_read_b32 v33,a121
v_accvgpr_read_b32 v34,a122
v_accvgpr_read_b32 v35,a123
v_accvgpr_read_b32 v36,a124
v_accvgpr_read_b32 v37,a125
v_accvgpr_read_b32 v38,a126
v_accvgpr_read_b32 v39,a127
v_pk_add_f32 v[40:41],v[40:41],v[48:49] op_sel:[0,1] op_sel_hi:[1,1]
v_pk_add_f32 v[42:43],v[42:43],v[48:49] op_sel:[0,1] op_sel_hi:[1,1]
v_pk_add_f32 v[44:45],v[44:45],v[48:49] op_sel:[0,1] op_sel_hi:[1,1]
v_pk_add_f32 v[46:47],v[46:47],v[48:49] op_sel:[0,1] op_sel_hi:[1,1]
v_rcp_f32 v40,v40
v_rcp_f32 v41,v41
v_rcp_f32 v42,v42
v_rcp_f32 v43,v43
v_rcp_f32 v44,v44
v_rcp_f32 v45,v45
v_rcp_f32 v46,v46
v_rcp_f32 v47,v47
v_pk_mul_f32 v[24:25],v[24:25],v[40:41]
v_pk_mul_f32 v[26:27],v[26:27],v[42:43]
v_pk_mul_f32 v[28:29],v[28:29],v[44:45]
v_pk_mul_f32 v[30:31],v[30:31],v[46:47]
v_pk_mul_f32 v[24:25],v[24:25],v[32:33]
v_pk_mul_f32 v[26:27],v[26:27],v[34:35]
v_pk_mul_f32 v[28:29],v[28:29],v[36:37]
v_pk_mul_f32 v[30:31],v[30:31],v[38:39]
v_cvt_pk_bf16_f32 v92,v24,v25
v_cvt_pk_bf16_f32 v93,v26,v27
v_cvt_pk_bf16_f32 v94,v28,v29
v_cvt_pk_bf16_f32 v95,v30,v31
global_store_dwordx4 v2,v[92:95],s[30:31] offset:1024 sc1
s_add_u32 s30,s30,114688
s_addc_u32 s31,s31,0
v_accvgpr_read_b32 v24,a128
v_accvgpr_read_b32 v25,a129
v_accvgpr_read_b32 v26,a130
v_accvgpr_read_b32 v27,a131
v_accvgpr_read_b32 v28,a132
v_accvgpr_read_b32 v29,a133
v_accvgpr_read_b32 v30,a134
v_accvgpr_read_b32 v31,a135
v_pk_mul_f32 v[40:41],v[24:25],v[48:49] op_sel_hi:[1,0]
v_pk_mul_f32 v[42:43],v[26:27],v[48:49] op_sel_hi:[1,0]
v_pk_mul_f32 v[44:45],v[28:29],v[48:49] op_sel_hi:[1,0]
v_pk_mul_f32 v[46:47],v[30:31],v[48:49] op_sel_hi:[1,0]
v_exp_f32 v40,v40
v_exp_f32 v41,v41
v_exp_f32 v42,v42
v_exp_f32 v43,v43
v_exp_f32 v44,v44
v_exp_f32 v45,v45
v_exp_f32 v46,v46
v_exp_f32 v47,v47
v_accvgpr_read_b32 v32,a144
v_accvgpr_read_b32 v33,a145
v_accvgpr_read_b32 v34,a146
v_accvgpr_read_b32 v35,a147
v_accvgpr_read_b32 v36,a148
v_accvgpr_read_b32 v37,a149
v_accvgpr_read_b32 v38,a150
v_accvgpr_read_b32 v39,a151
v_pk_add_f32 v[40:41],v[40:41],v[48:49] op_sel:[0,1] op_sel_hi:[1,1]
v_pk_add_f32 v[42:43],v[42:43],v[48:49] op_sel:[0,1] op_sel_hi:[1,1]
v_pk_add_f32 v[44:45],v[44:45],v[48:49] op_sel:[0,1] op_sel_hi:[1,1]
v_pk_add_f32 v[46:47],v[46:47],v[48:49] op_sel:[0,1] op_sel_hi:[1,1]
v_rcp_f32 v40,v40
v_rcp_f32 v41,v41
v_rcp_f32 v42,v42
v_rcp_f32 v43,v43
v_rcp_f32 v44,v44
v_rcp_f32 v45,v45
v_rcp_f32 v46,v46
v_rcp_f32 v47,v47
v_pk_mul_f32 v[24:25],v[24:25],v[40:41]
v_pk_mul_f32 v[26:27],v[26:27],v[42:43]
v_pk_mul_f32 v[28:29],v[28:29],v[44:45]
v_pk_mul_f32 v[30:31],v[30:31],v[46:47]
v_pk_mul_f32 v[24:25],v[24:25],v[32:33]
v_pk_mul_f32 v[26:27],v[26:27],v[34:35]
v_pk_mul_f32 v[28:29],v[28:29],v[36:37]
v_pk_mul_f32 v[30:31],v[30:31],v[38:39]
v_cvt_pk_bf16_f32 v96,v24,v25
v_cvt_pk_bf16_f32 v97,v26,v27
v_cvt_pk_bf16_f32 v98,v28,v29
v_cvt_pk_bf16_f32 v99,v30,v31
global_store_dwordx4 v2,v[96:99],s[30:31] offset:0 sc1
v_accvgpr_read_b32 v24,a136
v_accvgpr_read_b32 v25,a137
v_accvgpr_read_b32 v26,a138
v_accvgpr_read_b32 v27,a139
v_accvgpr_read_b32 v28,a140
v_accvgpr_read_b32 v29,a141
v_accvgpr_read_b32 v30,a142
v_accvgpr_read_b32 v31,a143
v_pk_mul_f32 v[40:41],v[24:25],v[48:49] op_sel_hi:[1,0]
v_pk_mul_f32 v[42:43],v[26:27],v[48:49] op_sel_hi:[1,0]
v_pk_mul_f32 v[44:45],v[28:29],v[48:49] op_sel_hi:[1,0]
v_pk_mul_f32 v[46:47],v[30:31],v[48:49] op_sel_hi:[1,0]
v_exp_f32 v40,v40
v_exp_f32 v41,v41
v_exp_f32 v42,v42
v_exp_f32 v43,v43
v_exp_f32 v44,v44
v_exp_f32 v45,v45
v_exp_f32 v46,v46
v_exp_f32 v47,v47
v_accvgpr_read_b32 v32,a152
v_accvgpr_read_b32 v33,a153
v_accvgpr_read_b32 v34,a154
v_accvgpr_read_b32 v35,a155
v_accvgpr_read_b32 v36,a156
v_accvgpr_read_b32 v37,a157
v_accvgpr_read_b32 v38,a158
v_accvgpr_read_b32 v39,a159
v_pk_add_f32 v[40:41],v[40:41],v[48:49] op_sel:[0,1] op_sel_hi:[1,1]
v_pk_add_f32 v[42:43],v[42:43],v[48:49] op_sel:[0,1] op_sel_hi:[1,1]
v_pk_add_f32 v[44:45],v[44:45],v[48:49] op_sel:[0,1] op_sel_hi:[1,1]
v_pk_add_f32 v[46:47],v[46:47],v[48:49] op_sel:[0,1] op_sel_hi:[1,1]
v_rcp_f32 v40,v40
v_rcp_f32 v41,v41
v_rcp_f32 v42,v42
v_rcp_f32 v43,v43
v_rcp_f32 v44,v44
v_rcp_f32 v45,v45
v_rcp_f32 v46,v46
v_rcp_f32 v47,v47
v_pk_mul_f32 v[24:25],v[24:25],v[40:41]
v_pk_mul_f32 v[26:27],v[26:27],v[42:43]
v_pk_mul_f32 v[28:29],v[28:29],v[44:45]
v_pk_mul_f32 v[30:31],v[30:31],v[46:47]
v_pk_mul_f32 v[24:25],v[24:25],v[32:33]
v_pk_mul_f32 v[26:27],v[26:27],v[34:35]
v_pk_mul_f32 v[28:29],v[28:29],v[36:37]
v_pk_mul_f32 v[30:31],v[30:31],v[38:39]
v_cvt_pk_bf16_f32 v100,v24,v25
v_cvt_pk_bf16_f32 v101,v26,v27
v_cvt_pk_bf16_f32 v102,v28,v29
v_cvt_pk_bf16_f32 v103,v30,v31
global_store_dwordx4 v2,v[100:103],s[30:31] offset:1024 sc1
s_add_u32 s30,s30,114688
s_addc_u32 s31,s31,0
v_accvgpr_read_b32 v24,a160
v_accvgpr_read_b32 v25,a161
v_accvgpr_read_b32 v26,a162
v_accvgpr_read_b32 v27,a163
v_accvgpr_read_b32 v28,a164
v_accvgpr_read_b32 v29,a165
v_accvgpr_read_b32 v30,a166
v_accvgpr_read_b32 v31,a167
v_pk_mul_f32 v[40:41],v[24:25],v[48:49] op_sel_hi:[1,0]
v_pk_mul_f32 v[42:43],v[26:27],v[48:49] op_sel_hi:[1,0]
v_pk_mul_f32 v[44:45],v[28:29],v[48:49] op_sel_hi:[1,0]
v_pk_mul_f32 v[46:47],v[30:31],v[48:49] op_sel_hi:[1,0]
v_exp_f32 v40,v40
v_exp_f32 v41,v41
v_exp_f32 v42,v42
v_exp_f32 v43,v43
v_exp_f32 v44,v44
v_exp_f32 v45,v45
v_exp_f32 v46,v46
v_exp_f32 v47,v47
v_accvgpr_read_b32 v32,a176
v_accvgpr_read_b32 v33,a177
v_accvgpr_read_b32 v34,a178
v_accvgpr_read_b32 v35,a179
v_accvgpr_read_b32 v36,a180
v_accvgpr_read_b32 v37,a181
v_accvgpr_read_b32 v38,a182
v_accvgpr_read_b32 v39,a183
v_pk_add_f32 v[40:41],v[40:41],v[48:49] op_sel:[0,1] op_sel_hi:[1,1]
v_pk_add_f32 v[42:43],v[42:43],v[48:49] op_sel:[0,1] op_sel_hi:[1,1]
v_pk_add_f32 v[44:45],v[44:45],v[48:49] op_sel:[0,1] op_sel_hi:[1,1]
v_pk_add_f32 v[46:47],v[46:47],v[48:49] op_sel:[0,1] op_sel_hi:[1,1]
v_rcp_f32 v40,v40
v_rcp_f32 v41,v41
v_rcp_f32 v42,v42
v_rcp_f32 v43,v43
v_rcp_f32 v44,v44
v_rcp_f32 v45,v45
v_rcp_f32 v46,v46
v_rcp_f32 v47,v47
v_pk_mul_f32 v[24:25],v[24:25],v[40:41]
v_pk_mul_f32 v[26:27],v[26:27],v[42:43]
v_pk_mul_f32 v[28:29],v[28:29],v[44:45]
v_pk_mul_f32 v[30:31],v[30:31],v[46:47]
v_pk_mul_f32 v[24:25],v[24:25],v[32:33]
v_pk_mul_f32 v[26:27],v[26:27],v[34:35]
v_pk_mul_f32 v[28:29],v[28:29],v[36:37]
v_pk_mul_f32 v[30:31],v[30:31],v[38:39]
v_cvt_pk_bf16_f32 v104,v24,v25
v_cvt_pk_bf16_f32 v105,v26,v27
v_cvt_pk_bf16_f32 v106,v28,v29
v_cvt_pk_bf16_f32 v107,v30,v31
global_store_dwordx4 v2,v[104:107],s[30:31] offset:0 sc1
v_accvgpr_read_b32 v24,a168
v_accvgpr_read_b32 v25,a169
v_accvgpr_read_b32 v26,a170
v_accvgpr_read_b32 v27,a171
v_accvgpr_read_b32 v28,a172
v_accvgpr_read_b32 v29,a173
v_accvgpr_read_b32 v30,a174
v_accvgpr_read_b32 v31,a175
v_pk_mul_f32 v[40:41],v[24:25],v[48:49] op_sel_hi:[1,0]
v_pk_mul_f32 v[42:43],v[26:27],v[48:49] op_sel_hi:[1,0]
v_pk_mul_f32 v[44:45],v[28:29],v[48:49] op_sel_hi:[1,0]
v_pk_mul_f32 v[46:47],v[30:31],v[48:49] op_sel_hi:[1,0]
v_exp_f32 v40,v40
v_exp_f32 v41,v41
v_exp_f32 v42,v42
v_exp_f32 v43,v43
v_exp_f32 v44,v44
v_exp_f32 v45,v45
v_exp_f32 v46,v46
v_exp_f32 v47,v47
v_accvgpr_read_b32 v32,a184
v_accvgpr_read_b32 v33,a185
v_accvgpr_read_b32 v34,a186
v_accvgpr_read_b32 v35,a187
v_accvgpr_read_b32 v36,a188
v_accvgpr_read_b32 v37,a189
v_accvgpr_read_b32 v38,a190
v_accvgpr_read_b32 v39,a191
v_pk_add_f32 v[40:41],v[40:41],v[48:49] op_sel:[0,1] op_sel_hi:[1,1]
v_pk_add_f32 v[42:43],v[42:43],v[48:49] op_sel:[0,1] op_sel_hi:[1,1]
v_pk_add_f32 v[44:45],v[44:45],v[48:49] op_sel:[0,1] op_sel_hi:[1,1]
v_pk_add_f32 v[46:47],v[46:47],v[48:49] op_sel:[0,1] op_sel_hi:[1,1]
v_rcp_f32 v40,v40
v_rcp_f32 v41,v41
v_rcp_f32 v42,v42
v_rcp_f32 v43,v43
v_rcp_f32 v44,v44
v_rcp_f32 v45,v45
v_rcp_f32 v46,v46
v_rcp_f32 v47,v47
v_pk_mul_f32 v[24:25],v[24:25],v[40:41]
v_pk_mul_f32 v[26:27],v[26:27],v[42:43]
v_pk_mul_f32 v[28:29],v[28:29],v[44:45]
v_pk_mul_f32 v[30:31],v[30:31],v[46:47]
v_pk_mul_f32 v[24:25],v[24:25],v[32:33]
v_pk_mul_f32 v[26:27],v[26:27],v[34:35]
v_pk_mul_f32 v[28:29],v[28:29],v[36:37]
v_pk_mul_f32 v[30:31],v[30:31],v[38:39]
v_cvt_pk_bf16_f32 v108,v24,v25
v_cvt_pk_bf16_f32 v109,v26,v27
v_cvt_pk_bf16_f32 v110,v28,v29
v_cvt_pk_bf16_f32 v111,v30,v31
global_store_dwordx4 v2,v[108:111],s[30:31] offset:1024 sc1
s_add_u32 s30,s30,114688
s_addc_u32 s31,s31,0
v_accvgpr_read_b32 v24,a192
v_accvgpr_read_b32 v25,a193
v_accvgpr_read_b32 v26,a194
v_accvgpr_read_b32 v27,a195
v_accvgpr_read_b32 v28,a196
v_accvgpr_read_b32 v29,a197
v_accvgpr_read_b32 v30,a198
v_accvgpr_read_b32 v31,a199
v_pk_mul_f32 v[40:41],v[24:25],v[48:49] op_sel_hi:[1,0]
v_pk_mul_f32 v[42:43],v[26:27],v[48:49] op_sel_hi:[1,0]
v_pk_mul_f32 v[44:45],v[28:29],v[48:49] op_sel_hi:[1,0]
v_pk_mul_f32 v[46:47],v[30:31],v[48:49] op_sel_hi:[1,0]
v_exp_f32 v40,v40
v_exp_f32 v41,v41
v_exp_f32 v42,v42
v_exp_f32 v43,v43
v_exp_f32 v44,v44
v_exp_f32 v45,v45
v_exp_f32 v46,v46
v_exp_f32 v47,v47
v_accvgpr_read_b32 v32,a208
v_accvgpr_read_b32 v33,a209
v_accvgpr_read_b32 v34,a210
v_accvgpr_read_b32 v35,a211
v_accvgpr_read_b32 v36,a212
v_accvgpr_read_b32 v37,a213
v_accvgpr_read_b32 v38,a214
v_accvgpr_read_b32 v39,a215
v_pk_add_f32 v[40:41],v[40:41],v[48:49] op_sel:[0,1] op_sel_hi:[1,1]
v_pk_add_f32 v[42:43],v[42:43],v[48:49] op_sel:[0,1] op_sel_hi:[1,1]
v_pk_add_f32 v[44:45],v[44:45],v[48:49] op_sel:[0,1] op_sel_hi:[1,1]
v_pk_add_f32 v[46:47],v[46:47],v[48:49] op_sel:[0,1] op_sel_hi:[1,1]
v_rcp_f32 v40,v40
v_rcp_f32 v41,v41
v_rcp_f32 v42,v42
v_rcp_f32 v43,v43
v_rcp_f32 v44,v44
v_rcp_f32 v45,v45
v_rcp_f32 v46,v46
v_rcp_f32 v47,v47
v_pk_mul_f32 v[24:25],v[24:25],v[40:41]
v_pk_mul_f32 v[26:27],v[26:27],v[42:43]
v_pk_mul_f32 v[28:29],v[28:29],v[44:45]
v_pk_mul_f32 v[30:31],v[30:31],v[46:47]
v_pk_mul_f32 v[24:25],v[24:25],v[32:33]
v_pk_mul_f32 v[26:27],v[26:27],v[34:35]
v_pk_mul_f32 v[28:29],v[28:29],v[36:37]
v_pk_mul_f32 v[30:31],v[30:31],v[38:39]
v_cvt_pk_bf16_f32 v112,v24,v25
v_cvt_pk_bf16_f32 v113,v26,v27
v_cvt_pk_bf16_f32 v114,v28,v29
v_cvt_pk_bf16_f32 v115,v30,v31
global_store_dwordx4 v2,v[112:115],s[30:31] offset:0 sc1
v_accvgpr_read_b32 v24,a200
v_accvgpr_read_b32 v25,a201
v_accvgpr_read_b32 v26,a202
v_accvgpr_read_b32 v27,a203
v_accvgpr_read_b32 v28,a204
v_accvgpr_read_b32 v29,a205
v_accvgpr_read_b32 v30,a206
v_accvgpr_read_b32 v31,a207
v_pk_mul_f32 v[40:41],v[24:25],v[48:49] op_sel_hi:[1,0]
v_pk_mul_f32 v[42:43],v[26:27],v[48:49] op_sel_hi:[1,0]
v_pk_mul_f32 v[44:45],v[28:29],v[48:49] op_sel_hi:[1,0]
v_pk_mul_f32 v[46:47],v[30:31],v[48:49] op_sel_hi:[1,0]
v_exp_f32 v40,v40
v_exp_f32 v41,v41
v_exp_f32 v42,v42
v_exp_f32 v43,v43
v_exp_f32 v44,v44
v_exp_f32 v45,v45
v_exp_f32 v46,v46
v_exp_f32 v47,v47
v_accvgpr_read_b32 v32,a216
v_accvgpr_read_b32 v33,a217
v_accvgpr_read_b32 v34,a218
v_accvgpr_read_b32 v35,a219
v_accvgpr_read_b32 v36,a220
v_accvgpr_read_b32 v37,a221
v_accvgpr_read_b32 v38,a222
v_accvgpr_read_b32 v39,a223
v_pk_add_f32 v[40:41],v[40:41],v[48:49] op_sel:[0,1] op_sel_hi:[1,1]
v_pk_add_f32 v[42:43],v[42:43],v[48:49] op_sel:[0,1] op_sel_hi:[1,1]
v_pk_add_f32 v[44:45],v[44:45],v[48:49] op_sel:[0,1] op_sel_hi:[1,1]
v_pk_add_f32 v[46:47],v[46:47],v[48:49] op_sel:[0,1] op_sel_hi:[1,1]
v_rcp_f32 v40,v40
v_rcp_f32 v41,v41
v_rcp_f32 v42,v42
v_rcp_f32 v43,v43
v_rcp_f32 v44,v44
v_rcp_f32 v45,v45
v_rcp_f32 v46,v46
v_rcp_f32 v47,v47
v_pk_mul_f32 v[24:25],v[24:25],v[40:41]
v_pk_mul_f32 v[26:27],v[26:27],v[42:43]
v_pk_mul_f32 v[28:29],v[28:29],v[44:45]
v_pk_mul_f32 v[30:31],v[30:31],v[46:47]
v_pk_mul_f32 v[24:25],v[24:25],v[32:33]
v_pk_mul_f32 v[26:27],v[26:27],v[34:35]
v_pk_mul_f32 v[28:29],v[28:29],v[36:37]
v_pk_mul_f32 v[30:31],v[30:31],v[38:39]
v_cvt_pk_bf16_f32 v116,v24,v25
v_cvt_pk_bf16_f32 v117,v26,v27
v_cvt_pk_bf16_f32 v118,v28,v29
v_cvt_pk_bf16_f32 v119,v30,v31
global_store_dwordx4 v2,v[116:119],s[30:31] offset:1024 sc1
s_add_u32 s30,s30,114688
s_addc_u32 s31,s31,0
v_accvgpr_read_b32 v24,a224
v_accvgpr_read_b32 v25,a225
v_accvgpr_read_b32 v26,a226
v_accvgpr_read_b32 v27,a227
v_accvgpr_read_b32 v28,a228
v_accvgpr_read_b32 v29,a229
v_accvgpr_read_b32 v30,a230
v_accvgpr_read_b32 v31,a231
v_pk_mul_f32 v[40:41],v[24:25],v[48:49] op_sel_hi:[1,0]
v_pk_mul_f32 v[42:43],v[26:27],v[48:49] op_sel_hi:[1,0]
v_pk_mul_f32 v[44:45],v[28:29],v[48:49] op_sel_hi:[1,0]
v_pk_mul_f32 v[46:47],v[30:31],v[48:49] op_sel_hi:[1,0]
v_exp_f32 v40,v40
v_exp_f32 v41,v41
v_exp_f32 v42,v42
v_exp_f32 v43,v43
v_exp_f32 v44,v44
v_exp_f32 v45,v45
v_exp_f32 v46,v46
v_exp_f32 v47,v47
v_accvgpr_read_b32 v32,a240
v_accvgpr_read_b32 v33,a241
v_accvgpr_read_b32 v34,a242
v_accvgpr_read_b32 v35,a243
v_accvgpr_read_b32 v36,a244
v_accvgpr_read_b32 v37,a245
v_accvgpr_read_b32 v38,a246
v_accvgpr_read_b32 v39,a247
v_pk_add_f32 v[40:41],v[40:41],v[48:49] op_sel:[0,1] op_sel_hi:[1,1]
v_pk_add_f32 v[42:43],v[42:43],v[48:49] op_sel:[0,1] op_sel_hi:[1,1]
v_pk_add_f32 v[44:45],v[44:45],v[48:49] op_sel:[0,1] op_sel_hi:[1,1]
v_pk_add_f32 v[46:47],v[46:47],v[48:49] op_sel:[0,1] op_sel_hi:[1,1]
v_rcp_f32 v40,v40
v_rcp_f32 v41,v41
v_rcp_f32 v42,v42
v_rcp_f32 v43,v43
v_rcp_f32 v44,v44
v_rcp_f32 v45,v45
v_rcp_f32 v46,v46
v_rcp_f32 v47,v47
v_pk_mul_f32 v[24:25],v[24:25],v[40:41]
v_pk_mul_f32 v[26:27],v[26:27],v[42:43]
v_pk_mul_f32 v[28:29],v[28:29],v[44:45]
v_pk_mul_f32 v[30:31],v[30:31],v[46:47]
v_pk_mul_f32 v[24:25],v[24:25],v[32:33]
v_pk_mul_f32 v[26:27],v[26:27],v[34:35]
v_pk_mul_f32 v[28:29],v[28:29],v[36:37]
v_pk_mul_f32 v[30:31],v[30:31],v[38:39]
v_cvt_pk_bf16_f32 v120,v24,v25
v_cvt_pk_bf16_f32 v121,v26,v27
v_cvt_pk_bf16_f32 v122,v28,v29
v_cvt_pk_bf16_f32 v123,v30,v31
global_store_dwordx4 v2,v[120:123],s[30:31] offset:0 sc1
v_accvgpr_read_b32 v24,a232
v_accvgpr_read_b32 v25,a233
v_accvgpr_read_b32 v26,a234
v_accvgpr_read_b32 v27,a235
v_accvgpr_read_b32 v28,a236
v_accvgpr_read_b32 v29,a237
v_accvgpr_read_b32 v30,a238
v_accvgpr_read_b32 v31,a239
v_pk_mul_f32 v[40:41],v[24:25],v[48:49] op_sel_hi:[1,0]
v_pk_mul_f32 v[42:43],v[26:27],v[48:49] op_sel_hi:[1,0]
v_pk_mul_f32 v[44:45],v[28:29],v[48:49] op_sel_hi:[1,0]
v_pk_mul_f32 v[46:47],v[30:31],v[48:49] op_sel_hi:[1,0]
v_exp_f32 v40,v40
v_exp_f32 v41,v41
v_exp_f32 v42,v42
v_exp_f32 v43,v43
v_exp_f32 v44,v44
v_exp_f32 v45,v45
v_exp_f32 v46,v46
v_exp_f32 v47,v47
v_accvgpr_read_b32 v32,a248
v_accvgpr_read_b32 v33,a249
v_accvgpr_read_b32 v34,a250
v_accvgpr_read_b32 v35,a251
v_accvgpr_read_b32 v36,a252
v_accvgpr_read_b32 v37,a253
v_accvgpr_read_b32 v38,a254
v_accvgpr_read_b32 v39,a255
v_pk_add_f32 v[40:41],v[40:41],v[48:49] op_sel:[0,1] op_sel_hi:[1,1]
v_pk_add_f32 v[42:43],v[42:43],v[48:49] op_sel:[0,1] op_sel_hi:[1,1]
v_pk_add_f32 v[44:45],v[44:45],v[48:49] op_sel:[0,1] op_sel_hi:[1,1]
v_pk_add_f32 v[46:47],v[46:47],v[48:49] op_sel:[0,1] op_sel_hi:[1,1]
v_rcp_f32 v40,v40
v_rcp_f32 v41,v41
v_rcp_f32 v42,v42
v_rcp_f32 v43,v43
v_rcp_f32 v44,v44
v_rcp_f32 v45,v45
v_rcp_f32 v46,v46
v_rcp_f32 v47,v47
v_pk_mul_f32 v[24:25],v[24:25],v[40:41]
v_pk_mul_f32 v[26:27],v[26:27],v[42:43]
v_pk_mul_f32 v[28:29],v[28:29],v[44:45]
v_pk_mul_f32 v[30:31],v[30:31],v[46:47]
v_pk_mul_f32 v[24:25],v[24:25],v[32:33]
v_pk_mul_f32 v[26:27],v[26:27],v[34:35]
v_pk_mul_f32 v[28:29],v[28:29],v[36:37]
v_pk_mul_f32 v[30:31],v[30:31],v[38:39]
v_cvt_pk_bf16_f32 v124,v24,v25
v_cvt_pk_bf16_f32 v125,v26,v27
v_cvt_pk_bf16_f32 v126,v28,v29
v_cvt_pk_bf16_f32 v127,v30,v31
global_store_dwordx4 v2,v[124:127],s[30:31] offset:1024 sc1
s_lshl_b32 s54,s32,7
s_add_u32 s54,s54,94437376
v_mov_b32 v233,s54
s_cmp_eq_u32 s32,63
s_cselect_b32 s39,0,s38
s_cmp_le_u32 s36,3
s_cselect_b32 s54,2,1
s_cmp_eq_u32 s36,5
s_cselect_b32 s54,2,s54
v_mov_b32 v252,s54
s_waitcnt vmcnt(16)
s_branch L_bulk_adv
L_e_db:
global_load_dwordx2 v[160:161],v237,s[44:45] offset:0 sc1
global_load_dwordx2 v[162:163],v237,s[44:45] offset:128 sc1
global_load_dwordx2 v[164:165],v237,s[44:45] offset:256 sc1
global_load_dwordx2 v[166:167],v237,s[44:45] offset:384 sc1
global_load_dwordx2 v[168:169],v237,s[44:45] offset:512 sc1
global_load_dwordx2 v[170:171],v237,s[44:45] offset:640 sc1
global_load_dwordx2 v[172:173],v237,s[44:45] offset:768 sc1
global_load_dwordx2 v[174:175],v237,s[44:45] offset:896 sc1
s_waitcnt vmcnt(0)
v_accvgpr_read_b32 v24,a0
v_accvgpr_read_b32 v25,a1
v_accvgpr_read_b32 v26,a2
v_accvgpr_read_b32 v27,a3
v_accvgpr_read_b32 v28,a4
v_accvgpr_read_b32 v29,a5
v_accvgpr_read_b32 v30,a6
v_accvgpr_read_b32 v31,a7
v_cvt_pk_bf16_f32 v32,v24,v25
v_cvt_pk_bf16_f32 v33,v26,v27
v_cvt_pk_bf16_f32 v34,v28,v29
v_cvt_pk_bf16_f32 v35,v30,v31
v_lshlrev_b32 v24,16,v32
v_and_b32 v25,0xffff0000,v32
v_lshlrev_b32 v26,16,v33
v_and_b32 v27,0xffff0000,v33
v_lshlrev_b32 v28,16,v34
v_and_b32 v29,0xffff0000,v34
v_lshlrev_b32 v30,16,v35
v_and_b32 v31,0xffff0000,v35
v_pk_mul_f32 v[24:25],v[24:25],v[160:161] op_sel:[0,1] op_sel_hi:[1,1]
v_pk_mul_f32 v[26:27],v[26:27],v[160:161] op_sel:[0,1] op_sel_hi:[1,1]
v_pk_mul_f32 v[28:29],v[28:29],v[160:161] op_sel:[0,1] op_sel_hi:[1,1]
v_pk_mul_f32 v[30:31],v[30:31],v[160:161] op_sel:[0,1] op_sel_hi:[1,1]
v_cvt_pk_bf16_f32 v64,v24,v25
v_cvt_pk_bf16_f32 v65,v26,v27
v_cvt_pk_bf16_f32 v66,v28,v29
v_cvt_pk_bf16_f32 v67,v30,v31
global_store_dwordx4 v2,v[64:67],s[30:31] offset:0 sc1
v_accvgpr_read_b32 v24,a8
v_accvgpr_read_b32 v25,a9
v_accvgpr_read_b32 v26,a10
v_accvgpr_read_b32 v27,a11
v_accvgpr_read_b32 v28,a12
v_accvgpr_read_b32 v29,a13
v_accvgpr_read_b32 v30,a14
v_accvgpr_read_b32 v31,a15
v_cvt_pk_bf16_f32 v32,v24,v25
v_cvt_pk_bf16_f32 v33,v26,v27
v_cvt_pk_bf16_f32 v34,v28,v29
v_cvt_pk_bf16_f32 v35,v30,v31
v_lshlrev_b32 v24,16,v32
v_and_b32 v25,0xffff0000,v32
v_lshlrev_b32 v26,16,v33
v_and_b32 v27,0xffff0000,v33
v_lshlrev_b32 v28,16,v34
v_and_b32 v29,0xffff0000,v34
v_lshlrev_b32 v30,16,v35
v_and_b32 v31,0xffff0000,v35
v_pk_mul_f32 v[24:25],v[24:25],v[160:161] op_sel:[0,1] op_sel_hi:[1,1]
v_pk_mul_f32 v[26:27],v[26:27],v[160:161] op_sel:[0,1] op_sel_hi:[1,1]
v_pk_mul_f32 v[28:29],v[28:29],v[160:161] op_sel:[0,1] op_sel_hi:[1,1]
v_pk_mul_f32 v[30:31],v[30:31],v[160:161] op_sel:[0,1] op_sel_hi:[1,1]
v_cvt_pk_bf16_f32 v68,v24,v25
v_cvt_pk_bf16_f32 v69,v26,v27
v_cvt_pk_bf16_f32 v70,v28,v29
v_cvt_pk_bf16_f32 v71,v30,v31
global_store_dwordx4 v2,v[68:71],s[30:31] offset:1024 sc1
v_accvgpr_read_b32 v24,a16
v_accvgpr_read_b32 v25,a17
v_accvgpr_read_b32 v26,a18
v_accvgpr_read_b32 v27,a19
v_accvgpr_read_b32 v28,a20
v_accvgpr_read_b32 v29,a21
v_accvgpr_read_b32 v30,a22
v_accvgpr_read_b32 v31,a23
v_cvt_pk_bf16_f32 v32,v24,v25
v_cvt_pk_bf16_f32 v33,v26,v27
v_cvt_pk_bf16_f32 v34,v28,v29
v_cvt_pk_bf16_f32 v35,v30,v31
v_lshlrev_b32 v24,16,v32
v_and_b32 v25,0xffff0000,v32
v_lshlrev_b32 v26,16,v33
v_and_b32 v27,0xffff0000,v33
v_lshlrev_b32 v28,16,v34
v_and_b32 v29,0xffff0000,v34
v_lshlrev_b32 v30,16,v35
v_and_b32 v31,0xffff0000,v35
v_pk_mul_f32 v[24:25],v[24:25],v[160:161] op_sel:[0,1] op_sel_hi:[1,1]
v_pk_mul_f32 v[26:27],v[26:27],v[160:161] op_sel:[0,1] op_sel_hi:[1,1]
v_pk_mul_f32 v[28:29],v[28:29],v[160:161] op_sel:[0,1] op_sel_hi:[1,1]
v_pk_mul_f32 v[30:31],v[30:31],v[160:161] op_sel:[0,1] op_sel_hi:[1,1]
v_cvt_pk_bf16_f32 v72,v24,v25
v_cvt_pk_bf16_f32 v73,v26,v27
v_cvt_pk_bf16_f32 v74,v28,v29
v_cvt_pk_bf16_f32 v75,v30,v31
global_store_dwordx4 v2,v[72:75],s[30:31] offset:2048 sc1
v_accvgpr_read_b32 v24,a24
v_accvgpr_read_b32 v25,a25
v_accvgpr_read_b32 v26,a26
v_accvgpr_read_b32 v27,a27
v_accvgpr_read_b32 v28,a28
v_accvgpr_read_b32 v29,a29
v_accvgpr_read_b32 v30,a30
v_accvgpr_read_b32 v31,a31
v_cvt_pk_bf16_f32 v32,v24,v25
v_cvt_pk_bf16_f32 v33,v26,v27
v_cvt_pk_bf16_f32 v34,v28,v29
v_cvt_pk_bf16_f32 v35,v30,v31
v_lshlrev_b32 v24,16,v32
v_and_b32 v25,0xffff0000,v32
v_lshlrev_b32 v26,16,v33
v_and_b32 v27,0xffff0000,v33
v_lshlrev_b32 v28,16,v34
v_and_b32 v29,0xffff0000,v34
v_lshlrev_b32 v30,16,v35
v_and_b32 v31,0xffff0000,v35
v_pk_mul_f32 v[24:25],v[24:25],v[160:161] op_sel:[0,1] op_sel_hi:[1,1]
v_pk_mul_f32 v[26:27],v[26:27],v[160:161] op_sel:[0,1] op_sel_hi:[1,1]
v_pk_mul_f32 v[28:29],v[28:29],v[160:161] op_sel:[0,1] op_sel_hi:[1,1]
v_pk_mul_f32 v[30:31],v[30:31],v[160:161] op_sel:[0,1] op_sel_hi:[1,1]
v_cvt_pk_bf16_f32 v76,v24,v25
v_cvt_pk_bf16_f32 v77,v26,v27
v_cvt_pk_bf16_f32 v78,v28,v29
v_cvt_pk_bf16_f32 v79,v30,v31
global_store_dwordx4 v2,v[76:79],s[30:31] offset:3072 sc1
s_add_u32 s30,s30,32768
s_addc_u32 s31,s31,0
v_accvgpr_read_b32 v24,a32
v_accvgpr_read_b32 v25,a33
v_accvgpr_read_b32 v26,a34
v_accvgpr_read_b32 v27,a35
v_accvgpr_read_b32 v28,a36
v_accvgpr_read_b32 v29,a37
v_accvgpr_read_b32 v30,a38
v_accvgpr_read_b32 v31,a39
v_cvt_pk_bf16_f32 v32,v24,v25
v_cvt_pk_bf16_f32 v33,v26,v27
v_cvt_pk_bf16_f32 v34,v28,v29
v_cvt_pk_bf16_f32 v35,v30,v31
v_lshlrev_b32 v24,16,v32
v_and_b32 v25,0xffff0000,v32
v_lshlrev_b32 v26,16,v33
v_and_b32 v27,0xffff0000,v33
v_lshlrev_b32 v28,16,v34
v_and_b32 v29,0xffff0000,v34
v_lshlrev_b32 v30,16,v35
v_and_b32 v31,0xffff0000,v35
v_pk_mul_f32 v[24:25],v[24:25],v[162:163] op_sel:[0,1] op_sel_hi:[1,1]
v_pk_mul_f32 v[26:27],v[26:27],v[162:163] op_sel:[0,1] op_sel_hi:[1,1]
v_pk_mul_f32 v[28:29],v[28:29],v[162:163] op_sel:[0,1] op_sel_hi:[1,1]
v_pk_mul_f32 v[30:31],v[30:31],v[162:163] op_sel:[0,1] op_sel_hi:[1,1]
v_cvt_pk_bf16_f32 v80,v24,v25
v_cvt_pk_bf16_f32 v81,v26,v27
v_cvt_pk_bf16_f32 v82,v28,v29
v_cvt_pk_bf16_f32 v83,v30,v31
global_store_dwordx4 v2,v[80:83],s[30:31] offset:0 sc1
v_accvgpr_read_b32 v24,a40
v_accvgpr_read_b32 v25,a41
v_accvgpr_read_b32 v26,a42
v_accvgpr_read_b32 v27,a43
v_accvgpr_read_b32 v28,a44
v_accvgpr_read_b32 v29,a45
v_accvgpr_read_b32 v30,a46
v_accvgpr_read_b32 v31,a47
v_cvt_pk_bf16_f32 v32,v24,v25
v_cvt_pk_bf16_f32 v33,v26,v27
v_cvt_pk_bf16_f32 v34,v28,v29
v_cvt_pk_bf16_f32 v35,v30,v31
v_lshlrev_b32 v24,16,v32
v_and_b32 v25,0xffff0000,v32
v_lshlrev_b32 v26,16,v33
v_and_b32 v27,0xffff0000,v33
v_lshlrev_b32 v28,16,v34
v_and_b32 v29,0xffff0000,v34
v_lshlrev_b32 v30,16,v35
v_and_b32 v31,0xffff0000,v35
v_pk_mul_f32 v[24:25],v[24:25],v[162:163] op_sel:[0,1] op_sel_hi:[1,1]
v_pk_mul_f32 v[26:27],v[26:27],v[162:163] op_sel:[0,1] op_sel_hi:[1,1]
v_pk_mul_f32 v[28:29],v[28:29],v[162:163] op_sel:[0,1] op_sel_hi:[1,1]
v_pk_mul_f32 v[30:31],v[30:31],v[162:163] op_sel:[0,1] op_sel_hi:[1,1]
v_cvt_pk_bf16_f32 v84,v24,v25
v_cvt_pk_bf16_f32 v85,v26,v27
v_cvt_pk_bf16_f32 v86,v28,v29
v_cvt_pk_bf16_f32 v87,v30,v31
global_store_dwordx4 v2,v[84:87],s[30:31] offset:1024 sc1
v_accvgpr_read_b32 v24,a48
v_accvgpr_read_b32 v25,a49
v_accvgpr_read_b32 v26,a50
v_accvgpr_read_b32 v27,a51
v_accvgpr_read_b32 v28,a52
v_accvgpr_read_b32 v29,a53
v_accvgpr_read_b32 v30,a54
v_accvgpr_read_b32 v31,a55
v_cvt_pk_bf16_f32 v32,v24,v25
v_cvt_pk_bf16_f32 v33,v26,v27
v_cvt_pk_bf16_f32 v34,v28,v29
v_cvt_pk_bf16_f32 v35,v30,v31
v_lshlrev_b32 v24,16,v32
v_and_b32 v25,0xffff0000,v32
v_lshlrev_b32 v26,16,v33
v_and_b32 v27,0xffff0000,v33
v_lshlrev_b32 v28,16,v34
v_and_b32 v29,0xffff0000,v34
v_lshlrev_b32 v30,16,v35
v_and_b32 v31,0xffff0000,v35
v_pk_mul_f32 v[24:25],v[24:25],v[162:163] op_sel:[0,1] op_sel_hi:[1,1]
v_pk_mul_f32 v[26:27],v[26:27],v[162:163] op_sel:[0,1] op_sel_hi:[1,1]
v_pk_mul_f32 v[28:29],v[28:29],v[162:163] op_sel:[0,1] op_sel_hi:[1,1]
v_pk_mul_f32 v[30:31],v[30:31],v[162:163] op_sel:[0,1] op_sel_hi:[1,1]
v_cvt_pk_bf16_f32 v88,v24,v25
v_cvt_pk_bf16_f32 v89,v26,v27
v_cvt_pk_bf16_f32 v90,v28,v29
v_cvt_pk_bf16_f32 v91,v30,v31
global_store_dwordx4 v2,v[88:91],s[30:31] offset:2048 sc1
v_accvgpr_read_b32 v24,a56
v_accvgpr_read_b32 v25,a57
v_accvgpr_read_b32 v26,a58
v_accvgpr_read_b32 v27,a59
v_accvgpr_read_b32 v28,a60
v_accvgpr_read_b32 v29,a61
v_accvgpr_read_b32 v30,a62
v_accvgpr_read_b32 v31,a63
v_cvt_pk_bf16_f32 v32,v24,v25
v_cvt_pk_bf16_f32 v33,v26,v27
v_cvt_pk_bf16_f32 v34,v28,v29
v_cvt_pk_bf16_f32 v35,v30,v31
v_lshlrev_b32 v24,16,v32
v_and_b32 v25,0xffff0000,v32
v_lshlrev_b32 v26,16,v33
v_and_b32 v27,0xffff0000,v33
v_lshlrev_b32 v28,16,v34
v_and_b32 v29,0xffff0000,v34
v_lshlrev_b32 v30,16,v35
v_and_b32 v31,0xffff0000,v35
v_pk_mul_f32 v[24:25],v[24:25],v[162:163] op_sel:[0,1] op_sel_hi:[1,1]
v_pk_mul_f32 v[26:27],v[26:27],v[162:163] op_sel:[0,1] op_sel_hi:[1,1]
v_pk_mul_f32 v[28:29],v[28:29],v[162:163] op_sel:[0,1] op_sel_hi:[1,1]
v_pk_mul_f32 v[30:31],v[30:31],v[162:163] op_sel:[0,1] op_sel_hi:[1,1]
v_cvt_pk_bf16_f32 v92,v24,v25
v_cvt_pk_bf16_f32 v93,v26,v27
v_cvt_pk_bf16_f32 v94,v28,v29
v_cvt_pk_bf16_f32 v95,v30,v31
global_store_dwordx4 v2,v[92:95],s[30:31] offset:3072 sc1
s_add_u32 s30,s30,32768
s_addc_u32 s31,s31,0
v_accvgpr_read_b32 v24,a64
v_accvgpr_read_b32 v25,a65
v_accvgpr_read_b32 v26,a66
v_accvgpr_read_b32 v27,a67
v_accvgpr_read_b32 v28,a68
v_accvgpr_read_b32 v29,a69
v_accvgpr_read_b32 v30,a70
v_accvgpr_read_b32 v31,a71
v_cvt_pk_bf16_f32 v32,v24,v25
v_cvt_pk_bf16_f32 v33,v26,v27
v_cvt_pk_bf16_f32 v34,v28,v29
v_cvt_pk_bf16_f32 v35,v30,v31
v_lshlrev_b32 v24,16,v32
v_and_b32 v25,0xffff0000,v32
v_lshlrev_b32 v26,16,v33
v_and_b32 v27,0xffff0000,v33
v_lshlrev_b32 v28,16,v34
v_and_b32 v29,0xffff0000,v34
v_lshlrev_b32 v30,16,v35
v_and_b32 v31,0xffff0000,v35
v_pk_mul_f32 v[24:25],v[24:25],v[164:165] op_sel:[0,1] op_sel_hi:[1,1]
v_pk_mul_f32 v[26:27],v[26:27],v[164:165] op_sel:[0,1] op_sel_hi:[1,1]
v_pk_mul_f32 v[28:29],v[28:29],v[164:165] op_sel:[0,1] op_sel_hi:[1,1]
v_pk_mul_f32 v[30:31],v[30:31],v[164:165] op_sel:[0,1] op_sel_hi:[1,1]
v_cvt_pk_bf16_f32 v96,v24,v25
v_cvt_pk_bf16_f32 v97,v26,v27
v_cvt_pk_bf16_f32 v98,v28,v29
v_cvt_pk_bf16_f32 v99,v30,v31
global_store_dwordx4 v2,v[96:99],s[30:31] offset:0 sc1
v_accvgpr_read_b32 v24,a72
v_accvgpr_read_b32 v25,a73
v_accvgpr_read_b32 v26,a74
v_accvgpr_read_b32 v27,a75
v_accvgpr_read_b32 v28,a76
v_accvgpr_read_b32 v29,a77
v_accvgpr_read_b32 v30,a78
v_accvgpr_read_b32 v31,a79
v_cvt_pk_bf16_f32 v32,v24,v25
v_cvt_pk_bf16_f32 v33,v26,v27
v_cvt_pk_bf16_f32 v34,v28,v29
v_cvt_pk_bf16_f32 v35,v30,v31
v_lshlrev_b32 v24,16,v32
v_and_b32 v25,0xffff0000,v32
v_lshlrev_b32 v26,16,v33
v_and_b32 v27,0xffff0000,v33
v_lshlrev_b32 v28,16,v34
v_and_b32 v29,0xffff0000,v34
v_lshlrev_b32 v30,16,v35
v_and_b32 v31,0xffff0000,v35
v_pk_mul_f32 v[24:25],v[24:25],v[164:165] op_sel:[0,1] op_sel_hi:[1,1]
v_pk_mul_f32 v[26:27],v[26:27],v[164:165] op_sel:[0,1] op_sel_hi:[1,1]
v_pk_mul_f32 v[28:29],v[28:29],v[164:165] op_sel:[0,1] op_sel_hi:[1,1]
v_pk_mul_f32 v[30:31],v[30:31],v[164:165] op_sel:[0,1] op_sel_hi:[1,1]
v_cvt_pk_bf16_f32 v100,v24,v25
v_cvt_pk_bf16_f32 v101,v26,v27
v_cvt_pk_bf16_f32 v102,v28,v29
v_cvt_pk_bf16_f32 v103,v30,v31
global_store_dwordx4 v2,v[100:103],s[30:31] offset:1024 sc1
v_accvgpr_read_b32 v24,a80
v_accvgpr_read_b32 v25,a81
v_accvgpr_read_b32 v26,a82
v_accvgpr_read_b32 v27,a83
v_accvgpr_read_b32 v28,a84
v_accvgpr_read_b32 v29,a85
v_accvgpr_read_b32 v30,a86
v_accvgpr_read_b32 v31,a87
v_cvt_pk_bf16_f32 v32,v24,v25
v_cvt_pk_bf16_f32 v33,v26,v27
v_cvt_pk_bf16_f32 v34,v28,v29
v_cvt_pk_bf16_f32 v35,v30,v31
v_lshlrev_b32 v24,16,v32
v_and_b32 v25,0xffff0000,v32
v_lshlrev_b32 v26,16,v33
v_and_b32 v27,0xffff0000,v33
v_lshlrev_b32 v28,16,v34
v_and_b32 v29,0xffff0000,v34
v_lshlrev_b32 v30,16,v35
v_and_b32 v31,0xffff0000,v35
v_pk_mul_f32 v[24:25],v[24:25],v[164:165] op_sel:[0,1] op_sel_hi:[1,1]
v_pk_mul_f32 v[26:27],v[26:27],v[164:165] op_sel:[0,1] op_sel_hi:[1,1]
v_pk_mul_f32 v[28:29],v[28:29],v[164:165] op_sel:[0,1] op_sel_hi:[1,1]
v_pk_mul_f32 v[30:31],v[30:31],v[164:165] op_sel:[0,1] op_sel_hi:[1,1]
v_cvt_pk_bf16_f32 v104,v24,v25
v_cvt_pk_bf16_f32 v105,v26,v27
v_cvt_pk_bf16_f32 v106,v28,v29
v_cvt_pk_bf16_f32 v107,v30,v31
global_store_dwordx4 v2,v[104:107],s[30:31] offset:2048 sc1
v_accvgpr_read_b32 v24,a88
v_accvgpr_read_b32 v25,a89
v_accvgpr_read_b32 v26,a90
v_accvgpr_read_b32 v27,a91
v_accvgpr_read_b32 v28,a92
v_accvgpr_read_b32 v29,a93
v_accvgpr_read_b32 v30,a94
v_accvgpr_read_b32 v31,a95
v_cvt_pk_bf16_f32 v32,v24,v25
v_cvt_pk_bf16_f32 v33,v26,v27
v_cvt_pk_bf16_f32 v34,v28,v29
v_cvt_pk_bf16_f32 v35,v30,v31
v_lshlrev_b32 v24,16,v32
v_and_b32 v25,0xffff0000,v32
v_lshlrev_b32 v26,16,v33
v_and_b32 v27,0xffff0000,v33
v_lshlrev_b32 v28,16,v34
v_and_b32 v29,0xffff0000,v34
v_lshlrev_b32 v30,16,v35
v_and_b32 v31,0xffff0000,v35
v_pk_mul_f32 v[24:25],v[24:25],v[164:165] op_sel:[0,1] op_sel_hi:[1,1]
v_pk_mul_f32 v[26:27],v[26:27],v[164:165] op_sel:[0,1] op_sel_hi:[1,1]
v_pk_mul_f32 v[28:29],v[28:29],v[164:165] op_sel:[0,1] op_sel_hi:[1,1]
v_pk_mul_f32 v[30:31],v[30:31],v[164:165] op_sel:[0,1] op_sel_hi:[1,1]
v_cvt_pk_bf16_f32 v108,v24,v25
v_cvt_pk_bf16_f32 v109,v26,v27
v_cvt_pk_bf16_f32 v110,v28,v29
v_cvt_pk_bf16_f32 v111,v30,v31
global_store_dwordx4 v2,v[108:111],s[30:31] offset:3072 sc1
s_add_u32 s30,s30,32768
s_addc_u32 s31,s31,0
v_accvgpr_read_b32 v24,a96
v_accvgpr_read_b32 v25,a97
v_accvgpr_read_b32 v26,a98
v_accvgpr_read_b32 v27,a99
v_accvgpr_read_b32 v28,a100
v_accvgpr_read_b32 v29,a101
v_accvgpr_read_b32 v30,a102
v_accvgpr_read_b32 v31,a103
v_cvt_pk_bf16_f32 v32,v24,v25
v_cvt_pk_bf16_f32 v33,v26,v27
v_cvt_pk_bf16_f32 v34,v28,v29
v_cvt_pk_bf16_f32 v35,v30,v31
v_lshlrev_b32 v24,16,v32
v_and_b32 v25,0xffff0000,v32
v_lshlrev_b32 v26,16,v33
v_and_b32 v27,0xffff0000,v33
v_lshlrev_b32 v28,16,v34
v_and_b32 v29,0xffff0000,v34
v_lshlrev_b32 v30,16,v35
v_and_b32 v31,0xffff0000,v35
v_pk_mul_f32 v[24:25],v[24:25],v[166:167] op_sel:[0,1] op_sel_hi:[1,1]
v_pk_mul_f32 v[26:27],v[26:27],v[166:167] op_sel:[0,1] op_sel_hi:[1,1]
v_pk_mul_f32 v[28:29],v[28:29],v[166:167] op_sel:[0,1] op_sel_hi:[1,1]
v_pk_mul_f32 v[30:31],v[30:31],v[166:167] op_sel:[0,1] op_sel_hi:[1,1]
v_cvt_pk_bf16_f32 v112,v24,v25
v_cvt_pk_bf16_f32 v113,v26,v27
v_cvt_pk_bf16_f32 v114,v28,v29
v_cvt_pk_bf16_f32 v115,v30,v31
global_store_dwordx4 v2,v[112:115],s[30:31] offset:0 sc1
v_accvgpr_read_b32 v24,a104
v_accvgpr_read_b32 v25,a105
v_accvgpr_read_b32 v26,a106
v_accvgpr_read_b32 v27,a107
v_accvgpr_read_b32 v28,a108
v_accvgpr_read_b32 v29,a109
v_accvgpr_read_b32 v30,a110
v_accvgpr_read_b32 v31,a111
v_cvt_pk_bf16_f32 v32,v24,v25
v_cvt_pk_bf16_f32 v33,v26,v27
v_cvt_pk_bf16_f32 v34,v28,v29
v_cvt_pk_bf16_f32 v35,v30,v31
v_lshlrev_b32 v24,16,v32
v_and_b32 v25,0xffff0000,v32
v_lshlrev_b32 v26,16,v33
v_and_b32 v27,0xffff0000,v33
v_lshlrev_b32 v28,16,v34
v_and_b32 v29,0xffff0000,v34
v_lshlrev_b32 v30,16,v35
v_and_b32 v31,0xffff0000,v35
v_pk_mul_f32 v[24:25],v[24:25],v[166:167] op_sel:[0,1] op_sel_hi:[1,1]
v_pk_mul_f32 v[26:27],v[26:27],v[166:167] op_sel:[0,1] op_sel_hi:[1,1]
v_pk_mul_f32 v[28:29],v[28:29],v[166:167] op_sel:[0,1] op_sel_hi:[1,1]
v_pk_mul_f32 v[30:31],v[30:31],v[166:167] op_sel:[0,1] op_sel_hi:[1,1]
v_cvt_pk_bf16_f32 v116,v24,v25
v_cvt_pk_bf16_f32 v117,v26,v27
v_cvt_pk_bf16_f32 v118,v28,v29
v_cvt_pk_bf16_f32 v119,v30,v31
global_store_dwordx4 v2,v[116:119],s[30:31] offset:1024 sc1
v_accvgpr_read_b32 v24,a112
v_accvgpr_read_b32 v25,a113
v_accvgpr_read_b32 v26,a114
v_accvgpr_read_b32 v27,a115
v_accvgpr_read_b32 v28,a116
v_accvgpr_read_b32 v29,a117
v_accvgpr_read_b32 v30,a118
v_accvgpr_read_b32 v31,a119
v_cvt_pk_bf16_f32 v32,v24,v25
v_cvt_pk_bf16_f32 v33,v26,v27
v_cvt_pk_bf16_f32 v34,v28,v29
v_cvt_pk_bf16_f32 v35,v30,v31
v_lshlrev_b32 v24,16,v32
v_and_b32 v25,0xffff0000,v32
v_lshlrev_b32 v26,16,v33
v_and_b32 v27,0xffff0000,v33
v_lshlrev_b32 v28,16,v34
v_and_b32 v29,0xffff0000,v34
v_lshlrev_b32 v30,16,v35
v_and_b32 v31,0xffff0000,v35
v_pk_mul_f32 v[24:25],v[24:25],v[166:167] op_sel:[0,1] op_sel_hi:[1,1]
v_pk_mul_f32 v[26:27],v[26:27],v[166:167] op_sel:[0,1] op_sel_hi:[1,1]
v_pk_mul_f32 v[28:29],v[28:29],v[166:167] op_sel:[0,1] op_sel_hi:[1,1]
v_pk_mul_f32 v[30:31],v[30:31],v[166:167] op_sel:[0,1] op_sel_hi:[1,1]
v_cvt_pk_bf16_f32 v120,v24,v25
v_cvt_pk_bf16_f32 v121,v26,v27
v_cvt_pk_bf16_f32 v122,v28,v29
v_cvt_pk_bf16_f32 v123,v30,v31
global_store_dwordx4 v2,v[120:123],s[30:31] offset:2048 sc1
v_accvgpr_read_b32 v24,a120
v_accvgpr_read_b32 v25,a121
v_accvgpr_read_b32 v26,a122
v_accvgpr_read_b32 v27,a123
v_accvgpr_read_b32 v28,a124
v_accvgpr_read_b32 v29,a125
v_accvgpr_read_b32 v30,a126
v_accvgpr_read_b32 v31,a127
v_cvt_pk_bf16_f32 v32,v24,v25
v_cvt_pk_bf16_f32 v33,v26,v27
v_cvt_pk_bf16_f32 v34,v28,v29
v_cvt_pk_bf16_f32 v35,v30,v31
v_lshlrev_b32 v24,16,v32
v_and_b32 v25,0xffff0000,v32
v_lshlrev_b32 v26,16,v33
v_and_b32 v27,0xffff0000,v33
v_lshlrev_b32 v28,16,v34
v_and_b32 v29,0xffff0000,v34
v_lshlrev_b32 v30,16,v35
v_and_b32 v31,0xffff0000,v35
v_pk_mul_f32 v[24:25],v[24:25],v[166:167] op_sel:[0,1] op_sel_hi:[1,1]
v_pk_mul_f32 v[26:27],v[26:27],v[166:167] op_sel:[0,1] op_sel_hi:[1,1]
v_pk_mul_f32 v[28:29],v[28:29],v[166:167] op_sel:[0,1] op_sel_hi:[1,1]
v_pk_mul_f32 v[30:31],v[30:31],v[166:167] op_sel:[0,1] op_sel_hi:[1,1]
v_cvt_pk_bf16_f32 v124,v24,v25
v_cvt_pk_bf16_f32 v125,v26,v27
v_cvt_pk_bf16_f32 v126,v28,v29
v_cvt_pk_bf16_f32 v127,v30,v31
global_store_dwordx4 v2,v[124:127],s[30:31] offset:3072 sc1
s_add_u32 s30,s30,32768
s_addc_u32 s31,s31,0
v_accvgpr_read_b32 v24,a128
v_accvgpr_read_b32 v25,a129
v_accvgpr_read_b32 v26,a130
v_accvgpr_read_b32 v27,a131
v_accvgpr_read_b32 v28,a132
v_accvgpr_read_b32 v29,a133
v_accvgpr_read_b32 v30,a134
v_accvgpr_read_b32 v31,a135
v_cvt_pk_bf16_f32 v32,v24,v25
v_cvt_pk_bf16_f32 v33,v26,v27
v_cvt_pk_bf16_f32 v34,v28,v29
v_cvt_pk_bf16_f32 v35,v30,v31
v_lshlrev_b32 v24,16,v32
v_and_b32 v25,0xffff0000,v32
v_lshlrev_b32 v26,16,v33
v_and_b32 v27,0xffff0000,v33
v_lshlrev_b32 v28,16,v34
v_and_b32 v29,0xffff0000,v34
v_lshlrev_b32 v30,16,v35
v_and_b32 v31,0xffff0000,v35
v_pk_mul_f32 v[24:25],v[24:25],v[168:169] op_sel:[0,1] op_sel_hi:[1,1]
v_pk_mul_f32 v[26:27],v[26:27],v[168:169] op_sel:[0,1] op_sel_hi:[1,1]
v_pk_mul_f32 v[28:29],v[28:29],v[168:169] op_sel:[0,1] op_sel_hi:[1,1]
v_pk_mul_f32 v[30:31],v[30:31],v[168:169] op_sel:[0,1] op_sel_hi:[1,1]
v_cvt_pk_bf16_f32 v64,v24,v25
v_cvt_pk_bf16_f32 v65,v26,v27
v_cvt_pk_bf16_f32 v66,v28,v29
v_cvt_pk_bf16_f32 v67,v30,v31
global_store_dwordx4 v2,v[64:67],s[30:31] offset:0 sc1
v_accvgpr_read_b32 v24,a136
v_accvgpr_read_b32 v25,a137
v_accvgpr_read_b32 v26,a138
v_accvgpr_read_b32 v27,a139
v_accvgpr_read_b32 v28,a140
v_accvgpr_read_b32 v29,a141
v_accvgpr_read_b32 v30,a142
v_accvgpr_read_b32 v31,a143
v_cvt_pk_bf16_f32 v32,v24,v25
v_cvt_pk_bf16_f32 v33,v26,v27
v_cvt_pk_bf16_f32 v34,v28,v29
v_cvt_pk_bf16_f32 v35,v30,v31
v_lshlrev_b32 v24,16,v32
v_and_b32 v25,0xffff0000,v32
v_lshlrev_b32 v26,16,v33
v_and_b32 v27,0xffff0000,v33
v_lshlrev_b32 v28,16,v34
v_and_b32 v29,0xffff0000,v34
v_lshlrev_b32 v30,16,v35
v_and_b32 v31,0xffff0000,v35
v_pk_mul_f32 v[24:25],v[24:25],v[168:169] op_sel:[0,1] op_sel_hi:[1,1]
v_pk_mul_f32 v[26:27],v[26:27],v[168:169] op_sel:[0,1] op_sel_hi:[1,1]
v_pk_mul_f32 v[28:29],v[28:29],v[168:169] op_sel:[0,1] op_sel_hi:[1,1]
v_pk_mul_f32 v[30:31],v[30:31],v[168:169] op_sel:[0,1] op_sel_hi:[1,1]
v_cvt_pk_bf16_f32 v68,v24,v25
v_cvt_pk_bf16_f32 v69,v26,v27
v_cvt_pk_bf16_f32 v70,v28,v29
v_cvt_pk_bf16_f32 v71,v30,v31
global_store_dwordx4 v2,v[68:71],s[30:31] offset:1024 sc1
v_accvgpr_read_b32 v24,a144
v_accvgpr_read_b32 v25,a145
v_accvgpr_read_b32 v26,a146
v_accvgpr_read_b32 v27,a147
v_accvgpr_read_b32 v28,a148
v_accvgpr_read_b32 v29,a149
v_accvgpr_read_b32 v30,a150
v_accvgpr_read_b32 v31,a151
v_cvt_pk_bf16_f32 v32,v24,v25
v_cvt_pk_bf16_f32 v33,v26,v27
v_cvt_pk_bf16_f32 v34,v28,v29
v_cvt_pk_bf16_f32 v35,v30,v31
v_lshlrev_b32 v24,16,v32
v_and_b32 v25,0xffff0000,v32
v_lshlrev_b32 v26,16,v33
v_and_b32 v27,0xffff0000,v33
v_lshlrev_b32 v28,16,v34
v_and_b32 v29,0xffff0000,v34
v_lshlrev_b32 v30,16,v35
v_and_b32 v31,0xffff0000,v35
v_pk_mul_f32 v[24:25],v[24:25],v[168:169] op_sel:[0,1] op_sel_hi:[1,1]
v_pk_mul_f32 v[26:27],v[26:27],v[168:169] op_sel:[0,1] op_sel_hi:[1,1]
v_pk_mul_f32 v[28:29],v[28:29],v[168:169] op_sel:[0,1] op_sel_hi:[1,1]
v_pk_mul_f32 v[30:31],v[30:31],v[168:169] op_sel:[0,1] op_sel_hi:[1,1]
v_cvt_pk_bf16_f32 v72,v24,v25
v_cvt_pk_bf16_f32 v73,v26,v27
v_cvt_pk_bf16_f32 v74,v28,v29
v_cvt_pk_bf16_f32 v75,v30,v31
global_store_dwordx4 v2,v[72:75],s[30:31] offset:2048 sc1
v_accvgpr_read_b32 v24,a152
v_accvgpr_read_b32 v25,a153
v_accvgpr_read_b32 v26,a154
v_accvgpr_read_b32 v27,a155
v_accvgpr_read_b32 v28,a156
v_accvgpr_read_b32 v29,a157
v_accvgpr_read_b32 v30,a158
v_accvgpr_read_b32 v31,a159
v_cvt_pk_bf16_f32 v32,v24,v25
v_cvt_pk_bf16_f32 v33,v26,v27
v_cvt_pk_bf16_f32 v34,v28,v29
v_cvt_pk_bf16_f32 v35,v30,v31
v_lshlrev_b32 v24,16,v32
v_and_b32 v25,0xffff0000,v32
v_lshlrev_b32 v26,16,v33
v_and_b32 v27,0xffff0000,v33
v_lshlrev_b32 v28,16,v34
v_and_b32 v29,0xffff0000,v34
v_lshlrev_b32 v30,16,v35
v_and_b32 v31,0xffff0000,v35
v_pk_mul_f32 v[24:25],v[24:25],v[168:169] op_sel:[0,1] op_sel_hi:[1,1]
v_pk_mul_f32 v[26:27],v[26:27],v[168:169] op_sel:[0,1] op_sel_hi:[1,1]
v_pk_mul_f32 v[28:29],v[28:29],v[168:169] op_sel:[0,1] op_sel_hi:[1,1]
v_pk_mul_f32 v[30:31],v[30:31],v[168:169] op_sel:[0,1] op_sel_hi:[1,1]
v_cvt_pk_bf16_f32 v76,v24,v25
v_cvt_pk_bf16_f32 v77,v26,v27
v_cvt_pk_bf16_f32 v78,v28,v29
v_cvt_pk_bf16_f32 v79,v30,v31
global_store_dwordx4 v2,v[76:79],s[30:31] offset:3072 sc1
s_add_u32 s30,s30,32768
s_addc_u32 s31,s31,0
v_accvgpr_read_b32 v24,a160
v_accvgpr_read_b32 v25,a161
v_accvgpr_read_b32 v26,a162
v_accvgpr_read_b32 v27,a163
v_accvgpr_read_b32 v28,a164
v_accvgpr_read_b32 v29,a165
v_accvgpr_read_b32 v30,a166
v_accvgpr_read_b32 v31,a167
v_cvt_pk_bf16_f32 v32,v24,v25
v_cvt_pk_bf16_f32 v33,v26,v27
v_cvt_pk_bf16_f32 v34,v28,v29
v_cvt_pk_bf16_f32 v35,v30,v31
v_lshlrev_b32 v24,16,v32
v_and_b32 v25,0xffff0000,v32
v_lshlrev_b32 v26,16,v33
v_and_b32 v27,0xffff0000,v33
v_lshlrev_b32 v28,16,v34
v_and_b32 v29,0xffff0000,v34
v_lshlrev_b32 v30,16,v35
v_and_b32 v31,0xffff0000,v35
v_pk_mul_f32 v[24:25],v[24:25],v[170:171] op_sel:[0,1] op_sel_hi:[1,1]
v_pk_mul_f32 v[26:27],v[26:27],v[170:171] op_sel:[0,1] op_sel_hi:[1,1]
v_pk_mul_f32 v[28:29],v[28:29],v[170:171] op_sel:[0,1] op_sel_hi:[1,1]
v_pk_mul_f32 v[30:31],v[30:31],v[170:171] op_sel:[0,1] op_sel_hi:[1,1]
v_cvt_pk_bf16_f32 v80,v24,v25
v_cvt_pk_bf16_f32 v81,v26,v27
v_cvt_pk_bf16_f32 v82,v28,v29
v_cvt_pk_bf16_f32 v83,v30,v31
global_store_dwordx4 v2,v[80:83],s[30:31] offset:0 sc1
v_accvgpr_read_b32 v24,a168
v_accvgpr_read_b32 v25,a169
v_accvgpr_read_b32 v26,a170
v_accvgpr_read_b32 v27,a171
v_accvgpr_read_b32 v28,a172
v_accvgpr_read_b32 v29,a173
v_accvgpr_read_b32 v30,a174
v_accvgpr_read_b32 v31,a175
v_cvt_pk_bf16_f32 v32,v24,v25
v_cvt_pk_bf16_f32 v33,v26,v27
v_cvt_pk_bf16_f32 v34,v28,v29
v_cvt_pk_bf16_f32 v35,v30,v31
v_lshlrev_b32 v24,16,v32
v_and_b32 v25,0xffff0000,v32
v_lshlrev_b32 v26,16,v33
v_and_b32 v27,0xffff0000,v33
v_lshlrev_b32 v28,16,v34
v_and_b32 v29,0xffff0000,v34
v_lshlrev_b32 v30,16,v35
v_and_b32 v31,0xffff0000,v35
v_pk_mul_f32 v[24:25],v[24:25],v[170:171] op_sel:[0,1] op_sel_hi:[1,1]
v_pk_mul_f32 v[26:27],v[26:27],v[170:171] op_sel:[0,1] op_sel_hi:[1,1]
v_pk_mul_f32 v[28:29],v[28:29],v[170:171] op_sel:[0,1] op_sel_hi:[1,1]
v_pk_mul_f32 v[30:31],v[30:31],v[170:171] op_sel:[0,1] op_sel_hi:[1,1]
v_cvt_pk_bf16_f32 v84,v24,v25
v_cvt_pk_bf16_f32 v85,v26,v27
v_cvt_pk_bf16_f32 v86,v28,v29
v_cvt_pk_bf16_f32 v87,v30,v31
global_store_dwordx4 v2,v[84:87],s[30:31] offset:1024 sc1
v_accvgpr_read_b32 v24,a176
v_accvgpr_read_b32 v25,a177
v_accvgpr_read_b32 v26,a178
v_accvgpr_read_b32 v27,a179
v_accvgpr_read_b32 v28,a180
v_accvgpr_read_b32 v29,a181
v_accvgpr_read_b32 v30,a182
v_accvgpr_read_b32 v31,a183
v_cvt_pk_bf16_f32 v32,v24,v25
v_cvt_pk_bf16_f32 v33,v26,v27
v_cvt_pk_bf16_f32 v34,v28,v29
v_cvt_pk_bf16_f32 v35,v30,v31
v_lshlrev_b32 v24,16,v32
v_and_b32 v25,0xffff0000,v32
v_lshlrev_b32 v26,16,v33
v_and_b32 v27,0xffff0000,v33
v_lshlrev_b32 v28,16,v34
v_and_b32 v29,0xffff0000,v34
v_lshlrev_b32 v30,16,v35
v_and_b32 v31,0xffff0000,v35
v_pk_mul_f32 v[24:25],v[24:25],v[170:171] op_sel:[0,1] op_sel_hi:[1,1]
v_pk_mul_f32 v[26:27],v[26:27],v[170:171] op_sel:[0,1] op_sel_hi:[1,1]
v_pk_mul_f32 v[28:29],v[28:29],v[170:171] op_sel:[0,1] op_sel_hi:[1,1]
v_pk_mul_f32 v[30:31],v[30:31],v[170:171] op_sel:[0,1] op_sel_hi:[1,1]
v_cvt_pk_bf16_f32 v88,v24,v25
v_cvt_pk_bf16_f32 v89,v26,v27
v_cvt_pk_bf16_f32 v90,v28,v29
v_cvt_pk_bf16_f32 v91,v30,v31
global_store_dwordx4 v2,v[88:91],s[30:31] offset:2048 sc1
v_accvgpr_read_b32 v24,a184
v_accvgpr_read_b32 v25,a185
v_accvgpr_read_b32 v26,a186
v_accvgpr_read_b32 v27,a187
v_accvgpr_read_b32 v28,a188
v_accvgpr_read_b32 v29,a189
v_accvgpr_read_b32 v30,a190
v_accvgpr_read_b32 v31,a191
v_cvt_pk_bf16_f32 v32,v24,v25
v_cvt_pk_bf16_f32 v33,v26,v27
v_cvt_pk_bf16_f32 v34,v28,v29
v_cvt_pk_bf16_f32 v35,v30,v31
v_lshlrev_b32 v24,16,v32
v_and_b32 v25,0xffff0000,v32
v_lshlrev_b32 v26,16,v33
v_and_b32 v27,0xffff0000,v33
v_lshlrev_b32 v28,16,v34
v_and_b32 v29,0xffff0000,v34
v_lshlrev_b32 v30,16,v35
v_and_b32 v31,0xffff0000,v35
v_pk_mul_f32 v[24:25],v[24:25],v[170:171] op_sel:[0,1] op_sel_hi:[1,1]
v_pk_mul_f32 v[26:27],v[26:27],v[170:171] op_sel:[0,1] op_sel_hi:[1,1]
v_pk_mul_f32 v[28:29],v[28:29],v[170:171] op_sel:[0,1] op_sel_hi:[1,1]
v_pk_mul_f32 v[30:31],v[30:31],v[170:171] op_sel:[0,1] op_sel_hi:[1,1]
v_cvt_pk_bf16_f32 v92,v24,v25
v_cvt_pk_bf16_f32 v93,v26,v27
v_cvt_pk_bf16_f32 v94,v28,v29
v_cvt_pk_bf16_f32 v95,v30,v31
global_store_dwordx4 v2,v[92:95],s[30:31] offset:3072 sc1
s_add_u32 s30,s30,32768
s_addc_u32 s31,s31,0
v_accvgpr_read_b32 v24,a192
v_accvgpr_read_b32 v25,a193
v_accvgpr_read_b32 v26,a194
v_accvgpr_read_b32 v27,a195
v_accvgpr_read_b32 v28,a196
v_accvgpr_read_b32 v29,a197
v_accvgpr_read_b32 v30,a198
v_accvgpr_read_b32 v31,a199
v_cvt_pk_bf16_f32 v32,v24,v25
v_cvt_pk_bf16_f32 v33,v26,v27
v_cvt_pk_bf16_f32 v34,v28,v29
v_cvt_pk_bf16_f32 v35,v30,v31
v_lshlrev_b32 v24,16,v32
v_and_b32 v25,0xffff0000,v32
v_lshlrev_b32 v26,16,v33
v_and_b32 v27,0xffff0000,v33
v_lshlrev_b32 v28,16,v34
v_and_b32 v29,0xffff0000,v34
v_lshlrev_b32 v30,16,v35
v_and_b32 v31,0xffff0000,v35
v_pk_mul_f32 v[24:25],v[24:25],v[172:173] op_sel:[0,1] op_sel_hi:[1,1]
v_pk_mul_f32 v[26:27],v[26:27],v[172:173] op_sel:[0,1] op_sel_hi:[1,1]
v_pk_mul_f32 v[28:29],v[28:29],v[172:173] op_sel:[0,1] op_sel_hi:[1,1]
v_pk_mul_f32 v[30:31],v[30:31],v[172:173] op_sel:[0,1] op_sel_hi:[1,1]
v_cvt_pk_bf16_f32 v96,v24,v25
v_cvt_pk_bf16_f32 v97,v26,v27
v_cvt_pk_bf16_f32 v98,v28,v29
v_cvt_pk_bf16_f32 v99,v30,v31
global_store_dwordx4 v2,v[96:99],s[30:31] offset:0 sc1
v_accvgpr_read_b32 v24,a200
v_accvgpr_read_b32 v25,a201
v_accvgpr_read_b32 v26,a202
v_accvgpr_read_b32 v27,a203
v_accvgpr_read_b32 v28,a204
v_accvgpr_read_b32 v29,a205
v_accvgpr_read_b32 v30,a206
v_accvgpr_read_b32 v31,a207
v_cvt_pk_bf16_f32 v32,v24,v25
v_cvt_pk_bf16_f32 v33,v26,v27
v_cvt_pk_bf16_f32 v34,v28,v29
v_cvt_pk_bf16_f32 v35,v30,v31
v_lshlrev_b32 v24,16,v32
v_and_b32 v25,0xffff0000,v32
v_lshlrev_b32 v26,16,v33
v_and_b32 v27,0xffff0000,v33
v_lshlrev_b32 v28,16,v34
v_and_b32 v29,0xffff0000,v34
v_lshlrev_b32 v30,16,v35
v_and_b32 v31,0xffff0000,v35
v_pk_mul_f32 v[24:25],v[24:25],v[172:173] op_sel:[0,1] op_sel_hi:[1,1]
v_pk_mul_f32 v[26:27],v[26:27],v[172:173] op_sel:[0,1] op_sel_hi:[1,1]
v_pk_mul_f32 v[28:29],v[28:29],v[172:173] op_sel:[0,1] op_sel_hi:[1,1]
v_pk_mul_f32 v[30:31],v[30:31],v[172:173] op_sel:[0,1] op_sel_hi:[1,1]
v_cvt_pk_bf16_f32 v100,v24,v25
v_cvt_pk_bf16_f32 v101,v26,v27
v_cvt_pk_bf16_f32 v102,v28,v29
v_cvt_pk_bf16_f32 v103,v30,v31
global_store_dwordx4 v2,v[100:103],s[30:31] offset:1024 sc1
v_accvgpr_read_b32 v24,a208
v_accvgpr_read_b32 v25,a209
v_accvgpr_read_b32 v26,a210
v_accvgpr_read_b32 v27,a211
v_accvgpr_read_b32 v28,a212
v_accvgpr_read_b32 v29,a213
v_accvgpr_read_b32 v30,a214
v_accvgpr_read_b32 v31,a215
v_cvt_pk_bf16_f32 v32,v24,v25
v_cvt_pk_bf16_f32 v33,v26,v27
v_cvt_pk_bf16_f32 v34,v28,v29
v_cvt_pk_bf16_f32 v35,v30,v31
v_lshlrev_b32 v24,16,v32
v_and_b32 v25,0xffff0000,v32
v_lshlrev_b32 v26,16,v33
v_and_b32 v27,0xffff0000,v33
v_lshlrev_b32 v28,16,v34
v_and_b32 v29,0xffff0000,v34
v_lshlrev_b32 v30,16,v35
v_and_b32 v31,0xffff0000,v35
v_pk_mul_f32 v[24:25],v[24:25],v[172:173] op_sel:[0,1] op_sel_hi:[1,1]
v_pk_mul_f32 v[26:27],v[26:27],v[172:173] op_sel:[0,1] op_sel_hi:[1,1]
v_pk_mul_f32 v[28:29],v[28:29],v[172:173] op_sel:[0,1] op_sel_hi:[1,1]
v_pk_mul_f32 v[30:31],v[30:31],v[172:173] op_sel:[0,1] op_sel_hi:[1,1]
v_cvt_pk_bf16_f32 v104,v24,v25
v_cvt_pk_bf16_f32 v105,v26,v27
v_cvt_pk_bf16_f32 v106,v28,v29
v_cvt_pk_bf16_f32 v107,v30,v31
global_store_dwordx4 v2,v[104:107],s[30:31] offset:2048 sc1
v_accvgpr_read_b32 v24,a216
v_accvgpr_read_b32 v25,a217
v_accvgpr_read_b32 v26,a218
v_accvgpr_read_b32 v27,a219
v_accvgpr_read_b32 v28,a220
v_accvgpr_read_b32 v29,a221
v_accvgpr_read_b32 v30,a222
v_accvgpr_read_b32 v31,a223
v_cvt_pk_bf16_f32 v32,v24,v25
v_cvt_pk_bf16_f32 v33,v26,v27
v_cvt_pk_bf16_f32 v34,v28,v29
v_cvt_pk_bf16_f32 v35,v30,v31
v_lshlrev_b32 v24,16,v32
v_and_b32 v25,0xffff0000,v32
v_lshlrev_b32 v26,16,v33
v_and_b32 v27,0xffff0000,v33
v_lshlrev_b32 v28,16,v34
v_and_b32 v29,0xffff0000,v34
v_lshlrev_b32 v30,16,v35
v_and_b32 v31,0xffff0000,v35
v_pk_mul_f32 v[24:25],v[24:25],v[172:173] op_sel:[0,1] op_sel_hi:[1,1]
v_pk_mul_f32 v[26:27],v[26:27],v[172:173] op_sel:[0,1] op_sel_hi:[1,1]
v_pk_mul_f32 v[28:29],v[28:29],v[172:173] op_sel:[0,1] op_sel_hi:[1,1]
v_pk_mul_f32 v[30:31],v[30:31],v[172:173] op_sel:[0,1] op_sel_hi:[1,1]
v_cvt_pk_bf16_f32 v108,v24,v25
v_cvt_pk_bf16_f32 v109,v26,v27
v_cvt_pk_bf16_f32 v110,v28,v29
v_cvt_pk_bf16_f32 v111,v30,v31
global_store_dwordx4 v2,v[108:111],s[30:31] offset:3072 sc1
s_add_u32 s30,s30,32768
s_addc_u32 s31,s31,0
v_accvgpr_read_b32 v24,a224
v_accvgpr_read_b32 v25,a225
v_accvgpr_read_b32 v26,a226
v_accvgpr_read_b32 v27,a227
v_accvgpr_read_b32 v28,a228
v_accvgpr_read_b32 v29,a229
v_accvgpr_read_b32 v30,a230
v_accvgpr_read_b32 v31,a231
v_cvt_pk_bf16_f32 v32,v24,v25
v_cvt_pk_bf16_f32 v33,v26,v27
v_cvt_pk_bf16_f32 v34,v28,v29
v_cvt_pk_bf16_f32 v35,v30,v31
v_lshlrev_b32 v24,16,v32
v_and_b32 v25,0xffff0000,v32
v_lshlrev_b32 v26,16,v33
v_and_b32 v27,0xffff0000,v33
v_lshlrev_b32 v28,16,v34
v_and_b32 v29,0xffff0000,v34
v_lshlrev_b32 v30,16,v35
v_and_b32 v31,0xffff0000,v35
v_pk_mul_f32 v[24:25],v[24:25],v[174:175] op_sel:[0,1] op_sel_hi:[1,1]
v_pk_mul_f32 v[26:27],v[26:27],v[174:175] op_sel:[0,1] op_sel_hi:[1,1]
v_pk_mul_f32 v[28:29],v[28:29],v[174:175] op_sel:[0,1] op_sel_hi:[1,1]
v_pk_mul_f32 v[30:31],v[30:31],v[174:175] op_sel:[0,1] op_sel_hi:[1,1]
v_cvt_pk_bf16_f32 v112,v24,v25
v_cvt_pk_bf16_f32 v113,v26,v27
v_cvt_pk_bf16_f32 v114,v28,v29
v_cvt_pk_bf16_f32 v115,v30,v31
global_store_dwordx4 v2,v[112:115],s[30:31] offset:0 sc1
v_accvgpr_read_b32 v24,a232
v_accvgpr_read_b32 v25,a233
v_accvgpr_read_b32 v26,a234
v_accvgpr_read_b32 v27,a235
v_accvgpr_read_b32 v28,a236
v_accvgpr_read_b32 v29,a237
v_accvgpr_read_b32 v30,a238
v_accvgpr_read_b32 v31,a239
v_cvt_pk_bf16_f32 v32,v24,v25
v_cvt_pk_bf16_f32 v33,v26,v27
v_cvt_pk_bf16_f32 v34,v28,v29
v_cvt_pk_bf16_f32 v35,v30,v31
v_lshlrev_b32 v24,16,v32
v_and_b32 v25,0xffff0000,v32
v_lshlrev_b32 v26,16,v33
v_and_b32 v27,0xffff0000,v33
v_lshlrev_b32 v28,16,v34
v_and_b32 v29,0xffff0000,v34
v_lshlrev_b32 v30,16,v35
v_and_b32 v31,0xffff0000,v35
v_pk_mul_f32 v[24:25],v[24:25],v[174:175] op_sel:[0,1] op_sel_hi:[1,1]
v_pk_mul_f32 v[26:27],v[26:27],v[174:175] op_sel:[0,1] op_sel_hi:[1,1]
v_pk_mul_f32 v[28:29],v[28:29],v[174:175] op_sel:[0,1] op_sel_hi:[1,1]
v_pk_mul_f32 v[30:31],v[30:31],v[174:175] op_sel:[0,1] op_sel_hi:[1,1]
v_cvt_pk_bf16_f32 v116,v24,v25
v_cvt_pk_bf16_f32 v117,v26,v27
v_cvt_pk_bf16_f32 v118,v28,v29
v_cvt_pk_bf16_f32 v119,v30,v31
global_store_dwordx4 v2,v[116:119],s[30:31] offset:1024 sc1
v_accvgpr_read_b32 v24,a240
v_accvgpr_read_b32 v25,a241
v_accvgpr_read_b32 v26,a242
v_accvgpr_read_b32 v27,a243
v_accvgpr_read_b32 v28,a244
v_accvgpr_read_b32 v29,a245
v_accvgpr_read_b32 v30,a246
v_accvgpr_read_b32 v31,a247
v_cvt_pk_bf16_f32 v32,v24,v25
v_cvt_pk_bf16_f32 v33,v26,v27
v_cvt_pk_bf16_f32 v34,v28,v29
v_cvt_pk_bf16_f32 v35,v30,v31
v_lshlrev_b32 v24,16,v32
v_and_b32 v25,0xffff0000,v32
v_lshlrev_b32 v26,16,v33
v_and_b32 v27,0xffff0000,v33
v_lshlrev_b32 v28,16,v34
v_and_b32 v29,0xffff0000,v34
v_lshlrev_b32 v30,16,v35
v_and_b32 v31,0xffff0000,v35
v_pk_mul_f32 v[24:25],v[24:25],v[174:175] op_sel:[0,1] op_sel_hi:[1,1]
v_pk_mul_f32 v[26:27],v[26:27],v[174:175] op_sel:[0,1] op_sel_hi:[1,1]
v_pk_mul_f32 v[28:29],v[28:29],v[174:175] op_sel:[0,1] op_sel_hi:[1,1]
v_pk_mul_f32 v[30:31],v[30:31],v[174:175] op_sel:[0,1] op_sel_hi:[1,1]
v_cvt_pk_bf16_f32 v120,v24,v25
v_cvt_pk_bf16_f32 v121,v26,v27
v_cvt_pk_bf16_f32 v122,v28,v29
v_cvt_pk_bf16_f32 v123,v30,v31
global_store_dwordx4 v2,v[120:123],s[30:31] offset:2048 sc1
v_accvgpr_read_b32 v24,a248
v_accvgpr_read_b32 v25,a249
v_accvgpr_read_b32 v26,a250
v_accvgpr_read_b32 v27,a251
v_accvgpr_read_b32 v28,a252
v_accvgpr_read_b32 v29,a253
v_accvgpr_read_b32 v30,a254
v_accvgpr_read_b32 v31,a255
v_cvt_pk_bf16_f32 v32,v24,v25
v_cvt_pk_bf16_f32 v33,v26,v27
v_cvt_pk_bf16_f32 v34,v28,v29
v_cvt_pk_bf16_f32 v35,v30,v31
v_lshlrev_b32 v24,16,v32
v_and_b32 v25,0xffff0000,v32
v_lshlrev_b32 v26,16,v33
v_and_b32 v27,0xffff0000,v33
v_lshlrev_b32 v28,16,v34
v_and_b32 v29,0xffff0000,v34
v_lshlrev_b32 v30,16,v35
v_and_b32 v31,0xffff0000,v35
v_pk_mul_f32 v[24:25],v[24:25],v[174:175] op_sel:[0,1] op_sel_hi:[1,1]
v_pk_mul_f32 v[26:27],v[26:27],v[174:175] op_sel:[0,1] op_sel_hi:[1,1]
v_pk_mul_f32 v[28:29],v[28:29],v[174:175] op_sel:[0,1] op_sel_hi:[1,1]
v_pk_mul_f32 v[30:31],v[30:31],v[174:175] op_sel:[0,1] op_sel_hi:[1,1]
v_cvt_pk_bf16_f32 v124,v24,v25
v_cvt_pk_bf16_f32 v125,v26,v27
v_cvt_pk_bf16_f32 v126,v28,v29
v_cvt_pk_bf16_f32 v127,v30,v31
global_store_dwordx4 v2,v[124:127],s[30:31] offset:3072 sc1
s_lshl_b32 s54,s32,7
s_add_u32 s54,s54,94437376
v_mov_b32 v233,s54
s_cmp_eq_u32 s32,63
s_cselect_b32 s39,0,s38
s_cmp_le_u32 s36,3
s_cselect_b32 s54,2,1
s_cmp_eq_u32 s36,5
s_cselect_b32 s54,2,s54
v_mov_b32 v252,s54
s_waitcnt vmcnt(32)
s_branch L_bulk_adv
L_g_v:
s_barrier
ds_read_b128 v[64:67],v12 offset:0
ds_read_b64_tr_b16 v[96:97],v16 offset:0
ds_read_b64_tr_b16 v[98:99],v16 offset:4096
ds_read_b128 v[68:71],v12 offset:1024
ds_read_b64_tr_b16 v[100:101],v17 offset:0
ds_read_b64_tr_b16 v[102:103],v17 offset:4096
ds_read_b128 v[72:75],v12 offset:2048
ds_read_b64_tr_b16 v[104:105],v18 offset:0
ds_read_b64_tr_b16 v[106:107],v18 offset:4096
ds_read_b128 v[76:79],v12 offset:3072
ds_read_b64_tr_b16 v[108:109],v19 offset:0
ds_read_b64_tr_b16 v[110:111],v19 offset:4096
ds_read_b128 v[80:83],v12 offset:4096
ds_read_b64_tr_b16 v[112:113],v20 offset:0
ds_read_b64_tr_b16 v[114:115],v20 offset:4096
ds_read_b128 v[84:87],v12 offset:5120
ds_read_b64_tr_b16 v[116:117],v21 offset:0
ds_read_b64_tr_b16 v[118:119],v21 offset:4096
ds_read_b128 v[88:91],v12 offset:6144
ds_read_b64_tr_b16 v[120:121],v22 offset:0
ds_read_b64_tr_b16 v[122:123],v22 offset:4096
ds_read_b128 v[92:95],v12 offset:7168
ds_read_b64_tr_b16 v[124:125],v23 offset:0
ds_read_b64_tr_b16 v[126:127],v23 offset:4096
s_waitcnt vmcnt(63) lgkmcnt(0)
s_barrier
v_mfma_f32_16x16x32_bf16 a[0:3],v[64:67],v[96:99],0
ds_read_b128 v[128:131],v12 offset:16384
v_mfma_f32_16x16x32_bf16 a[4:7],v[64:67],v[100:103],0
s_add_u32 m0,s23,0
v_mfma_f32_16x16x32_bf16 a[8:11],v[64:67],v[104:107],0
ds_read_b64_tr_b16 v[160:161],v16 offset:16384
v_mfma_f32_16x16x32_bf16 a[12:15],v[64:67],v[108:111],0
global_load_lds_dwordx4 v4,s[16:17] offset:0 sc1
v_mfma_f32_16x16x32_bf16 a[16:19],v[64:67],v[112:115],0
ds_read_b64_tr_b16 v[162:163],v16 offset:20480
v_mfma_f32_16x16x32_bf16 a[20:23],v[64:67],v[116:119],0
v_mfma_f32_16x16x32_bf16 a[24:27],v[64:67],v[120:123],0
ds_read_b128 v[132:135],v12 offset:17408
v_mfma_f32_16x16x32_bf16 a[28:31],v[64:67],v[124:127],0
global_load_lds_dwordx4 v5,s[16:17] offset:1024 sc1
v_mfma_f32_16x16x32_bf16 a[32:35],v[68:71],v[96:99],0
ds_read_b64_tr_b16 v[164:165],v17 offset:16384
v_mfma_f32_16x16x32_bf16 a[36:39],v[68:71],v[100:103],0
v_mfma_f32_16x16x32_bf16 a[40:43],v[68:71],v[104:107],0
ds_read_b64_tr_b16 v[166:167],v17 offset:20480
v_mfma_f32_16x16x32_bf16 a[44:47],v[68:71],v[108:111],0
global_load_lds_dwordx4 v6,s[16:17] offset:2048 sc1
v_mfma_f32_16x16x32_bf16 a[48:51],v[68:71],v[112:115],0
ds_read_b128 v[136:139],v12 offset:18432
v_mfma_f32_16x16x32_bf16 a[52:55],v[68:71],v[116:119],0
v_mfma_f32_16x16x32_bf16 a[56:59],v[68:71],v[120:123],0
ds_read_b64_tr_b16 v[168:169],v18 offset:16384
v_mfma_f32_16x16x32_bf16 a[60:63],v[68:71],v[124:127],0
global_load_lds_dwordx4 v7,s[16:17] offset:3072 sc1
v_mfma_f32_16x16x32_bf16 a[64:67],v[72:75],v[96:99],0
ds_read_b64_tr_b16 v[170:171],v18 offset:20480
v_mfma_f32_16x16x32_bf16 a[68:71],v[72:75],v[100:103],0
v_mfma_f32_16x16x32_bf16 a[72:75],v[72:75],v[104:107],0
ds_read_b128 v[140:143],v12 offset:19456
v_mfma_f32_16x16x32_bf16 a[76:79],v[72:75],v[108:111],0
s_add_u32 m0,s23,65536
v_mfma_f32_16x16x32_bf16 a[80:83],v[72:75],v[112:115],0
ds_read_b64_tr_b16 v[172:173],v19 offset:16384
v_mfma_f32_16x16x32_bf16 a[84:87],v[72:75],v[116:119],0
s_add_u32 s16,s16,s20
v_mfma_f32_16x16x32_bf16 a[88:91],v[72:75],v[120:123],0
ds_read_b64_tr_b16 v[174:175],v19 offset:20480
v_mfma_f32_16x16x32_bf16 a[92:95],v[72:75],v[124:127],0
s_addc_u32 s17,s17,0
v_mfma_f32_16x16x32_bf16 a[96:99],v[76:79],v[96:99],0
ds_read_b128 v[144:147],v12 offset:20480
v_mfma_f32_16x16x32_bf16 a[100:103],v[76:79],v[100:103],0
global_load_lds_dwordx4 v8,s[18:19] offset:0
v_mfma_f32_16x16x32_bf16 a[104:107],v[76:79],v[104:107],0
ds_read_b64_tr_b16 v[176:177],v20 offset:16384
v_mfma_f32_16x16x32_bf16 a[108:111],v[76:79],v[108:111],0
v_mfma_f32_16x16x32_bf16 a[112:115],v[76:79],v[112:115],0
ds_read_b64_tr_b16 v[178:179],v20 offset:20480
v_mfma_f32_16x16x32_bf16 a[116:119],v[76:79],v[116:119],0
global_load_lds_dwordx4 v9,s[18:19] offset:1024
v_mfma_f32_16x16x32_bf16 a[120:123],v[76:79],v[120:123],0
ds_read_b128 v[148:151],v12 offset:21504
v_mfma_f32_16x16x32_bf16 a[124:127],v[76:79],v[124:127],0
v_mfma_f32_16x16x32_bf16 a[128:131],v[80:83],v[96:99],0
ds_read_b64_tr_b16 v[180:181],v21 offset:16384
v_mfma_f32_16x16x32_bf16 a[132:135],v[80:83],v[100:103],0
global_load_lds_dwordx4 v10,s[18:19] offset:2048
v_mfma_f32_16x16x32_bf16 a[136:139],v[80:83],v[104:107],0
ds_read_b64_tr_b16 v[182:183],v21 offset:20480
v_mfma_f32_16x16x32_bf16 a[140:143],v[80:83],v[108:111],0
v_mfma_f32_16x16x32_bf16 a[144:147],v[80:83],v[112:115],0
ds_read_b128 v[152:155],v12 offset:22528
v_mfma_f32_16x16x32_bf16 a[148:151],v[80:83],v[116:119],0
global_load_lds_dwordx4 v11,s[18:19] offset:3072
v_mfma_f32_16x16x32_bf16 a[152:155],v[80:83],v[120:123],0
ds_read_b64_tr_b16 v[184:185],v22 offset:16384
v_mfma_f32_16x16x32_bf16 a[156:159],v[80:83],v[124:127],0
v_mfma_f32_16x16x32_bf16 a[160:163],v[84:87],v[96:99],0
ds_read_b64_tr_b16 v[186:187],v22 offset:20480
v_mfma_f32_16x16x32_bf16 a[164:167],v[84:87],v[100:103],0
s_add_u32 s18,s18,s21
v_mfma_f32_16x16x32_bf16 a[168:171],v[84:87],v[104:107],0
ds_read_b128 v[156:159],v12 offset:23552
v_mfma_f32_16x16x32_bf16 a[172:175],v[84:87],v[108:111],0
s_addc_u32 s19,s19,0
v_mfma_f32_16x16x32_bf16 a[176:179],v[84:87],v[112:115],0
ds_read_b64_tr_b16 v[188:189],v23 offset:16384
v_mfma_f32_16x16x32_bf16 a[180:183],v[84:87],v[116:119],0
v_mfma_f32_16x16x32_bf16 a[184:187],v[84:87],v[120:123],0
ds_read_b64_tr_b16 v[190:191],v23 offset:20480
v_mfma_f32_16x16x32_bf16 a[188:191],v[84:87],v[124:127],0
v_mfma_f32_16x16x32_bf16 a[192:195],v[88:91],v[96:99],0
v_mfma_f32_16x16x32_bf16 a[196:199],v[88:91],v[100:103],0
v_mfma_f32_16x16x32_bf16 a[200:203],v[88:91],v[104:107],0
v_mfma_f32_16x16x32_bf16 a[204:207],v[88:91],v[108:111],0
v_mfma_f32_16x16x32_bf16 a[208:211],v[88:91],v[112:115],0
v_mfma_f32_16x16x32_bf16 a[212:215],v[88:91],v[116:119],0
v_mfma_f32_16x16x32_bf16 a[216:219],v[88:91],v[120:123],0
v_mfma_f32_16x16x32_bf16 a[220:223],v[88:91],v[124:127],0
v_mfma_f32_16x16x32_bf16 a[224:227],v[92:95],v[96:99],0
v_mfma_f32_16x16x32_bf16 a[228:231],v[92:95],v[100:103],0
v_mfma_f32_16x16x32_bf16 a[232:235],v[92:95],v[104:107],0
v_mfma_f32_16x16x32_bf16 a[236:239],v[92:95],v[108:111],0
v_mfma_f32_16x16x32_bf16 a[240:243],v[92:95],v[112:115],0
v_mfma_f32_16x16x32_bf16 a[244:247],v[92:95],v[116:119],0
v_mfma_f32_16x16x32_bf16 a[248:251],v[92:95],v[120:123],0
v_mfma_f32_16x16x32_bf16 a[252:255],v[92:95],v[124:127],0
s_waitcnt vmcnt(63) lgkmcnt(0)
s_barrier
v_mfma_f32_16x16x32_bf16 a[0:3],v[128:131],v[160:163],a[0:3]
ds_read_b128 v[64:67],v12 offset:32768
v_mfma_f32_16x16x32_bf16 a[4:7],v[128:131],v[164:167],a[4:7]
s_add_u32 m0,s23,16384
v_mfma_f32_16x16x32_bf16 a[8:11],v[128:131],v[168:171],a[8:11]
ds_read_b64_tr_b16 v[96:97],v16 offset:32768
v_mfma_f32_16x16x32_bf16 a[12:15],v[128:131],v[172:175],a[12:15]
global_load_lds_dwordx4 v4,s[16:17] offset:0 sc1
v_mfma_f32_16x16x32_bf16 a[16:19],v[128:131],v[176:179],a[16:19]
ds_read_b64_tr_b16 v[98:99],v16 offset:36864
v_mfma_f32_16x16x32_bf16 a[20:23],v[128:131],v[180:183],a[20:23]
v_mfma_f32_16x16x32_bf16 a[24:27],v[128:131],v[184:187],a[24:27]
ds_read_b128 v[68:71],v12 offset:33792
v_mfma_f32_16x16x32_bf16 a[28:31],v[128:131],v[188:191],a[28:31]
global_load_lds_dwordx4 v5,s[16:17] offset:1024 sc1
v_mfma_f32_16x16x32_bf16 a[32:35],v[132:135],v[160:163],a[32:35]
ds_read_b64_tr_b16 v[100:101],v17 offset:32768
v_mfma_f32_16x16x32_bf16 a[36:39],v[132:135],v[164:167],a[36:39]
v_mfma_f32_16x16x32_bf16 a[40:43],v[132:135],v[168:171],a[40:43]
ds_read_b64_tr_b16 v[102:103],v17 offset:36864
v_mfma_f32_16x16x32_bf16 a[44:47],v[132:135],v[172:175],a[44:47]
global_load_lds_dwordx4 v6,s[16:17] offset:2048 sc1
v_mfma_f32_16x16x32_bf16 a[48:51],v[132:135],v[176:179],a[48:51]
ds_read_b128 v[72:75],v12 offset:34816
v_mfma_f32_16x16x32_bf16 a[52:55],v[132:135],v[180:183],a[52:55]
v_mfma_f32_16x16x32_bf16 a[56:59],v[132:135],v[184:187],a[56:59]
ds_read_b64_tr_b16 v[104:105],v18 offset:32768
v_mfma_f32_16x16x32_bf16 a[60:63],v[132:135],v[188:191],a[60:63]
global_load_lds_dwordx4 v7,s[16:17] offset:3072 sc1
v_mfma_f32_16x16x32_bf16 a[64:67],v[136:139],v[160:163],a[64:67]
ds_read_b64_tr_b16 v[106:107],v18 offset:36864
v_mfma_f32_16x16x32_bf16 a[68:71],v[136:139],v[164:167],a[68:71]
v_mfma_f32_16x16x32_bf16 a[72:75],v[136:139],v[168:171],a[72:75]
ds_read_b128 v[76:79],v12 offset:35840
v_mfma_f32_16x16x32_bf16 a[76:79],v[136:139],v[172:175],a[76:79]
s_add_u32 m0,s23,81920
v_mfma_f32_16x16x32_bf16 a[80:83],v[136:139],v[176:179],a[80:83]
ds_read_b64_tr_b16 v[108:109],v19 offset:32768
v_mfma_f32_16x16x32_bf16 a[84:87],v[136:139],v[180:183],a[84:87]
s_add_u32 s16,s16,s20
v_mfma_f32_16x16x32_bf16 a[88:91],v[136:139],v[184:187],a[88:91]
ds_read_b64_tr_b16 v[110:111],v19 offset:36864
v_mfma_f32_16x16x32_bf16 a[92:95],v[136:139],v[188:191],a[92:95]
s_addc_u32 s17,s17,0
v_mfma_f32_16x16x32_bf16 a[96:99],v[140:143],v[160:163],a[96:99]
ds_read_b128 v[80:83],v12 offset:36864
v_mfma_f32_16x16x32_bf16 a[100:103],v[140:143],v[164:167],a[100:103]
global_load_lds_dwordx4 v8,s[18:19] offset:0
v_mfma_f32_16x16x32_bf16 a[104:107],v[140:143],v[168:171],a[104:107]
ds_read_b64_tr_b16 v[112:113],v20 offset:32768
v_mfma_f32_16x16x32_bf16 a[108:111],v[140:143],v[172:175],a[108:111]
v_mfma_f32_16x16x32_bf16 a[112:115],v[140:143],v[176:179],a[112:115]
ds_read_b64_tr_b16 v[114:115],v20 offset:36864
v_mfma_f32_16x16x32_bf16 a[116:119],v[140:143],v[180:183],a[116:119]
global_load_lds_dwordx4 v9,s[18:19] offset:1024
v_mfma_f32_16x16x32_bf16 a[120:123],v[140:143],v[184:187],a[120:123]
ds_read_b128 v[84:87],v12 offset:37888
v_mfma_f32_16x16x32_bf16 a[124:127],v[140:143],v[188:191],a[124:127]
v_mfma_f32_16x16x32_bf16 a[128:131],v[144:147],v[160:163],a[128:131]
ds_read_b64_tr_b16 v[116:117],v21 offset:32768
v_mfma_f32_16x16x32_bf16 a[132:135],v[144:147],v[164:167],a[132:135]
global_load_lds_dwordx4 v10,s[18:19] offset:2048
v_mfma_f32_16x16x32_bf16 a[136:139],v[144:147],v[168:171],a[136:139]
ds_read_b64_tr_b16 v[118:119],v21 offset:36864
v_mfma_f32_16x16x32_bf16 a[140:143],v[144:147],v[172:175],a[140:143]
v_mfma_f32_16x16x32_bf16 a[144:147],v[144:147],v[176:179],a[144:147]
ds_read_b128 v[88:91],v12 offset:38912
v_mfma_f32_16x16x32_bf16 a[148:151],v[144:147],v[180:183],a[148:151]
global_load_lds_dwordx4 v11,s[18:19] offset:3072
v_mfma_f32_16x16x32_bf16 a[152:155],v[144:147],v[184:187],a[152:155]
ds_read_b64_tr_b16 v[120:121],v22 offset:32768
v_mfma_f32_16x16x32_bf16 a[156:159],v[144:147],v[188:191],a[156:159]
v_mfma_f32_16x16x32_bf16 a[160:163],v[148:151],v[160:163],a[160:163]
ds_read_b64_tr_b16 v[122:123],v22 offset:36864
v_mfma_f32_16x16x32_bf16 a[164:167],v[148:151],v[164:167],a[164:167]
s_add_u32 s18,s18,s21
v_mfma_f32_16x16x32_bf16 a[168:171],v[148:151],v[168:171],a[168:171]
ds_read_b128 v[92:95],v12 offset:39936
v_mfma_f32_16x16x32_bf16 a[172:175],v[148:151],v[172:175],a[172:175]
s_addc_u32 s19,s19,0
v_mfma_f32_16x16x32_bf16 a[176:179],v[148:151],v[176:179],a[176:179]
ds_read_b64_tr_b16 v[124:125],v23 offset:32768
v_mfma_f32_16x16x32_bf16 a[180:183],v[148:151],v[180:183],a[180:183]
v_mfma_f32_16x16x32_bf16 a[184:187],v[148:151],v[184:187],a[184:187]
ds_read_b64_tr_b16 v[126:127],v23 offset:36864
v_mfma_f32_16x16x32_bf16 a[188:191],v[148:151],v[188:191],a[188:191]
v_mfma_f32_16x16x32_bf16 a[192:195],v[152:155],v[160:163],a[192:195]
v_mfma_f32_16x16x32_bf16 a[196:199],v[152:155],v[164:167],a[196:199]
v_mfma_f32_16x16x32_bf16 a[200:203],v[152:155],v[168:171],a[200:203]
v_mfma_f32_16x16x32_bf16 a[204:207],v[152:155],v[172:175],a[204:207]
v_mfma_f32_16x16x32_bf16 a[208:211],v[152:155],v[176:179],a[208:211]
v_mfma_f32_16x16x32_bf16 a[212:215],v[152:155],v[180:183],a[212:215]
v_mfma_f32_16x16x32_bf16 a[216:219],v[152:155],v[184:187],a[216:219]
v_mfma_f32_16x16x32_bf16 a[220:223],v[152:155],v[188:191],a[220:223]
v_mfma_f32_16x16x32_bf16 a[224:227],v[156:159],v[160:163],a[224:227]
v_mfma_f32_16x16x32_bf16 a[228:231],v[156:159],v[164:167],a[228:231]
v_mfma_f32_16x16x32_bf16 a[232:235],v[156:159],v[168:171],a[232:235]
v_mfma_f32_16x16x32_bf16 a[236:239],v[156:159],v[172:175],a[236:239]
v_mfma_f32_16x16x32_bf16 a[240:243],v[156:159],v[176:179],a[240:243]
v_mfma_f32_16x16x32_bf16 a[244:247],v[156:159],v[180:183],a[244:247]
v_mfma_f32_16x16x32_bf16 a[248:251],v[156:159],v[184:187],a[248:251]
v_mfma_f32_16x16x32_bf16 a[252:255],v[156:159],v[188:191],a[252:255]
s_waitcnt vmcnt(63) lgkmcnt(0)
s_barrier
v_mfma_f32_16x16x32_bf16 a[0:3],v[64:67],v[96:99],a[0:3]
ds_read_b128 v[128:131],v12 offset:49152
v_mfma_f32_16x16x32_bf16 a[4:7],v[64:67],v[100:103],a[4:7]
s_add_u32 m0,s23,32768
v_mfma_f32_16x16x32_bf16 a[8:11],v[64:67],v[104:107],a[8:11]
ds_read_b64_tr_b16 v[160:161],v16 offset:49152
v_mfma_f32_16x16x32_bf16 a[12:15],v[64:67],v[108:111],a[12:15]
global_load_lds_dwordx4 v4,s[16:17] offset:0 sc1
v_mfma_f32_16x16x32_bf16 a[16:19],v[64:67],v[112:115],a[16:19]
ds_read_b64_tr_b16 v[162:163],v16 offset:53248
v_mfma_f32_16x16x32_bf16 a[20:23],v[64:67],v[116:119],a[20:23]
v_mfma_f32_16x16x32_bf16 a[24:27],v[64:67],v[120:123],a[24:27]
ds_read_b128 v[132:135],v12 offset:50176
v_mfma_f32_16x16x32_bf16 a[28:31],v[64:67],v[124:127],a[28:31]
global_load_lds_dwordx4 v5,s[16:17] offset:1024 sc1
v_mfma_f32_16x16x32_bf16 a[32:35],v[68:71],v[96:99],a[32:35]
ds_read_b64_tr_b16 v[164:165],v17 offset:49152
v_mfma_f32_16x16x32_bf16 a[36:39],v[68:71],v[100:103],a[36:39]
v_mfma_f32_16x16x32_bf16 a[40:43],v[68:71],v[104:107],a[40:43]
ds_read_b64_tr_b16 v[166:167],v17 offset:53248
v_mfma_f32_16x16x32_bf16 a[44:47],v[68:71],v[108:111],a[44:47]
global_load_lds_dwordx4 v6,s[16:17] offset:2048 sc1
v_mfma_f32_16x16x32_bf16 a[48:51],v[68:71],v[112:115],a[48:51]
ds_read_b128 v[136:139],v12 offset:51200
v_mfma_f32_16x16x32_bf16 a[52:55],v[68:71],v[116:119],a[52:55]
v_mfma_f32_16x16x32_bf16 a[56:59],v[68:71],v[120:123],a[56:59]
ds_read_b64_tr_b16 v[168:169],v18 offset:49152
v_mfma_f32_16x16x32_bf16 a[60:63],v[68:71],v[124:127],a[60:63]
global_load_lds_dwordx4 v7,s[16:17] offset:3072 sc1
v_mfma_f32_16x16x32_bf16 a[64:67],v[72:75],v[96:99],a[64:67]
ds_read_b64_tr_b16 v[170:171],v18 offset:53248
v_mfma_f32_16x16x32_bf16 a[68:71],v[72:75],v[100:103],a[68:71]
v_mfma_f32_16x16x32_bf16 a[72:75],v[72:75],v[104:107],a[72:75]
ds_read_b128 v[140:143],v12 offset:52224
v_mfma_f32_16x16x32_bf16 a[76:79],v[72:75],v[108:111],a[76:79]
s_add_u32 m0,s23,98304
v_mfma_f32_16x16x32_bf16 a[80:83],v[72:75],v[112:115],a[80:83]
ds_read_b64_tr_b16 v[172:173],v19 offset:49152
v_mfma_f32_16x16x32_bf16 a[84:87],v[72:75],v[116:119],a[84:87]
s_add_u32 s16,s16,s20
v_mfma_f32_16x16x32_bf16 a[88:91],v[72:75],v[120:123],a[88:91]
ds_read_b64_tr_b16 v[174:175],v19 offset:53248
v_mfma_f32_16x16x32_bf16 a[92:95],v[72:75],v[124:127],a[92:95]
s_addc_u32 s17,s17,0
v_mfma_f32_16x16x32_bf16 a[96:99],v[76:79],v[96:99],a[96:99]
ds_read_b128 v[144:147],v12 offset:53248
v_mfma_f32_16x16x32_bf16 a[100:103],v[76:79],v[100:103],a[100:103]
global_load_lds_dwordx4 v8,s[18:19] offset:0
v_mfma_f32_16x16x32_bf16 a[104:107],v[76:79],v[104:107],a[104:107]
ds_read_b64_tr_b16 v[176:177],v20 offset:49152
v_mfma_f32_16x16x32_bf16 a[108:111],v[76:79],v[108:111],a[108:111]
v_mfma_f32_16x16x32_bf16 a[112:115],v[76:79],v[112:115],a[112:115]
ds_read_b64_tr_b16 v[178:179],v20 offset:53248
v_mfma_f32_16x16x32_bf16 a[116:119],v[76:79],v[116:119],a[116:119]
global_load_lds_dwordx4 v9,s[18:19] offset:1024
v_mfma_f32_16x16x32_bf16 a[120:123],v[76:79],v[120:123],a[120:123]
ds_read_b128 v[148:151],v12 offset:54272
v_mfma_f32_16x16x32_bf16 a[124:127],v[76:79],v[124:127],a[124:127]
v_mfma_f32_16x16x32_bf16 a[128:131],v[80:83],v[96:99],a[128:131]
ds_read_b64_tr_b16 v[180:181],v21 offset:49152
v_mfma_f32_16x16x32_bf16 a[132:135],v[80:83],v[100:103],a[132:135]
global_load_lds_dwordx4 v10,s[18:19] offset:2048
v_mfma_f32_16x16x32_bf16 a[136:139],v[80:83],v[104:107],a[136:139]
ds_read_b64_tr_b16 v[182:183],v21 offset:53248
v_mfma_f32_16x16x32_bf16 a[140:143],v[80:83],v[108:111],a[140:143]
v_mfma_f32_16x16x32_bf16 a[144:147],v[80:83],v[112:115],a[144:147]
ds_read_b128 v[152:155],v12 offset:55296
v_mfma_f32_16x16x32_bf16 a[148:151],v[80:83],v[116:119],a[148:151]
global_load_lds_dwordx4 v11,s[18:19] offset:3072
v_mfma_f32_16x16x32_bf16 a[152:155],v[80:83],v[120:123],a[152:155]
ds_read_b64_tr_b16 v[184:185],v22 offset:49152
v_mfma_f32_16x16x32_bf16 a[156:159],v[80:83],v[124:127],a[156:159]
v_mfma_f32_16x16x32_bf16 a[160:163],v[84:87],v[96:99],a[160:163]
ds_read_b64_tr_b16 v[186:187],v22 offset:53248
v_mfma_f32_16x16x32_bf16 a[164:167],v[84:87],v[100:103],a[164:167]
s_add_u32 s18,s18,s21
v_mfma_f32_16x16x32_bf16 a[168:171],v[84:87],v[104:107],a[168:171]
ds_read_b128 v[156:159],v12 offset:56320
v_mfma_f32_16x16x32_bf16 a[172:175],v[84:87],v[108:111],a[172:175]
s_addc_u32 s19,s19,0
v_mfma_f32_16x16x32_bf16 a[176:179],v[84:87],v[112:115],a[176:179]
ds_read_b64_tr_b16 v[188:189],v23 offset:49152
v_mfma_f32_16x16x32_bf16 a[180:183],v[84:87],v[116:119],a[180:183]
v_mfma_f32_16x16x32_bf16 a[184:187],v[84:87],v[120:123],a[184:187]
ds_read_b64_tr_b16 v[190:191],v23 offset:53248
v_mfma_f32_16x16x32_bf16 a[188:191],v[84:87],v[124:127],a[188:191]
v_mfma_f32_16x16x32_bf16 a[192:195],v[88:91],v[96:99],a[192:195]
v_mfma_f32_16x16x32_bf16 a[196:199],v[88:91],v[100:103],a[196:199]
v_mfma_f32_16x16x32_bf16 a[200:203],v[88:91],v[104:107],a[200:203]
v_mfma_f32_16x16x32_bf16 a[204:207],v[88:91],v[108:111],a[204:207]
v_mfma_f32_16x16x32_bf16 a[208:211],v[88:91],v[112:115],a[208:211]
v_mfma_f32_16x16x32_bf16 a[212:215],v[88:91],v[116:119],a[212:215]
v_mfma_f32_16x16x32_bf16 a[216:219],v[88:91],v[120:123],a[216:219]
v_mfma_f32_16x16x32_bf16 a[220:223],v[88:91],v[124:127],a[220:223]
v_mfma_f32_16x16x32_bf16 a[224:227],v[92:95],v[96:99],a[224:227]
v_mfma_f32_16x16x32_bf16 a[228:231],v[92:95],v[100:103],a[228:231]
v_mfma_f32_16x16x32_bf16 a[232:235],v[92:95],v[104:107],a[232:235]
v_mfma_f32_16x16x32_bf16 a[236:239],v[92:95],v[108:111],a[236:239]
v_mfma_f32_16x16x32_bf16 a[240:243],v[92:95],v[112:115],a[240:243]
v_mfma_f32_16x16x32_bf16 a[244:247],v[92:95],v[116:119],a[244:247]
v_mfma_f32_16x16x32_bf16 a[248:251],v[92:95],v[120:123],a[248:251]
v_mfma_f32_16x16x32_bf16 a[252:255],v[92:95],v[124:127],a[252:255]
s_waitcnt vmcnt(16) lgkmcnt(0)
s_barrier
v_mfma_f32_16x16x32_bf16 a[0:3],v[128:131],v[160:163],a[0:3]
ds_read_b128 v[64:67],v12 offset:0
v_mfma_f32_16x16x32_bf16 a[4:7],v[128:131],v[164:167],a[4:7]
s_add_u32 m0,s23,49152
v_mfma_f32_16x16x32_bf16 a[8:11],v[128:131],v[168:171],a[8:11]
ds_read_b64_tr_b16 v[96:97],v16 offset:0
v_mfma_f32_16x16x32_bf16 a[12:15],v[128:131],v[172:175],a[12:15]
global_load_lds_dwordx4 v4,s[16:17] offset:0 sc1
v_mfma_f32_16x16x32_bf16 a[16:19],v[128:131],v[176:179],a[16:19]
ds_read_b64_tr_b16 v[98:99],v16 offset:4096
v_mfma_f32_16x16x32_bf16 a[20:23],v[128:131],v[180:183],a[20:23]
v_mfma_f32_16x16x32_bf16 a[24:27],v[128:131],v[184:187],a[24:27]
ds_read_b128 v[68:71],v12 offset:1024
v_mfma_f32_16x16x32_bf16 a[28:31],v[128:131],v[188:191],a[28:31]
global_load_lds_dwordx4 v5,s[16:17] offset:1024 sc1
v_mfma_f32_16x16x32_bf16 a[32:35],v[132:135],v[160:163],a[32:35]
ds_read_b64_tr_b16 v[100:101],v17 offset:0
v_mfma_f32_16x16x32_bf16 a[36:39],v[132:135],v[164:167],a[36:39]
v_mfma_f32_16x16x32_bf16 a[40:43],v[132:135],v[168:171],a[40:43]
ds_read_b64_tr_b16 v[102:103],v17 offset:4096
v_mfma_f32_16x16x32_bf16 a[44:47],v[132:135],v[172:175],a[44:47]
global_load_lds_dwordx4 v6,s[16:17] offset:2048 sc1
v_mfma_f32_16x16x32_bf16 a[48:51],v[132:135],v[176:179],a[48:51]
ds_read_b128 v[72:75],v12 offset:2048
v_mfma_f32_16x16x32_bf16 a[52:55],v[132:135],v[180:183],a[52:55]
v_mfma_f32_16x16x32_bf16 a[56:59],v[132:135],v[184:187],a[56:59]
ds_read_b64_tr_b16 v[104:105],v18 offset:0
v_mfma_f32_16x16x32_bf16 a[60:63],v[132:135],v[188:191],a[60:63]
global_load_lds_dwordx4 v7,s[16:17] offset:3072 sc1
v_mfma_f32_16x16x32_bf16 a[64:67],v[136:139],v[160:163],a[64:67]
ds_read_b64_tr_b16 v[106:107],v18 offset:4096
v_mfma_f32_16x16x32_bf16 a[68:71],v[136:139],v[164:167],a[68:71]
v_mfma_f32_16x16x32_bf16 a[72:75],v[136:139],v[168:171],a[72:75]
ds_read_b128 v[76:79],v12 offset:3072
v_mfma_f32_16x16x32_bf16 a[76:79],v[136:139],v[172:175],a[76:79]
s_add_u32 m0,s23,114688
v_mfma_f32_16x16x32_bf16 a[80:83],v[136:139],v[176:179],a[80:83]
ds_read_b64_tr_b16 v[108:109],v19 offset:0
v_mfma_f32_16x16x32_bf16 a[84:87],v[136:139],v[180:183],a[84:87]
s_add_u32 s16,s16,s20
v_mfma_f32_16x16x32_bf16 a[88:91],v[136:139],v[184:187],a[88:91]
ds_read_b64_tr_b16 v[110:111],v19 offset:4096
v_mfma_f32_16x16x32_bf16 a[92:95],v[136:139],v[188:191],a[92:95]
s_addc_u32 s17,s17,0
v_mfma_f32_16x16x32_bf16 a[96:99],v[140:143],v[160:163],a[96:99]
ds_read_b128 v[80:83],v12 offset:4096
v_mfma_f32_16x16x32_bf16 a[100:103],v[140:143],v[164:167],a[100:103]
global_load_lds_dwordx4 v8,s[18:19] offset:0
v_mfma_f32_16x16x32_bf16 a[104:107],v[140:143],v[168:171],a[104:107]
ds_read_b64_tr_b16 v[112:113],v20 offset:0
v_mfma_f32_16x16x32_bf16 a[108:111],v[140:143],v[172:175],a[108:111]
v_mfma_f32_16x16x32_bf16 a[112:115],v[140:143],v[176:179],a[112:115]
ds_read_b64_tr_b16 v[114:115],v20 offset:4096
v_mfma_f32_16x16x32_bf16 a[116:119],v[140:143],v[180:183],a[116:119]
global_load_lds_dwordx4 v9,s[18:19] offset:1024
v_mfma_f32_16x16x32_bf16 a[120:123],v[140:143],v[184:187],a[120:123]
ds_read_b128 v[84:87],v12 offset:5120
v_mfma_f32_16x16x32_bf16 a[124:127],v[140:143],v[188:191],a[124:127]
v_mfma_f32_16x16x32_bf16 a[128:131],v[144:147],v[160:163],a[128:131]
ds_read_b64_tr_b16 v[116:117],v21 offset:0
v_mfma_f32_16x16x32_bf16 a[132:135],v[144:147],v[164:167],a[132:135]
global_load_lds_dwordx4 v10,s[18:19] offset:2048
v_mfma_f32_16x16x32_bf16 a[136:139],v[144:147],v[168:171],a[136:139]
ds_read_b64_tr_b16 v[118:119],v21 offset:4096
v_mfma_f32_16x16x32_bf16 a[140:143],v[144:147],v[172:175],a[140:143]
v_mfma_f32_16x16x32_bf16 a[144:147],v[144:147],v[176:179],a[144:147]
ds_read_b128 v[88:91],v12 offset:6144
v_mfma_f32_16x16x32_bf16 a[148:151],v[144:147],v[180:183],a[148:151]
global_load_lds_dwordx4 v11,s[18:19] offset:3072
v_mfma_f32_16x16x32_bf16 a[152:155],v[144:147],v[184:187],a[152:155]
ds_read_b64_tr_b16 v[120:121],v22 offset:0
v_mfma_f32_16x16x32_bf16 a[156:159],v[144:147],v[188:191],a[156:159]
v_mfma_f32_16x16x32_bf16 a[160:163],v[148:151],v[160:163],a[160:163]
ds_read_b64_tr_b16 v[122:123],v22 offset:4096
v_mfma_f32_16x16x32_bf16 a[164:167],v[148:151],v[164:167],a[164:167]
s_add_u32 s18,s18,s21
v_mfma_f32_16x16x32_bf16 a[168:171],v[148:151],v[168:171],a[168:171]
ds_read_b128 v[92:95],v12 offset:7168
v_mfma_f32_16x16x32_bf16 a[172:175],v[148:151],v[172:175],a[172:175]
s_addc_u32 s19,s19,0
v_mfma_f32_16x16x32_bf16 a[176:179],v[148:151],v[176:179],a[176:179]
ds_read_b64_tr_b16 v[124:125],v23 offset:0
v_mfma_f32_16x16x32_bf16 a[180:183],v[148:151],v[180:183],a[180:183]
s_cmp_eq_u32 s39,0
s_cbranch_scc1 L_sig3
s_mov_b32 s39,0
s_mov_b64 exec,1
global_atomic_add v233,v252,s[4:5]
s_mov_b64 exec,-1
v_mov_b32 v252,1
L_sig3:
s_nop 0
v_mfma_f32_16x16x32_bf16 a[184:187],v[148:151],v[184:187],a[184:187]
ds_read_b64_tr_b16 v[126:127],v23 offset:4096
v_mfma_f32_16x16x32_bf16 a[188:191],v[148:151],v[188:191],a[188:191]
global_load_dword v236,v238,s[4:5] sc1
v_mfma_f32_16x16x32_bf16 a[192:195],v[152:155],v[160:163],a[192:195]
v_mfma_f32_16x16x32_bf16 a[196:199],v[152:155],v[164:167],a[196:199]
v_mfma_f32_16x16x32_bf16 a[200:203],v[152:155],v[168:171],a[200:203]
v_mfma_f32_16x16x32_bf16 a[204:207],v[152:155],v[172:175],a[204:207]
v_mfma_f32_16x16x32_bf16 a[208:211],v[152:155],v[176:179],a[208:211]
v_mfma_f32_16x16x32_bf16 a[212:215],v[152:155],v[180:183],a[212:215]
v_mfma_f32_16x16x32_bf16 a[216:219],v[152:155],v[184:187],a[216:219]
v_mfma_f32_16x16x32_bf16 a[220:223],v[152:155],v[188:191],a[220:223]
v_mfma_f32_16x16x32_bf16 a[224:227],v[156:159],v[160:163],a[224:227]
v_mfma_f32_16x16x32_bf16 a[228:231],v[156:159],v[164:167],a[228:231]
v_mfma_f32_16x16x32_bf16 a[232:235],v[156:159],v[168:171],a[232:235]
v_mfma_f32_16x16x32_bf16 a[236:239],v[156:159],v[172:175],a[236:239]
v_mfma_f32_16x16x32_bf16 a[240:243],v[156:159],v[176:179],a[240:243]
v_mfma_f32_16x16x32_bf16 a[244:247],v[156:159],v[180:183],a[244:247]
v_mfma_f32_16x16x32_bf16 a[248:251],v[156:159],v[184:187],a[248:251]
v_mfma_f32_16x16x32_bf16 a[252:255],v[156:159],v[188:191],a[252:255]
L_g_v_mid:
s_waitcnt vmcnt(16) lgkmcnt(0)
s_barrier
v_mfma_f32_16x16x32_bf16 a[0:3],v[64:67],v[96:99],a[0:3]
ds_read_b128 v[128:131],v12 offset:16384
v_mfma_f32_16x16x32_bf16 a[4:7],v[64:67],v[100:103],a[4:7]
s_add_u32 m0,s23,0
v_mfma_f32_16x16x32_bf16 a[8:11],v[64:67],v[104:107],a[8:11]
ds_read_b64_tr_b16 v[160:161],v16 offset:16384
v_mfma_f32_16x16x32_bf16 a[12:15],v[64:67],v[108:111],a[12:15]
global_load_lds_dwordx4 v4,s[16:17] offset:0 sc1
v_mfma_f32_16x16x32_bf16 a[16:19],v[64:67],v[112:115],a[16:19]
ds_read_b64_tr_b16 v[162:163],v16 offset:20480
v_mfma_f32_16x16x32_bf16 a[20:23],v[64:67],v[116:119],a[20:23]
v_mfma_f32_16x16x32_bf16 a[24:27],v[64:67],v[120:123],a[24:27]
ds_read_b128 v[132:135],v12 offset:17408
v_mfma_f32_16x16x32_bf16 a[28:31],v[64:67],v[124:127],a[28:31]
global_load_lds_dwordx4 v5,s[16:17] offset:1024 sc1
v_mfma_f32_16x16x32_bf16 a[32:35],v[68:71],v[96:99],a[32:35]
ds_read_b64_tr_b16 v[164:165],v17 offset:16384
v_mfma_f32_16x16x32_bf16 a[36:39],v[68:71],v[100:103],a[36:39]
v_mfma_f32_16x16x32_bf16 a[40:43],v[68:71],v[104:107],a[40:43]
ds_read_b64_tr_b16 v[166:167],v17 offset:20480
v_mfma_f32_16x16x32_bf16 a[44:47],v[68:71],v[108:111],a[44:47]
global_load_lds_dwordx4 v6,s[16:17] offset:2048 sc1
v_mfma_f32_16x16x32_bf16 a[48:51],v[68:71],v[112:115],a[48:51]
ds_read_b128 v[136:139],v12 offset:18432
v_mfma_f32_16x16x32_bf16 a[52:55],v[68:71],v[116:119],a[52:55]
v_mfma_f32_16x16x32_bf16 a[56:59],v[68:71],v[120:123],a[56:59]
ds_read_b64_tr_b16 v[168:169],v18 offset:16384
v_mfma_f32_16x16x32_bf16 a[60:63],v[68:71],v[124:127],a[60:63]
global_load_lds_dwordx4 v7,s[16:17] offset:3072 sc1
v_mfma_f32_16x16x32_bf16 a[64:67],v[72:75],v[96:99],a[64:67]
ds_read_b64_tr_b16 v[170:171],v18 offset:20480
v_mfma_f32_16x16x32_bf16 a[68:71],v[72:75],v[100:103],a[68:71]
v_mfma_f32_16x16x32_bf16 a[72:75],v[72:75],v[104:107],a[72:75]
ds_read_b128 v[140:143],v12 offset:19456
v_mfma_f32_16x16x32_bf16 a[76:79],v[72:75],v[108:111],a[76:79]
s_add_u32 m0,s23,65536
v_mfma_f32_16x16x32_bf16 a[80:83],v[72:75],v[112:115],a[80:83]
ds_read_b64_tr_b16 v[172:173],v19 offset:16384
v_mfma_f32_16x16x32_bf16 a[84:87],v[72:75],v[116:119],a[84:87]
s_add_u32 s16,s16,s20
v_mfma_f32_16x16x32_bf16 a[88:91],v[72:75],v[120:123],a[88:91]
ds_read_b64_tr_b16 v[174:175],v19 offset:20480
v_mfma_f32_16x16x32_bf16 a[92:95],v[72:75],v[124:127],a[92:95]
s_addc_u32 s17,s17,0
v_mfma_f32_16x16x32_bf16 a[96:99],v[76:79],v[96:99],a[96:99]
ds_read_b128 v[144:147],v12 offset:20480
v_mfma_f32_16x16x32_bf16 a[100:103],v[76:79],v[100:103],a[100:103]
global_load_lds_dwordx4 v8,s[18:19] offset:0
v_mfma_f32_16x16x32_bf16 a[104:107],v[76:79],v[104:107],a[104:107]
ds_read_b64_tr_b16 v[176:177],v20 offset:16384
v_mfma_f32_16x16x32_bf16 a[108:111],v[76:79],v[108:111],a[108:111]
v_mfma_f32_16x16x32_bf16 a[112:115],v[76:79],v[112:115],a[112:115]
ds_read_b64_tr_b16 v[178:179],v20 offset:20480
v_mfma_f32_16x16x32_bf16 a[116:119],v[76:79],v[116:119],a[116:119]
global_load_lds_dwordx4 v9,s[18:19] offset:1024
v_mfma_f32_16x16x32_bf16 a[120:123],v[76:79],v[120:123],a[120:123]
ds_read_b128 v[148:151],v12 offset:21504
v_mfma_f32_16x16x32_bf16 a[124:127],v[76:79],v[124:127],a[124:127]
v_mfma_f32_16x16x32_bf16 a[128:131],v[80:83],v[96:99],a[128:131]
ds_read_b64_tr_b16 v[180:181],v21 offset:16384
v_mfma_f32_16x16x32_bf16 a[132:135],v[80:83],v[100:103],a[132:135]
global_load_lds_dwordx4 v10,s[18:19] offset:2048
v_mfma_f32_16x16x32_bf16 a[136:139],v[80:83],v[104:107],a[136:139]
ds_read_b64_tr_b16 v[182:183],v21 offset:20480
v_mfma_f32_16x16x32_bf16 a[140:143],v[80:83],v[108:111],a[140:143]
v_mfma_f32_16x16x32_bf16 a[144:147],v[80:83],v[112:115],a[144:147]
ds_read_b128 v[152:155],v12 offset:22528
v_mfma_f32_16x16x32_bf16 a[148:151],v[80:83],v[116:119],a[148:151]
global_load_lds_dwordx4 v11,s[18:19] offset:3072
v_mfma_f32_16x16x32_bf16 a[152:155],v[80:83],v[120:123],a[152:155]
ds_read_b64_tr_b16 v[184:185],v22 offset:16384
v_mfma_f32_16x16x32_bf16 a[156:159],v[80:83],v[124:127],a[156:159]
v_mfma_f32_16x16x32_bf16 a[160:163],v[84:87],v[96:99],a[160:163]
ds_read_b64_tr_b16 v[186:187],v22 offset:20480
v_mfma_f32_16x16x32_bf16 a[164:167],v[84:87],v[100:103],a[164:167]
s_add_u32 s18,s18,s21
v_mfma_f32_16x16x32_bf16 a[168:171],v[84:87],v[104:107],a[168:171]
ds_read_b128 v[156:159],v12 offset:23552
v_mfma_f32_16x16x32_bf16 a[172:175],v[84:87],v[108:111],a[172:175]
s_addc_u32 s19,s19,0
v_mfma_f32_16x16x32_bf16 a[176:179],v[84:87],v[112:115],a[176:179]
ds_read_b64_tr_b16 v[188:189],v23 offset:16384
v_mfma_f32_16x16x32_bf16 a[180:183],v[84:87],v[116:119],a[180:183]
v_mfma_f32_16x16x32_bf16 a[184:187],v[84:87],v[120:123],a[184:187]
ds_read_b64_tr_b16 v[190:191],v23 offset:20480
v_mfma_f32_16x16x32_bf16 a[188:191],v[84:87],v[124:127],a[188:191]
v_mfma_f32_16x16x32_bf16 a[192:195],v[88:91],v[96:99],a[192:195]
v_mfma_f32_16x16x32_bf16 a[196:199],v[88:91],v[100:103],a[196:199]
v_mfma_f32_16x16x32_bf16 a[200:203],v[88:91],v[104:107],a[200:203]
v_mfma_f32_16x16x32_bf16 a[204:207],v[88:91],v[108:111],a[204:207]
v_mfma_f32_16x16x32_bf16 a[208:211],v[88:91],v[112:115],a[208:211]
v_mfma_f32_16x16x32_bf16 a[212:215],v[88:91],v[116:119],a[212:215]
v_mfma_f32_16x16x32_bf16 a[216:219],v[88:91],v[120:123],a[216:219]
v_mfma_f32_16x16x32_bf16 a[220:223],v[88:91],v[124:127],a[220:223]
v_mfma_f32_16x16x32_bf16 a[224:227],v[92:95],v[96:99],a[224:227]
v_mfma_f32_16x16x32_bf16 a[228:231],v[92:95],v[100:103],a[228:231]
v_mfma_f32_16x16x32_bf16 a[232:235],v[92:95],v[104:107],a[232:235]
v_mfma_f32_16x16x32_bf16 a[236:239],v[92:95],v[108:111],a[236:239]
v_mfma_f32_16x16x32_bf16 a[240:243],v[92:95],v[112:115],a[240:243]
v_mfma_f32_16x16x32_bf16 a[244:247],v[92:95],v[116:119],a[244:247]
v_mfma_f32_16x16x32_bf16 a[248:251],v[92:95],v[120:123],a[248:251]
v_mfma_f32_16x16x32_bf16 a[252:255],v[92:95],v[124:127],a[252:255]
s_waitcnt vmcnt(16) lgkmcnt(0)
s_barrier
v_mfma_f32_16x16x32_bf16 a[0:3],v[128:131],v[160:163],a[0:3]
ds_read_b128 v[64:67],v12 offset:32768
v_mfma_f32_16x16x32_bf16 a[4:7],v[128:131],v[164:167],a[4:7]
s_add_u32 m0,s23,16384
v_mfma_f32_16x16x32_bf16 a[8:11],v[128:131],v[168:171],a[8:11]
ds_read_b64_tr_b16 v[96:97],v16 offset:32768
v_mfma_f32_16x16x32_bf16 a[12:15],v[128:131],v[172:175],a[12:15]
global_load_lds_dwordx4 v4,s[16:17] offset:0 sc1
v_mfma_f32_16x16x32_bf16 a[16:19],v[128:131],v[176:179],a[16:19]
ds_read_b64_tr_b16 v[98:99],v16 offset:36864
v_mfma_f32_16x16x32_bf16 a[20:23],v[128:131],v[180:183],a[20:23]
v_mfma_f32_16x16x32_bf16 a[24:27],v[128:131],v[184:187],a[24:27]
ds_read_b128 v[68:71],v12 offset:33792
v_mfma_f32_16x16x32_bf16 a[28:31],v[128:131],v[188:191],a[28:31]
global_load_lds_dwordx4 v5,s[16:17] offset:1024 sc1
v_mfma_f32_16x16x32_bf16 a[32:35],v[132:135],v[160:163],a[32:35]
ds_read_b64_tr_b16 v[100:101],v17 offset:32768
v_mfma_f32_16x16x32_bf16 a[36:39],v[132:135],v[164:167],a[36:39]
v_mfma_f32_16x16x32_bf16 a[40:43],v[132:135],v[168:171],a[40:43]
ds_read_b64_tr_b16 v[102:103],v17 offset:36864
v_mfma_f32_16x16x32_bf16 a[44:47],v[132:135],v[172:175],a[44:47]
global_load_lds_dwordx4 v6,s[16:17] offset:2048 sc1
v_mfma_f32_16x16x32_bf16 a[48:51],v[132:135],v[176:179],a[48:51]
ds_read_b128 v[72:75],v12 offset:34816
v_mfma_f32_16x16x32_bf16 a[52:55],v[132:135],v[180:183],a[52:55]
v_mfma_f32_16x16x32_bf16 a[56:59],v[132:135],v[184:187],a[56:59]
ds_read_b64_tr_b16 v[104:105],v18 offset:32768
v_mfma_f32_16x16x32_bf16 a[60:63],v[132:135],v[188:191],a[60:63]
global_load_lds_dwordx4 v7,s[16:17] offset:3072 sc1
v_mfma_f32_16x16x32_bf16 a[64:67],v[136:139],v[160:163],a[64:67]
ds_read_b64_tr_b16 v[106:107],v18 offset:36864
v_mfma_f32_16x16x32_bf16 a[68:71],v[136:139],v[164:167],a[68:71]
v_mfma_f32_16x16x32_bf16 a[72:75],v[136:139],v[168:171],a[72:75]
ds_read_b128 v[76:79],v12 offset:35840
v_mfma_f32_16x16x32_bf16 a[76:79],v[136:139],v[172:175],a[76:79]
s_add_u32 m0,s23,81920
v_mfma_f32_16x16x32_bf16 a[80:83],v[136:139],v[176:179],a[80:83]
ds_read_b64_tr_b16 v[108:109],v19 offset:32768
v_mfma_f32_16x16x32_bf16 a[84:87],v[136:139],v[180:183],a[84:87]
s_add_u32 s16,s16,s20
v_mfma_f32_16x16x32_bf16 a[88:91],v[136:139],v[184:187],a[88:91]
ds_read_b64_tr_b16 v[110:111],v19 offset:36864
v_mfma_f32_16x16x32_bf16 a[92:95],v[136:139],v[188:191],a[92:95]
s_addc_u32 s17,s17,0
v_mfma_f32_16x16x32_bf16 a[96:99],v[140:143],v[160:163],a[96:99]
ds_read_b128 v[80:83],v12 offset:36864
v_mfma_f32_16x16x32_bf16 a[100:103],v[140:143],v[164:167],a[100:103]
global_load_lds_dwordx4 v8,s[18:19] offset:0
v_mfma_f32_16x16x32_bf16 a[104:107],v[140:143],v[168:171],a[104:107]
ds_read_b64_tr_b16 v[112:113],v20 offset:32768
v_mfma_f32_16x16x32_bf16 a[108:111],v[140:143],v[172:175],a[108:111]
v_mfma_f32_16x16x32_bf16 a[112:115],v[140:143],v[176:179],a[112:115]
ds_read_b64_tr_b16 v[114:115],v20 offset:36864
v_mfma_f32_16x16x32_bf16 a[116:119],v[140:143],v[180:183],a[116:119]
global_load_lds_dwordx4 v9,s[18:19] offset:1024
v_mfma_f32_16x16x32_bf16 a[120:123],v[140:143],v[184:187],a[120:123]
ds_read_b128 v[84:87],v12 offset:37888
v_mfma_f32_16x16x32_bf16 a[124:127],v[140:143],v[188:191],a[124:127]
v_mfma_f32_16x16x32_bf16 a[128:131],v[144:147],v[160:163],a[128:131]
ds_read_b64_tr_b16 v[116:117],v21 offset:32768
v_mfma_f32_16x16x32_bf16 a[132:135],v[144:147],v[164:167],a[132:135]
global_load_lds_dwordx4 v10,s[18:19] offset:2048
v_mfma_f32_16x16x32_bf16 a[136:139],v[144:147],v[168:171],a[136:139]
ds_read_b64_tr_b16 v[118:119],v21 offset:36864
v_mfma_f32_16x16x32_bf16 a[140:143],v[144:147],v[172:175],a[140:143]
v_mfma_f32_16x16x32_bf16 a[144:147],v[144:147],v[176:179],a[144:147]
ds_read_b128 v[88:91],v12 offset:38912
v_mfma_f32_16x16x32_bf16 a[148:151],v[144:147],v[180:183],a[148:151]
global_load_lds_dwordx4 v11,s[18:19] offset:3072
v_mfma_f32_16x16x32_bf16 a[152:155],v[144:147],v[184:187],a[152:155]
ds_read_b64_tr_b16 v[120:121],v22 offset:32768
v_mfma_f32_16x16x32_bf16 a[156:159],v[144:147],v[188:191],a[156:159]
v_mfma_f32_16x16x32_bf16 a[160:163],v[148:151],v[160:163],a[160:163]
ds_read_b64_tr_b16 v[122:123],v22 offset:36864
v_mfma_f32_16x16x32_bf16 a[164:167],v[148:151],v[164:167],a[164:167]
s_add_u32 s18,s18,s21
v_mfma_f32_16x16x32_bf16 a[168:171],v[148:151],v[168:171],a[168:171]
ds_read_b128 v[92:95],v12 offset:39936
v_mfma_f32_16x16x32_bf16 a[172:175],v[148:151],v[172:175],a[172:175]
s_addc_u32 s19,s19,0
v_mfma_f32_16x16x32_bf16 a[176:179],v[148:151],v[176:179],a[176:179]
ds_read_b64_tr_b16 v[124:125],v23 offset:32768
v_mfma_f32_16x16x32_bf16 a[180:183],v[148:151],v[180:183],a[180:183]
v_mfma_f32_16x16x32_bf16 a[184:187],v[148:151],v[184:187],a[184:187]
ds_read_b64_tr_b16 v[126:127],v23 offset:36864
v_mfma_f32_16x16x32_bf16 a[188:191],v[148:151],v[188:191],a[188:191]
v_mfma_f32_16x16x32_bf16 a[192:195],v[152:155],v[160:163],a[192:195]
v_mfma_f32_16x16x32_bf16 a[196:199],v[152:155],v[164:167],a[196:199]
v_mfma_f32_16x16x32_bf16 a[200:203],v[152:155],v[168:171],a[200:203]
v_mfma_f32_16x16x32_bf16 a[204:207],v[152:155],v[172:175],a[204:207]
v_mfma_f32_16x16x32_bf16 a[208:211],v[152:155],v[176:179],a[208:211]
v_mfma_f32_16x16x32_bf16 a[212:215],v[152:155],v[180:183],a[212:215]
v_mfma_f32_16x16x32_bf16 a[216:219],v[152:155],v[184:187],a[216:219]
v_mfma_f32_16x16x32_bf16 a[220:223],v[152:155],v[188:191],a[220:223]
v_mfma_f32_16x16x32_bf16 a[224:227],v[156:159],v[160:163],a[224:227]
v_mfma_f32_16x16x32_bf16 a[228:231],v[156:159],v[164:167],a[228:231]
v_mfma_f32_16x16x32_bf16 a[232:235],v[156:159],v[168:171],a[232:235]
v_mfma_f32_16x16x32_bf16 a[236:239],v[156:159],v[172:175],a[236:239]
v_mfma_f32_16x16x32_bf16 a[240:243],v[156:159],v[176:179],a[240:243]
v_mfma_f32_16x16x32_bf16 a[244:247],v[156:159],v[180:183],a[244:247]
v_mfma_f32_16x16x32_bf16 a[248:251],v[156:159],v[184:187],a[248:251]
v_mfma_f32_16x16x32_bf16 a[252:255],v[156:159],v[188:191],a[252:255]
s_waitcnt vmcnt(16) lgkmcnt(0)
s_barrier
v_mfma_f32_16x16x32_bf16 a[0:3],v[64:67],v[96:99],a[0:3]
ds_read_b128 v[128:131],v12 offset:49152
v_mfma_f32_16x16x32_bf16 a[4:7],v[64:67],v[100:103],a[4:7]
s_add_u32 m0,s23,32768
v_mfma_f32_16x16x32_bf16 a[8:11],v[64:67],v[104:107],a[8:11]
ds_read_b64_tr_b16 v[160:161],v16 offset:49152
v_mfma_f32_16x16x32_bf16 a[12:15],v[64:67],v[108:111],a[12:15]
global_load_lds_dwordx4 v4,s[16:17] offset:0 sc1
v_mfma_f32_16x16x32_bf16 a[16:19],v[64:67],v[112:115],a[16:19]
ds_read_b64_tr_b16 v[162:163],v16 offset:53248
v_mfma_f32_16x16x32_bf16 a[20:23],v[64:67],v[116:119],a[20:23]
v_mfma_f32_16x16x32_bf16 a[24:27],v[64:67],v[120:123],a[24:27]
ds_read_b128 v[132:135],v12 offset:50176
v_mfma_f32_16x16x32_bf16 a[28:31],v[64:67],v[124:127],a[28:31]
global_load_lds_dwordx4 v5,s[16:17] offset:1024 sc1
v_mfma_f32_16x16x32_bf16 a[32:35],v[68:71],v[96:99],a[32:35]
ds_read_b64_tr_b16 v[164:165],v17 offset:49152
v_mfma_f32_16x16x32_bf16 a[36:39],v[68:71],v[100:103],a[36:39]
v_mfma_f32_16x16x32_bf16 a[40:43],v[68:71],v[104:107],a[40:43]
ds_read_b64_tr_b16 v[166:167],v17 offset:53248
v_mfma_f32_16x16x32_bf16 a[44:47],v[68:71],v[108:111],a[44:47]
global_load_lds_dwordx4 v6,s[16:17] offset:2048 sc1
v_mfma_f32_16x16x32_bf16 a[48:51],v[68:71],v[112:115],a[48:51]
ds_read_b128 v[136:139],v12 offset:51200
v_mfma_f32_16x16x32_bf16 a[52:55],v[68:71],v[116:119],a[52:55]
v_mfma_f32_16x16x32_bf16 a[56:59],v[68:71],v[120:123],a[56:59]
ds_read_b64_tr_b16 v[168:169],v18 offset:49152
v_mfma_f32_16x16x32_bf16 a[60:63],v[68:71],v[124:127],a[60:63]
global_load_lds_dwordx4 v7,s[16:17] offset:3072 sc1
v_mfma_f32_16x16x32_bf16 a[64:67],v[72:75],v[96:99],a[64:67]
ds_read_b64_tr_b16 v[170:171],v18 offset:53248
v_mfma_f32_16x16x32_bf16 a[68:71],v[72:75],v[100:103],a[68:71]
v_mfma_f32_16x16x32_bf16 a[72:75],v[72:75],v[104:107],a[72:75]
ds_read_b128 v[140:143],v12 offset:52224
v_mfma_f32_16x16x32_bf16 a[76:79],v[72:75],v[108:111],a[76:79]
s_add_u32 m0,s23,98304
v_mfma_f32_16x16x32_bf16 a[80:83],v[72:75],v[112:115],a[80:83]
ds_read_b64_tr_b16 v[172:173],v19 offset:49152
v_mfma_f32_16x16x32_bf16 a[84:87],v[72:75],v[116:119],a[84:87]
s_add_u32 s16,s16,s20
v_mfma_f32_16x16x32_bf16 a[88:91],v[72:75],v[120:123],a[88:91]
ds_read_b64_tr_b16 v[174:175],v19 offset:53248
v_mfma_f32_16x16x32_bf16 a[92:95],v[72:75],v[124:127],a[92:95]
s_addc_u32 s17,s17,0
v_mfma_f32_16x16x32_bf16 a[96:99],v[76:79],v[96:99],a[96:99]
ds_read_b128 v[144:147],v12 offset:53248
v_mfma_f32_16x16x32_bf16 a[100:103],v[76:79],v[100:103],a[100:103]
global_load_lds_dwordx4 v8,s[18:19] offset:0
v_mfma_f32_16x16x32_bf16 a[104:107],v[76:79],v[104:107],a[104:107]
ds_read_b64_tr_b16 v[176:177],v20 offset:49152
v_mfma_f32_16x16x32_bf16 a[108:111],v[76:79],v[108:111],a[108:111]
v_mfma_f32_16x16x32_bf16 a[112:115],v[76:79],v[112:115],a[112:115]
ds_read_b64_tr_b16 v[178:179],v20 offset:53248
v_mfma_f32_16x16x32_bf16 a[116:119],v[76:79],v[116:119],a[116:119]
global_load_lds_dwordx4 v9,s[18:19] offset:1024
v_mfma_f32_16x16x32_bf16 a[120:123],v[76:79],v[120:123],a[120:123]
ds_read_b128 v[148:151],v12 offset:54272
v_mfma_f32_16x16x32_bf16 a[124:127],v[76:79],v[124:127],a[124:127]
v_mfma_f32_16x16x32_bf16 a[128:131],v[80:83],v[96:99],a[128:131]
ds_read_b64_tr_b16 v[180:181],v21 offset:49152
v_mfma_f32_16x16x32_bf16 a[132:135],v[80:83],v[100:103],a[132:135]
global_load_lds_dwordx4 v10,s[18:19] offset:2048
v_mfma_f32_16x16x32_bf16 a[136:139],v[80:83],v[104:107],a[136:139]
ds_read_b64_tr_b16 v[182:183],v21 offset:53248
v_mfma_f32_16x16x32_bf16 a[140:143],v[80:83],v[108:111],a[140:143]
v_mfma_f32_16x16x32_bf16 a[144:147],v[80:83],v[112:115],a[144:147]
ds_read_b128 v[152:155],v12 offset:55296
v_mfma_f32_16x16x32_bf16 a[148:151],v[80:83],v[116:119],a[148:151]
global_load_lds_dwordx4 v11,s[18:19] offset:3072
v_mfma_f32_16x16x32_bf16 a[152:155],v[80:83],v[120:123],a[152:155]
ds_read_b64_tr_b16 v[184:185],v22 offset:49152
v_mfma_f32_16x16x32_bf16 a[156:159],v[80:83],v[124:127],a[156:159]
v_mfma_f32_16x16x32_bf16 a[160:163],v[84:87],v[96:99],a[160:163]
ds_read_b64_tr_b16 v[186:187],v22 offset:53248
v_mfma_f32_16x16x32_bf16 a[164:167],v[84:87],v[100:103],a[164:167]
s_add_u32 s18,s18,s21
v_mfma_f32_16x16x32_bf16 a[168:171],v[84:87],v[104:107],a[168:171]
ds_read_b128 v[156:159],v12 offset:56320
v_mfma_f32_16x16x32_bf16 a[172:175],v[84:87],v[108:111],a[172:175]
s_addc_u32 s19,s19,0
v_mfma_f32_16x16x32_bf16 a[176:179],v[84:87],v[112:115],a[176:179]
ds_read_b64_tr_b16 v[188:189],v23 offset:49152
v_mfma_f32_16x16x32_bf16 a[180:183],v[84:87],v[116:119],a[180:183]
ds_write_b32 v239,v236
v_mfma_f32_16x16x32_bf16 a[184:187],v[84:87],v[120:123],a[184:187]
ds_read_b64_tr_b16 v[190:191],v23 offset:53248
v_mfma_f32_16x16x32_bf16 a[188:191],v[84:87],v[124:127],a[188:191]
v_mfma_f32_16x16x32_bf16 a[192:195],v[88:91],v[96:99],a[192:195]
v_mfma_f32_16x16x32_bf16 a[196:199],v[88:91],v[100:103],a[196:199]
v_mfma_f32_16x16x32_bf16 a[200:203],v[88:91],v[104:107],a[200:203]
v_mfma_f32_16x16x32_bf16 a[204:207],v[88:91],v[108:111],a[204:207]
v_mfma_f32_16x16x32_bf16 a[208:211],v[88:91],v[112:115],a[208:211]
v_mfma_f32_16x16x32_bf16 a[212:215],v[88:91],v[116:119],a[212:215]
v_mfma_f32_16x16x32_bf16 a[216:219],v[88:91],v[120:123],a[216:219]
v_mfma_f32_16x16x32_bf16 a[220:223],v[88:91],v[124:127],a[220:223]
v_mfma_f32_16x16x32_bf16 a[224:227],v[92:95],v[96:99],a[224:227]
v_mfma_f32_16x16x32_bf16 a[228:231],v[92:95],v[100:103],a[228:231]
v_mfma_f32_16x16x32_bf16 a[232:235],v[92:95],v[104:107],a[232:235]
v_mfma_f32_16x16x32_bf16 a[236:239],v[92:95],v[108:111],a[236:239]
v_mfma_f32_16x16x32_bf16 a[240:243],v[92:95],v[112:115],a[240:243]
v_mfma_f32_16x16x32_bf16 a[244:247],v[92:95],v[116:119],a[244:247]
v_mfma_f32_16x16x32_bf16 a[248:251],v[92:95],v[120:123],a[248:251]
v_mfma_f32_16x16x32_bf16 a[252:255],v[92:95],v[124:127],a[252:255]
s_waitcnt vmcnt(16) lgkmcnt(0)
s_barrier
v_mfma_f32_16x16x32_bf16 a[0:3],v[128:131],v[160:163],a[0:3]
ds_read_b128 v[64:67],v12 offset:0
v_mfma_f32_16x16x32_bf16 a[4:7],v[128:131],v[164:167],a[4:7]
s_add_u32 m0,s23,49152
v_mfma_f32_16x16x32_bf16 a[8:11],v[128:131],v[168:171],a[8:11]
ds_read_b64_tr_b16 v[96:97],v16 offset:0
v_mfma_f32_16x16x32_bf16 a[12:15],v[128:131],v[172:175],a[12:15]
global_load_lds_dwordx4 v4,s[16:17] offset:0 sc1
v_mfma_f32_16x16x32_bf16 a[16:19],v[128:131],v[176:179],a[16:19]
ds_read_b64_tr_b16 v[98:99],v16 offset:4096
v_mfma_f32_16x16x32_bf16 a[20:23],v[128:131],v[180:183],a[20:23]
v_mfma_f32_16x16x32_bf16 a[24:27],v[128:131],v[184:187],a[24:27]
ds_read_b128 v[68:71],v12 offset:1024
v_mfma_f32_16x16x32_bf16 a[28:31],v[128:131],v[188:191],a[28:31]
global_load_lds_dwordx4 v5,s[16:17] offset:1024 sc1
v_mfma_f32_16x16x32_bf16 a[32:35],v[132:135],v[160:163],a[32:35]
ds_read_b64_tr_b16 v[100:101],v17 offset:0
v_mfma_f32_16x16x32_bf16 a[36:39],v[132:135],v[164:167],a[36:39]
v_mfma_f32_16x16x32_bf16 a[40:43],v[132:135],v[168:171],a[40:43]
ds_read_b64_tr_b16 v[102:103],v17 offset:4096
v_mfma_f32_16x16x32_bf16 a[44:47],v[132:135],v[172:175],a[44:47]
global_load_lds_dwordx4 v6,s[16:17] offset:2048 sc1
v_mfma_f32_16x16x32_bf16 a[48:51],v[132:135],v[176:179],a[48:51]
ds_read_b128 v[72:75],v12 offset:2048
v_mfma_f32_16x16x32_bf16 a[52:55],v[132:135],v[180:183],a[52:55]
v_mfma_f32_16x16x32_bf16 a[56:59],v[132:135],v[184:187],a[56:59]
ds_read_b64_tr_b16 v[104:105],v18 offset:0
v_mfma_f32_16x16x32_bf16 a[60:63],v[132:135],v[188:191],a[60:63]
global_load_lds_dwordx4 v7,s[16:17] offset:3072 sc1
v_mfma_f32_16x16x32_bf16 a[64:67],v[136:139],v[160:163],a[64:67]
ds_read_b64_tr_b16 v[106:107],v18 offset:4096
v_mfma_f32_16x16x32_bf16 a[68:71],v[136:139],v[164:167],a[68:71]
v_mfma_f32_16x16x32_bf16 a[72:75],v[136:139],v[168:171],a[72:75]
ds_read_b128 v[76:79],v12 offset:3072
v_mfma_f32_16x16x32_bf16 a[76:79],v[136:139],v[172:175],a[76:79]
s_add_u32 m0,s23,114688
v_mfma_f32_16x16x32_bf16 a[80:83],v[136:139],v[176:179],a[80:83]
ds_read_b64_tr_b16 v[108:109],v19 offset:0
v_mfma_f32_16x16x32_bf16 a[84:87],v[136:139],v[180:183],a[84:87]
s_add_u32 s16,s16,s20
v_mfma_f32_16x16x32_bf16 a[88:91],v[136:139],v[184:187],a[88:91]
ds_read_b64_tr_b16 v[110:111],v19 offset:4096
v_mfma_f32_16x16x32_bf16 a[92:95],v[136:139],v[188:191],a[92:95]
s_addc_u32 s17,s17,0
v_mfma_f32_16x16x32_bf16 a[96:99],v[140:143],v[160:163],a[96:99]
ds_read_b128 v[80:83],v12 offset:4096
v_mfma_f32_16x16x32_bf16 a[100:103],v[140:143],v[164:167],a[100:103]
global_load_lds_dwordx4 v8,s[18:19] offset:0
v_mfma_f32_16x16x32_bf16 a[104:107],v[140:143],v[168:171],a[104:107]
ds_read_b64_tr_b16 v[112:113],v20 offset:0
v_mfma_f32_16x16x32_bf16 a[108:111],v[140:143],v[172:175],a[108:111]
v_mfma_f32_16x16x32_bf16 a[112:115],v[140:143],v[176:179],a[112:115]
ds_read_b64_tr_b16 v[114:115],v20 offset:4096
v_mfma_f32_16x16x32_bf16 a[116:119],v[140:143],v[180:183],a[116:119]
global_load_lds_dwordx4 v9,s[18:19] offset:1024
v_mfma_f32_16x16x32_bf16 a[120:123],v[140:143],v[184:187],a[120:123]
ds_read_b128 v[84:87],v12 offset:5120
v_mfma_f32_16x16x32_bf16 a[124:127],v[140:143],v[188:191],a[124:127]
v_mfma_f32_16x16x32_bf16 a[128:131],v[144:147],v[160:163],a[128:131]
ds_read_b64_tr_b16 v[116:117],v21 offset:0
v_mfma_f32_16x16x32_bf16 a[132:135],v[144:147],v[164:167],a[132:135]
global_load_lds_dwordx4 v10,s[18:19] offset:2048
v_mfma_f32_16x16x32_bf16 a[136:139],v[144:147],v[168:171],a[136:139]
ds_read_b64_tr_b16 v[118:119],v21 offset:4096
v_mfma_f32_16x16x32_bf16 a[140:143],v[144:147],v[172:175],a[140:143]
v_mfma_f32_16x16x32_bf16 a[144:147],v[144:147],v[176:179],a[144:147]
ds_read_b128 v[88:91],v12 offset:6144
v_mfma_f32_16x16x32_bf16 a[148:151],v[144:147],v[180:183],a[148:151]
global_load_lds_dwordx4 v11,s[18:19] offset:3072
v_mfma_f32_16x16x32_bf16 a[152:155],v[144:147],v[184:187],a[152:155]
ds_read_b64_tr_b16 v[120:121],v22 offset:0
v_mfma_f32_16x16x32_bf16 a[156:159],v[144:147],v[188:191],a[156:159]
v_mfma_f32_16x16x32_bf16 a[160:163],v[148:151],v[160:163],a[160:163]
ds_read_b64_tr_b16 v[122:123],v22 offset:4096
v_mfma_f32_16x16x32_bf16 a[164:167],v[148:151],v[164:167],a[164:167]
s_add_u32 s18,s18,s21
v_mfma_f32_16x16x32_bf16 a[168:171],v[148:151],v[168:171],a[168:171]
ds_read_b128 v[92:95],v12 offset:7168
v_mfma_f32_16x16x32_bf16 a[172:175],v[148:151],v[172:175],a[172:175]
s_addc_u32 s19,s19,0
v_mfma_f32_16x16x32_bf16 a[176:179],v[148:151],v[176:179],a[176:179]
ds_read_b64_tr_b16 v[124:125],v23 offset:0
v_mfma_f32_16x16x32_bf16 a[180:183],v[148:151],v[180:183],a[180:183]
global_load_dword v236,v238,s[4:5] sc1
v_mfma_f32_16x16x32_bf16 a[184:187],v[148:151],v[184:187],a[184:187]
ds_read_b64_tr_b16 v[126:127],v23 offset:4096
v_mfma_f32_16x16x32_bf16 a[188:191],v[148:151],v[188:191],a[188:191]
v_mfma_f32_16x16x32_bf16 a[192:195],v[152:155],v[160:163],a[192:195]
v_mfma_f32_16x16x32_bf16 a[196:199],v[152:155],v[164:167],a[196:199]
v_mfma_f32_16x16x32_bf16 a[200:203],v[152:155],v[168:171],a[200:203]
v_mfma_f32_16x16x32_bf16 a[204:207],v[152:155],v[172:175],a[204:207]
v_mfma_f32_16x16x32_bf16 a[208:211],v[152:155],v[176:179],a[208:211]
v_mfma_f32_16x16x32_bf16 a[212:215],v[152:155],v[180:183],a[212:215]
v_mfma_f32_16x16x32_bf16 a[216:219],v[152:155],v[184:187],a[216:219]
v_mfma_f32_16x16x32_bf16 a[220:223],v[152:155],v[188:191],a[220:223]
v_mfma_f32_16x16x32_bf16 a[224:227],v[156:159],v[160:163],a[224:227]
v_mfma_f32_16x16x32_bf16 a[228:231],v[156:159],v[164:167],a[228:231]
v_mfma_f32_16x16x32_bf16 a[232:235],v[156:159],v[168:171],a[232:235]
v_mfma_f32_16x16x32_bf16 a[236:239],v[156:159],v[172:175],a[236:239]
v_mfma_f32_16x16x32_bf16 a[240:243],v[156:159],v[176:179],a[240:243]
v_mfma_f32_16x16x32_bf16 a[244:247],v[156:159],v[180:183],a[244:247]
v_mfma_f32_16x16x32_bf16 a[248:251],v[156:159],v[184:187],a[248:251]
v_mfma_f32_16x16x32_bf16 a[252:255],v[156:159],v[188:191],a[252:255]
s_sub_u32 s22,s22,1
s_cmp_lg_u32 s22,0
s_cbranch_scc1 L_g_v_mid
s_mov_b32 s36,s33
s_and_b32 s33,s27,15
s_bfe_u32 s34,s27,0x40004
s_bfe_u32 s35,s27,0x60008
s_mov_b32 s28,1
s_sub_u32 s54,s33,1
s_cmp_lt_u32 s54,5
s_cbranch_scc1 L_g_v_h_ck
s_sub_u32 s54,s33,9
s_cmp_lt_u32 s54,4
s_cbranch_scc0 L_g_v_h_no
L_g_v_h_ck:
ds_read_b128 v[24:27],v15
s_bfe_u32 s55,s27,0x60014
s_waitcnt lgkmcnt(0)
v_min3_u32 v24,v24,v25,v26
v_min_u32 v24,v24,v27
s_nop 0
v_readfirstlane_b32 s54,v24
s_nop 0
s_cmp_ge_u32 s54,s55
s_cbranch_scc1 L_g_v_h_pf
L_g_v_h_no:
s_mov_b32 s28,0
s_mov_b32 s33,1
s_mov_b32 s34,0
s_mov_b32 s35,0
L_g_v_h_pf:
s_lshr_b32 s55,s14,1
s_mov_b32 s24,-1
s_cmp_eq_u32 s33,5
s_cbranch_scc1 L_g_v_h_sd_d8
s_cmp_eq_u32 s33,8
s_cbranch_scc1 L_g_v_h_sd_d4
s_cmp_eq_u32 s33,12
s_cbranch_scc1 L_g_v_h_sd_d4
s_sub_u32 s54,s33,6
s_cmp_lt_u32 s54,2
s_cbranch_scc1 L_g_v_h_sd_db
s_lshl_b32 s54,s34,19
s_add_u32 s54,s54,104857600
s_add_u32 s16,s4,s54
s_addc_u32 s17,s5,0
s_mov_b32 s20,1024
v_mov_b32 v4,v192
v_mov_b32 v5,v193
v_mov_b32 v6,v194
v_mov_b32 v7,v195
s_cmp_lt_u32 s33,9
s_cbranch_scc1 L_g_v_h_sd_big
s_lshl_b32 s54,s34,18
s_lshl_b32 s59,s14,16
s_add_u32 s54,s54,s59
s_add_u32 s54,s54,104857600
s_add_u32 s16,s4,s54
s_addc_u32 s17,s5,0
v_mov_b32 v4,v2
v_add_u32 v5,31744,v2
v_mov_b32 v6,0
v_mov_b32 v7,0
L_g_v_h_sd_big:
s_cmp_eq_u32 s33,4
s_cbranch_scc1 L_g_v_h_sd_up
s_cmp_eq_u32 s33,1
s_cselect_b64 s[56:57],s[66:67],s[68:69]
s_cmp_eq_u32 s33,3
s_cselect_b64 s[56:57],s[70:71],s[56:57]
s_cmp_eq_u32 s33,11
s_cselect_b64 s[56:57],s[70:71],s[56:57]
s_cmp_eq_u32 s33,9
s_cselect_b64 s[56:57],s[66:67],s[56:57]
s_lshl_b32 s54,s35,9
s_lshl_b32 s59,s55,8
s_add_u32 s54,s54,s59
s_add_u32 s18,s56,s54
s_addc_u32 s19,s57,0
s_mov_b32 s21,262144
v_mov_b32 v8,v200
v_mov_b32 v9,v201
v_mov_b32 v10,v202
v_mov_b32 v11,v203
s_branch L_g_v_h_sd_e
L_g_v_h_sd_up:
s_cmp_eq_u32 s55,1
s_cselect_b64 s[56:57],s[74:75],s[72:73]
s_and_b32 s54,s35,31
s_lshl_b32 s54,s54,8
s_add_u32 s18,s56,s54
s_addc_u32 s19,s57,0
s_mov_b32 s21,229376
v_mov_b32 v8,v204
v_mov_b32 v9,v205
v_mov_b32 v10,v206
v_mov_b32 v11,v207
s_bitcmp1_b32 s35,5
s_cbranch_scc0 L_g_v_h_sd_e
s_and_b32 s54,s34,3
s_mul_i32 s24,s54,2
s_mul_i32 s25,s20,32
s_mul_i32 s3,s21,32
s_lshl_b32 s54,s24,2
s_mul_i32 s57,s54,s20
s_add_u32 s16,s16,s57
s_addc_u32 s17,s17,0
s_mul_i32 s57,s54,s21
s_add_u32 s18,s18,s57
s_addc_u32 s19,s19,0
s_branch L_g_v_h_sd_e
L_g_v_h_sd_d8:
s_mul_i32 s54,s34,1835008
s_add_u32 s54,s54,50331648
s_add_u32 s16,s4,s54
s_addc_u32 s17,s5,0
s_mov_b32 s20,1024
s_and_b32 s54,s35,31
s_lshl_b32 s54,s54,9
s_lshl_b32 s59,s55,8
s_add_u32 s54,s54,s59
s_add_u32 s18,s76,s54
s_addc_u32 s19,s77,0
s_mov_b32 s21,65536
v_mov_b32 v4,v196
v_add_u32 v5,113664,v196
v_add_u32 v6,227328,v196
v_add_u32 v7,340992,v196
v_mov_b32 v8,v208
v_mov_b32 v9,v209
v_mov_b32 v10,v210
v_mov_b32 v11,v211
s_bitcmp1_b32 s35,5
s_cbranch_scc0 L_g_v_h_sd_e
s_and_b32 s54,s34,3
s_mul_i32 s24,s54,7
s_mul_i32 s25,s20,112
s_mul_i32 s3,s21,112
s_lshl_b32 s54,s24,2
s_mul_i32 s57,s54,s20
s_add_u32 s16,s16,s57
s_addc_u32 s17,s17,0
s_mul_i32 s57,s54,s21
s_add_u32 s18,s18,s57
s_addc_u32 s19,s19,0
s_branch L_g_v_h_sd_e
L_g_v_h_sd_d4:
s_lshl_b32 s54,s34,20
s_lshl_b32 s59,s14,18
s_add_u32 s54,s54,s59
s_add_u32 s54,s54,67108864
s_mul_i32 s58,s34,917504
s_mul_i32 s59,s14,229376
s_add_u32 s58,s58,s59
s_add_u32 s58,s58,50331648
s_cmp_eq_u32 s33,8
s_cselect_b32 s54,s54,s58
s_cselect_b32 s58,16,0
s_cselect_b64 s[56:57],s[60:61],s[76:77]
s_add_u32 s16,s4,s54
s_addc_u32 s17,s5,0
s_mov_b32 s20,1024
s_lshl_b32 s54,s35,9
s_lshl_b32 s59,s55,8
s_add_u32 s54,s54,s59
s_add_u32 s18,s56,s54
s_addc_u32 s19,s57,0
s_mov_b32 s21,65536
v_mov_b32 v4,v2
s_lshl_b32 s58,s58,10
s_add_u32 s58,s58,113664
v_add_u32 v5,s58,v2
v_mov_b32 v6,0
v_mov_b32 v7,0
v_mov_b32 v8,v208
v_mov_b32 v9,v209
v_mov_b32 v10,v210
v_mov_b32 v11,v211
s_branch L_g_v_h_sd_e
L_g_v_h_sd_db:
s_lshr_b32 s57,s35,3
s_lshl_b32 s54,s34,20
s_lshl_b32 s59,s57,15
s_add_u32 s54,s54,s59
s_add_u32 s54,s54,67106816
s_and_b32 s12,s35,7
s_lshl_b32 s12,s12,8
s_lshl_b32 s59,s55,16
s_add_u32 s12,s12,s59
s_lshl_b32 s59,s57,21
s_add_u32 s12,s12,s59
s_add_u32 s16,s4,s54
s_addc_u32 s17,s5,0
s_mov_b32 s20,2048
s_add_u32 s18,s60,s12
s_addc_u32 s19,s61,0
s_mov_b32 s21,131072
s_lshl_b32 s54,s14,1
s_add_u32 s54,s54,s57
s_and_b32 s54,s54,3
s_lshl_b32 s54,s54,17
s_lshl_b32 s59,s55,19
s_add_u32 s54,s54,s59
s_add_u32 s54,s54,2048
v_add_u32 v4,s54,v2
v_mov_b32 v5,v4
s_lshl_b32 s54,s14,1
s_add_u32 s54,s54,s57
s_add_u32 s54,s54,1
s_and_b32 s54,s54,3
s_lshl_b32 s54,s54,17
s_lshl_b32 s59,s55,19
s_add_u32 s54,s54,s59
v_add_u32 v6,s54,v2
v_mov_b32 v7,v6
v_mov_b32 v8,v208
v_mov_b32 v9,v209
v_mov_b32 v10,v210
v_mov_b32 v11,v211
L_g_v_h_sd_e:
s_cmp_eq_u32 s28,0
s_cselect_b64 s[16:17],s[64:65],s[16:17]
s_cselect_b32 s54,0,-1
s_and_b32 s21,s21,s54
v_and_b32 v4,s54,v4
v_and_b32 v5,s54,v5
v_and_b32 v6,s54,v6
v_and_b32 v7,s54,v7
v_and_b32 v8,s54,v8
v_and_b32 v9,s54,v9
v_and_b32 v10,s54,v10
v_and_b32 v11,s54,v11
s_waitcnt vmcnt(16) lgkmcnt(0)
s_barrier
v_mfma_f32_16x16x32_bf16 a[0:3],v[64:67],v[96:99],a[0:3]
ds_read_b128 v[128:131],v12 offset:16384
v_mfma_f32_16x16x32_bf16 a[4:7],v[64:67],v[100:103],a[4:7]
s_add_u32 m0,s23,0
v_mfma_f32_16x16x32_bf16 a[8:11],v[64:67],v[104:107],a[8:11]
ds_read_b64_tr_b16 v[160:161],v16 offset:16384
v_mfma_f32_16x16x32_bf16 a[12:15],v[64:67],v[108:111],a[12:15]
global_load_lds_dwordx4 v4,s[16:17] offset:0 sc1
v_mfma_f32_16x16x32_bf16 a[16:19],v[64:67],v[112:115],a[16:19]
ds_read_b64_tr_b16 v[162:163],v16 offset:20480
v_mfma_f32_16x16x32_bf16 a[20:23],v[64:67],v[116:119],a[20:23]
v_mfma_f32_16x16x32_bf16 a[24:27],v[64:67],v[120:123],a[24:27]
ds_read_b128 v[132:135],v12 offset:17408
v_mfma_f32_16x16x32_bf16 a[28:31],v[64:67],v[124:127],a[28:31]
global_load_lds_dwordx4 v5,s[16:17] offset:1024 sc1
v_mfma_f32_16x16x32_bf16 a[32:35],v[68:71],v[96:99],a[32:35]
ds_read_b64_tr_b16 v[164:165],v17 offset:16384
v_mfma_f32_16x16x32_bf16 a[36:39],v[68:71],v[100:103],a[36:39]
v_mfma_f32_16x16x32_bf16 a[40:43],v[68:71],v[104:107],a[40:43]
ds_read_b64_tr_b16 v[166:167],v17 offset:20480
v_mfma_f32_16x16x32_bf16 a[44:47],v[68:71],v[108:111],a[44:47]
global_load_lds_dwordx4 v6,s[16:17] offset:2048 sc1
v_mfma_f32_16x16x32_bf16 a[48:51],v[68:71],v[112:115],a[48:51]
ds_read_b128 v[136:139],v12 offset:18432
v_mfma_f32_16x16x32_bf16 a[52:55],v[68:71],v[116:119],a[52:55]
v_mfma_f32_16x16x32_bf16 a[56:59],v[68:71],v[120:123],a[56:59]
ds_read_b64_tr_b16 v[168:169],v18 offset:16384
v_mfma_f32_16x16x32_bf16 a[60:63],v[68:71],v[124:127],a[60:63]
global_load_lds_dwordx4 v7,s[16:17] offset:3072 sc1
v_mfma_f32_16x16x32_bf16 a[64:67],v[72:75],v[96:99],a[64:67]
ds_read_b64_tr_b16 v[170:171],v18 offset:20480
v_mfma_f32_16x16x32_bf16 a[68:71],v[72:75],v[100:103],a[68:71]
v_mfma_f32_16x16x32_bf16 a[72:75],v[72:75],v[104:107],a[72:75]
ds_read_b128 v[140:143],v12 offset:19456
v_mfma_f32_16x16x32_bf16 a[76:79],v[72:75],v[108:111],a[76:79]
s_add_u32 m0,s23,65536
v_mfma_f32_16x16x32_bf16 a[80:83],v[72:75],v[112:115],a[80:83]
ds_read_b64_tr_b16 v[172:173],v19 offset:16384
v_mfma_f32_16x16x32_bf16 a[84:87],v[72:75],v[116:119],a[84:87]
s_add_u32 s16,s16,s20
v_mfma_f32_16x16x32_bf16 a[88:91],v[72:75],v[120:123],a[88:91]
ds_read_b64_tr_b16 v[174:175],v19 offset:20480
v_mfma_f32_16x16x32_bf16 a[92:95],v[72:75],v[124:127],a[92:95]
s_addc_u32 s17,s17,0
v_mfma_f32_16x16x32_bf16 a[96:99],v[76:79],v[96:99],a[96:99]
ds_read_b128 v[144:147],v12 offset:20480
v_mfma_f32_16x16x32_bf16 a[100:103],v[76:79],v[100:103],a[100:103]
global_load_lds_dwordx4 v8,s[18:19] offset:0
v_mfma_f32_16x16x32_bf16 a[104:107],v[76:79],v[104:107],a[104:107]
ds_read_b64_tr_b16 v[176:177],v20 offset:16384
v_mfma_f32_16x16x32_bf16 a[108:111],v[76:79],v[108:111],a[108:111]
v_mfma_f32_16x16x32_bf16 a[112:115],v[76:79],v[112:115],a[112:115]
ds_read_b64_tr_b16 v[178:179],v20 offset:20480
v_mfma_f32_16x16x32_bf16 a[116:119],v[76:79],v[116:119],a[116:119]
global_load_lds_dwordx4 v9,s[18:19] offset:1024
v_mfma_f32_16x16x32_bf16 a[120:123],v[76:79],v[120:123],a[120:123]
ds_read_b128 v[148:151],v12 offset:21504
v_mfma_f32_16x16x32_bf16 a[124:127],v[76:79],v[124:127],a[124:127]
v_mfma_f32_16x16x32_bf16 a[128:131],v[80:83],v[96:99],a[128:131]
ds_read_b64_tr_b16 v[180:181],v21 offset:16384
v_mfma_f32_16x16x32_bf16 a[132:135],v[80:83],v[100:103],a[132:135]
global_load_lds_dwordx4 v10,s[18:19] offset:2048
v_mfma_f32_16x16x32_bf16 a[136:139],v[80:83],v[104:107],a[136:139]
ds_read_b64_tr_b16 v[182:183],v21 offset:20480
v_mfma_f32_16x16x32_bf16 a[140:143],v[80:83],v[108:111],a[140:143]
v_mfma_f32_16x16x32_bf16 a[144:147],v[80:83],v[112:115],a[144:147]
ds_read_b128 v[152:155],v12 offset:22528
v_mfma_f32_16x16x32_bf16 a[148:151],v[80:83],v[116:119],a[148:151]
global_load_lds_dwordx4 v11,s[18:19] offset:3072
v_mfma_f32_16x16x32_bf16 a[152:155],v[80:83],v[120:123],a[152:155]
ds_read_b64_tr_b16 v[184:185],v22 offset:16384
v_mfma_f32_16x16x32_bf16 a[156:159],v[80:83],v[124:127],a[156:159]
v_mfma_f32_16x16x32_bf16 a[160:163],v[84:87],v[96:99],a[160:163]
ds_read_b64_tr_b16 v[186:187],v22 offset:20480
v_mfma_f32_16x16x32_bf16 a[164:167],v[84:87],v[100:103],a[164:167]
s_add_u32 s18,s18,s21
v_mfma_f32_16x16x32_bf16 a[168:171],v[84:87],v[104:107],a[168:171]
ds_read_b128 v[156:159],v12 offset:23552
v_mfma_f32_16x16x32_bf16 a[172:175],v[84:87],v[108:111],a[172:175]
s_addc_u32 s19,s19,0
v_mfma_f32_16x16x32_bf16 a[176:179],v[84:87],v[112:115],a[176:179]
ds_read_b64_tr_b16 v[188:189],v23 offset:16384
v_mfma_f32_16x16x32_bf16 a[180:183],v[84:87],v[116:119],a[180:183]
v_mfma_f32_16x16x32_bf16 a[184:187],v[84:87],v[120:123],a[184:187]
ds_read_b64_tr_b16 v[190:191],v23 offset:20480
v_mfma_f32_16x16x32_bf16 a[188:191],v[84:87],v[124:127],a[188:191]
v_mfma_f32_16x16x32_bf16 a[192:195],v[88:91],v[96:99],a[192:195]
v_mfma_f32_16x16x32_bf16 a[196:199],v[88:91],v[100:103],a[196:199]
v_mfma_f32_16x16x32_bf16 a[200:203],v[88:91],v[104:107],a[200:203]
v_mfma_f32_16x16x32_bf16 a[204:207],v[88:91],v[108:111],a[204:207]
v_mfma_f32_16x16x32_bf16 a[208:211],v[88:91],v[112:115],a[208:211]
v_mfma_f32_16x16x32_bf16 a[212:215],v[88:91],v[116:119],a[212:215]
v_mfma_f32_16x16x32_bf16 a[216:219],v[88:91],v[120:123],a[216:219]
v_mfma_f32_16x16x32_bf16 a[220:223],v[88:91],v[124:127],a[220:223]
v_mfma_f32_16x16x32_bf16 a[224:227],v[92:95],v[96:99],a[224:227]
v_mfma_f32_16x16x32_bf16 a[228:231],v[92:95],v[100:103],a[228:231]
v_mfma_f32_16x16x32_bf16 a[232:235],v[92:95],v[104:107],a[232:235]
v_mfma_f32_16x16x32_bf16 a[236:239],v[92:95],v[108:111],a[236:239]
v_mfma_f32_16x16x32_bf16 a[240:243],v[92:95],v[112:115],a[240:243]
v_mfma_f32_16x16x32_bf16 a[244:247],v[92:95],v[116:119],a[244:247]
v_mfma_f32_16x16x32_bf16 a[248:251],v[92:95],v[120:123],a[248:251]
v_mfma_f32_16x16x32_bf16 a[252:255],v[92:95],v[124:127],a[252:255]
s_waitcnt vmcnt(16) lgkmcnt(0)
s_barrier
v_mfma_f32_16x16x32_bf16 a[0:3],v[128:131],v[160:163],a[0:3]
ds_read_b128 v[64:67],v12 offset:32768
v_mfma_f32_16x16x32_bf16 a[4:7],v[128:131],v[164:167],a[4:7]
s_add_u32 m0,s23,16384
v_mfma_f32_16x16x32_bf16 a[8:11],v[128:131],v[168:171],a[8:11]
ds_read_b64_tr_b16 v[96:97],v16 offset:32768
v_mfma_f32_16x16x32_bf16 a[12:15],v[128:131],v[172:175],a[12:15]
global_load_lds_dwordx4 v4,s[16:17] offset:0 sc1
v_mfma_f32_16x16x32_bf16 a[16:19],v[128:131],v[176:179],a[16:19]
ds_read_b64_tr_b16 v[98:99],v16 offset:36864
v_mfma_f32_16x16x32_bf16 a[20:23],v[128:131],v[180:183],a[20:23]
v_mfma_f32_16x16x32_bf16 a[24:27],v[128:131],v[184:187],a[24:27]
ds_read_b128 v[68:71],v12 offset:33792
v_mfma_f32_16x16x32_bf16 a[28:31],v[128:131],v[188:191],a[28:31]
global_load_lds_dwordx4 v5,s[16:17] offset:1024 sc1
v_mfma_f32_16x16x32_bf16 a[32:35],v[132:135],v[160:163],a[32:35]
ds_read_b64_tr_b16 v[100:101],v17 offset:32768
v_mfma_f32_16x16x32_bf16 a[36:39],v[132:135],v[164:167],a[36:39]
v_mfma_f32_16x16x32_bf16 a[40:43],v[132:135],v[168:171],a[40:43]
ds_read_b64_tr_b16 v[102:103],v17 offset:36864
v_mfma_f32_16x16x32_bf16 a[44:47],v[132:135],v[172:175],a[44:47]
global_load_lds_dwordx4 v6,s[16:17] offset:2048 sc1
v_mfma_f32_16x16x32_bf16 a[48:51],v[132:135],v[176:179],a[48:51]
ds_read_b128 v[72:75],v12 offset:34816
v_mfma_f32_16x16x32_bf16 a[52:55],v[132:135],v[180:183],a[52:55]
v_mfma_f32_16x16x32_bf16 a[56:59],v[132:135],v[184:187],a[56:59]
ds_read_b64_tr_b16 v[104:105],v18 offset:32768
v_mfma_f32_16x16x32_bf16 a[60:63],v[132:135],v[188:191],a[60:63]
global_load_lds_dwordx4 v7,s[16:17] offset:3072 sc1
v_mfma_f32_16x16x32_bf16 a[64:67],v[136:139],v[160:163],a[64:67]
ds_read_b64_tr_b16 v[106:107],v18 offset:36864
v_mfma_f32_16x16x32_bf16 a[68:71],v[136:139],v[164:167],a[68:71]
v_mfma_f32_16x16x32_bf16 a[72:75],v[136:139],v[168:171],a[72:75]
ds_read_b128 v[76:79],v12 offset:35840
v_mfma_f32_16x16x32_bf16 a[76:79],v[136:139],v[172:175],a[76:79]
s_add_u32 m0,s23,81920
v_mfma_f32_16x16x32_bf16 a[80:83],v[136:139],v[176:179],a[80:83]
ds_read_b64_tr_b16 v[108:109],v19 offset:32768
v_mfma_f32_16x16x32_bf16 a[84:87],v[136:139],v[180:183],a[84:87]
s_add_u32 s16,s16,s20
v_mfma_f32_16x16x32_bf16 a[88:91],v[136:139],v[184:187],a[88:91]
ds_read_b64_tr_b16 v[110:111],v19 offset:36864
v_mfma_f32_16x16x32_bf16 a[92:95],v[136:139],v[188:191],a[92:95]
s_addc_u32 s17,s17,0
v_mfma_f32_16x16x32_bf16 a[96:99],v[140:143],v[160:163],a[96:99]
ds_read_b128 v[80:83],v12 offset:36864
v_mfma_f32_16x16x32_bf16 a[100:103],v[140:143],v[164:167],a[100:103]
global_load_lds_dwordx4 v8,s[18:19] offset:0
v_mfma_f32_16x16x32_bf16 a[104:107],v[140:143],v[168:171],a[104:107]
ds_read_b64_tr_b16 v[112:113],v20 offset:32768
v_mfma_f32_16x16x32_bf16 a[108:111],v[140:143],v[172:175],a[108:111]
v_mfma_f32_16x16x32_bf16 a[112:115],v[140:143],v[176:179],a[112:115]
ds_read_b64_tr_b16 v[114:115],v20 offset:36864
v_mfma_f32_16x16x32_bf16 a[116:119],v[140:143],v[180:183],a[116:119]
global_load_lds_dwordx4 v9,s[18:19] offset:1024
v_mfma_f32_16x16x32_bf16 a[120:123],v[140:143],v[184:187],a[120:123]
ds_read_b128 v[84:87],v12 offset:37888
v_mfma_f32_16x16x32_bf16 a[124:127],v[140:143],v[188:191],a[124:127]
v_mfma_f32_16x16x32_bf16 a[128:131],v[144:147],v[160:163],a[128:131]
ds_read_b64_tr_b16 v[116:117],v21 offset:32768
v_mfma_f32_16x16x32_bf16 a[132:135],v[144:147],v[164:167],a[132:135]
global_load_lds_dwordx4 v10,s[18:19] offset:2048
v_mfma_f32_16x16x32_bf16 a[136:139],v[144:147],v[168:171],a[136:139]
ds_read_b64_tr_b16 v[118:119],v21 offset:36864
v_mfma_f32_16x16x32_bf16 a[140:143],v[144:147],v[172:175],a[140:143]
v_mfma_f32_16x16x32_bf16 a[144:147],v[144:147],v[176:179],a[144:147]
ds_read_b128 v[88:91],v12 offset:38912
v_mfma_f32_16x16x32_bf16 a[148:151],v[144:147],v[180:183],a[148:151]
global_load_lds_dwordx4 v11,s[18:19] offset:3072
v_mfma_f32_16x16x32_bf16 a[152:155],v[144:147],v[184:187],a[152:155]
ds_read_b64_tr_b16 v[120:121],v22 offset:32768
v_mfma_f32_16x16x32_bf16 a[156:159],v[144:147],v[188:191],a[156:159]
v_mfma_f32_16x16x32_bf16 a[160:163],v[148:151],v[160:163],a[160:163]
ds_read_b64_tr_b16 v[122:123],v22 offset:36864
v_mfma_f32_16x16x32_bf16 a[164:167],v[148:151],v[164:167],a[164:167]
s_add_u32 s18,s18,s21
v_mfma_f32_16x16x32_bf16 a[168:171],v[148:151],v[168:171],a[168:171]
ds_read_b128 v[92:95],v12 offset:39936
v_mfma_f32_16x16x32_bf16 a[172:175],v[148:151],v[172:175],a[172:175]
s_addc_u32 s19,s19,0
v_mfma_f32_16x16x32_bf16 a[176:179],v[148:151],v[176:179],a[176:179]
ds_read_b64_tr_b16 v[124:125],v23 offset:32768
v_mfma_f32_16x16x32_bf16 a[180:183],v[148:151],v[180:183],a[180:183]
v_mfma_f32_16x16x32_bf16 a[184:187],v[148:151],v[184:187],a[184:187]
ds_read_b64_tr_b16 v[126:127],v23 offset:36864
v_mfma_f32_16x16x32_bf16 a[188:191],v[148:151],v[188:191],a[188:191]
v_mfma_f32_16x16x32_bf16 a[192:195],v[152:155],v[160:163],a[192:195]
v_mfma_f32_16x16x32_bf16 a[196:199],v[152:155],v[164:167],a[196:199]
v_mfma_f32_16x16x32_bf16 a[200:203],v[152:155],v[168:171],a[200:203]
v_mfma_f32_16x16x32_bf16 a[204:207],v[152:155],v[172:175],a[204:207]
v_mfma_f32_16x16x32_bf16 a[208:211],v[152:155],v[176:179],a[208:211]
v_mfma_f32_16x16x32_bf16 a[212:215],v[152:155],v[180:183],a[212:215]
v_mfma_f32_16x16x32_bf16 a[216:219],v[152:155],v[184:187],a[216:219]
v_mfma_f32_16x16x32_bf16 a[220:223],v[152:155],v[188:191],a[220:223]
v_mfma_f32_16x16x32_bf16 a[224:227],v[156:159],v[160:163],a[224:227]
v_mfma_f32_16x16x32_bf16 a[228:231],v[156:159],v[164:167],a[228:231]
v_mfma_f32_16x16x32_bf16 a[232:235],v[156:159],v[168:171],a[232:235]
v_mfma_f32_16x16x32_bf16 a[236:239],v[156:159],v[172:175],a[236:239]
v_mfma_f32_16x16x32_bf16 a[240:243],v[156:159],v[176:179],a[240:243]
v_mfma_f32_16x16x32_bf16 a[244:247],v[156:159],v[180:183],a[244:247]
v_mfma_f32_16x16x32_bf16 a[248:251],v[156:159],v[184:187],a[248:251]
v_mfma_f32_16x16x32_bf16 a[252:255],v[156:159],v[188:191],a[252:255]
s_waitcnt vmcnt(16) lgkmcnt(0)
s_barrier
v_mfma_f32_16x16x32_bf16 a[0:3],v[64:67],v[96:99],a[0:3]
ds_read_b128 v[128:131],v12 offset:49152
v_mfma_f32_16x16x32_bf16 a[4:7],v[64:67],v[100:103],a[4:7]
s_add_u32 m0,s23,32768
v_mfma_f32_16x16x32_bf16 a[8:11],v[64:67],v[104:107],a[8:11]
ds_read_b64_tr_b16 v[160:161],v16 offset:49152
v_mfma_f32_16x16x32_bf16 a[12:15],v[64:67],v[108:111],a[12:15]
global_load_lds_dwordx4 v4,s[16:17] offset:0 sc1
v_mfma_f32_16x16x32_bf16 a[16:19],v[64:67],v[112:115],a[16:19]
ds_read_b64_tr_b16 v[162:163],v16 offset:53248
v_mfma_f32_16x16x32_bf16 a[20:23],v[64:67],v[116:119],a[20:23]
v_mfma_f32_16x16x32_bf16 a[24:27],v[64:67],v[120:123],a[24:27]
ds_read_b128 v[132:135],v12 offset:50176
v_mfma_f32_16x16x32_bf16 a[28:31],v[64:67],v[124:127],a[28:31]
global_load_lds_dwordx4 v5,s[16:17] offset:1024 sc1
v_mfma_f32_16x16x32_bf16 a[32:35],v[68:71],v[96:99],a[32:35]
ds_read_b64_tr_b16 v[164:165],v17 offset:49152
v_mfma_f32_16x16x32_bf16 a[36:39],v[68:71],v[100:103],a[36:39]
v_mfma_f32_16x16x32_bf16 a[40:43],v[68:71],v[104:107],a[40:43]
ds_read_b64_tr_b16 v[166:167],v17 offset:53248
v_mfma_f32_16x16x32_bf16 a[44:47],v[68:71],v[108:111],a[44:47]
global_load_lds_dwordx4 v6,s[16:17] offset:2048 sc1
v_mfma_f32_16x16x32_bf16 a[48:51],v[68:71],v[112:115],a[48:51]
ds_read_b128 v[136:139],v12 offset:51200
v_mfma_f32_16x16x32_bf16 a[52:55],v[68:71],v[116:119],a[52:55]
v_mfma_f32_16x16x32_bf16 a[56:59],v[68:71],v[120:123],a[56:59]
ds_read_b64_tr_b16 v[168:169],v18 offset:49152
v_mfma_f32_16x16x32_bf16 a[60:63],v[68:71],v[124:127],a[60:63]
global_load_lds_dwordx4 v7,s[16:17] offset:3072 sc1
v_mfma_f32_16x16x32_bf16 a[64:67],v[72:75],v[96:99],a[64:67]
ds_read_b64_tr_b16 v[170:171],v18 offset:53248
v_mfma_f32_16x16x32_bf16 a[68:71],v[72:75],v[100:103],a[68:71]
v_mfma_f32_16x16x32_bf16 a[72:75],v[72:75],v[104:107],a[72:75]
ds_read_b128 v[140:143],v12 offset:52224
v_mfma_f32_16x16x32_bf16 a[76:79],v[72:75],v[108:111],a[76:79]
s_add_u32 m0,s23,98304
v_mfma_f32_16x16x32_bf16 a[80:83],v[72:75],v[112:115],a[80:83]
ds_read_b64_tr_b16 v[172:173],v19 offset:49152
v_mfma_f32_16x16x32_bf16 a[84:87],v[72:75],v[116:119],a[84:87]
s_add_u32 s16,s16,s20
v_mfma_f32_16x16x32_bf16 a[88:91],v[72:75],v[120:123],a[88:91]
ds_read_b64_tr_b16 v[174:175],v19 offset:53248
v_mfma_f32_16x16x32_bf16 a[92:95],v[72:75],v[124:127],a[92:95]
s_addc_u32 s17,s17,0
v_mfma_f32_16x16x32_bf16 a[96:99],v[76:79],v[96:99],a[96:99]
ds_read_b128 v[144:147],v12 offset:53248
v_mfma_f32_16x16x32_bf16 a[100:103],v[76:79],v[100:103],a[100:103]
global_load_lds_dwordx4 v8,s[18:19] offset:0
v_mfma_f32_16x16x32_bf16 a[104:107],v[76:79],v[104:107],a[104:107]
ds_read_b64_tr_b16 v[176:177],v20 offset:49152
v_mfma_f32_16x16x32_bf16 a[108:111],v[76:79],v[108:111],a[108:111]
v_mfma_f32_16x16x32_bf16 a[112:115],v[76:79],v[112:115],a[112:115]
ds_read_b64_tr_b16 v[178:179],v20 offset:53248
v_mfma_f32_16x16x32_bf16 a[116:119],v[76:79],v[116:119],a[116:119]
global_load_lds_dwordx4 v9,s[18:19] offset:1024
v_mfma_f32_16x16x32_bf16 a[120:123],v[76:79],v[120:123],a[120:123]
ds_read_b128 v[148:151],v12 offset:54272
v_mfma_f32_16x16x32_bf16 a[124:127],v[76:79],v[124:127],a[124:127]
v_mfma_f32_16x16x32_bf16 a[128:131],v[80:83],v[96:99],a[128:131]
ds_read_b64_tr_b16 v[180:181],v21 offset:49152
v_mfma_f32_16x16x32_bf16 a[132:135],v[80:83],v[100:103],a[132:135]
global_load_lds_dwordx4 v10,s[18:19] offset:2048
v_mfma_f32_16x16x32_bf16 a[136:139],v[80:83],v[104:107],a[136:139]
ds_read_b64_tr_b16 v[182:183],v21 offset:53248
v_mfma_f32_16x16x32_bf16 a[140:143],v[80:83],v[108:111],a[140:143]
v_mfma_f32_16x16x32_bf16 a[144:147],v[80:83],v[112:115],a[144:147]
ds_read_b128 v[152:155],v12 offset:55296
v_mfma_f32_16x16x32_bf16 a[148:151],v[80:83],v[116:119],a[148:151]
global_load_lds_dwordx4 v11,s[18:19] offset:3072
v_mfma_f32_16x16x32_bf16 a[152:155],v[80:83],v[120:123],a[152:155]
ds_read_b64_tr_b16 v[184:185],v22 offset:49152
v_mfma_f32_16x16x32_bf16 a[156:159],v[80:83],v[124:127],a[156:159]
v_mfma_f32_16x16x32_bf16 a[160:163],v[84:87],v[96:99],a[160:163]
ds_read_b64_tr_b16 v[186:187],v22 offset:53248
v_mfma_f32_16x16x32_bf16 a[164:167],v[84:87],v[100:103],a[164:167]
s_add_u32 s18,s18,s21
v_mfma_f32_16x16x32_bf16 a[168:171],v[84:87],v[104:107],a[168:171]
ds_read_b128 v[156:159],v12 offset:56320
v_mfma_f32_16x16x32_bf16 a[172:175],v[84:87],v[108:111],a[172:175]
s_addc_u32 s19,s19,0
v_mfma_f32_16x16x32_bf16 a[176:179],v[84:87],v[112:115],a[176:179]
ds_read_b64_tr_b16 v[188:189],v23 offset:49152
v_mfma_f32_16x16x32_bf16 a[180:183],v[84:87],v[116:119],a[180:183]
v_mfma_f32_16x16x32_bf16 a[184:187],v[84:87],v[120:123],a[184:187]
ds_read_b64_tr_b16 v[190:191],v23 offset:53248
v_mfma_f32_16x16x32_bf16 a[188:191],v[84:87],v[124:127],a[188:191]
v_mfma_f32_16x16x32_bf16 a[192:195],v[88:91],v[96:99],a[192:195]
v_mfma_f32_16x16x32_bf16 a[196:199],v[88:91],v[100:103],a[196:199]
v_mfma_f32_16x16x32_bf16 a[200:203],v[88:91],v[104:107],a[200:203]
v_mfma_f32_16x16x32_bf16 a[204:207],v[88:91],v[108:111],a[204:207]
v_mfma_f32_16x16x32_bf16 a[208:211],v[88:91],v[112:115],a[208:211]
v_mfma_f32_16x16x32_bf16 a[212:215],v[88:91],v[116:119],a[212:215]
v_mfma_f32_16x16x32_bf16 a[216:219],v[88:91],v[120:123],a[216:219]
v_mfma_f32_16x16x32_bf16 a[220:223],v[88:91],v[124:127],a[220:223]
v_mfma_f32_16x16x32_bf16 a[224:227],v[92:95],v[96:99],a[224:227]
v_mfma_f32_16x16x32_bf16 a[228:231],v[92:95],v[100:103],a[228:231]
v_mfma_f32_16x16x32_bf16 a[232:235],v[92:95],v[104:107],a[232:235]
v_mfma_f32_16x16x32_bf16 a[236:239],v[92:95],v[108:111],a[236:239]
v_mfma_f32_16x16x32_bf16 a[240:243],v[92:95],v[112:115],a[240:243]
v_mfma_f32_16x16x32_bf16 a[244:247],v[92:95],v[116:119],a[244:247]
v_mfma_f32_16x16x32_bf16 a[248:251],v[92:95],v[120:123],a[248:251]
v_mfma_f32_16x16x32_bf16 a[252:255],v[92:95],v[124:127],a[252:255]
s_waitcnt vmcnt(63) lgkmcnt(0)
s_barrier
v_mfma_f32_16x16x32_bf16 a[0:3],v[128:131],v[160:163],a[0:3]
v_mfma_f32_16x16x32_bf16 a[4:7],v[128:131],v[164:167],a[4:7]
s_add_u32 m0,s23,49152
v_mfma_f32_16x16x32_bf16 a[8:11],v[128:131],v[168:171],a[8:11]
v_mfma_f32_16x16x32_bf16 a[12:15],v[128:131],v[172:175],a[12:15]
global_load_lds_dwordx4 v4,s[16:17] offset:0 sc1
v_mfma_f32_16x16x32_bf16 a[16:19],v[128:131],v[176:179],a[16:19]
v_mfma_f32_16x16x32_bf16 a[20:23],v[128:131],v[180:183],a[20:23]
v_mfma_f32_16x16x32_bf16 a[24:27],v[128:131],v[184:187],a[24:27]
v_mfma_f32_16x16x32_bf16 a[28:31],v[128:131],v[188:191],a[28:31]
global_load_lds_dwordx4 v5,s[16:17] offset:1024 sc1
v_mfma_f32_16x16x32_bf16 a[32:35],v[132:135],v[160:163],a[32:35]
v_mfma_f32_16x16x32_bf16 a[36:39],v[132:135],v[164:167],a[36:39]
v_mfma_f32_16x16x32_bf16 a[40:43],v[132:135],v[168:171],a[40:43]
v_mfma_f32_16x16x32_bf16 a[44:47],v[132:135],v[172:175],a[44:47]
global_load_lds_dwordx4 v6,s[16:17] offset:2048 sc1
v_mfma_f32_16x16x32_bf16 a[48:51],v[132:135],v[176:179],a[48:51]
v_mfma_f32_16x16x32_bf16 a[52:55],v[132:135],v[180:183],a[52:55]
v_mfma_f32_16x16x32_bf16 a[56:59],v[132:135],v[184:187],a[56:59]
v_mfma_f32_16x16x32_bf16 a[60:63],v[132:135],v[188:191],a[60:63]
global_load_lds_dwordx4 v7,s[16:17] offset:3072 sc1
v_mfma_f32_16x16x32_bf16 a[64:67],v[136:139],v[160:163],a[64:67]
v_mfma_f32_16x16x32_bf16 a[68:71],v[136:139],v[164:167],a[68:71]
v_mfma_f32_16x16x32_bf16 a[72:75],v[136:139],v[168:171],a[72:75]
v_mfma_f32_16x16x32_bf16 a[76:79],v[136:139],v[172:175],a[76:79]
s_add_u32 m0,s23,114688
v_mfma_f32_16x16x32_bf16 a[80:83],v[136:139],v[176:179],a[80:83]
v_mfma_f32_16x16x32_bf16 a[84:87],v[136:139],v[180:183],a[84:87]
s_add_u32 s16,s16,s20
v_mfma_f32_16x16x32_bf16 a[88:91],v[136:139],v[184:187],a[88:91]
v_mfma_f32_16x16x32_bf16 a[92:95],v[136:139],v[188:191],a[92:95]
s_addc_u32 s17,s17,0
v_mfma_f32_16x16x32_bf16 a[96:99],v[140:143],v[160:163],a[96:99]
v_mfma_f32_16x16x32_bf16 a[100:103],v[140:143],v[164:167],a[100:103]
global_load_lds_dwordx4 v8,s[18:19] offset:0
v_mfma_f32_16x16x32_bf16 a[104:107],v[140:143],v[168:171],a[104:107]
v_mfma_f32_16x16x32_bf16 a[108:111],v[140:143],v[172:175],a[108:111]
v_mfma_f32_16x16x32_bf16 a[112:115],v[140:143],v[176:179],a[112:115]
v_mfma_f32_16x16x32_bf16 a[116:119],v[140:143],v[180:183],a[116:119]
global_load_lds_dwordx4 v9,s[18:19] offset:1024
v_mfma_f32_16x16x32_bf16 a[120:123],v[140:143],v[184:187],a[120:123]
v_mfma_f32_16x16x32_bf16 a[124:127],v[140:143],v[188:191],a[124:127]
v_mfma_f32_16x16x32_bf16 a[128:131],v[144:147],v[160:163],a[128:131]
v_mfma_f32_16x16x32_bf16 a[132:135],v[144:147],v[164:167],a[132:135]
global_load_lds_dwordx4 v10,s[18:19] offset:2048
v_mfma_f32_16x16x32_bf16 a[136:139],v[144:147],v[168:171],a[136:139]
v_mfma_f32_16x16x32_bf16 a[140:143],v[144:147],v[172:175],a[140:143]
v_mfma_f32_16x16x32_bf16 a[144:147],v[144:147],v[176:179],a[144:147]
v_mfma_f32_16x16x32_bf16 a[148:151],v[144:147],v[180:183],a[148:151]
global_load_lds_dwordx4 v11,s[18:19] offset:3072
v_mfma_f32_16x16x32_bf16 a[152:155],v[144:147],v[184:187],a[152:155]
v_mfma_f32_16x16x32_bf16 a[156:159],v[144:147],v[188:191],a[156:159]
v_mfma_f32_16x16x32_bf16 a[160:163],v[148:151],v[160:163],a[160:163]
v_mfma_f32_16x16x32_bf16 a[164:167],v[148:151],v[164:167],a[164:167]
s_add_u32 s18,s18,s21
v_mfma_f32_16x16x32_bf16 a[168:171],v[148:151],v[168:171],a[168:171]
v_mfma_f32_16x16x32_bf16 a[172:175],v[148:151],v[172:175],a[172:175]
s_addc_u32 s19,s19,0
v_mfma_f32_16x16x32_bf16 a[176:179],v[148:151],v[176:179],a[176:179]
v_mfma_f32_16x16x32_bf16 a[180:183],v[148:151],v[180:183],a[180:183]
v_mfma_f32_16x16x32_bf16 a[184:187],v[148:151],v[184:187],a[184:187]
v_mfma_f32_16x16x32_bf16 a[188:191],v[148:151],v[188:191],a[188:191]
v_mfma_f32_16x16x32_bf16 a[192:195],v[152:155],v[160:163],a[192:195]
v_mfma_f32_16x16x32_bf16 a[196:199],v[152:155],v[164:167],a[196:199]
v_mfma_f32_16x16x32_bf16 a[200:203],v[152:155],v[168:171],a[200:203]
v_mfma_f32_16x16x32_bf16 a[204:207],v[152:155],v[172:175],a[204:207]
v_mfma_f32_16x16x32_bf16 a[208:211],v[152:155],v[176:179],a[208:211]
v_mfma_f32_16x16x32_bf16 a[212:215],v[152:155],v[180:183],a[212:215]
v_mfma_f32_16x16x32_bf16 a[216:219],v[152:155],v[184:187],a[216:219]
v_mfma_f32_16x16x32_bf16 a[220:223],v[152:155],v[188:191],a[220:223]
v_mfma_f32_16x16x32_bf16 a[224:227],v[156:159],v[160:163],a[224:227]
v_mfma_f32_16x16x32_bf16 a[228:231],v[156:159],v[164:167],a[228:231]
v_mfma_f32_16x16x32_bf16 a[232:235],v[156:159],v[168:171],a[232:235]
v_mfma_f32_16x16x32_bf16 a[236:239],v[156:159],v[172:175],a[236:239]
v_mfma_f32_16x16x32_bf16 a[240:243],v[156:159],v[176:179],a[240:243]
v_mfma_f32_16x16x32_bf16 a[244:247],v[156:159],v[180:183],a[244:247]
v_mfma_f32_16x16x32_bf16 a[248:251],v[156:159],v[184:187],a[248:251]
v_mfma_f32_16x16x32_bf16 a[252:255],v[156:159],v[188:191],a[252:255]
v_accvgpr_read_b32 v32,a0
v_accvgpr_read_b32 v33,a1
v_accvgpr_read_b32 v34,a2
v_accvgpr_read_b32 v35,a3
v_accvgpr_read_b32 v36,a32
v_accvgpr_read_b32 v37,a33
v_accvgpr_read_b32 v38,a34
v_accvgpr_read_b32 v39,a35
v_cvt_pk_bf16_f32 v64,v32,v33
v_cvt_pk_bf16_f32 v65,v34,v35
v_cvt_pk_bf16_f32 v66,v36,v37
v_cvt_pk_bf16_f32 v67,v38,v39
global_store_dwordx4 v2,v[64:67],s[30:31] offset:0 sc1
v_accvgpr_read_b32 v24,a4
v_accvgpr_read_b32 v25,a5
v_accvgpr_read_b32 v26,a6
v_accvgpr_read_b32 v27,a7
v_accvgpr_read_b32 v28,a36
v_accvgpr_read_b32 v29,a37
v_accvgpr_read_b32 v30,a38
v_accvgpr_read_b32 v31,a39
v_cvt_pk_bf16_f32 v68,v24,v25
v_cvt_pk_bf16_f32 v69,v26,v27
v_cvt_pk_bf16_f32 v70,v28,v29
v_cvt_pk_bf16_f32 v71,v30,v31
global_store_dwordx4 v2,v[68:71],s[30:31] offset:1024 sc1
v_accvgpr_read_b32 v32,a8
v_accvgpr_read_b32 v33,a9
v_accvgpr_read_b32 v34,a10
v_accvgpr_read_b32 v35,a11
v_accvgpr_read_b32 v36,a40
v_accvgpr_read_b32 v37,a41
v_accvgpr_read_b32 v38,a42
v_accvgpr_read_b32 v39,a43
v_cvt_pk_bf16_f32 v72,v32,v33
v_cvt_pk_bf16_f32 v73,v34,v35
v_cvt_pk_bf16_f32 v74,v36,v37
v_cvt_pk_bf16_f32 v75,v38,v39
global_store_dwordx4 v2,v[72:75],s[30:31] offset:2048 sc1
v_accvgpr_read_b32 v24,a12
v_accvgpr_read_b32 v25,a13
v_accvgpr_read_b32 v26,a14
v_accvgpr_read_b32 v27,a15
v_accvgpr_read_b32 v28,a44
v_accvgpr_read_b32 v29,a45
v_accvgpr_read_b32 v30,a46
v_accvgpr_read_b32 v31,a47
v_cvt_pk_bf16_f32 v76,v24,v25
v_cvt_pk_bf16_f32 v77,v26,v27
v_cvt_pk_bf16_f32 v78,v28,v29
v_cvt_pk_bf16_f32 v79,v30,v31
global_store_dwordx4 v2,v[76:79],s[30:31] offset:3072 sc1
v_accvgpr_read_b32 v32,a16
v_accvgpr_read_b32 v33,a17
v_accvgpr_read_b32 v34,a18
v_accvgpr_read_b32 v35,a19
v_accvgpr_read_b32 v36,a48
v_accvgpr_read_b32 v37,a49
v_accvgpr_read_b32 v38,a50
v_accvgpr_read_b32 v39,a51
v_cvt_pk_bf16_f32 v80,v32,v33
v_cvt_pk_bf16_f32 v81,v34,v35
v_cvt_pk_bf16_f32 v82,v36,v37
v_cvt_pk_bf16_f32 v83,v38,v39
global_store_dwordx4 v3,v[80:83],s[30:31] offset:0 sc1
v_accvgpr_read_b32 v24,a20
v_accvgpr_read_b32 v25,a21
v_accvgpr_read_b32 v26,a22
v_accvgpr_read_b32 v27,a23
v_accvgpr_read_b32 v28,a52
v_accvgpr_read_b32 v29,a53
v_accvgpr_read_b32 v30,a54
v_accvgpr_read_b32 v31,a55
v_cvt_pk_bf16_f32 v84,v24,v25
v_cvt_pk_bf16_f32 v85,v26,v27
v_cvt_pk_bf16_f32 v86,v28,v29
v_cvt_pk_bf16_f32 v87,v30,v31
global_store_dwordx4 v3,v[84:87],s[30:31] offset:1024 sc1
v_accvgpr_read_b32 v32,a24
v_accvgpr_read_b32 v33,a25
v_accvgpr_read_b32 v34,a26
v_accvgpr_read_b32 v35,a27
v_accvgpr_read_b32 v36,a56
v_accvgpr_read_b32 v37,a57
v_accvgpr_read_b32 v38,a58
v_accvgpr_read_b32 v39,a59
v_cvt_pk_bf16_f32 v88,v32,v33
v_cvt_pk_bf16_f32 v89,v34,v35
v_cvt_pk_bf16_f32 v90,v36,v37
v_cvt_pk_bf16_f32 v91,v38,v39
global_store_dwordx4 v3,v[88:91],s[30:31] offset:2048 sc1
v_accvgpr_read_b32 v24,a28
v_accvgpr_read_b32 v25,a29
v_accvgpr_read_b32 v26,a30
v_accvgpr_read_b32 v27,a31
v_accvgpr_read_b32 v28,a60
v_accvgpr_read_b32 v29,a61
v_accvgpr_read_b32 v30,a62
v_accvgpr_read_b32 v31,a63
v_cvt_pk_bf16_f32 v92,v24,v25
v_cvt_pk_bf16_f32 v93,v26,v27
v_cvt_pk_bf16_f32 v94,v28,v29
v_cvt_pk_bf16_f32 v95,v30,v31
global_store_dwordx4 v3,v[92:95],s[30:31] offset:3072 sc1
s_add_u32 s30,s30,8192
s_addc_u32 s31,s31,0
v_accvgpr_read_b32 v32,a64
v_accvgpr_read_b32 v33,a65
v_accvgpr_read_b32 v34,a66
v_accvgpr_read_b32 v35,a67
v_accvgpr_read_b32 v36,a96
v_accvgpr_read_b32 v37,a97
v_accvgpr_read_b32 v38,a98
v_accvgpr_read_b32 v39,a99
v_cvt_pk_bf16_f32 v96,v32,v33
v_cvt_pk_bf16_f32 v97,v34,v35
v_cvt_pk_bf16_f32 v98,v36,v37
v_cvt_pk_bf16_f32 v99,v38,v39
global_store_dwordx4 v2,v[96:99],s[30:31] offset:0 sc1
v_accvgpr_read_b32 v24,a68
v_accvgpr_read_b32 v25,a69
v_accvgpr_read_b32 v26,a70
v_accvgpr_read_b32 v27,a71
v_accvgpr_read_b32 v28,a100
v_accvgpr_read_b32 v29,a101
v_accvgpr_read_b32 v30,a102
v_accvgpr_read_b32 v31,a103
v_cvt_pk_bf16_f32 v100,v24,v25
v_cvt_pk_bf16_f32 v101,v26,v27
v_cvt_pk_bf16_f32 v102,v28,v29
v_cvt_pk_bf16_f32 v103,v30,v31
global_store_dwordx4 v2,v[100:103],s[30:31] offset:1024 sc1
v_accvgpr_read_b32 v32,a72
v_accvgpr_read_b32 v33,a73
v_accvgpr_read_b32 v34,a74
v_accvgpr_read_b32 v35,a75
v_accvgpr_read_b32 v36,a104
v_accvgpr_read_b32 v37,a105
v_accvgpr_read_b32 v38,a106
v_accvgpr_read_b32 v39,a107
v_cvt_pk_bf16_f32 v104,v32,v33
v_cvt_pk_bf16_f32 v105,v34,v35
v_cvt_pk_bf16_f32 v106,v36,v37
v_cvt_pk_bf16_f32 v107,v38,v39
global_store_dwordx4 v2,v[104:107],s[30:31] offset:2048 sc1
v_accvgpr_read_b32 v24,a76
v_accvgpr_read_b32 v25,a77
v_accvgpr_read_b32 v26,a78
v_accvgpr_read_b32 v27,a79
v_accvgpr_read_b32 v28,a108
v_accvgpr_read_b32 v29,a109
v_accvgpr_read_b32 v30,a110
v_accvgpr_read_b32 v31,a111
v_cvt_pk_bf16_f32 v108,v24,v25
v_cvt_pk_bf16_f32 v109,v26,v27
v_cvt_pk_bf16_f32 v110,v28,v29
v_cvt_pk_bf16_f32 v111,v30,v31
global_store_dwordx4 v2,v[108:111],s[30:31] offset:3072 sc1
v_accvgpr_read_b32 v32,a80
v_accvgpr_read_b32 v33,a81
v_accvgpr_read_b32 v34,a82
v_accvgpr_read_b32 v35,a83
v_accvgpr_read_b32 v36,a112
v_accvgpr_read_b32 v37,a113
v_accvgpr_read_b32 v38,a114
v_accvgpr_read_b32 v39,a115
v_cvt_pk_bf16_f32 v112,v32,v33
v_cvt_pk_bf16_f32 v113,v34,v35
v_cvt_pk_bf16_f32 v114,v36,v37
v_cvt_pk_bf16_f32 v115,v38,v39
global_store_dwordx4 v3,v[112:115],s[30:31] offset:0 sc1
v_accvgpr_read_b32 v24,a84
v_accvgpr_read_b32 v25,a85
v_accvgpr_read_b32 v26,a86
v_accvgpr_read_b32 v27,a87
v_accvgpr_read_b32 v28,a116
v_accvgpr_read_b32 v29,a117
v_accvgpr_read_b32 v30,a118
v_accvgpr_read_b32 v31,a119
v_cvt_pk_bf16_f32 v116,v24,v25
v_cvt_pk_bf16_f32 v117,v26,v27
v_cvt_pk_bf16_f32 v118,v28,v29
v_cvt_pk_bf16_f32 v119,v30,v31
global_store_dwordx4 v3,v[116:119],s[30:31] offset:1024 sc1
v_accvgpr_read_b32 v32,a88
v_accvgpr_read_b32 v33,a89
v_accvgpr_read_b32 v34,a90
v_accvgpr_read_b32 v35,a91
v_accvgpr_read_b32 v36,a120
v_accvgpr_read_b32 v37,a121
v_accvgpr_read_b32 v38,a122
v_accvgpr_read_b32 v39,a123
v_cvt_pk_bf16_f32 v120,v32,v33
v_cvt_pk_bf16_f32 v121,v34,v35
v_cvt_pk_bf16_f32 v122,v36,v37
v_cvt_pk_bf16_f32 v123,v38,v39
global_store_dwordx4 v3,v[120:123],s[30:31] offset:2048 sc1
v_accvgpr_read_b32 v24,a92
v_accvgpr_read_b32 v25,a93
v_accvgpr_read_b32 v26,a94
v_accvgpr_read_b32 v27,a95
v_accvgpr_read_b32 v28,a124
v_accvgpr_read_b32 v29,a125
v_accvgpr_read_b32 v30,a126
v_accvgpr_read_b32 v31,a127
v_cvt_pk_bf16_f32 v124,v24,v25
v_cvt_pk_bf16_f32 v125,v26,v27
v_cvt_pk_bf16_f32 v126,v28,v29
v_cvt_pk_bf16_f32 v127,v30,v31
global_store_dwordx4 v3,v[124:127],s[30:31] offset:3072 sc1
s_add_u32 s30,s30,8192
s_addc_u32 s31,s31,0
v_accvgpr_read_b32 v32,a128
v_accvgpr_read_b32 v33,a129
v_accvgpr_read_b32 v34,a130
v_accvgpr_read_b32 v35,a131
v_accvgpr_read_b32 v36,a160
v_accvgpr_read_b32 v37,a161
v_accvgpr_read_b32 v38,a162
v_accvgpr_read_b32 v39,a163
v_cvt_pk_bf16_f32 v64,v32,v33
v_cvt_pk_bf16_f32 v65,v34,v35
v_cvt_pk_bf16_f32 v66,v36,v37
v_cvt_pk_bf16_f32 v67,v38,v39
global_store_dwordx4 v2,v[64:67],s[30:31] offset:0 sc1
v_accvgpr_read_b32 v24,a132
v_accvgpr_read_b32 v25,a133
v_accvgpr_read_b32 v26,a134
v_accvgpr_read_b32 v27,a135
v_accvgpr_read_b32 v28,a164
v_accvgpr_read_b32 v29,a165
v_accvgpr_read_b32 v30,a166
v_accvgpr_read_b32 v31,a167
v_cvt_pk_bf16_f32 v68,v24,v25
v_cvt_pk_bf16_f32 v69,v26,v27
v_cvt_pk_bf16_f32 v70,v28,v29
v_cvt_pk_bf16_f32 v71,v30,v31
global_store_dwordx4 v2,v[68:71],s[30:31] offset:1024 sc1
v_accvgpr_read_b32 v32,a136
v_accvgpr_read_b32 v33,a137
v_accvgpr_read_b32 v34,a138
v_accvgpr_read_b32 v35,a139
v_accvgpr_read_b32 v36,a168
v_accvgpr_read_b32 v37,a169
v_accvgpr_read_b32 v38,a170
v_accvgpr_read_b32 v39,a171
v_cvt_pk_bf16_f32 v72,v32,v33
v_cvt_pk_bf16_f32 v73,v34,v35
v_cvt_pk_bf16_f32 v74,v36,v37
v_cvt_pk_bf16_f32 v75,v38,v39
global_store_dwordx4 v2,v[72:75],s[30:31] offset:2048 sc1
v_accvgpr_read_b32 v24,a140
v_accvgpr_read_b32 v25,a141
v_accvgpr_read_b32 v26,a142
v_accvgpr_read_b32 v27,a143
v_accvgpr_read_b32 v28,a172
v_accvgpr_read_b32 v29,a173
v_accvgpr_read_b32 v30,a174
v_accvgpr_read_b32 v31,a175
v_cvt_pk_bf16_f32 v76,v24,v25
v_cvt_pk_bf16_f32 v77,v26,v27
v_cvt_pk_bf16_f32 v78,v28,v29
v_cvt_pk_bf16_f32 v79,v30,v31
global_store_dwordx4 v2,v[76:79],s[30:31] offset:3072 sc1
v_accvgpr_read_b32 v32,a144
v_accvgpr_read_b32 v33,a145
v_accvgpr_read_b32 v34,a146
v_accvgpr_read_b32 v35,a147
v_accvgpr_read_b32 v36,a176
v_accvgpr_read_b32 v37,a177
v_accvgpr_read_b32 v38,a178
v_accvgpr_read_b32 v39,a179
v_cvt_pk_bf16_f32 v80,v32,v33
v_cvt_pk_bf16_f32 v81,v34,v35
v_cvt_pk_bf16_f32 v82,v36,v37
v_cvt_pk_bf16_f32 v83,v38,v39
global_store_dwordx4 v3,v[80:83],s[30:31] offset:0 sc1
v_accvgpr_read_b32 v24,a148
v_accvgpr_read_b32 v25,a149
v_accvgpr_read_b32 v26,a150
v_accvgpr_read_b32 v27,a151
v_accvgpr_read_b32 v28,a180
v_accvgpr_read_b32 v29,a181
v_accvgpr_read_b32 v30,a182
v_accvgpr_read_b32 v31,a183
v_cvt_pk_bf16_f32 v84,v24,v25
v_cvt_pk_bf16_f32 v85,v26,v27
v_cvt_pk_bf16_f32 v86,v28,v29
v_cvt_pk_bf16_f32 v87,v30,v31
global_store_dwordx4 v3,v[84:87],s[30:31] offset:1024 sc1
v_accvgpr_read_b32 v32,a152
v_accvgpr_read_b32 v33,a153
v_accvgpr_read_b32 v34,a154
v_accvgpr_read_b32 v35,a155
v_accvgpr_read_b32 v36,a184
v_accvgpr_read_b32 v37,a185
v_accvgpr_read_b32 v38,a186
v_accvgpr_read_b32 v39,a187
v_cvt_pk_bf16_f32 v88,v32,v33
v_cvt_pk_bf16_f32 v89,v34,v35
v_cvt_pk_bf16_f32 v90,v36,v37
v_cvt_pk_bf16_f32 v91,v38,v39
global_store_dwordx4 v3,v[88:91],s[30:31] offset:2048 sc1
v_accvgpr_read_b32 v24,a156
v_accvgpr_read_b32 v25,a157
v_accvgpr_read_b32 v26,a158
v_accvgpr_read_b32 v27,a159
v_accvgpr_read_b32 v28,a188
v_accvgpr_read_b32 v29,a189
v_accvgpr_read_b32 v30,a190
v_accvgpr_read_b32 v31,a191
v_cvt_pk_bf16_f32 v92,v24,v25
v_cvt_pk_bf16_f32 v93,v26,v27
v_cvt_pk_bf16_f32 v94,v28,v29
v_cvt_pk_bf16_f32 v95,v30,v31
global_store_dwordx4 v3,v[92:95],s[30:31] offset:3072 sc1
s_add_u32 s30,s30,8192
s_addc_u32 s31,s31,0
v_accvgpr_read_b32 v32,a192
v_accvgpr_read_b32 v33,a193
v_accvgpr_read_b32 v34,a194
v_accvgpr_read_b32 v35,a195
v_accvgpr_read_b32 v36,a224
v_accvgpr_read_b32 v37,a225
v_accvgpr_read_b32 v38,a226
v_accvgpr_read_b32 v39,a227
v_cvt_pk_bf16_f32 v96,v32,v33
v_cvt_pk_bf16_f32 v97,v34,v35
v_cvt_pk_bf16_f32 v98,v36,v37
v_cvt_pk_bf16_f32 v99,v38,v39
global_store_dwordx4 v2,v[96:99],s[30:31] offset:0 sc1
v_accvgpr_read_b32 v24,a196
v_accvgpr_read_b32 v25,a197
v_accvgpr_read_b32 v26,a198
v_accvgpr_read_b32 v27,a199
v_accvgpr_read_b32 v28,a228
v_accvgpr_read_b32 v29,a229
v_accvgpr_read_b32 v30,a230
v_accvgpr_read_b32 v31,a231
v_cvt_pk_bf16_f32 v100,v24,v25
v_cvt_pk_bf16_f32 v101,v26,v27
v_cvt_pk_bf16_f32 v102,v28,v29
v_cvt_pk_bf16_f32 v103,v30,v31
global_store_dwordx4 v2,v[100:103],s[30:31] offset:1024 sc1
v_accvgpr_read_b32 v32,a200
v_accvgpr_read_b32 v33,a201
v_accvgpr_read_b32 v34,a202
v_accvgpr_read_b32 v35,a203
v_accvgpr_read_b32 v36,a232
v_accvgpr_read_b32 v37,a233
v_accvgpr_read_b32 v38,a234
v_accvgpr_read_b32 v39,a235
v_cvt_pk_bf16_f32 v104,v32,v33
v_cvt_pk_bf16_f32 v105,v34,v35
v_cvt_pk_bf16_f32 v106,v36,v37
v_cvt_pk_bf16_f32 v107,v38,v39
global_store_dwordx4 v2,v[104:107],s[30:31] offset:2048 sc1
v_accvgpr_read_b32 v24,a204
v_accvgpr_read_b32 v25,a205
v_accvgpr_read_b32 v26,a206
v_accvgpr_read_b32 v27,a207
v_accvgpr_read_b32 v28,a236
v_accvgpr_read_b32 v29,a237
v_accvgpr_read_b32 v30,a238
v_accvgpr_read_b32 v31,a239
v_cvt_pk_bf16_f32 v108,v24,v25
v_cvt_pk_bf16_f32 v109,v26,v27
v_cvt_pk_bf16_f32 v110,v28,v29
v_cvt_pk_bf16_f32 v111,v30,v31
global_store_dwordx4 v2,v[108:111],s[30:31] offset:3072 sc1
v_accvgpr_read_b32 v32,a208
v_accvgpr_read_b32 v33,a209
v_accvgpr_read_b32 v34,a210
v_accvgpr_read_b32 v35,a211
v_accvgpr_read_b32 v36,a240
v_accvgpr_read_b32 v37,a241
v_accvgpr_read_b32 v38,a242
v_accvgpr_read_b32 v39,a243
v_cvt_pk_bf16_f32 v112,v32,v33
v_cvt_pk_bf16_f32 v113,v34,v35
v_cvt_pk_bf16_f32 v114,v36,v37
v_cvt_pk_bf16_f32 v115,v38,v39
global_store_dwordx4 v3,v[112:115],s[30:31] offset:0 sc1
v_accvgpr_read_b32 v24,a212
v_accvgpr_read_b32 v25,a213
v_accvgpr_read_b32 v26,a214
v_accvgpr_read_b32 v27,a215
v_accvgpr_read_b32 v28,a244
v_accvgpr_read_b32 v29,a245
v_accvgpr_read_b32 v30,a246
v_accvgpr_read_b32 v31,a247
v_cvt_pk_bf16_f32 v116,v24,v25
v_cvt_pk_bf16_f32 v117,v26,v27
v_cvt_pk_bf16_f32 v118,v28,v29
v_cvt_pk_bf16_f32 v119,v30,v31
global_store_dwordx4 v3,v[116:119],s[30:31] offset:1024 sc1
v_accvgpr_read_b32 v32,a216
v_accvgpr_read_b32 v33,a217
v_accvgpr_read_b32 v34,a218
v_accvgpr_read_b32 v35,a219
v_accvgpr_read_b32 v36,a248
v_accvgpr_read_b32 v37,a249
v_accvgpr_read_b32 v38,a250
v_accvgpr_read_b32 v39,a251
v_cvt_pk_bf16_f32 v120,v32,v33
v_cvt_pk_bf16_f32 v121,v34,v35
v_cvt_pk_bf16_f32 v122,v36,v37
v_cvt_pk_bf16_f32 v123,v38,v39
global_store_dwordx4 v3,v[120:123],s[30:31] offset:2048 sc1
v_accvgpr_read_b32 v24,a220
v_accvgpr_read_b32 v25,a221
v_accvgpr_read_b32 v26,a222
v_accvgpr_read_b32 v27,a223
v_accvgpr_read_b32 v28,a252
v_accvgpr_read_b32 v29,a253
v_accvgpr_read_b32 v30,a254
v_accvgpr_read_b32 v31,a255
v_cvt_pk_bf16_f32 v124,v24,v25
v_cvt_pk_bf16_f32 v125,v26,v27
v_cvt_pk_bf16_f32 v126,v28,v29
v_cvt_pk_bf16_f32 v127,v30,v31
global_store_dwordx4 v3,v[124:127],s[30:31] offset:3072 sc1
s_lshl_b32 s54,s32,7
s_add_u32 s54,s54,94437376
v_mov_b32 v233,s54
s_cmp_eq_u32 s32,63
s_cselect_b32 s39,0,s38
s_cmp_le_u32 s36,3
s_cselect_b32 s54,2,1
s_cmp_eq_u32 s36,5
s_cselect_b32 s54,2,s54
v_mov_b32 v252,s54
s_waitcnt vmcnt(32)
s_branch L_bulk_adv
L_g_small:
s_sub_u32 s57,s33,9
s_lshl_b32 s54,s57,24
s_lshl_b32 s59,s34,15
s_add_u32 s54,s54,s59
s_lshl_b32 s59,s55,14
s_add_u32 s54,s54,s59
s_lshl_b32 s59,s35,20
s_add_u32 s54,s54,s59
s_lshl_b32 s59,s56,19
s_add_u32 s54,s54,s59
s_add_u32 s30,s4,s54
s_addc_u32 s31,s5,0
s_cmp_eq_u32 s33,11
s_cbranch_scc1 L_g_vs
s_sub_u32 s54,s33,9
s_cmp_lt_u32 s54,2
s_cbranch_scc1 L_g_ks
s_cmp_eq_u32 s33,8
s_cselect_b32 s22,30,26
s_lshl_b32 s54,s34,18
s_lshl_b32 s59,s55,17
s_add_u32 s54,s54,s59
s_lshl_b32 s59,s35,13
s_add_u32 s54,s54,s59
s_lshl_b32 s59,s56,12
s_add_u32 s54,s54,s59
s_add_u32 s54,s54,100663296
s_add_u32 s30,s4,s54
s_addc_u32 s31,s5,0
s_lshl_b32 s54,s34,18
s_lshl_b32 s59,s35,9
s_add_u32 s54,s54,s59
s_lshl_b32 s59,s56,7
s_add_u32 s54,s54,s59
s_add_u32 s44,s62,s54
s_addc_u32 s45,s63,0
s_lshl_b32 s54,s34,10
s_add_u32 s46,s4,s54
s_addc_u32 s47,s5,0
global_load_dwordx2 v[240:241],v237,s[46:47] offset:0 sc1
global_load_dwordx2 v[242:243],v237,s[46:47] offset:128 sc1
global_load_dwordx2 v[244:245],v237,s[46:47] offset:256 sc1
global_load_dwordx2 v[246:247],v237,s[46:47] offset:384 sc1
L_g_ks:
s_waitcnt vmcnt(6)
s_barrier
ds_read_b128 v[64:67],v12 offset:0
ds_read_b64_tr_b16 v[96:97],v16 offset:0
ds_read_b64_tr_b16 v[98:99],v16 offset:4096
ds_read_b128 v[68:71],v12 offset:1024
ds_read_b64_tr_b16 v[100:101],v17 offset:0
ds_read_b64_tr_b16 v[102:103],v17 offset:4096
ds_read_b128 v[72:75],v12 offset:4096
ds_read_b64_tr_b16 v[104:105],v18 offset:0
ds_read_b64_tr_b16 v[106:107],v18 offset:4096
ds_read_b128 v[76:79],v12 offset:5120
ds_read_b64_tr_b16 v[108:109],v19 offset:0
ds_read_b64_tr_b16 v[110:111],v19 offset:4096
ds_read_b64_tr_b16 v[112:113],v20 offset:0
ds_read_b64_tr_b16 v[114:115],v20 offset:4096
ds_read_b64_tr_b16 v[116:117],v21 offset:0
ds_read_b64_tr_b16 v[118:119],v21 offset:4096
ds_read_b64_tr_b16 v[120:121],v22 offset:0
ds_read_b64_tr_b16 v[122:123],v22 offset:4096
ds_read_b64_tr_b16 v[124:125],v23 offset:0
ds_read_b64_tr_b16 v[126:127],v23 offset:4096
s_waitcnt vmcnt(4) lgkmcnt(0)
s_barrier
v_mfma_f32_16x16x32_bf16 a[0:3],v[96:99],v[64:67],0
ds_read_b128 v[128:131],v12 offset:16384
v_mfma_f32_16x16x32_bf16 a[4:7],v[100:103],v[64:67],0
ds_read_b64_tr_b16 v[160:161],v16 offset:16384
s_add_u32 m0,s23,0
v_mfma_f32_16x16x32_bf16 a[8:11],v[104:107],v[64:67],0
ds_read_b64_tr_b16 v[162:163],v16 offset:20480
global_load_lds_dwordx4 v4,s[16:17] offset:0 sc1
v_mfma_f32_16x16x32_bf16 a[12:15],v[108:111],v[64:67],0
ds_read_b128 v[132:135],v12 offset:17408
v_mfma_f32_16x16x32_bf16 a[16:19],v[112:115],v[64:67],0
ds_read_b64_tr_b16 v[164:165],v17 offset:16384
global_load_lds_dwordx4 v5,s[16:17] offset:1024 sc1
v_mfma_f32_16x16x32_bf16 a[20:23],v[116:119],v[64:67],0
ds_read_b64_tr_b16 v[166:167],v17 offset:20480
v_mfma_f32_16x16x32_bf16 a[24:27],v[120:123],v[64:67],0
ds_read_b128 v[136:139],v12 offset:20480
s_add_u32 m0,s23,65536
v_mfma_f32_16x16x32_bf16 a[28:31],v[124:127],v[64:67],0
ds_read_b64_tr_b16 v[168:169],v18 offset:16384
s_add_u32 s16,s16,s20
v_mfma_f32_16x16x32_bf16 a[32:35],v[96:99],v[68:71],0
ds_read_b64_tr_b16 v[170:171],v18 offset:20480
s_addc_u32 s17,s17,0
v_mfma_f32_16x16x32_bf16 a[36:39],v[100:103],v[68:71],0
ds_read_b128 v[140:143],v12 offset:21504
global_load_lds_dwordx4 v8,s[18:19] offset:0
v_mfma_f32_16x16x32_bf16 a[40:43],v[104:107],v[68:71],0
ds_read_b64_tr_b16 v[172:173],v19 offset:16384
v_mfma_f32_16x16x32_bf16 a[44:47],v[108:111],v[68:71],0
ds_read_b64_tr_b16 v[174:175],v19 offset:20480
global_load_lds_dwordx4 v9,s[18:19] offset:1024
v_mfma_f32_16x16x32_bf16 a[48:51],v[112:115],v[68:71],0
ds_read_b64_tr_b16 v[176:177],v20 offset:16384
v_mfma_f32_16x16x32_bf16 a[52:55],v[116:119],v[68:71],0
ds_read_b64_tr_b16 v[178:179],v20 offset:20480
global_load_lds_dwordx4 v10,s[18:19] offset:2048
v_mfma_f32_16x16x32_bf16 a[56:59],v[120:123],v[68:71],0
ds_read_b64_tr_b16 v[180:181],v21 offset:16384
v_mfma_f32_16x16x32_bf16 a[60:63],v[124:127],v[68:71],0
ds_read_b64_tr_b16 v[182:183],v21 offset:20480
global_load_lds_dwordx4 v11,s[18:19] offset:3072
v_mfma_f32_16x16x32_bf16 a[64:67],v[96:99],v[72:75],0
ds_read_b64_tr_b16 v[184:185],v22 offset:16384
v_mfma_f32_16x16x32_bf16 a[68:71],v[100:103],v[72:75],0
ds_read_b64_tr_b16 v[186:187],v22 offset:20480
s_add_u32 s18,s18,s21
v_mfma_f32_16x16x32_bf16 a[72:75],v[104:107],v[72:75],0
ds_read_b64_tr_b16 v[188:189],v23 offset:16384
s_addc_u32 s19,s19,0
v_mfma_f32_16x16x32_bf16 a[76:79],v[108:111],v[72:75],0
ds_read_b64_tr_b16 v[190:191],v23 offset:20480
v_mfma_f32_16x16x32_bf16 a[80:83],v[112:115],v[72:75],0
v_mfma_f32_16x16x32_bf16 a[84:87],v[116:119],v[72:75],0
v_mfma_f32_16x16x32_bf16 a[88:91],v[120:123],v[72:75],0
v_mfma_f32_16x16x32_bf16 a[92:95],v[124:127],v[72:75],0
v_mfma_f32_16x16x32_bf16 a[96:99],v[96:99],v[76:79],0
v_mfma_f32_16x16x32_bf16 a[100:103],v[100:103],v[76:79],0
v_mfma_f32_16x16x32_bf16 a[104:107],v[104:107],v[76:79],0
v_mfma_f32_16x16x32_bf16 a[108:111],v[108:111],v[76:79],0
v_mfma_f32_16x16x32_bf16 a[112:115],v[112:115],v[76:79],0
v_mfma_f32_16x16x32_bf16 a[116:119],v[116:119],v[76:79],0
v_mfma_f32_16x16x32_bf16 a[120:123],v[120:123],v[76:79],0
v_mfma_f32_16x16x32_bf16 a[124:127],v[124:127],v[76:79],0
s_waitcnt vmcnt(8) lgkmcnt(0)
s_barrier
v_mfma_f32_16x16x32_bf16 a[0:3],v[160:163],v[128:131],a[0:3]
ds_read_b128 v[64:67],v12 offset:32768
v_mfma_f32_16x16x32_bf16 a[4:7],v[164:167],v[128:131],a[4:7]
ds_read_b64_tr_b16 v[96:97],v16 offset:32768
s_add_u32 m0,s23,16384
v_mfma_f32_16x16x32_bf16 a[8:11],v[168:171],v[128:131],a[8:11]
ds_read_b64_tr_b16 v[98:99],v16 offset:36864
global_load_lds_dwordx4 v4,s[16:17] offset:0 sc1
v_mfma_f32_16x16x32_bf16 a[12:15],v[172:175],v[128:131],a[12:15]
ds_read_b128 v[68:71],v12 offset:33792
v_mfma_f32_16x16x32_bf16 a[16:19],v[176:179],v[128:131],a[16:19]
ds_read_b64_tr_b16 v[100:101],v17 offset:32768
global_load_lds_dwordx4 v5,s[16:17] offset:1024 sc1
v_mfma_f32_16x16x32_bf16 a[20:23],v[180:183],v[128:131],a[20:23]
ds_read_b64_tr_b16 v[102:103],v17 offset:36864
v_mfma_f32_16x16x32_bf16 a[24:27],v[184:187],v[128:131],a[24:27]
ds_read_b128 v[72:75],v12 offset:36864
s_add_u32 m0,s23,81920
v_mfma_f32_16x16x32_bf16 a[28:31],v[188:191],v[128:131],a[28:31]
ds_read_b64_tr_b16 v[104:105],v18 offset:32768
s_add_u32 s16,s16,s20
v_mfma_f32_16x16x32_bf16 a[32:35],v[160:163],v[132:135],a[32:35]
ds_read_b64_tr_b16 v[106:107],v18 offset:36864
s_addc_u32 s17,s17,0
v_mfma_f32_16x16x32_bf16 a[36:39],v[164:167],v[132:135],a[36:39]
ds_read_b128 v[76:79],v12 offset:37888
global_load_lds_dwordx4 v8,s[18:19] offset:0
v_mfma_f32_16x16x32_bf16 a[40:43],v[168:171],v[132:135],a[40:43]
ds_read_b64_tr_b16 v[108:109],v19 offset:32768
v_mfma_f32_16x16x32_bf16 a[44:47],v[172:175],v[132:135],a[44:47]
ds_read_b64_tr_b16 v[110:111],v19 offset:36864
global_load_lds_dwordx4 v9,s[18:19] offset:1024
v_mfma_f32_16x16x32_bf16 a[48:51],v[176:179],v[132:135],a[48:51]
ds_read_b64_tr_b16 v[112:113],v20 offset:32768
v_mfma_f32_16x16x32_bf16 a[52:55],v[180:183],v[132:135],a[52:55]
ds_read_b64_tr_b16 v[114:115],v20 offset:36864
global_load_lds_dwordx4 v10,s[18:19] offset:2048
v_mfma_f32_16x16x32_bf16 a[56:59],v[184:187],v[132:135],a[56:59]
ds_read_b64_tr_b16 v[116:117],v21 offset:32768
v_mfma_f32_16x16x32_bf16 a[60:63],v[188:191],v[132:135],a[60:63]
ds_read_b64_tr_b16 v[118:119],v21 offset:36864
global_load_lds_dwordx4 v11,s[18:19] offset:3072
v_mfma_f32_16x16x32_bf16 a[64:67],v[160:163],v[136:139],a[64:67]
ds_read_b64_tr_b16 v[120:121],v22 offset:32768
v_mfma_f32_16x16x32_bf16 a[68:71],v[164:167],v[136:139],a[68:71]
ds_read_b64_tr_b16 v[122:123],v22 offset:36864
s_add_u32 s18,s18,s21
v_mfma_f32_16x16x32_bf16 a[72:75],v[168:171],v[136:139],a[72:75]
ds_read_b64_tr_b16 v[124:125],v23 offset:32768
s_addc_u32 s19,s19,0
v_mfma_f32_16x16x32_bf16 a[76:79],v[172:175],v[136:139],a[76:79]
ds_read_b64_tr_b16 v[126:127],v23 offset:36864
v_mfma_f32_16x16x32_bf16 a[80:83],v[176:179],v[136:139],a[80:83]
v_mfma_f32_16x16x32_bf16 a[84:87],v[180:183],v[136:139],a[84:87]
v_mfma_f32_16x16x32_bf16 a[88:91],v[184:187],v[136:139],a[88:91]
v_mfma_f32_16x16x32_bf16 a[92:95],v[188:191],v[136:139],a[92:95]
v_mfma_f32_16x16x32_bf16 a[96:99],v[160:163],v[140:143],a[96:99]
v_mfma_f32_16x16x32_bf16 a[100:103],v[164:167],v[140:143],a[100:103]
v_mfma_f32_16x16x32_bf16 a[104:107],v[168:171],v[140:143],a[104:107]
v_mfma_f32_16x16x32_bf16 a[108:111],v[172:175],v[140:143],a[108:111]
v_mfma_f32_16x16x32_bf16 a[112:115],v[176:179],v[140:143],a[112:115]
v_mfma_f32_16x16x32_bf16 a[116:119],v[180:183],v[140:143],a[116:119]
v_mfma_f32_16x16x32_bf16 a[120:123],v[184:187],v[140:143],a[120:123]
v_mfma_f32_16x16x32_bf16 a[124:127],v[188:191],v[140:143],a[124:127]
s_waitcnt vmcnt(12) lgkmcnt(0)
s_barrier
v_mfma_f32_16x16x32_bf16 a[0:3],v[96:99],v[64:67],a[0:3]
ds_read_b128 v[128:131],v12 offset:49152
v_mfma_f32_16x16x32_bf16 a[4:7],v[100:103],v[64:67],a[4:7]
ds_read_b64_tr_b16 v[160:161],v16 offset:49152
s_add_u32 m0,s23,32768
v_mfma_f32_16x16x32_bf16 a[8:11],v[104:107],v[64:67],a[8:11]
ds_read_b64_tr_b16 v[162:163],v16 offset:53248
global_load_lds_dwordx4 v4,s[16:17] offset:0 sc1
v_mfma_f32_16x16x32_bf16 a[12:15],v[108:111],v[64:67],a[12:15]
ds_read_b128 v[132:135],v12 offset:50176
v_mfma_f32_16x16x32_bf16 a[16:19],v[112:115],v[64:67],a[16:19]
ds_read_b64_tr_b16 v[164:165],v17 offset:49152
global_load_lds_dwordx4 v5,s[16:17] offset:1024 sc1
v_mfma_f32_16x16x32_bf16 a[20:23],v[116:119],v[64:67],a[20:23]
ds_read_b64_tr_b16 v[166:167],v17 offset:53248
v_mfma_f32_16x16x32_bf16 a[24:27],v[120:123],v[64:67],a[24:27]
ds_read_b128 v[136:139],v12 offset:53248
s_add_u32 m0,s23,98304
v_mfma_f32_16x16x32_bf16 a[28:31],v[124:127],v[64:67],a[28:31]
ds_read_b64_tr_b16 v[168:169],v18 offset:49152
s_add_u32 s16,s16,s20
v_mfma_f32_16x16x32_bf16 a[32:35],v[96:99],v[68:71],a[32:35]
ds_read_b64_tr_b16 v[170:171],v18 offset:53248
s_addc_u32 s17,s17,0
v_mfma_f32_16x16x32_bf16 a[36:39],v[100:103],v[68:71],a[36:39]
ds_read_b128 v[140:143],v12 offset:54272
global_load_lds_dwordx4 v8,s[18:19] offset:0
v_mfma_f32_16x16x32_bf16 a[40:43],v[104:107],v[68:71],a[40:43]
ds_read_b64_tr_b16 v[172:173],v19 offset:49152
v_mfma_f32_16x16x32_bf16 a[44:47],v[108:111],v[68:71],a[44:47]
ds_read_b64_tr_b16 v[174:175],v19 offset:53248
global_load_lds_dwordx4 v9,s[18:19] offset:1024
v_mfma_f32_16x16x32_bf16 a[48:51],v[112:115],v[68:71],a[48:51]
ds_read_b64_tr_b16 v[176:177],v20 offset:49152
v_mfma_f32_16x16x32_bf16 a[52:55],v[116:119],v[68:71],a[52:55]
ds_read_b64_tr_b16 v[178:179],v20 offset:53248
global_load_lds_dwordx4 v10,s[18:19] offset:2048
v_mfma_f32_16x16x32_bf16 a[56:59],v[120:123],v[68:71],a[56:59]
ds_read_b64_tr_b16 v[180:181],v21 offset:49152
v_mfma_f32_16x16x32_bf16 a[60:63],v[124:127],v[68:71],a[60:63]
ds_read_b64_tr_b16 v[182:183],v21 offset:53248
global_load_lds_dwordx4 v11,s[18:19] offset:3072
v_mfma_f32_16x16x32_bf16 a[64:67],v[96:99],v[72:75],a[64:67]
ds_read_b64_tr_b16 v[184:185],v22 offset:49152
v_mfma_f32_16x16x32_bf16 a[68:71],v[100:103],v[72:75],a[68:71]
ds_read_b64_tr_b16 v[186:187],v22 offset:53248
s_add_u32 s18,s18,s21
v_mfma_f32_16x16x32_bf16 a[72:75],v[104:107],v[72:75],a[72:75]
ds_read_b64_tr_b16 v[188:189],v23 offset:49152
s_addc_u32 s19,s19,0
v_mfma_f32_16x16x32_bf16 a[76:79],v[108:111],v[72:75],a[76:79]
ds_read_b64_tr_b16 v[190:191],v23 offset:53248
v_mfma_f32_16x16x32_bf16 a[80:83],v[112:115],v[72:75],a[80:83]
v_mfma_f32_16x16x32_bf16 a[84:87],v[116:119],v[72:75],a[84:87]
v_mfma_f32_16x16x32_bf16 a[88:91],v[120:123],v[72:75],a[88:91]
v_mfma_f32_16x16x32_bf16 a[92:95],v[124:127],v[72:75],a[92:95]
v_mfma_f32_16x16x32_bf16 a[96:99],v[96:99],v[76:79],a[96:99]
v_mfma_f32_16x16x32_bf16 a[100:103],v[100:103],v[76:79],a[100:103]
v_mfma_f32_16x16x32_bf16 a[104:107],v[104:107],v[76:79],a[104:107]
v_mfma_f32_16x16x32_bf16 a[108:111],v[108:111],v[76:79],a[108:111]
v_mfma_f32_16x16x32_bf16 a[112:115],v[112:115],v[76:79],a[112:115]
v_mfma_f32_16x16x32_bf16 a[116:119],v[116:119],v[76:79],a[116:119]
v_mfma_f32_16x16x32_bf16 a[120:123],v[120:123],v[76:79],a[120:123]
v_mfma_f32_16x16x32_bf16 a[124:127],v[124:127],v[76:79],a[124:127]
s_waitcnt vmcnt(12) lgkmcnt(0)
s_barrier
v_mfma_f32_16x16x32_bf16 a[0:3],v[160:163],v[128:131],a[0:3]
ds_read_b128 v[64:67],v12 offset:0
v_mfma_f32_16x16x32_bf16 a[4:7],v[164:167],v[128:131],a[4:7]
ds_read_b64_tr_b16 v[96:97],v16 offset:0
s_add_u32 m0,s23,49152
v_mfma_f32_16x16x32_bf16 a[8:11],v[168:171],v[128:131],a[8:11]
ds_read_b64_tr_b16 v[98:99],v16 offset:4096
global_load_lds_dwordx4 v4,s[16:17] offset:0 sc1
v_mfma_f32_16x16x32_bf16 a[12:15],v[172:175],v[128:131],a[12:15]
ds_read_b128 v[68:71],v12 offset:1024
v_mfma_f32_16x16x32_bf16 a[16:19],v[176:179],v[128:131],a[16:19]
ds_read_b64_tr_b16 v[100:101],v17 offset:0
global_load_lds_dwordx4 v5,s[16:17] offset:1024 sc1
v_mfma_f32_16x16x32_bf16 a[20:23],v[180:183],v[128:131],a[20:23]
ds_read_b64_tr_b16 v[102:103],v17 offset:4096
v_mfma_f32_16x16x32_bf16 a[24:27],v[184:187],v[128:131],a[24:27]
ds_read_b128 v[72:75],v12 offset:4096
s_add_u32 m0,s23,114688
v_mfma_f32_16x16x32_bf16 a[28:31],v[188:191],v[128:131],a[28:31]
ds_read_b64_tr_b16 v[104:105],v18 offset:0
s_add_u32 s16,s16,s20
v_mfma_f32_16x16x32_bf16 a[32:35],v[160:163],v[132:135],a[32:35]
ds_read_b64_tr_b16 v[106:107],v18 offset:4096
s_addc_u32 s17,s17,0
v_mfma_f32_16x16x32_bf16 a[36:39],v[164:167],v[132:135],a[36:39]
ds_read_b128 v[76:79],v12 offset:5120
global_load_lds_dwordx4 v8,s[18:19] offset:0
v_mfma_f32_16x16x32_bf16 a[40:43],v[168:171],v[132:135],a[40:43]
ds_read_b64_tr_b16 v[108:109],v19 offset:0
v_mfma_f32_16x16x32_bf16 a[44:47],v[172:175],v[132:135],a[44:47]
ds_read_b64_tr_b16 v[110:111],v19 offset:4096
global_load_lds_dwordx4 v9,s[18:19] offset:1024
v_mfma_f32_16x16x32_bf16 a[48:51],v[176:179],v[132:135],a[48:51]
ds_read_b64_tr_b16 v[112:113],v20 offset:0
v_mfma_f32_16x16x32_bf16 a[52:55],v[180:183],v[132:135],a[52:55]
ds_read_b64_tr_b16 v[114:115],v20 offset:4096
global_load_lds_dwordx4 v10,s[18:19] offset:2048
v_mfma_f32_16x16x32_bf16 a[56:59],v[184:187],v[132:135],a[56:59]
ds_read_b64_tr_b16 v[116:117],v21 offset:0
v_mfma_f32_16x16x32_bf16 a[60:63],v[188:191],v[132:135],a[60:63]
ds_read_b64_tr_b16 v[118:119],v21 offset:4096
global_load_lds_dwordx4 v11,s[18:19] offset:3072
v_mfma_f32_16x16x32_bf16 a[64:67],v[160:163],v[136:139],a[64:67]
ds_read_b64_tr_b16 v[120:121],v22 offset:0
v_mfma_f32_16x16x32_bf16 a[68:71],v[164:167],v[136:139],a[68:71]
ds_read_b64_tr_b16 v[122:123],v22 offset:4096
s_add_u32 s18,s18,s21
v_mfma_f32_16x16x32_bf16 a[72:75],v[168:171],v[136:139],a[72:75]
ds_read_b64_tr_b16 v[124:125],v23 offset:0
s_addc_u32 s19,s19,0
v_mfma_f32_16x16x32_bf16 a[76:79],v[172:175],v[136:139],a[76:79]
ds_read_b64_tr_b16 v[126:127],v23 offset:4096
s_cmp_eq_u32 s39,0
s_cbranch_scc1 L_sig4
s_mov_b32 s39,0
s_mov_b64 exec,1
global_atomic_add v233,v252,s[4:5]
s_mov_b64 exec,-1
v_mov_b32 v252,1
L_sig4:
s_nop 0
v_mfma_f32_16x16x32_bf16 a[80:83],v[176:179],v[136:139],a[80:83]
global_load_dword v236,v238,s[4:5] sc1
v_mfma_f32_16x16x32_bf16 a[84:87],v[180:183],v[136:139],a[84:87]
v_mfma_f32_16x16x32_bf16 a[88:91],v[184:187],v[136:139],a[88:91]
v_mfma_f32_16x16x32_bf16 a[92:95],v[188:191],v[136:139],a[92:95]
v_mfma_f32_16x16x32_bf16 a[96:99],v[160:163],v[140:143],a[96:99]
v_mfma_f32_16x16x32_bf16 a[100:103],v[164:167],v[140:143],a[100:103]
v_mfma_f32_16x16x32_bf16 a[104:107],v[168:171],v[140:143],a[104:107]
v_mfma_f32_16x16x32_bf16 a[108:111],v[172:175],v[140:143],a[108:111]
v_mfma_f32_16x16x32_bf16 a[112:115],v[176:179],v[140:143],a[112:115]
v_mfma_f32_16x16x32_bf16 a[116:119],v[180:183],v[140:143],a[116:119]
v_mfma_f32_16x16x32_bf16 a[120:123],v[184:187],v[140:143],a[120:123]
v_mfma_f32_16x16x32_bf16 a[124:127],v[188:191],v[140:143],a[124:127]
L_g_ks_mid:
s_waitcnt vmcnt(12) lgkmcnt(0)
s_barrier
v_mfma_f32_16x16x32_bf16 a[0:3],v[96:99],v[64:67],a[0:3]
ds_read_b128 v[128:131],v12 offset:16384
v_mfma_f32_16x16x32_bf16 a[4:7],v[100:103],v[64:67],a[4:7]
ds_read_b64_tr_b16 v[160:161],v16 offset:16384
s_add_u32 m0,s23,0
v_mfma_f32_16x16x32_bf16 a[8:11],v[104:107],v[64:67],a[8:11]
ds_read_b64_tr_b16 v[162:163],v16 offset:20480
global_load_lds_dwordx4 v4,s[16:17] offset:0 sc1
v_mfma_f32_16x16x32_bf16 a[12:15],v[108:111],v[64:67],a[12:15]
ds_read_b128 v[132:135],v12 offset:17408
v_mfma_f32_16x16x32_bf16 a[16:19],v[112:115],v[64:67],a[16:19]
ds_read_b64_tr_b16 v[164:165],v17 offset:16384
global_load_lds_dwordx4 v5,s[16:17] offset:1024 sc1
v_mfma_f32_16x16x32_bf16 a[20:23],v[116:119],v[64:67],a[20:23]
ds_read_b64_tr_b16 v[166:167],v17 offset:20480
v_mfma_f32_16x16x32_bf16 a[24:27],v[120:123],v[64:67],a[24:27]
ds_read_b128 v[136:139],v12 offset:20480
s_add_u32 m0,s23,65536
v_mfma_f32_16x16x32_bf16 a[28:31],v[124:127],v[64:67],a[28:31]
ds_read_b64_tr_b16 v[168:169],v18 offset:16384
s_add_u32 s16,s16,s20
v_mfma_f32_16x16x32_bf16 a[32:35],v[96:99],v[68:71],a[32:35]
ds_read_b64_tr_b16 v[170:171],v18 offset:20480
s_addc_u32 s17,s17,0
v_mfma_f32_16x16x32_bf16 a[36:39],v[100:103],v[68:71],a[36:39]
ds_read_b128 v[140:143],v12 offset:21504
global_load_lds_dwordx4 v8,s[18:19] offset:0
v_mfma_f32_16x16x32_bf16 a[40:43],v[104:107],v[68:71],a[40:43]
ds_read_b64_tr_b16 v[172:173],v19 offset:16384
v_mfma_f32_16x16x32_bf16 a[44:47],v[108:111],v[68:71],a[44:47]
ds_read_b64_tr_b16 v[174:175],v19 offset:20480
global_load_lds_dwordx4 v9,s[18:19] offset:1024
v_mfma_f32_16x16x32_bf16 a[48:51],v[112:115],v[68:71],a[48:51]
ds_read_b64_tr_b16 v[176:177],v20 offset:16384
v_mfma_f32_16x16x32_bf16 a[52:55],v[116:119],v[68:71],a[52:55]
ds_read_b64_tr_b16 v[178:179],v20 offset:20480
global_load_lds_dwordx4 v10,s[18:19] offset:2048
v_mfma_f32_16x16x32_bf16 a[56:59],v[120:123],v[68:71],a[56:59]
ds_read_b64_tr_b16 v[180:181],v21 offset:16384
v_mfma_f32_16x16x32_bf16 a[60:63],v[124:127],v[68:71],a[60:63]
ds_read_b64_tr_b16 v[182:183],v21 offset:20480
global_load_lds_dwordx4 v11,s[18:19] offset:3072
v_mfma_f32_16x16x32_bf16 a[64:67],v[96:99],v[72:75],a[64:67]
ds_read_b64_tr_b16 v[184:185],v22 offset:16384
v_mfma_f32_16x16x32_bf16 a[68:71],v[100:103],v[72:75],a[68:71]
ds_read_b64_tr_b16 v[186:187],v22 offset:20480
s_add_u32 s18,s18,s21
v_mfma_f32_16x16x32_bf16 a[72:75],v[104:107],v[72:75],a[72:75]
ds_read_b64_tr_b16 v[188:189],v23 offset:16384
s_addc_u32 s19,s19,0
v_mfma_f32_16x16x32_bf16 a[76:79],v[108:111],v[72:75],a[76:79]
ds_read_b64_tr_b16 v[190:191],v23 offset:20480
v_mfma_f32_16x16x32_bf16 a[80:83],v[112:115],v[72:75],a[80:83]
v_mfma_f32_16x16x32_bf16 a[84:87],v[116:119],v[72:75],a[84:87]
v_mfma_f32_16x16x32_bf16 a[88:91],v[120:123],v[72:75],a[88:91]
v_mfma_f32_16x16x32_bf16 a[92:95],v[124:127],v[72:75],a[92:95]
v_mfma_f32_16x16x32_bf16 a[96:99],v[96:99],v[76:79],a[96:99]
v_mfma_f32_16x16x32_bf16 a[100:103],v[100:103],v[76:79],a[100:103]
v_mfma_f32_16x16x32_bf16 a[104:107],v[104:107],v[76:79],a[104:107]
v_mfma_f32_16x16x32_bf16 a[108:111],v[108:111],v[76:79],a[108:111]
v_mfma_f32_16x16x32_bf16 a[112:115],v[112:115],v[76:79],a[112:115]
v_mfma_f32_16x16x32_bf16 a[116:119],v[116:119],v[76:79],a[116:119]
v_mfma_f32_16x16x32_bf16 a[120:123],v[120:123],v[76:79],a[120:123]
v_mfma_f32_16x16x32_bf16 a[124:127],v[124:127],v[76:79],a[124:127]
s_waitcnt vmcnt(12) lgkmcnt(0)
s_barrier
v_mfma_f32_16x16x32_bf16 a[0:3],v[160:163],v[128:131],a[0:3]
ds_read_b128 v[64:67],v12 offset:32768
v_mfma_f32_16x16x32_bf16 a[4:7],v[164:167],v[128:131],a[4:7]
ds_read_b64_tr_b16 v[96:97],v16 offset:32768
s_add_u32 m0,s23,16384
v_mfma_f32_16x16x32_bf16 a[8:11],v[168:171],v[128:131],a[8:11]
ds_read_b64_tr_b16 v[98:99],v16 offset:36864
global_load_lds_dwordx4 v4,s[16:17] offset:0 sc1
v_mfma_f32_16x16x32_bf16 a[12:15],v[172:175],v[128:131],a[12:15]
ds_read_b128 v[68:71],v12 offset:33792
v_mfma_f32_16x16x32_bf16 a[16:19],v[176:179],v[128:131],a[16:19]
ds_read_b64_tr_b16 v[100:101],v17 offset:32768
global_load_lds_dwordx4 v5,s[16:17] offset:1024 sc1
v_mfma_f32_16x16x32_bf16 a[20:23],v[180:183],v[128:131],a[20:23]
ds_read_b64_tr_b16 v[102:103],v17 offset:36864
v_mfma_f32_16x16x32_bf16 a[24:27],v[184:187],v[128:131],a[24:27]
ds_read_b128 v[72:75],v12 offset:36864
s_add_u32 m0,s23,81920
v_mfma_f32_16x16x32_bf16 a[28:31],v[188:191],v[128:131],a[28:31]
ds_read_b64_tr_b16 v[104:105],v18 offset:32768
s_add_u32 s16,s16,s20
v_mfma_f32_16x16x32_bf16 a[32:35],v[160:163],v[132:135],a[32:35]
ds_read_b64_tr_b16 v[106:107],v18 offset:36864
s_addc_u32 s17,s17,0
v_mfma_f32_16x16x32_bf16 a[36:39],v[164:167],v[132:135],a[36:39]
ds_read_b128 v[76:79],v12 offset:37888
global_load_lds_dwordx4 v8,s[18:19] offset:0
v_mfma_f32_16x16x32_bf16 a[40:43],v[168:171],v[132:135],a[40:43]
ds_read_b64_tr_b16 v[108:109],v19 offset:32768
v_mfma_f32_16x16x32_bf16 a[44:47],v[172:175],v[132:135],a[44:47]
ds_read_b64_tr_b16 v[110:111],v19 offset:36864
global_load_lds_dwordx4 v9,s[18:19] offset:1024
v_mfma_f32_16x16x32_bf16 a[48:51],v[176:179],v[132:135],a[48:51]
ds_read_b64_tr_b16 v[112:113],v20 offset:32768
v_mfma_f32_16x16x32_bf16 a[52:55],v[180:183],v[132:135],a[52:55]
ds_read_b64_tr_b16 v[114:115],v20 offset:36864
global_load_lds_dwordx4 v10,s[18:19] offset:2048
v_mfma_f32_16x16x32_bf16 a[56:59],v[184:187],v[132:135],a[56:59]
ds_read_b64_tr_b16 v[116:117],v21 offset:32768
v_mfma_f32_16x16x32_bf16 a[60:63],v[188:191],v[132:135],a[60:63]
ds_read_b64_tr_b16 v[118:119],v21 offset:36864
global_load_lds_dwordx4 v11,s[18:19] offset:3072
v_mfma_f32_16x16x32_bf16 a[64:67],v[160:163],v[136:139],a[64:67]
ds_read_b64_tr_b16 v[120:121],v22 offset:32768
v_mfma_f32_16x16x32_bf16 a[68:71],v[164:167],v[136:139],a[68:71]
ds_read_b64_tr_b16 v[122:123],v22 offset:36864
s_add_u32 s18,s18,s21
v_mfma_f32_16x16x32_bf16 a[72:75],v[168:171],v[136:139],a[72:75]
ds_read_b64_tr_b16 v[124:125],v23 offset:32768
s_addc_u32 s19,s19,0
v_mfma_f32_16x16x32_bf16 a[76:79],v[172:175],v[136:139],a[76:79]
ds_read_b64_tr_b16 v[126:127],v23 offset:36864
v_mfma_f32_16x16x32_bf16 a[80:83],v[176:179],v[136:139],a[80:83]
v_mfma_f32_16x16x32_bf16 a[84:87],v[180:183],v[136:139],a[84:87]
v_mfma_f32_16x16x32_bf16 a[88:91],v[184:187],v[136:139],a[88:91]
v_mfma_f32_16x16x32_bf16 a[92:95],v[188:191],v[136:139],a[92:95]
v_mfma_f32_16x16x32_bf16 a[96:99],v[160:163],v[140:143],a[96:99]
v_mfma_f32_16x16x32_bf16 a[100:103],v[164:167],v[140:143],a[100:103]
v_mfma_f32_16x16x32_bf16 a[104:107],v[168:171],v[140:143],a[104:107]
v_mfma_f32_16x16x32_bf16 a[108:111],v[172:175],v[140:143],a[108:111]
v_mfma_f32_16x16x32_bf16 a[112:115],v[176:179],v[140:143],a[112:115]
v_mfma_f32_16x16x32_bf16 a[116:119],v[180:183],v[140:143],a[116:119]
v_mfma_f32_16x16x32_bf16 a[120:123],v[184:187],v[140:143],a[120:123]
v_mfma_f32_16x16x32_bf16 a[124:127],v[188:191],v[140:143],a[124:127]
s_waitcnt vmcnt(12) lgkmcnt(0)
s_barrier
v_mfma_f32_16x16x32_bf16 a[0:3],v[96:99],v[64:67],a[0:3]
ds_read_b128 v[128:131],v12 offset:49152
v_mfma_f32_16x16x32_bf16 a[4:7],v[100:103],v[64:67],a[4:7]
ds_read_b64_tr_b16 v[160:161],v16 offset:49152
s_add_u32 m0,s23,32768
v_mfma_f32_16x16x32_bf16 a[8:11],v[104:107],v[64:67],a[8:11]
ds_read_b64_tr_b16 v[162:163],v16 offset:53248
global_load_lds_dwordx4 v4,s[16:17] offset:0 sc1
v_mfma_f32_16x16x32_bf16 a[12:15],v[108:111],v[64:67],a[12:15]
ds_read_b128 v[132:135],v12 offset:50176
v_mfma_f32_16x16x32_bf16 a[16:19],v[112:115],v[64:67],a[16:19]
ds_read_b64_tr_b16 v[164:165],v17 offset:49152
global_load_lds_dwordx4 v5,s[16:17] offset:1024 sc1
v_mfma_f32_16x16x32_bf16 a[20:23],v[116:119],v[64:67],a[20:23]
ds_read_b64_tr_b16 v[166:167],v17 offset:53248
v_mfma_f32_16x16x32_bf16 a[24:27],v[120:123],v[64:67],a[24:27]
ds_read_b128 v[136:139],v12 offset:53248
s_add_u32 m0,s23,98304
v_mfma_f32_16x16x32_bf16 a[28:31],v[124:127],v[64:67],a[28:31]
ds_read_b64_tr_b16 v[168:169],v18 offset:49152
s_add_u32 s16,s16,s20
v_mfma_f32_16x16x32_bf16 a[32:35],v[96:99],v[68:71],a[32:35]
ds_read_b64_tr_b16 v[170:171],v18 offset:53248
s_addc_u32 s17,s17,0
v_mfma_f32_16x16x32_bf16 a[36:39],v[100:103],v[68:71],a[36:39]
ds_read_b128 v[140:143],v12 offset:54272
global_load_lds_dwordx4 v8,s[18:19] offset:0
v_mfma_f32_16x16x32_bf16 a[40:43],v[104:107],v[68:71],a[40:43]
ds_read_b64_tr_b16 v[172:173],v19 offset:49152
v_mfma_f32_16x16x32_bf16 a[44:47],v[108:111],v[68:71],a[44:47]
ds_read_b64_tr_b16 v[174:175],v19 offset:53248
global_load_lds_dwordx4 v9,s[18:19] offset:1024
v_mfma_f32_16x16x32_bf16 a[48:51],v[112:115],v[68:71],a[48:51]
ds_read_b64_tr_b16 v[176:177],v20 offset:49152
v_mfma_f32_16x16x32_bf16 a[52:55],v[116:119],v[68:71],a[52:55]
ds_read_b64_tr_b16 v[178:179],v20 offset:53248
global_load_lds_dwordx4 v10,s[18:19] offset:2048
v_mfma_f32_16x16x32_bf16 a[56:59],v[120:123],v[68:71],a[56:59]
ds_read_b64_tr_b16 v[180:181],v21 offset:49152
v_mfma_f32_16x16x32_bf16 a[60:63],v[124:127],v[68:71],a[60:63]
ds_read_b64_tr_b16 v[182:183],v21 offset:53248
global_load_lds_dwordx4 v11,s[18:19] offset:3072
v_mfma_f32_16x16x32_bf16 a[64:67],v[96:99],v[72:75],a[64:67]
ds_read_b64_tr_b16 v[184:185],v22 offset:49152
v_mfma_f32_16x16x32_bf16 a[68:71],v[100:103],v[72:75],a[68:71]
ds_read_b64_tr_b16 v[186:187],v22 offset:53248
s_add_u32 s18,s18,s21
v_mfma_f32_16x16x32_bf16 a[72:75],v[104:107],v[72:75],a[72:75]
ds_read_b64_tr_b16 v[188:189],v23 offset:49152
s_addc_u32 s19,s19,0
v_mfma_f32_16x16x32_bf16 a[76:79],v[108:111],v[72:75],a[76:79]
ds_read_b64_tr_b16 v[190:191],v23 offset:53248
ds_write_b32 v239,v236
v_mfma_f32_16x16x32_bf16 a[80:83],v[112:115],v[72:75],a[80:83]
v_mfma_f32_16x16x32_bf16 a[84:87],v[116:119],v[72:75],a[84:87]
v_mfma_f32_16x16x32_bf16 a[88:91],v[120:123],v[72:75],a[88:91]
v_mfma_f32_16x16x32_bf16 a[92:95],v[124:127],v[72:75],a[92:95]
v_mfma_f32_16x16x32_bf16 a[96:99],v[96:99],v[76:79],a[96:99]
v_mfma_f32_16x16x32_bf16 a[100:103],v[100:103],v[76:79],a[100:103]
v_mfma_f32_16x16x32_bf16 a[104:107],v[104:107],v[76:79],a[104:107]
v_mfma_f32_16x16x32_bf16 a[108:111],v[108:111],v[76:79],a[108:111]
v_mfma_f32_16x16x32_bf16 a[112:115],v[112:115],v[76:79],a[112:115]
v_mfma_f32_16x16x32_bf16 a[116:119],v[116:119],v[76:79],a[116:119]
v_mfma_f32_16x16x32_bf16 a[120:123],v[120:123],v[76:79],a[120:123]
v_mfma_f32_16x16x32_bf16 a[124:127],v[124:127],v[76:79],a[124:127]
s_waitcnt vmcnt(12) lgkmcnt(0)
s_barrier
v_mfma_f32_16x16x32_bf16 a[0:3],v[160:163],v[128:131],a[0:3]
ds_read_b128 v[64:67],v12 offset:0
v_mfma_f32_16x16x32_bf16 a[4:7],v[164:167],v[128:131],a[4:7]
ds_read_b64_tr_b16 v[96:97],v16 offset:0
s_add_u32 m0,s23,49152
v_mfma_f32_16x16x32_bf16 a[8:11],v[168:171],v[128:131],a[8:11]
ds_read_b64_tr_b16 v[98:99],v16 offset:4096
global_load_lds_dwordx4 v4,s[16:17] offset:0 sc1
v_mfma_f32_16x16x32_bf16 a[12:15],v[172:175],v[128:131],a[12:15]
ds_read_b128 v[68:71],v12 offset:1024
v_mfma_f32_16x16x32_bf16 a[16:19],v[176:179],v[128:131],a[16:19]
ds_read_b64_tr_b16 v[100:101],v17 offset:0
global_load_lds_dwordx4 v5,s[16:17] offset:1024 sc1
v_mfma_f32_16x16x32_bf16 a[20:23],v[180:183],v[128:131],a[20:23]
ds_read_b64_tr_b16 v[102:103],v17 offset:4096
v_mfma_f32_16x16x32_bf16 a[24:27],v[184:187],v[128:131],a[24:27]
ds_read_b128 v[72:75],v12 offset:4096
s_add_u32 m0,s23,114688
v_mfma_f32_16x16x32_bf16 a[28:31],v[188:191],v[128:131],a[28:31]
ds_read_b64_tr_b16 v[104:105],v18 offset:0
s_add_u32 s16,s16,s20
v_mfma_f32_16x16x32_bf16 a[32:35],v[160:163],v[132:135],a[32:35]
ds_read_b64_tr_b16 v[106:107],v18 offset:4096
s_addc_u32 s17,s17,0
v_mfma_f32_16x16x32_bf16 a[36:39],v[164:167],v[132:135],a[36:39]
ds_read_b128 v[76:79],v12 offset:5120
global_load_lds_dwordx4 v8,s[18:19] offset:0
v_mfma_f32_16x16x32_bf16 a[40:43],v[168:171],v[132:135],a[40:43]
ds_read_b64_tr_b16 v[108:109],v19 offset:0
v_mfma_f32_16x16x32_bf16 a[44:47],v[172:175],v[132:135],a[44:47]
ds_read_b64_tr_b16 v[110:111],v19 offset:4096
global_load_lds_dwordx4 v9,s[18:19] offset:1024
v_mfma_f32_16x16x32_bf16 a[48:51],v[176:179],v[132:135],a[48:51]
ds_read_b64_tr_b16 v[112:113],v20 offset:0
v_mfma_f32_16x16x32_bf16 a[52:55],v[180:183],v[132:135],a[52:55]
ds_read_b64_tr_b16 v[114:115],v20 offset:4096
global_load_lds_dwordx4 v10,s[18:19] offset:2048
v_mfma_f32_16x16x32_bf16 a[56:59],v[184:187],v[132:135],a[56:59]
ds_read_b64_tr_b16 v[116:117],v21 offset:0
v_mfma_f32_16x16x32_bf16 a[60:63],v[188:191],v[132:135],a[60:63]
ds_read_b64_tr_b16 v[118:119],v21 offset:4096
global_load_lds_dwordx4 v11,s[18:19] offset:3072
v_mfma_f32_16x16x32_bf16 a[64:67],v[160:163],v[136:139],a[64:67]
ds_read_b64_tr_b16 v[120:121],v22 offset:0
v_mfma_f32_16x16x32_bf16 a[68:71],v[164:167],v[136:139],a[68:71]
ds_read_b64_tr_b16 v[122:123],v22 offset:4096
s_add_u32 s18,s18,s21
v_mfma_f32_16x16x32_bf16 a[72:75],v[168:171],v[136:139],a[72:75]
ds_read_b64_tr_b16 v[124:125],v23 offset:0
s_addc_u32 s19,s19,0
v_mfma_f32_16x16x32_bf16 a[76:79],v[172:175],v[136:139],a[76:79]
ds_read_b64_tr_b16 v[126:127],v23 offset:4096
global_load_dword v236,v238,s[4:5] sc1
v_mfma_f32_16x16x32_bf16 a[80:83],v[176:179],v[136:139],a[80:83]
v_mfma_f32_16x16x32_bf16 a[84:87],v[180:183],v[136:139],a[84:87]
v_mfma_f32_16x16x32_bf16 a[88:91],v[184:187],v[136:139],a[88:91]
v_mfma_f32_16x16x32_bf16 a[92:95],v[188:191],v[136:139],a[92:95]
v_mfma_f32_16x16x32_bf16 a[96:99],v[160:163],v[140:143],a[96:99]
v_mfma_f32_16x16x32_bf16 a[100:103],v[164:167],v[140:143],a[100:103]
v_mfma_f32_16x16x32_bf16 a[104:107],v[168:171],v[140:143],a[104:107]
v_mfma_f32_16x16x32_bf16 a[108:111],v[172:175],v[140:143],a[108:111]
v_mfma_f32_16x16x32_bf16 a[112:115],v[176:179],v[140:143],a[112:115]
v_mfma_f32_16x16x32_bf16 a[116:119],v[180:183],v[140:143],a[116:119]
v_mfma_f32_16x16x32_bf16 a[120:123],v[184:187],v[140:143],a[120:123]
v_mfma_f32_16x16x32_bf16 a[124:127],v[188:191],v[140:143],a[124:127]
s_sub_u32 s22,s22,1
s_cmp_lg_u32 s22,0
s_cbranch_scc1 L_g_ks_mid
s_cmp_eq_u32 s33,8
s_cbranch_scc0 L_g_k3
s_lshr_b32 s54,s34,1
s_lshl_b32 s54,s54,7
s_add_u32 s54,s54,94442496
v_mov_b32 v24,s54
L_bulk_dep4:
global_load_dword v236,v24,s[4:5] offset:0 sc1
s_sub_u32 s40,s40,1
s_cbranch_scc1 L_bulk_bail
s_waitcnt vmcnt(0)
v_cmp_gt_u32 vcc,8,v236
s_cbranch_vccz L_bulk_dep4_ok
s_sleep 4
s_branch L_bulk_dep4
L_bulk_dep4_ok:
global_load_dwordx4 a[128:131],v2,s[30:31] offset:0 sc1
global_load_dwordx4 a[132:135],v2,s[30:31] offset:1024 sc1
global_load_dwordx4 a[136:139],v2,s[30:31] offset:2048 sc1
global_load_dwordx4 a[140:143],v2,s[30:31] offset:3072 sc1
s_add_u32 s30,s30,32768
s_addc_u32 s31,s31,0
global_load_dwordx4 a[144:147],v2,s[30:31] offset:0 sc1
global_load_dwordx4 a[148:151],v2,s[30:31] offset:1024 sc1
global_load_dwordx4 a[152:155],v2,s[30:31] offset:2048 sc1
global_load_dwordx4 a[156:159],v2,s[30:31] offset:3072 sc1
s_add_u32 s30,s30,32768
s_addc_u32 s31,s31,0
global_load_dwordx4 a[160:163],v2,s[30:31] offset:0 sc1
global_load_dwordx4 a[164:167],v2,s[30:31] offset:1024 sc1
global_load_dwordx4 a[168:171],v2,s[30:31] offset:2048 sc1
global_load_dwordx4 a[172:175],v2,s[30:31] offset:3072 sc1
s_add_u32 s30,s30,32768
s_addc_u32 s31,s31,0
global_load_dwordx4 a[176:179],v2,s[30:31] offset:0 sc1
global_load_dwordx4 a[180:183],v2,s[30:31] offset:1024 sc1
global_load_dwordx4 a[184:187],v2,s[30:31] offset:2048 sc1
global_load_dwordx4 a[188:191],v2,s[30:31] offset:3072 sc1
L_g_k3:
s_mov_b32 s36,s33
s_and_b32 s33,s27,15
s_bfe_u32 s34,s27,0x40004
s_bfe_u32 s35,s27,0x60008
s_mov_b32 s28,1
s_sub_u32 s54,s33,1
s_cmp_lt_u32 s54,5
s_cbranch_scc1 L_g_ks_h_ck
s_sub_u32 s54,s33,9
s_cmp_lt_u32 s54,4
s_cbranch_scc0 L_g_ks_h_no
L_g_ks_h_ck:
ds_read_b128 v[24:27],v15
s_bfe_u32 s55,s27,0x60014
s_waitcnt lgkmcnt(0)
v_min3_u32 v24,v24,v25,v26
v_min_u32 v24,v24,v27
s_nop 0
v_readfirstlane_b32 s54,v24
s_nop 0
s_cmp_ge_u32 s54,s55
s_cbranch_scc1 L_g_ks_h_pf
L_g_ks_h_no:
s_mov_b32 s28,0
s_mov_b32 s33,1
s_mov_b32 s34,0
s_mov_b32 s35,0
L_g_ks_h_pf:
s_lshr_b32 s55,s14,1
s_mov_b32 s24,-1
s_cmp_eq_u32 s33,5
s_cbranch_scc1 L_g_ks_h_sd_d8
s_cmp_eq_u32 s33,8
s_cbranch_scc1 L_g_ks_h_sd_d4
s_cmp_eq_u32 s33,12
s_cbranch_scc1 L_g_ks_h_sd_d4
s_sub_u32 s54,s33,6
s_cmp_lt_u32 s54,2
s_cbranch_scc1 L_g_ks_h_sd_db
s_lshl_b32 s54,s34,19
s_add_u32 s54,s54,104857600
s_add_u32 s16,s4,s54
s_addc_u32 s17,s5,0
s_mov_b32 s20,1024
v_mov_b32 v4,v192
v_mov_b32 v5,v193
v_mov_b32 v6,v194
v_mov_b32 v7,v195
s_cmp_lt_u32 s33,9
s_cbranch_scc1 L_g_ks_h_sd_big
s_lshl_b32 s54,s34,18
s_lshl_b32 s59,s14,16
s_add_u32 s54,s54,s59
s_add_u32 s54,s54,104857600
s_add_u32 s16,s4,s54
s_addc_u32 s17,s5,0
v_mov_b32 v4,v2
v_add_u32 v5,31744,v2
v_mov_b32 v6,0
v_mov_b32 v7,0
L_g_ks_h_sd_big:
s_cmp_eq_u32 s33,4
s_cbranch_scc1 L_g_ks_h_sd_up
s_cmp_eq_u32 s33,1
s_cselect_b64 s[56:57],s[66:67],s[68:69]
s_cmp_eq_u32 s33,3
s_cselect_b64 s[56:57],s[70:71],s[56:57]
s_cmp_eq_u32 s33,11
s_cselect_b64 s[56:57],s[70:71],s[56:57]
s_cmp_eq_u32 s33,9
s_cselect_b64 s[56:57],s[66:67],s[56:57]
s_lshl_b32 s54,s35,9
s_lshl_b32 s59,s55,8
s_add_u32 s54,s54,s59
s_add_u32 s18,s56,s54
s_addc_u32 s19,s57,0
s_mov_b32 s21,262144
v_mov_b32 v8,v200
v_mov_b32 v9,v201
v_mov_b32 v10,v202
v_mov_b32 v11,v203
s_branch L_g_ks_h_sd_e
L_g_ks_h_sd_up:
s_cmp_eq_u32 s55,1
s_cselect_b64 s[56:57],s[74:75],s[72:73]
s_and_b32 s54,s35,31
s_lshl_b32 s54,s54,8
s_add_u32 s18,s56,s54
s_addc_u32 s19,s57,0
s_mov_b32 s21,229376
v_mov_b32 v8,v204
v_mov_b32 v9,v205
v_mov_b32 v10,v206
v_mov_b32 v11,v207
s_bitcmp1_b32 s35,5
s_cbranch_scc0 L_g_ks_h_sd_e
s_and_b32 s54,s34,3
s_mul_i32 s24,s54,2
s_mul_i32 s25,s20,32
s_mul_i32 s3,s21,32
s_lshl_b32 s54,s24,2
s_mul_i32 s57,s54,s20
s_add_u32 s16,s16,s57
s_addc_u32 s17,s17,0
s_mul_i32 s57,s54,s21
s_add_u32 s18,s18,s57
s_addc_u32 s19,s19,0
s_branch L_g_ks_h_sd_e
L_g_ks_h_sd_d8:
s_mul_i32 s54,s34,1835008
s_add_u32 s54,s54,50331648
s_add_u32 s16,s4,s54
s_addc_u32 s17,s5,0
s_mov_b32 s20,1024
s_and_b32 s54,s35,31
s_lshl_b32 s54,s54,9
s_lshl_b32 s59,s55,8
s_add_u32 s54,s54,s59
s_add_u32 s18,s76,s54
s_addc_u32 s19,s77,0
s_mov_b32 s21,65536
v_mov_b32 v4,v196
v_add_u32 v5,113664,v196
v_add_u32 v6,227328,v196
v_add_u32 v7,340992,v196
v_mov_b32 v8,v208
v_mov_b32 v9,v209
v_mov_b32 v10,v210
v_mov_b32 v11,v211
s_bitcmp1_b32 s35,5
s_cbranch_scc0 L_g_ks_h_sd_e
s_and_b32 s54,s34,3
s_mul_i32 s24,s54,7
s_mul_i32 s25,s20,112
s_mul_i32 s3,s21,112
s_lshl_b32 s54,s24,2
s_mul_i32 s57,s54,s20
s_add_u32 s16,s16,s57
s_addc_u32 s17,s17,0
s_mul_i32 s57,s54,s21
s_add_u32 s18,s18,s57
s_addc_u32 s19,s19,0
s_branch L_g_ks_h_sd_e
L_g_ks_h_sd_d4:
s_lshl_b32 s54,s34,20
s_lshl_b32 s59,s14,18
s_add_u32 s54,s54,s59
s_add_u32 s54,s54,67108864
s_mul_i32 s58,s34,917504
s_mul_i32 s59,s14,229376
s_add_u32 s58,s58,s59
s_add_u32 s58,s58,50331648
s_cmp_eq_u32 s33,8
s_cselect_b32 s54,s54,s58
s_cselect_b32 s58,16,0
s_cselect_b64 s[56:57],s[60:61],s[76:77]
s_add_u32 s16,s4,s54
s_addc_u32 s17,s5,0
s_mov_b32 s20,1024
s_lshl_b32 s54,s35,9
s_lshl_b32 s59,s55,8
s_add_u32 s54,s54,s59
s_add_u32 s18,s56,s54
s_addc_u32 s19,s57,0
s_mov_b32 s21,65536
v_mov_b32 v4,v2
s_lshl_b32 s58,s58,10
s_add_u32 s58,s58,113664
v_add_u32 v5,s58,v2
v_mov_b32 v6,0
v_mov_b32 v7,0
v_mov_b32 v8,v208
v_mov_b32 v9,v209
v_mov_b32 v10,v210
v_mov_b32 v11,v211
s_branch L_g_ks_h_sd_e
L_g_ks_h_sd_db:
s_lshr_b32 s57,s35,3
s_lshl_b32 s54,s34,20
s_lshl_b32 s59,s57,15
s_add_u32 s54,s54,s59
s_add_u32 s54,s54,67106816
s_and_b32 s12,s35,7
s_lshl_b32 s12,s12,8
s_lshl_b32 s59,s55,16
s_add_u32 s12,s12,s59
s_lshl_b32 s59,s57,21
s_add_u32 s12,s12,s59
s_add_u32 s16,s4,s54
s_addc_u32 s17,s5,0
s_mov_b32 s20,2048
s_add_u32 s18,s60,s12
s_addc_u32 s19,s61,0
s_mov_b32 s21,131072
s_lshl_b32 s54,s14,1
s_add_u32 s54,s54,s57
s_and_b32 s54,s54,3
s_lshl_b32 s54,s54,17
s_lshl_b32 s59,s55,19
s_add_u32 s54,s54,s59
s_add_u32 s54,s54,2048
v_add_u32 v4,s54,v2
v_mov_b32 v5,v4
s_lshl_b32 s54,s14,1
s_add_u32 s54,s54,s57
s_add_u32 s54,s54,1
s_and_b32 s54,s54,3
s_lshl_b32 s54,s54,17
s_lshl_b32 s59,s55,19
s_add_u32 s54,s54,s59
v_add_u32 v6,s54,v2
v_mov_b32 v7,v6
v_mov_b32 v8,v208
v_mov_b32 v9,v209
v_mov_b32 v10,v210
v_mov_b32 v11,v211
L_g_ks_h_sd_e:
s_cmp_eq_u32 s28,0
s_cselect_b64 s[16:17],s[64:65],s[16:17]
s_cselect_b32 s54,0,-1
s_and_b32 s21,s21,s54
v_and_b32 v4,s54,v4
v_and_b32 v5,s54,v5
v_and_b32 v6,s54,v6
v_and_b32 v7,s54,v7
v_and_b32 v8,s54,v8
v_and_b32 v9,s54,v9
v_and_b32 v10,s54,v10
v_and_b32 v11,s54,v11
s_waitcnt vmcnt(12) lgkmcnt(0)
s_barrier
v_mfma_f32_16x16x32_bf16 a[0:3],v[96:99],v[64:67],a[0:3]
ds_read_b128 v[128:131],v12 offset:16384
v_mfma_f32_16x16x32_bf16 a[4:7],v[100:103],v[64:67],a[4:7]
ds_read_b64_tr_b16 v[160:161],v16 offset:16384
s_add_u32 m0,s23,0
v_mfma_f32_16x16x32_bf16 a[8:11],v[104:107],v[64:67],a[8:11]
ds_read_b64_tr_b16 v[162:163],v16 offset:20480
global_load_lds_dwordx4 v4,s[16:17] offset:0 sc1
v_mfma_f32_16x16x32_bf16 a[12:15],v[108:111],v[64:67],a[12:15]
ds_read_b128 v[132:135],v12 offset:17408
v_mfma_f32_16x16x32_bf16 a[16:19],v[112:115],v[64:67],a[16:19]
ds_read_b64_tr_b16 v[164:165],v17 offset:16384
global_load_lds_dwordx4 v5,s[16:17] offset:1024 sc1
v_mfma_f32_16x16x32_bf16 a[20:23],v[116:119],v[64:67],a[20:23]
ds_read_b64_tr_b16 v[166:167],v17 offset:20480
v_mfma_f32_16x16x32_bf16 a[24:27],v[120:123],v[64:67],a[24:27]
ds_read_b128 v[136:139],v12 offset:20480
global_load_lds_dwordx4 v6,s[16:17] offset:2048 sc1
v_mfma_f32_16x16x32_bf16 a[28:31],v[124:127],v[64:67],a[28:31]
ds_read_b64_tr_b16 v[168:169],v18 offset:16384
v_mfma_f32_16x16x32_bf16 a[32:35],v[96:99],v[68:71],a[32:35]
ds_read_b64_tr_b16 v[170:171],v18 offset:20480
global_load_lds_dwordx4 v7,s[16:17] offset:3072 sc1
v_mfma_f32_16x16x32_bf16 a[36:39],v[100:103],v[68:71],a[36:39]
ds_read_b128 v[140:143],v12 offset:21504
v_mfma_f32_16x16x32_bf16 a[40:43],v[104:107],v[68:71],a[40:43]
ds_read_b64_tr_b16 v[172:173],v19 offset:16384
s_add_u32 m0,s23,65536
v_mfma_f32_16x16x32_bf16 a[44:47],v[108:111],v[68:71],a[44:47]
ds_read_b64_tr_b16 v[174:175],v19 offset:20480
s_add_u32 s16,s16,s20
v_mfma_f32_16x16x32_bf16 a[48:51],v[112:115],v[68:71],a[48:51]
ds_read_b64_tr_b16 v[176:177],v20 offset:16384
s_addc_u32 s17,s17,0
v_mfma_f32_16x16x32_bf16 a[52:55],v[116:119],v[68:71],a[52:55]
ds_read_b64_tr_b16 v[178:179],v20 offset:20480
global_load_lds_dwordx4 v8,s[18:19] offset:0
v_mfma_f32_16x16x32_bf16 a[56:59],v[120:123],v[68:71],a[56:59]
ds_read_b64_tr_b16 v[180:181],v21 offset:16384
v_mfma_f32_16x16x32_bf16 a[60:63],v[124:127],v[68:71],a[60:63]
ds_read_b64_tr_b16 v[182:183],v21 offset:20480
global_load_lds_dwordx4 v9,s[18:19] offset:1024
v_mfma_f32_16x16x32_bf16 a[64:67],v[96:99],v[72:75],a[64:67]
ds_read_b64_tr_b16 v[184:185],v22 offset:16384
v_mfma_f32_16x16x32_bf16 a[68:71],v[100:103],v[72:75],a[68:71]
ds_read_b64_tr_b16 v[186:187],v22 offset:20480
global_load_lds_dwordx4 v10,s[18:19] offset:2048
v_mfma_f32_16x16x32_bf16 a[72:75],v[104:107],v[72:75],a[72:75]
ds_read_b64_tr_b16 v[188:189],v23 offset:16384
v_mfma_f32_16x16x32_bf16 a[76:79],v[108:111],v[72:75],a[76:79]
ds_read_b64_tr_b16 v[190:191],v23 offset:20480
global_load_lds_dwordx4 v11,s[18:19] offset:3072
v_mfma_f32_16x16x32_bf16 a[80:83],v[112:115],v[72:75],a[80:83]
v_mfma_f32_16x16x32_bf16 a[84:87],v[116:119],v[72:75],a[84:87]
s_add_u32 s18,s18,s21
v_mfma_f32_16x16x32_bf16 a[88:91],v[120:123],v[72:75],a[88:91]
s_addc_u32 s19,s19,0
v_mfma_f32_16x16x32_bf16 a[92:95],v[124:127],v[72:75],a[92:95]
v_mfma_f32_16x16x32_bf16 a[96:99],v[96:99],v[76:79],a[96:99]
v_mfma_f32_16x16x32_bf16 a[100:103],v[100:103],v[76:79],a[100:103]
v_mfma_f32_16x16x32_bf16 a[104:107],v[104:107],v[76:79],a[104:107]
v_mfma_f32_16x16x32_bf16 a[108:111],v[108:111],v[76:79],a[108:111]
v_mfma_f32_16x16x32_bf16 a[112:115],v[112:115],v[76:79],a[112:115]
v_mfma_f32_16x16x32_bf16 a[116:119],v[116:119],v[76:79],a[116:119]
v_mfma_f32_16x16x32_bf16 a[120:123],v[120:123],v[76:79],a[120:123]
v_mfma_f32_16x16x32_bf16 a[124:127],v[124:127],v[76:79],a[124:127]
s_waitcnt vmcnt(14) lgkmcnt(0)
s_barrier
v_mfma_f32_16x16x32_bf16 a[0:3],v[160:163],v[128:131],a[0:3]
ds_read_b128 v[64:67],v12 offset:32768
v_mfma_f32_16x16x32_bf16 a[4:7],v[164:167],v[128:131],a[4:7]
ds_read_b64_tr_b16 v[96:97],v16 offset:32768
s_add_u32 m0,s23,16384
v_mfma_f32_16x16x32_bf16 a[8:11],v[168:171],v[128:131],a[8:11]
ds_read_b64_tr_b16 v[98:99],v16 offset:36864
global_load_lds_dwordx4 v4,s[16:17] offset:0 sc1
v_mfma_f32_16x16x32_bf16 a[12:15],v[172:175],v[128:131],a[12:15]
ds_read_b128 v[68:71],v12 offset:33792
v_mfma_f32_16x16x32_bf16 a[16:19],v[176:179],v[128:131],a[16:19]
ds_read_b64_tr_b16 v[100:101],v17 offset:32768
global_load_lds_dwordx4 v5,s[16:17] offset:1024 sc1
v_mfma_f32_16x16x32_bf16 a[20:23],v[180:183],v[128:131],a[20:23]
ds_read_b64_tr_b16 v[102:103],v17 offset:36864
v_mfma_f32_16x16x32_bf16 a[24:27],v[184:187],v[128:131],a[24:27]
ds_read_b128 v[72:75],v12 offset:36864
global_load_lds_dwordx4 v6,s[16:17] offset:2048 sc1
v_mfma_f32_16x16x32_bf16 a[28:31],v[188:191],v[128:131],a[28:31]
ds_read_b64_tr_b16 v[104:105],v18 offset:32768
v_mfma_f32_16x16x32_bf16 a[32:35],v[160:163],v[132:135],a[32:35]
ds_read_b64_tr_b16 v[106:107],v18 offset:36864
global_load_lds_dwordx4 v7,s[16:17] offset:3072 sc1
v_mfma_f32_16x16x32_bf16 a[36:39],v[164:167],v[132:135],a[36:39]
ds_read_b128 v[76:79],v12 offset:37888
v_mfma_f32_16x16x32_bf16 a[40:43],v[168:171],v[132:135],a[40:43]
ds_read_b64_tr_b16 v[108:109],v19 offset:32768
s_add_u32 m0,s23,81920
v_mfma_f32_16x16x32_bf16 a[44:47],v[172:175],v[132:135],a[44:47]
ds_read_b64_tr_b16 v[110:111],v19 offset:36864
s_add_u32 s16,s16,s20
v_mfma_f32_16x16x32_bf16 a[48:51],v[176:179],v[132:135],a[48:51]
ds_read_b64_tr_b16 v[112:113],v20 offset:32768
s_addc_u32 s17,s17,0
v_mfma_f32_16x16x32_bf16 a[52:55],v[180:183],v[132:135],a[52:55]
ds_read_b64_tr_b16 v[114:115],v20 offset:36864
global_load_lds_dwordx4 v8,s[18:19] offset:0
v_mfma_f32_16x16x32_bf16 a[56:59],v[184:187],v[132:135],a[56:59]
ds_read_b64_tr_b16 v[116:117],v21 offset:32768
v_mfma_f32_16x16x32_bf16 a[60:63],v[188:191],v[132:135],a[60:63]
ds_read_b64_tr_b16 v[118:119],v21 offset:36864
global_load_lds_dwordx4 v9,s[18:19] offset:1024
v_mfma_f32_16x16x32_bf16 a[64:67],v[160:163],v[136:139],a[64:67]
ds_read_b64_tr_b16 v[120:121],v22 offset:32768
v_mfma_f32_16x16x32_bf16 a[68:71],v[164:167],v[136:139],a[68:71]
ds_read_b64_tr_b16 v[122:123],v22 offset:36864
global_load_lds_dwordx4 v10,s[18:19] offset:2048
v_mfma_f32_16x16x32_bf16 a[72:75],v[168:171],v[136:139],a[72:75]
ds_read_b64_tr_b16 v[124:125],v23 offset:32768
v_mfma_f32_16x16x32_bf16 a[76:79],v[172:175],v[136:139],a[76:79]
ds_read_b64_tr_b16 v[126:127],v23 offset:36864
global_load_lds_dwordx4 v11,s[18:19] offset:3072
v_mfma_f32_16x16x32_bf16 a[80:83],v[176:179],v[136:139],a[80:83]
v_mfma_f32_16x16x32_bf16 a[84:87],v[180:183],v[136:139],a[84:87]
s_add_u32 s18,s18,s21
v_mfma_f32_16x16x32_bf16 a[88:91],v[184:187],v[136:139],a[88:91]
s_addc_u32 s19,s19,0
v_mfma_f32_16x16x32_bf16 a[92:95],v[188:191],v[136:139],a[92:95]
v_mfma_f32_16x16x32_bf16 a[96:99],v[160:163],v[140:143],a[96:99]
v_mfma_f32_16x16x32_bf16 a[100:103],v[164:167],v[140:143],a[100:103]
v_mfma_f32_16x16x32_bf16 a[104:107],v[168:171],v[140:143],a[104:107]
v_mfma_f32_16x16x32_bf16 a[108:111],v[172:175],v[140:143],a[108:111]
v_mfma_f32_16x16x32_bf16 a[112:115],v[176:179],v[140:143],a[112:115]
v_mfma_f32_16x16x32_bf16 a[116:119],v[180:183],v[140:143],a[116:119]
v_mfma_f32_16x16x32_bf16 a[120:123],v[184:187],v[140:143],a[120:123]
v_mfma_f32_16x16x32_bf16 a[124:127],v[188:191],v[140:143],a[124:127]
s_waitcnt vmcnt(16) lgkmcnt(0)
s_barrier
v_mfma_f32_16x16x32_bf16 a[0:3],v[96:99],v[64:67],a[0:3]
ds_read_b128 v[128:131],v12 offset:49152
v_mfma_f32_16x16x32_bf16 a[4:7],v[100:103],v[64:67],a[4:7]
ds_read_b64_tr_b16 v[160:161],v16 offset:49152
s_add_u32 m0,s23,32768
v_mfma_f32_16x16x32_bf16 a[8:11],v[104:107],v[64:67],a[8:11]
ds_read_b64_tr_b16 v[162:163],v16 offset:53248
global_load_lds_dwordx4 v4,s[16:17] offset:0 sc1
v_mfma_f32_16x16x32_bf16 a[12:15],v[108:111],v[64:67],a[12:15]
ds_read_b128 v[132:135],v12 offset:50176
v_mfma_f32_16x16x32_bf16 a[16:19],v[112:115],v[64:67],a[16:19]
ds_read_b64_tr_b16 v[164:165],v17 offset:49152
global_load_lds_dwordx4 v5,s[16:17] offset:1024 sc1
v_mfma_f32_16x16x32_bf16 a[20:23],v[116:119],v[64:67],a[20:23]
ds_read_b64_tr_b16 v[166:167],v17 offset:53248
v_mfma_f32_16x16x32_bf16 a[24:27],v[120:123],v[64:67],a[24:27]
ds_read_b128 v[136:139],v12 offset:53248
global_load_lds_dwordx4 v6,s[16:17] offset:2048 sc1
v_mfma_f32_16x16x32_bf16 a[28:31],v[124:127],v[64:67],a[28:31]
ds_read_b64_tr_b16 v[168:169],v18 offset:49152
v_mfma_f32_16x16x32_bf16 a[32:35],v[96:99],v[68:71],a[32:35]
ds_read_b64_tr_b16 v[170:171],v18 offset:53248
global_load_lds_dwordx4 v7,s[16:17] offset:3072 sc1
v_mfma_f32_16x16x32_bf16 a[36:39],v[100:103],v[68:71],a[36:39]
ds_read_b128 v[140:143],v12 offset:54272
v_mfma_f32_16x16x32_bf16 a[40:43],v[104:107],v[68:71],a[40:43]
ds_read_b64_tr_b16 v[172:173],v19 offset:49152
s_add_u32 m0,s23,98304
v_mfma_f32_16x16x32_bf16 a[44:47],v[108:111],v[68:71],a[44:47]
ds_read_b64_tr_b16 v[174:175],v19 offset:53248
s_add_u32 s16,s16,s20
v_mfma_f32_16x16x32_bf16 a[48:51],v[112:115],v[68:71],a[48:51]
ds_read_b64_tr_b16 v[176:177],v20 offset:49152
s_addc_u32 s17,s17,0
v_mfma_f32_16x16x32_bf16 a[52:55],v[116:119],v[68:71],a[52:55]
ds_read_b64_tr_b16 v[178:179],v20 offset:53248
global_load_lds_dwordx4 v8,s[18:19] offset:0
v_mfma_f32_16x16x32_bf16 a[56:59],v[120:123],v[68:71],a[56:59]
ds_read_b64_tr_b16 v[180:181],v21 offset:49152
v_mfma_f32_16x16x32_bf16 a[60:63],v[124:127],v[68:71],a[60:63]
ds_read_b64_tr_b16 v[182:183],v21 offset:53248
global_load_lds_dwordx4 v9,s[18:19] offset:1024
v_mfma_f32_16x16x32_bf16 a[64:67],v[96:99],v[72:75],a[64:67]
ds_read_b64_tr_b16 v[184:185],v22 offset:49152
v_mfma_f32_16x16x32_bf16 a[68:71],v[100:103],v[72:75],a[68:71]
ds_read_b64_tr_b16 v[186:187],v22 offset:53248
global_load_lds_dwordx4 v10,s[18:19] offset:2048
v_mfma_f32_16x16x32_bf16 a[72:75],v[104:107],v[72:75],a[72:75]
ds_read_b64_tr_b16 v[188:189],v23 offset:49152
v_mfma_f32_16x16x32_bf16 a[76:79],v[108:111],v[72:75],a[76:79]
ds_read_b64_tr_b16 v[190:191],v23 offset:53248
global_load_lds_dwordx4 v11,s[18:19] offset:3072
v_mfma_f32_16x16x32_bf16 a[80:83],v[112:115],v[72:75],a[80:83]
v_mfma_f32_16x16x32_bf16 a[84:87],v[116:119],v[72:75],a[84:87]
s_add_u32 s18,s18,s21
v_mfma_f32_16x16x32_bf16 a[88:91],v[120:123],v[72:75],a[88:91]
s_addc_u32 s19,s19,0
v_mfma_f32_16x16x32_bf16 a[92:95],v[124:127],v[72:75],a[92:95]
v_mfma_f32_16x16x32_bf16 a[96:99],v[96:99],v[76:79],a[96:99]
v_mfma_f32_16x16x32_bf16 a[100:103],v[100:103],v[76:79],a[100:103]
v_mfma_f32_16x16x32_bf16 a[104:107],v[104:107],v[76:79],a[104:107]
v_mfma_f32_16x16x32_bf16 a[108:111],v[108:111],v[76:79],a[108:111]
v_mfma_f32_16x16x32_bf16 a[112:115],v[112:115],v[76:79],a[112:115]
v_mfma_f32_16x16x32_bf16 a[116:119],v[116:119],v[76:79],a[116:119]
v_mfma_f32_16x16x32_bf16 a[120:123],v[120:123],v[76:79],a[120:123]
v_mfma_f32_16x16x32_bf16 a[124:127],v[124:127],v[76:79],a[124:127]
s_waitcnt vmcnt(63) lgkmcnt(0)
s_barrier
v_mfma_f32_16x16x32_bf16 a[0:3],v[160:163],v[128:131],a[0:3]
v_mfma_f32_16x16x32_bf16 a[4:7],v[164:167],v[128:131],a[4:7]
s_add_u32 m0,s23,49152
v_mfma_f32_16x16x32_bf16 a[8:11],v[168:171],v[128:131],a[8:11]
global_load_lds_dwordx4 v4,s[16:17] offset:0 sc1
v_mfma_f32_16x16x32_bf16 a[12:15],v[172:175],v[128:131],a[12:15]
v_mfma_f32_16x16x32_bf16 a[16:19],v[176:179],v[128:131],a[16:19]
global_load_lds_dwordx4 v5,s[16:17] offset:1024 sc1
v_mfma_f32_16x16x32_bf16 a[20:23],v[180:183],v[128:131],a[20:23]
v_mfma_f32_16x16x32_bf16 a[24:27],v[184:187],v[128:131],a[24:27]
global_load_lds_dwordx4 v6,s[16:17] offset:2048 sc1
v_mfma_f32_16x16x32_bf16 a[28:31],v[188:191],v[128:131],a[28:31]
v_mfma_f32_16x16x32_bf16 a[32:35],v[160:163],v[132:135],a[32:35]
global_load_lds_dwordx4 v7,s[16:17] offset:3072 sc1
v_mfma_f32_16x16x32_bf16 a[36:39],v[164:167],v[132:135],a[36:39]
v_mfma_f32_16x16x32_bf16 a[40:43],v[168:171],v[132:135],a[40:43]
s_add_u32 m0,s23,114688
v_mfma_f32_16x16x32_bf16 a[44:47],v[172:175],v[132:135],a[44:47]
s_add_u32 s16,s16,s20
v_mfma_f32_16x16x32_bf16 a[48:51],v[176:179],v[132:135],a[48:51]
s_addc_u32 s17,s17,0
v_mfma_f32_16x16x32_bf16 a[52:55],v[180:183],v[132:135],a[52:55]
global_load_lds_dwordx4 v8,s[18:19] offset:0
v_mfma_f32_16x16x32_bf16 a[56:59],v[184:187],v[132:135],a[56:59]
v_mfma_f32_16x16x32_bf16 a[60:63],v[188:191],v[132:135],a[60:63]
global_load_lds_dwordx4 v9,s[18:19] offset:1024
v_mfma_f32_16x16x32_bf16 a[64:67],v[160:163],v[136:139],a[64:67]
v_mfma_f32_16x16x32_bf16 a[68:71],v[164:167],v[136:139],a[68:71]
global_load_lds_dwordx4 v10,s[18:19] offset:2048
v_mfma_f32_16x16x32_bf16 a[72:75],v[168:171],v[136:139],a[72:75]
v_mfma_f32_16x16x32_bf16 a[76:79],v[172:175],v[136:139],a[76:79]
global_load_lds_dwordx4 v11,s[18:19] offset:3072
v_mfma_f32_16x16x32_bf16 a[80:83],v[176:179],v[136:139],a[80:83]
v_mfma_f32_16x16x32_bf16 a[84:87],v[180:183],v[136:139],a[84:87]
s_add_u32 s18,s18,s21
v_mfma_f32_16x16x32_bf16 a[88:91],v[184:187],v[136:139],a[88:91]
s_addc_u32 s19,s19,0
v_mfma_f32_16x16x32_bf16 a[92:95],v[188:191],v[136:139],a[92:95]
v_mfma_f32_16x16x32_bf16 a[96:99],v[160:163],v[140:143],a[96:99]
v_mfma_f32_16x16x32_bf16 a[100:103],v[164:167],v[140:143],a[100:103]
v_mfma_f32_16x16x32_bf16 a[104:107],v[168:171],v[140:143],a[104:107]
v_mfma_f32_16x16x32_bf16 a[108:111],v[172:175],v[140:143],a[108:111]
v_mfma_f32_16x16x32_bf16 a[112:115],v[176:179],v[140:143],a[112:115]
v_mfma_f32_16x16x32_bf16 a[116:119],v[180:183],v[140:143],a[116:119]
v_mfma_f32_16x16x32_bf16 a[120:123],v[184:187],v[140:143],a[120:123]
v_mfma_f32_16x16x32_bf16 a[124:127],v[188:191],v[140:143],a[124:127]
s_cmp_eq_u32 s36,8
s_cbranch_scc1 L_e_da4
s_cmp_eq_u32 s36,12
s_cbranch_scc1 L_e_db4
v_accvgpr_read_b32 v32,a0
v_accvgpr_read_b32 v33,a1
v_accvgpr_read_b32 v34,a2
v_accvgpr_read_b32 v35,a3
v_accvgpr_read_b32 v36,a4
v_accvgpr_read_b32 v37,a5
v_accvgpr_read_b32 v38,a6
v_accvgpr_read_b32 v39,a7
v_cvt_pk_bf16_f32 v64,v32,v33
v_cvt_pk_bf16_f32 v65,v34,v35
v_cvt_pk_bf16_f32 v66,v36,v37
v_cvt_pk_bf16_f32 v67,v38,v39
global_store_dwordx4 v2,v[64:67],s[30:31] offset:0 sc1
v_accvgpr_read_b32 v24,a8
v_accvgpr_read_b32 v25,a9
v_accvgpr_read_b32 v26,a10
v_accvgpr_read_b32 v27,a11
v_accvgpr_read_b32 v28,a12
v_accvgpr_read_b32 v29,a13
v_accvgpr_read_b32 v30,a14
v_accvgpr_read_b32 v31,a15
v_cvt_pk_bf16_f32 v68,v24,v25
v_cvt_pk_bf16_f32 v69,v26,v27
v_cvt_pk_bf16_f32 v70,v28,v29
v_cvt_pk_bf16_f32 v71,v30,v31
global_store_dwordx4 v2,v[68:71],s[30:31] offset:1024 sc1
v_accvgpr_read_b32 v32,a16
v_accvgpr_read_b32 v33,a17
v_accvgpr_read_b32 v34,a18
v_accvgpr_read_b32 v35,a19
v_accvgpr_read_b32 v36,a20
v_accvgpr_read_b32 v37,a21
v_accvgpr_read_b32 v38,a22
v_accvgpr_read_b32 v39,a23
v_cvt_pk_bf16_f32 v72,v32,v33
v_cvt_pk_bf16_f32 v73,v34,v35
v_cvt_pk_bf16_f32 v74,v36,v37
v_cvt_pk_bf16_f32 v75,v38,v39
global_store_dwordx4 v2,v[72:75],s[30:31] offset:2048 sc1
v_accvgpr_read_b32 v24,a24
v_accvgpr_read_b32 v25,a25
v_accvgpr_read_b32 v26,a26
v_accvgpr_read_b32 v27,a27
v_accvgpr_read_b32 v28,a28
v_accvgpr_read_b32 v29,a29
v_accvgpr_read_b32 v30,a30
v_accvgpr_read_b32 v31,a31
v_cvt_pk_bf16_f32 v76,v24,v25
v_cvt_pk_bf16_f32 v77,v26,v27
v_cvt_pk_bf16_f32 v78,v28,v29
v_cvt_pk_bf16_f32 v79,v30,v31
global_store_dwordx4 v2,v[76:79],s[30:31] offset:3072 sc1
v_accvgpr_read_b32 v32,a32
v_accvgpr_read_b32 v33,a33
v_accvgpr_read_b32 v34,a34
v_accvgpr_read_b32 v35,a35
v_accvgpr_read_b32 v36,a36
v_accvgpr_read_b32 v37,a37
v_accvgpr_read_b32 v38,a38
v_accvgpr_read_b32 v39,a39
v_cvt_pk_bf16_f32 v80,v32,v33
v_cvt_pk_bf16_f32 v81,v34,v35
v_cvt_pk_bf16_f32 v82,v36,v37
v_cvt_pk_bf16_f32 v83,v38,v39
global_store_dwordx4 v3,v[80:83],s[30:31] offset:0 sc1
v_accvgpr_read_b32 v24,a40
v_accvgpr_read_b32 v25,a41
v_accvgpr_read_b32 v26,a42
v_accvgpr_read_b32 v27,a43
v_accvgpr_read_b32 v28,a44
v_accvgpr_read_b32 v29,a45
v_accvgpr_read_b32 v30,a46
v_accvgpr_read_b32 v31,a47
v_cvt_pk_bf16_f32 v84,v24,v25
v_cvt_pk_bf16_f32 v85,v26,v27
v_cvt_pk_bf16_f32 v86,v28,v29
v_cvt_pk_bf16_f32 v87,v30,v31
global_store_dwordx4 v3,v[84:87],s[30:31] offset:1024 sc1
v_accvgpr_read_b32 v32,a48
v_accvgpr_read_b32 v33,a49
v_accvgpr_read_b32 v34,a50
v_accvgpr_read_b32 v35,a51
v_accvgpr_read_b32 v36,a52
v_accvgpr_read_b32 v37,a53
v_accvgpr_read_b32 v38,a54
v_accvgpr_read_b32 v39,a55
v_cvt_pk_bf16_f32 v88,v32,v33
v_cvt_pk_bf16_f32 v89,v34,v35
v_cvt_pk_bf16_f32 v90,v36,v37
v_cvt_pk_bf16_f32 v91,v38,v39
global_store_dwordx4 v3,v[88:91],s[30:31] offset:2048 sc1
v_accvgpr_read_b32 v24,a56
v_accvgpr_read_b32 v25,a57
v_accvgpr_read_b32 v26,a58
v_accvgpr_read_b32 v27,a59
v_accvgpr_read_b32 v28,a60
v_accvgpr_read_b32 v29,a61
v_accvgpr_read_b32 v30,a62
v_accvgpr_read_b32 v31,a63
v_cvt_pk_bf16_f32 v92,v24,v25
v_cvt_pk_bf16_f32 v93,v26,v27
v_cvt_pk_bf16_f32 v94,v28,v29
v_cvt_pk_bf16_f32 v95,v30,v31
global_store_dwordx4 v3,v[92:95],s[30:31] offset:3072 sc1
s_add_u32 s30,s30,8192
s_addc_u32 s31,s31,0
v_accvgpr_read_b32 v32,a64
v_accvgpr_read_b32 v33,a65
v_accvgpr_read_b32 v34,a66
v_accvgpr_read_b32 v35,a67
v_accvgpr_read_b32 v36,a68
v_accvgpr_read_b32 v37,a69
v_accvgpr_read_b32 v38,a70
v_accvgpr_read_b32 v39,a71
v_cvt_pk_bf16_f32 v96,v32,v33
v_cvt_pk_bf16_f32 v97,v34,v35
v_cvt_pk_bf16_f32 v98,v36,v37
v_cvt_pk_bf16_f32 v99,v38,v39
global_store_dwordx4 v2,v[96:99],s[30:31] offset:0 sc1
v_accvgpr_read_b32 v24,a72
v_accvgpr_read_b32 v25,a73
v_accvgpr_read_b32 v26,a74
v_accvgpr_read_b32 v27,a75
v_accvgpr_read_b32 v28,a76
v_accvgpr_read_b32 v29,a77
v_accvgpr_read_b32 v30,a78
v_accvgpr_read_b32 v31,a79
v_cvt_pk_bf16_f32 v100,v24,v25
v_cvt_pk_bf16_f32 v101,v26,v27
v_cvt_pk_bf16_f32 v102,v28,v29
v_cvt_pk_bf16_f32 v103,v30,v31
global_store_dwordx4 v2,v[100:103],s[30:31] offset:1024 sc1
v_accvgpr_read_b32 v32,a80
v_accvgpr_read_b32 v33,a81
v_accvgpr_read_b32 v34,a82
v_accvgpr_read_b32 v35,a83
v_accvgpr_read_b32 v36,a84
v_accvgpr_read_b32 v37,a85
v_accvgpr_read_b32 v38,a86
v_accvgpr_read_b32 v39,a87
v_cvt_pk_bf16_f32 v104,v32,v33
v_cvt_pk_bf16_f32 v105,v34,v35
v_cvt_pk_bf16_f32 v106,v36,v37
v_cvt_pk_bf16_f32 v107,v38,v39
global_store_dwordx4 v2,v[104:107],s[30:31] offset:2048 sc1
v_accvgpr_read_b32 v24,a88
v_accvgpr_read_b32 v25,a89
v_accvgpr_read_b32 v26,a90
v_accvgpr_read_b32 v27,a91
v_accvgpr_read_b32 v28,a92
v_accvgpr_read_b32 v29,a93
v_accvgpr_read_b32 v30,a94
v_accvgpr_read_b32 v31,a95
v_cvt_pk_bf16_f32 v108,v24,v25
v_cvt_pk_bf16_f32 v109,v26,v27
v_cvt_pk_bf16_f32 v110,v28,v29
v_cvt_pk_bf16_f32 v111,v30,v31
global_store_dwordx4 v2,v[108:111],s[30:31] offset:3072 sc1
v_accvgpr_read_b32 v32,a96
v_accvgpr_read_b32 v33,a97
v_accvgpr_read_b32 v34,a98
v_accvgpr_read_b32 v35,a99
v_accvgpr_read_b32 v36,a100
v_accvgpr_read_b32 v37,a101
v_accvgpr_read_b32 v38,a102
v_accvgpr_read_b32 v39,a103
v_cvt_pk_bf16_f32 v112,v32,v33
v_cvt_pk_bf16_f32 v113,v34,v35
v_cvt_pk_bf16_f32 v114,v36,v37
v_cvt_pk_bf16_f32 v115,v38,v39
global_store_dwordx4 v3,v[112:115],s[30:31] offset:0 sc1
v_accvgpr_read_b32 v24,a104
v_accvgpr_read_b32 v25,a105
v_accvgpr_read_b32 v26,a106
v_accvgpr_read_b32 v27,a107
v_accvgpr_read_b32 v28,a108
v_accvgpr_read_b32 v29,a109
v_accvgpr_read_b32 v30,a110
v_accvgpr_read_b32 v31,a111
v_cvt_pk_bf16_f32 v116,v24,v25
v_cvt_pk_bf16_f32 v117,v26,v27
v_cvt_pk_bf16_f32 v118,v28,v29
v_cvt_pk_bf16_f32 v119,v30,v31
global_store_dwordx4 v3,v[116:119],s[30:31] offset:1024 sc1
v_accvgpr_read_b32 v32,a112
v_accvgpr_read_b32 v33,a113
v_accvgpr_read_b32 v34,a114
v_accvgpr_read_b32 v35,a115
v_accvgpr_read_b32 v36,a116
v_accvgpr_read_b32 v37,a117
v_accvgpr_read_b32 v38,a118
v_accvgpr_read_b32 v39,a119
v_cvt_pk_bf16_f32 v120,v32,v33
v_cvt_pk_bf16_f32 v121,v34,v35
v_cvt_pk_bf16_f32 v122,v36,v37
v_cvt_pk_bf16_f32 v123,v38,v39
global_store_dwordx4 v3,v[120:123],s[30:31] offset:2048 sc1
v_accvgpr_read_b32 v24,a120
v_accvgpr_read_b32 v25,a121
v_accvgpr_read_b32 v26,a122
v_accvgpr_read_b32 v27,a123
v_accvgpr_read_b32 v28,a124
v_accvgpr_read_b32 v29,a125
v_accvgpr_read_b32 v30,a126
v_accvgpr_read_b32 v31,a127
v_cvt_pk_bf16_f32 v124,v24,v25
v_cvt_pk_bf16_f32 v125,v26,v27
v_cvt_pk_bf16_f32 v126,v28,v29
v_cvt_pk_bf16_f32 v127,v30,v31
global_store_dwordx4 v3,v[124:127],s[30:31] offset:3072 sc1
s_lshl_b32 s54,s32,7
s_add_u32 s54,s54,94437376
v_mov_b32 v233,s54
s_cmp_eq_u32 s32,63
s_cselect_b32 s39,0,s38
s_cmp_le_u32 s36,3
s_cselect_b32 s54,2,1
s_cmp_eq_u32 s36,5
s_cselect_b32 s54,2,s54
v_mov_b32 v252,s54
s_waitcnt vmcnt(16)
s_branch L_bulk_adv
L_e_da4:
s_waitcnt vmcnt(32)
v_accvgpr_read_b32 v24,a0
v_accvgpr_read_b32 v25,a1
v_accvgpr_read_b32 v26,a2
v_accvgpr_read_b32 v27,a3
v_accvgpr_read_b32 v28,a4
v_accvgpr_read_b32 v29,a5
v_accvgpr_read_b32 v30,a6
v_accvgpr_read_b32 v31,a7
v_accvgpr_read_b32 v48,a128
v_accvgpr_read_b32 v49,a129
v_accvgpr_read_b32 v50,a130
v_accvgpr_read_b32 v51,a131
v_cvt_pk_bf16_f32 v32,v24,v25
v_cvt_pk_bf16_f32 v33,v26,v27
v_cvt_pk_bf16_f32 v34,v28,v29
v_cvt_pk_bf16_f32 v35,v30,v31
v_lshlrev_b32 v24,16,v32
v_and_b32 v25,0xffff0000,v32
v_lshlrev_b32 v26,16,v33
v_and_b32 v27,0xffff0000,v33
v_lshlrev_b32 v28,16,v34
v_and_b32 v29,0xffff0000,v34
v_lshlrev_b32 v30,16,v35
v_and_b32 v31,0xffff0000,v35
v_pk_mul_f32 v[24:25],v[24:25],v[240:241] op_sel_hi:[1,0]
v_pk_mul_f32 v[26:27],v[26:27],v[240:241] op_sel_hi:[1,0]
v_pk_mul_f32 v[28:29],v[28:29],v[240:241] op_sel_hi:[1,0]
v_pk_mul_f32 v[30:31],v[30:31],v[240:241] op_sel_hi:[1,0]
v_cvt_pk_bf16_f32 v32,v24,v25
v_cvt_pk_bf16_f32 v33,v26,v27
v_cvt_pk_bf16_f32 v34,v28,v29
v_cvt_pk_bf16_f32 v35,v30,v31
v_lshlrev_b32 v24,16,v32
v_and_b32 v25,0xffff0000,v32
v_lshlrev_b32 v26,16,v33
v_and_b32 v27,0xffff0000,v33
v_lshlrev_b32 v28,16,v34
v_and_b32 v29,0xffff0000,v34
v_lshlrev_b32 v30,16,v35
v_and_b32 v31,0xffff0000,v35
v_lshlrev_b32 v40,16,v48
v_and_b32 v41,0xffff0000,v48
v_lshlrev_b32 v42,16,v49
v_and_b32 v43,0xffff0000,v49
v_lshlrev_b32 v44,16,v50
v_and_b32 v45,0xffff0000,v50
v_lshlrev_b32 v46,16,v51
v_and_b32 v47,0xffff0000,v51
v_pk_add_f32 v[24:25],v[24:25],v[40:41]
v_pk_add_f32 v[26:27],v[26:27],v[42:43]
v_pk_add_f32 v[28:29],v[28:29],v[44:45]
v_pk_add_f32 v[30:31],v[30:31],v[46:47]
v_cvt_pk_bf16_f32 v64,v24,v25
v_cvt_pk_bf16_f32 v65,v26,v27
v_cvt_pk_bf16_f32 v66,v28,v29
v_cvt_pk_bf16_f32 v67,v30,v31
s_nop 0
v_permlane16_swap_b32 v64,v66
v_permlane16_swap_b32 v65,v67
global_store_dwordx4 v214,v[64:67],s[44:45] offset:0 sc1
v_accvgpr_read_b32 v24,a8
v_accvgpr_read_b32 v25,a9
v_accvgpr_read_b32 v26,a10
v_accvgpr_read_b32 v27,a11
v_accvgpr_read_b32 v28,a12
v_accvgpr_read_b32 v29,a13
v_accvgpr_read_b32 v30,a14
v_accvgpr_read_b32 v31,a15
v_accvgpr_read_b32 v48,a132
v_accvgpr_read_b32 v49,a133
v_accvgpr_read_b32 v50,a134
v_accvgpr_read_b32 v51,a135
v_cvt_pk_bf16_f32 v32,v24,v25
v_cvt_pk_bf16_f32 v33,v26,v27
v_cvt_pk_bf16_f32 v34,v28,v29
v_cvt_pk_bf16_f32 v35,v30,v31
v_lshlrev_b32 v24,16,v32
v_and_b32 v25,0xffff0000,v32
v_lshlrev_b32 v26,16,v33
v_and_b32 v27,0xffff0000,v33
v_lshlrev_b32 v28,16,v34
v_and_b32 v29,0xffff0000,v34
v_lshlrev_b32 v30,16,v35
v_and_b32 v31,0xffff0000,v35
v_pk_mul_f32 v[24:25],v[24:25],v[240:241] op_sel_hi:[1,0]
v_pk_mul_f32 v[26:27],v[26:27],v[240:241] op_sel_hi:[1,0]
v_pk_mul_f32 v[28:29],v[28:29],v[240:241] op_sel_hi:[1,0]
v_pk_mul_f32 v[30:31],v[30:31],v[240:241] op_sel_hi:[1,0]
v_cvt_pk_bf16_f32 v32,v24,v25
v_cvt_pk_bf16_f32 v33,v26,v27
v_cvt_pk_bf16_f32 v34,v28,v29
v_cvt_pk_bf16_f32 v35,v30,v31
v_lshlrev_b32 v24,16,v32
v_and_b32 v25,0xffff0000,v32
v_lshlrev_b32 v26,16,v33
v_and_b32 v27,0xffff0000,v33
v_lshlrev_b32 v28,16,v34
v_and_b32 v29,0xffff0000,v34
v_lshlrev_b32 v30,16,v35
v_and_b32 v31,0xffff0000,v35
v_lshlrev_b32 v40,16,v48
v_and_b32 v41,0xffff0000,v48
v_lshlrev_b32 v42,16,v49
v_and_b32 v43,0xffff0000,v49
v_lshlrev_b32 v44,16,v50
v_and_b32 v45,0xffff0000,v50
v_lshlrev_b32 v46,16,v51
v_and_b32 v47,0xffff0000,v51
v_pk_add_f32 v[24:25],v[24:25],v[40:41]
v_pk_add_f32 v[26:27],v[26:27],v[42:43]
v_pk_add_f32 v[28:29],v[28:29],v[44:45]
v_pk_add_f32 v[30:31],v[30:31],v[46:47]
v_cvt_pk_bf16_f32 v68,v24,v25
v_cvt_pk_bf16_f32 v69,v26,v27
v_cvt_pk_bf16_f32 v70,v28,v29
v_cvt_pk_bf16_f32 v71,v30,v31
s_nop 0
v_permlane16_swap_b32 v68,v70
v_permlane16_swap_b32 v69,v71
global_store_dwordx4 v214,v[68:71],s[44:45] offset:64 sc1
v_accvgpr_read_b32 v24,a16
v_accvgpr_read_b32 v25,a17
v_accvgpr_read_b32 v26,a18
v_accvgpr_read_b32 v27,a19
v_accvgpr_read_b32 v28,a20
v_accvgpr_read_b32 v29,a21
v_accvgpr_read_b32 v30,a22
v_accvgpr_read_b32 v31,a23
v_accvgpr_read_b32 v48,a136
v_accvgpr_read_b32 v49,a137
v_accvgpr_read_b32 v50,a138
v_accvgpr_read_b32 v51,a139
v_cvt_pk_bf16_f32 v32,v24,v25
v_cvt_pk_bf16_f32 v33,v26,v27
v_cvt_pk_bf16_f32 v34,v28,v29
v_cvt_pk_bf16_f32 v35,v30,v31
v_lshlrev_b32 v24,16,v32
v_and_b32 v25,0xffff0000,v32
v_lshlrev_b32 v26,16,v33
v_and_b32 v27,0xffff0000,v33
v_lshlrev_b32 v28,16,v34
v_and_b32 v29,0xffff0000,v34
v_lshlrev_b32 v30,16,v35
v_and_b32 v31,0xffff0000,v35
v_pk_mul_f32 v[24:25],v[24:25],v[240:241] op_sel_hi:[1,0]
v_pk_mul_f32 v[26:27],v[26:27],v[240:241] op_sel_hi:[1,0]
v_pk_mul_f32 v[28:29],v[28:29],v[240:241] op_sel_hi:[1,0]
v_pk_mul_f32 v[30:31],v[30:31],v[240:241] op_sel_hi:[1,0]
v_cvt_pk_bf16_f32 v32,v24,v25
v_cvt_pk_bf16_f32 v33,v26,v27
v_cvt_pk_bf16_f32 v34,v28,v29
v_cvt_pk_bf16_f32 v35,v30,v31
v_lshlrev_b32 v24,16,v32
v_and_b32 v25,0xffff0000,v32
v_lshlrev_b32 v26,16,v33
v_and_b32 v27,0xffff0000,v33
v_lshlrev_b32 v28,16,v34
v_and_b32 v29,0xffff0000,v34
v_lshlrev_b32 v30,16,v35
v_and_b32 v31,0xffff0000,v35
v_lshlrev_b32 v40,16,v48
v_and_b32 v41,0xffff0000,v48
v_lshlrev_b32 v42,16,v49
v_and_b32 v43,0xffff0000,v49
v_lshlrev_b32 v44,16,v50
v_and_b32 v45,0xffff0000,v50
v_lshlrev_b32 v46,16,v51
v_and_b32 v47,0xffff0000,v51
v_pk_add_f32 v[24:25],v[24:25],v[40:41]
v_pk_add_f32 v[26:27],v[26:27],v[42:43]
v_pk_add_f32 v[28:29],v[28:29],v[44:45]
v_pk_add_f32 v[30:31],v[30:31],v[46:47]
v_cvt_pk_bf16_f32 v72,v24,v25
v_cvt_pk_bf16_f32 v73,v26,v27
v_cvt_pk_bf16_f32 v74,v28,v29
v_cvt_pk_bf16_f32 v75,v30,v31
s_nop 0
v_permlane16_swap_b32 v72,v74
v_permlane16_swap_b32 v73,v75
global_store_dwordx4 v214,v[72:75],s[44:45] offset:128 sc1
v_accvgpr_read_b32 v24,a24
v_accvgpr_read_b32 v25,a25
v_accvgpr_read_b32 v26,a26
v_accvgpr_read_b32 v27,a27
v_accvgpr_read_b32 v28,a28
v_accvgpr_read_b32 v29,a29
v_accvgpr_read_b32 v30,a30
v_accvgpr_read_b32 v31,a31
v_accvgpr_read_b32 v48,a140
v_accvgpr_read_b32 v49,a141
v_accvgpr_read_b32 v50,a142
v_accvgpr_read_b32 v51,a143
v_cvt_pk_bf16_f32 v32,v24,v25
v_cvt_pk_bf16_f32 v33,v26,v27
v_cvt_pk_bf16_f32 v34,v28,v29
v_cvt_pk_bf16_f32 v35,v30,v31
v_lshlrev_b32 v24,16,v32
v_and_b32 v25,0xffff0000,v32
v_lshlrev_b32 v26,16,v33
v_and_b32 v27,0xffff0000,v33
v_lshlrev_b32 v28,16,v34
v_and_b32 v29,0xffff0000,v34
v_lshlrev_b32 v30,16,v35
v_and_b32 v31,0xffff0000,v35
v_pk_mul_f32 v[24:25],v[24:25],v[240:241] op_sel_hi:[1,0]
v_pk_mul_f32 v[26:27],v[26:27],v[240:241] op_sel_hi:[1,0]
v_pk_mul_f32 v[28:29],v[28:29],v[240:241] op_sel_hi:[1,0]
v_pk_mul_f32 v[30:31],v[30:31],v[240:241] op_sel_hi:[1,0]
v_cvt_pk_bf16_f32 v32,v24,v25
v_cvt_pk_bf16_f32 v33,v26,v27
v_cvt_pk_bf16_f32 v34,v28,v29
v_cvt_pk_bf16_f32 v35,v30,v31
v_lshlrev_b32 v24,16,v32
v_and_b32 v25,0xffff0000,v32
v_lshlrev_b32 v26,16,v33
v_and_b32 v27,0xffff0000,v33
v_lshlrev_b32 v28,16,v34
v_and_b32 v29,0xffff0000,v34
v_lshlrev_b32 v30,16,v35
v_and_b32 v31,0xffff0000,v35
v_lshlrev_b32 v40,16,v48
v_and_b32 v41,0xffff0000,v48
v_lshlrev_b32 v42,16,v49
v_and_b32 v43,0xffff0000,v49
v_lshlrev_b32 v44,16,v50
v_and_b32 v45,0xffff0000,v50
v_lshlrev_b32 v46,16,v51
v_and_b32 v47,0xffff0000,v51
v_pk_add_f32 v[24:25],v[24:25],v[40:41]
v_pk_add_f32 v[26:27],v[26:27],v[42:43]
v_pk_add_f32 v[28:29],v[28:29],v[44:45]
v_pk_add_f32 v[30:31],v[30:31],v[46:47]
v_cvt_pk_bf16_f32 v76,v24,v25
v_cvt_pk_bf16_f32 v77,v26,v27
v_cvt_pk_bf16_f32 v78,v28,v29
v_cvt_pk_bf16_f32 v79,v30,v31
s_nop 0
v_permlane16_swap_b32 v76,v78
v_permlane16_swap_b32 v77,v79
global_store_dwordx4 v214,v[76:79],s[44:45] offset:192 sc1
s_add_u32 s44,s44,32768
s_addc_u32 s45,s45,0
v_accvgpr_read_b32 v24,a32
v_accvgpr_read_b32 v25,a33
v_accvgpr_read_b32 v26,a34
v_accvgpr_read_b32 v27,a35
v_accvgpr_read_b32 v28,a36
v_accvgpr_read_b32 v29,a37
v_accvgpr_read_b32 v30,a38
v_accvgpr_read_b32 v31,a39
v_accvgpr_read_b32 v48,a144
v_accvgpr_read_b32 v49,a145
v_accvgpr_read_b32 v50,a146
v_accvgpr_read_b32 v51,a147
v_cvt_pk_bf16_f32 v32,v24,v25
v_cvt_pk_bf16_f32 v33,v26,v27
v_cvt_pk_bf16_f32 v34,v28,v29
v_cvt_pk_bf16_f32 v35,v30,v31
v_lshlrev_b32 v24,16,v32
v_and_b32 v25,0xffff0000,v32
v_lshlrev_b32 v26,16,v33
v_and_b32 v27,0xffff0000,v33
v_lshlrev_b32 v28,16,v34
v_and_b32 v29,0xffff0000,v34
v_lshlrev_b32 v30,16,v35
v_and_b32 v31,0xffff0000,v35
v_pk_mul_f32 v[24:25],v[24:25],v[242:243] op_sel_hi:[1,0]
v_pk_mul_f32 v[26:27],v[26:27],v[242:243] op_sel_hi:[1,0]
v_pk_mul_f32 v[28:29],v[28:29],v[242:243] op_sel_hi:[1,0]
v_pk_mul_f32 v[30:31],v[30:31],v[242:243] op_sel_hi:[1,0]
v_cvt_pk_bf16_f32 v32,v24,v25
v_cvt_pk_bf16_f32 v33,v26,v27
v_cvt_pk_bf16_f32 v34,v28,v29
v_cvt_pk_bf16_f32 v35,v30,v31
v_lshlrev_b32 v24,16,v32
v_and_b32 v25,0xffff0000,v32
v_lshlrev_b32 v26,16,v33
v_and_b32 v27,0xffff0000,v33
v_lshlrev_b32 v28,16,v34
v_and_b32 v29,0xffff0000,v34
v_lshlrev_b32 v30,16,v35
v_and_b32 v31,0xffff0000,v35
v_lshlrev_b32 v40,16,v48
v_and_b32 v41,0xffff0000,v48
v_lshlrev_b32 v42,16,v49
v_and_b32 v43,0xffff0000,v49
v_lshlrev_b32 v44,16,v50
v_and_b32 v45,0xffff0000,v50
v_lshlrev_b32 v46,16,v51
v_and_b32 v47,0xffff0000,v51
v_pk_add_f32 v[24:25],v[24:25],v[40:41]
v_pk_add_f32 v[26:27],v[26:27],v[42:43]
v_pk_add_f32 v[28:29],v[28:29],v[44:45]
v_pk_add_f32 v[30:31],v[30:31],v[46:47]
v_cvt_pk_bf16_f32 v80,v24,v25
v_cvt_pk_bf16_f32 v81,v26,v27
v_cvt_pk_bf16_f32 v82,v28,v29
v_cvt_pk_bf16_f32 v83,v30,v31
s_nop 0
v_permlane16_swap_b32 v80,v82
v_permlane16_swap_b32 v81,v83
global_store_dwordx4 v214,v[80:83],s[44:45] offset:0 sc1
v_accvgpr_read_b32 v24,a40
v_accvgpr_read_b32 v25,a41
v_accvgpr_read_b32 v26,a42
v_accvgpr_read_b32 v27,a43
v_accvgpr_read_b32 v28,a44
v_accvgpr_read_b32 v29,a45
v_accvgpr_read_b32 v30,a46
v_accvgpr_read_b32 v31,a47
v_accvgpr_read_b32 v48,a148
v_accvgpr_read_b32 v49,a149
v_accvgpr_read_b32 v50,a150
v_accvgpr_read_b32 v51,a151
v_cvt_pk_bf16_f32 v32,v24,v25
v_cvt_pk_bf16_f32 v33,v26,v27
v_cvt_pk_bf16_f32 v34,v28,v29
v_cvt_pk_bf16_f32 v35,v30,v31
v_lshlrev_b32 v24,16,v32
v_and_b32 v25,0xffff0000,v32
v_lshlrev_b32 v26,16,v33
v_and_b32 v27,0xffff0000,v33
v_lshlrev_b32 v28,16,v34
v_and_b32 v29,0xffff0000,v34
v_lshlrev_b32 v30,16,v35
v_and_b32 v31,0xffff0000,v35
v_pk_mul_f32 v[24:25],v[24:25],v[242:243] op_sel_hi:[1,0]
v_pk_mul_f32 v[26:27],v[26:27],v[242:243] op_sel_hi:[1,0]
v_pk_mul_f32 v[28:29],v[28:29],v[242:243] op_sel_hi:[1,0]
v_pk_mul_f32 v[30:31],v[30:31],v[242:243] op_sel_hi:[1,0]
v_cvt_pk_bf16_f32 v32,v24,v25
v_cvt_pk_bf16_f32 v33,v26,v27
v_cvt_pk_bf16_f32 v34,v28,v29
v_cvt_pk_bf16_f32 v35,v30,v31
v_lshlrev_b32 v24,16,v32
v_and_b32 v25,0xffff0000,v32
v_lshlrev_b32 v26,16,v33
v_and_b32 v27,0xffff0000,v33
v_lshlrev_b32 v28,16,v34
v_and_b32 v29,0xffff0000,v34
v_lshlrev_b32 v30,16,v35
v_and_b32 v31,0xffff0000,v35
v_lshlrev_b32 v40,16,v48
v_and_b32 v41,0xffff0000,v48
v_lshlrev_b32 v42,16,v49
v_and_b32 v43,0xffff0000,v49
v_lshlrev_b32 v44,16,v50
v_and_b32 v45,0xffff0000,v50
v_lshlrev_b32 v46,16,v51
v_and_b32 v47,0xffff0000,v51
v_pk_add_f32 v[24:25],v[24:25],v[40:41]
v_pk_add_f32 v[26:27],v[26:27],v[42:43]
v_pk_add_f32 v[28:29],v[28:29],v[44:45]
v_pk_add_f32 v[30:31],v[30:31],v[46:47]
v_cvt_pk_bf16_f32 v84,v24,v25
v_cvt_pk_bf16_f32 v85,v26,v27
v_cvt_pk_bf16_f32 v86,v28,v29
v_cvt_pk_bf16_f32 v87,v30,v31
s_nop 0
v_permlane16_swap_b32 v84,v86
v_permlane16_swap_b32 v85,v87
global_store_dwordx4 v214,v[84:87],s[44:45] offset:64 sc1
v_accvgpr_read_b32 v24,a48
v_accvgpr_read_b32 v25,a49
v_accvgpr_read_b32 v26,a50
v_accvgpr_read_b32 v27,a51
v_accvgpr_read_b32 v28,a52
v_accvgpr_read_b32 v29,a53
v_accvgpr_read_b32 v30,a54
v_accvgpr_read_b32 v31,a55
v_accvgpr_read_b32 v48,a152
v_accvgpr_read_b32 v49,a153
v_accvgpr_read_b32 v50,a154
v_accvgpr_read_b32 v51,a155
v_cvt_pk_bf16_f32 v32,v24,v25
v_cvt_pk_bf16_f32 v33,v26,v27
v_cvt_pk_bf16_f32 v34,v28,v29
v_cvt_pk_bf16_f32 v35,v30,v31
v_lshlrev_b32 v24,16,v32
v_and_b32 v25,0xffff0000,v32
v_lshlrev_b32 v26,16,v33
v_and_b32 v27,0xffff0000,v33
v_lshlrev_b32 v28,16,v34
v_and_b32 v29,0xffff0000,v34
v_lshlrev_b32 v30,16,v35
v_and_b32 v31,0xffff0000,v35
v_pk_mul_f32 v[24:25],v[24:25],v[242:243] op_sel_hi:[1,0]
v_pk_mul_f32 v[26:27],v[26:27],v[242:243] op_sel_hi:[1,0]
v_pk_mul_f32 v[28:29],v[28:29],v[242:243] op_sel_hi:[1,0]
v_pk_mul_f32 v[30:31],v[30:31],v[242:243] op_sel_hi:[1,0]
v_cvt_pk_bf16_f32 v32,v24,v25
v_cvt_pk_bf16_f32 v33,v26,v27
v_cvt_pk_bf16_f32 v34,v28,v29
v_cvt_pk_bf16_f32 v35,v30,v31
v_lshlrev_b32 v24,16,v32
v_and_b32 v25,0xffff0000,v32
v_lshlrev_b32 v26,16,v33
v_and_b32 v27,0xffff0000,v33
v_lshlrev_b32 v28,16,v34
v_and_b32 v29,0xffff0000,v34
v_lshlrev_b32 v30,16,v35
v_and_b32 v31,0xffff0000,v35
v_lshlrev_b32 v40,16,v48
v_and_b32 v41,0xffff0000,v48
v_lshlrev_b32 v42,16,v49
v_and_b32 v43,0xffff0000,v49
v_lshlrev_b32 v44,16,v50
v_and_b32 v45,0xffff0000,v50
v_lshlrev_b32 v46,16,v51
v_and_b32 v47,0xffff0000,v51
v_pk_add_f32 v[24:25],v[24:25],v[40:41]
v_pk_add_f32 v[26:27],v[26:27],v[42:43]
v_pk_add_f32 v[28:29],v[28:29],v[44:45]
v_pk_add_f32 v[30:31],v[30:31],v[46:47]
v_cvt_pk_bf16_f32 v88,v24,v25
v_cvt_pk_bf16_f32 v89,v26,v27
v_cvt_pk_bf16_f32 v90,v28,v29
v_cvt_pk_bf16_f32 v91,v30,v31
s_nop 0
v_permlane16_swap_b32 v88,v90
v_permlane16_swap_b32 v89,v91
global_store_dwordx4 v214,v[88:91],s[44:45] offset:128 sc1
v_accvgpr_read_b32 v24,a56
v_accvgpr_read_b32 v25,a57
v_accvgpr_read_b32 v26,a58
v_accvgpr_read_b32 v27,a59
v_accvgpr_read_b32 v28,a60
v_accvgpr_read_b32 v29,a61
v_accvgpr_read_b32 v30,a62
v_accvgpr_read_b32 v31,a63
v_accvgpr_read_b32 v48,a156
v_accvgpr_read_b32 v49,a157
v_accvgpr_read_b32 v50,a158
v_accvgpr_read_b32 v51,a159
v_cvt_pk_bf16_f32 v32,v24,v25
v_cvt_pk_bf16_f32 v33,v26,v27
v_cvt_pk_bf16_f32 v34,v28,v29
v_cvt_pk_bf16_f32 v35,v30,v31
v_lshlrev_b32 v24,16,v32
v_and_b32 v25,0xffff0000,v32
v_lshlrev_b32 v26,16,v33
v_and_b32 v27,0xffff0000,v33
v_lshlrev_b32 v28,16,v34
v_and_b32 v29,0xffff0000,v34
v_lshlrev_b32 v30,16,v35
v_and_b32 v31,0xffff0000,v35
v_pk_mul_f32 v[24:25],v[24:25],v[242:243] op_sel_hi:[1,0]
v_pk_mul_f32 v[26:27],v[26:27],v[242:243] op_sel_hi:[1,0]
v_pk_mul_f32 v[28:29],v[28:29],v[242:243] op_sel_hi:[1,0]
v_pk_mul_f32 v[30:31],v[30:31],v[242:243] op_sel_hi:[1,0]
v_cvt_pk_bf16_f32 v32,v24,v25
v_cvt_pk_bf16_f32 v33,v26,v27
v_cvt_pk_bf16_f32 v34,v28,v29
v_cvt_pk_bf16_f32 v35,v30,v31
v_lshlrev_b32 v24,16,v32
v_and_b32 v25,0xffff0000,v32
v_lshlrev_b32 v26,16,v33
v_and_b32 v27,0xffff0000,v33
v_lshlrev_b32 v28,16,v34
v_and_b32 v29,0xffff0000,v34
v_lshlrev_b32 v30,16,v35
v_and_b32 v31,0xffff0000,v35
v_lshlrev_b32 v40,16,v48
v_and_b32 v41,0xffff0000,v48
v_lshlrev_b32 v42,16,v49
v_and_b32 v43,0xffff0000,v49
v_lshlrev_b32 v44,16,v50
v_and_b32 v45,0xffff0000,v50
v_lshlrev_b32 v46,16,v51
v_and_b32 v47,0xffff0000,v51
v_pk_add_f32 v[24:25],v[24:25],v[40:41]
v_pk_add_f32 v[26:27],v[26:27],v[42:43]
v_pk_add_f32 v[28:29],v[28:29],v[44:45]
v_pk_add_f32 v[30:31],v[30:31],v[46:47]
v_cvt_pk_bf16_f32 v92,v24,v25
v_cvt_pk_bf16_f32 v93,v26,v27
v_cvt_pk_bf16_f32 v94,v28,v29
v_cvt_pk_bf16_f32 v95,v30,v31
s_nop 0
v_permlane16_swap_b32 v92,v94
v_permlane16_swap_b32 v93,v95
global_store_dwordx4 v214,v[92:95],s[44:45] offset:192 sc1
s_add_u32 s44,s44,32768
s_addc_u32 s45,s45,0
v_accvgpr_read_b32 v24,a64
v_accvgpr_read_b32 v25,a65
v_accvgpr_read_b32 v26,a66
v_accvgpr_read_b32 v27,a67
v_accvgpr_read_b32 v28,a68
v_accvgpr_read_b32 v29,a69
v_accvgpr_read_b32 v30,a70
v_accvgpr_read_b32 v31,a71
v_accvgpr_read_b32 v48,a160
v_accvgpr_read_b32 v49,a161
v_accvgpr_read_b32 v50,a162
v_accvgpr_read_b32 v51,a163
v_cvt_pk_bf16_f32 v32,v24,v25
v_cvt_pk_bf16_f32 v33,v26,v27
v_cvt_pk_bf16_f32 v34,v28,v29
v_cvt_pk_bf16_f32 v35,v30,v31
v_lshlrev_b32 v24,16,v32
v_and_b32 v25,0xffff0000,v32
v_lshlrev_b32 v26,16,v33
v_and_b32 v27,0xffff0000,v33
v_lshlrev_b32 v28,16,v34
v_and_b32 v29,0xffff0000,v34
v_lshlrev_b32 v30,16,v35
v_and_b32 v31,0xffff0000,v35
v_pk_mul_f32 v[24:25],v[24:25],v[244:245] op_sel_hi:[1,0]
v_pk_mul_f32 v[26:27],v[26:27],v[244:245] op_sel_hi:[1,0]
v_pk_mul_f32 v[28:29],v[28:29],v[244:245] op_sel_hi:[1,0]
v_pk_mul_f32 v[30:31],v[30:31],v[244:245] op_sel_hi:[1,0]
v_cvt_pk_bf16_f32 v32,v24,v25
v_cvt_pk_bf16_f32 v33,v26,v27
v_cvt_pk_bf16_f32 v34,v28,v29
v_cvt_pk_bf16_f32 v35,v30,v31
v_lshlrev_b32 v24,16,v32
v_and_b32 v25,0xffff0000,v32
v_lshlrev_b32 v26,16,v33
v_and_b32 v27,0xffff0000,v33
v_lshlrev_b32 v28,16,v34
v_and_b32 v29,0xffff0000,v34
v_lshlrev_b32 v30,16,v35
v_and_b32 v31,0xffff0000,v35
v_lshlrev_b32 v40,16,v48
v_and_b32 v41,0xffff0000,v48
v_lshlrev_b32 v42,16,v49
v_and_b32 v43,0xffff0000,v49
v_lshlrev_b32 v44,16,v50
v_and_b32 v45,0xffff0000,v50
v_lshlrev_b32 v46,16,v51
v_and_b32 v47,0xffff0000,v51
v_pk_add_f32 v[24:25],v[24:25],v[40:41]
v_pk_add_f32 v[26:27],v[26:27],v[42:43]
v_pk_add_f32 v[28:29],v[28:29],v[44:45]
v_pk_add_f32 v[30:31],v[30:31],v[46:47]
v_cvt_pk_bf16_f32 v96,v24,v25
v_cvt_pk_bf16_f32 v97,v26,v27
v_cvt_pk_bf16_f32 v98,v28,v29
v_cvt_pk_bf16_f32 v99,v30,v31
s_nop 0
v_permlane16_swap_b32 v96,v98
v_permlane16_swap_b32 v97,v99
global_store_dwordx4 v214,v[96:99],s[44:45] offset:0 sc1
v_accvgpr_read_b32 v24,a72
v_accvgpr_read_b32 v25,a73
v_accvgpr_read_b32 v26,a74
v_accvgpr_read_b32 v27,a75
v_accvgpr_read_b32 v28,a76
v_accvgpr_read_b32 v29,a77
v_accvgpr_read_b32 v30,a78
v_accvgpr_read_b32 v31,a79
v_accvgpr_read_b32 v48,a164
v_accvgpr_read_b32 v49,a165
v_accvgpr_read_b32 v50,a166
v_accvgpr_read_b32 v51,a167
v_cvt_pk_bf16_f32 v32,v24,v25
v_cvt_pk_bf16_f32 v33,v26,v27
v_cvt_pk_bf16_f32 v34,v28,v29
v_cvt_pk_bf16_f32 v35,v30,v31
v_lshlrev_b32 v24,16,v32
v_and_b32 v25,0xffff0000,v32
v_lshlrev_b32 v26,16,v33
v_and_b32 v27,0xffff0000,v33
v_lshlrev_b32 v28,16,v34
v_and_b32 v29,0xffff0000,v34
v_lshlrev_b32 v30,16,v35
v_and_b32 v31,0xffff0000,v35
v_pk_mul_f32 v[24:25],v[24:25],v[244:245] op_sel_hi:[1,0]
v_pk_mul_f32 v[26:27],v[26:27],v[244:245] op_sel_hi:[1,0]
v_pk_mul_f32 v[28:29],v[28:29],v[244:245] op_sel_hi:[1,0]
v_pk_mul_f32 v[30:31],v[30:31],v[244:245] op_sel_hi:[1,0]
v_cvt_pk_bf16_f32 v32,v24,v25
v_cvt_pk_bf16_f32 v33,v26,v27
v_cvt_pk_bf16_f32 v34,v28,v29
v_cvt_pk_bf16_f32 v35,v30,v31
v_lshlrev_b32 v24,16,v32
v_and_b32 v25,0xffff0000,v32
v_lshlrev_b32 v26,16,v33
v_and_b32 v27,0xffff0000,v33
v_lshlrev_b32 v28,16,v34
v_and_b32 v29,0xffff0000,v34
v_lshlrev_b32 v30,16,v35
v_and_b32 v31,0xffff0000,v35
v_lshlrev_b32 v40,16,v48
v_and_b32 v41,0xffff0000,v48
v_lshlrev_b32 v42,16,v49
v_and_b32 v43,0xffff0000,v49
v_lshlrev_b32 v44,16,v50
v_and_b32 v45,0xffff0000,v50
v_lshlrev_b32 v46,16,v51
v_and_b32 v47,0xffff0000,v51
v_pk_add_f32 v[24:25],v[24:25],v[40:41]
v_pk_add_f32 v[26:27],v[26:27],v[42:43]
v_pk_add_f32 v[28:29],v[28:29],v[44:45]
v_pk_add_f32 v[30:31],v[30:31],v[46:47]
v_cvt_pk_bf16_f32 v100,v24,v25
v_cvt_pk_bf16_f32 v101,v26,v27
v_cvt_pk_bf16_f32 v102,v28,v29
v_cvt_pk_bf16_f32 v103,v30,v31
s_nop 0
v_permlane16_swap_b32 v100,v102
v_permlane16_swap_b32 v101,v103
global_store_dwordx4 v214,v[100:103],s[44:45] offset:64 sc1
v_accvgpr_read_b32 v24,a80
v_accvgpr_read_b32 v25,a81
v_accvgpr_read_b32 v26,a82
v_accvgpr_read_b32 v27,a83
v_accvgpr_read_b32 v28,a84
v_accvgpr_read_b32 v29,a85
v_accvgpr_read_b32 v30,a86
v_accvgpr_read_b32 v31,a87
v_accvgpr_read_b32 v48,a168
v_accvgpr_read_b32 v49,a169
v_accvgpr_read_b32 v50,a170
v_accvgpr_read_b32 v51,a171
v_cvt_pk_bf16_f32 v32,v24,v25
v_cvt_pk_bf16_f32 v33,v26,v27
v_cvt_pk_bf16_f32 v34,v28,v29
v_cvt_pk_bf16_f32 v35,v30,v31
v_lshlrev_b32 v24,16,v32
v_and_b32 v25,0xffff0000,v32
v_lshlrev_b32 v26,16,v33
v_and_b32 v27,0xffff0000,v33
v_lshlrev_b32 v28,16,v34
v_and_b32 v29,0xffff0000,v34
v_lshlrev_b32 v30,16,v35
v_and_b32 v31,0xffff0000,v35
v_pk_mul_f32 v[24:25],v[24:25],v[244:245] op_sel_hi:[1,0]
v_pk_mul_f32 v[26:27],v[26:27],v[244:245] op_sel_hi:[1,0]
v_pk_mul_f32 v[28:29],v[28:29],v[244:245] op_sel_hi:[1,0]
v_pk_mul_f32 v[30:31],v[30:31],v[244:245] op_sel_hi:[1,0]
v_cvt_pk_bf16_f32 v32,v24,v25
v_cvt_pk_bf16_f32 v33,v26,v27
v_cvt_pk_bf16_f32 v34,v28,v29
v_cvt_pk_bf16_f32 v35,v30,v31
v_lshlrev_b32 v24,16,v32
v_and_b32 v25,0xffff0000,v32
v_lshlrev_b32 v26,16,v33
v_and_b32 v27,0xffff0000,v33
v_lshlrev_b32 v28,16,v34
v_and_b32 v29,0xffff0000,v34
v_lshlrev_b32 v30,16,v35
v_and_b32 v31,0xffff0000,v35
v_lshlrev_b32 v40,16,v48
v_and_b32 v41,0xffff0000,v48
v_lshlrev_b32 v42,16,v49
v_and_b32 v43,0xffff0000,v49
v_lshlrev_b32 v44,16,v50
v_and_b32 v45,0xffff0000,v50
v_lshlrev_b32 v46,16,v51
v_and_b32 v47,0xffff0000,v51
v_pk_add_f32 v[24:25],v[24:25],v[40:41]
v_pk_add_f32 v[26:27],v[26:27],v[42:43]
v_pk_add_f32 v[28:29],v[28:29],v[44:45]
v_pk_add_f32 v[30:31],v[30:31],v[46:47]
v_cvt_pk_bf16_f32 v104,v24,v25
v_cvt_pk_bf16_f32 v105,v26,v27
v_cvt_pk_bf16_f32 v106,v28,v29
v_cvt_pk_bf16_f32 v107,v30,v31
s_nop 0
v_permlane16_swap_b32 v104,v106
v_permlane16_swap_b32 v105,v107
global_store_dwordx4 v214,v[104:107],s[44:45] offset:128 sc1
v_accvgpr_read_b32 v24,a88
v_accvgpr_read_b32 v25,a89
v_accvgpr_read_b32 v26,a90
v_accvgpr_read_b32 v27,a91
v_accvgpr_read_b32 v28,a92
v_accvgpr_read_b32 v29,a93
v_accvgpr_read_b32 v30,a94
v_accvgpr_read_b32 v31,a95
v_accvgpr_read_b32 v48,a172
v_accvgpr_read_b32 v49,a173
v_accvgpr_read_b32 v50,a174
v_accvgpr_read_b32 v51,a175
v_cvt_pk_bf16_f32 v32,v24,v25
v_cvt_pk_bf16_f32 v33,v26,v27
v_cvt_pk_bf16_f32 v34,v28,v29
v_cvt_pk_bf16_f32 v35,v30,v31
v_lshlrev_b32 v24,16,v32
v_and_b32 v25,0xffff0000,v32
v_lshlrev_b32 v26,16,v33
v_and_b32 v27,0xffff0000,v33
v_lshlrev_b32 v28,16,v34
v_and_b32 v29,0xffff0000,v34
v_lshlrev_b32 v30,16,v35
v_and_b32 v31,0xffff0000,v35
v_pk_mul_f32 v[24:25],v[24:25],v[244:245] op_sel_hi:[1,0]
v_pk_mul_f32 v[26:27],v[26:27],v[244:245] op_sel_hi:[1,0]
v_pk_mul_f32 v[28:29],v[28:29],v[244:245] op_sel_hi:[1,0]
v_pk_mul_f32 v[30:31],v[30:31],v[244:245] op_sel_hi:[1,0]
v_cvt_pk_bf16_f32 v32,v24,v25
v_cvt_pk_bf16_f32 v33,v26,v27
v_cvt_pk_bf16_f32 v34,v28,v29
v_cvt_pk_bf16_f32 v35,v30,v31
v_lshlrev_b32 v24,16,v32
v_and_b32 v25,0xffff0000,v32
v_lshlrev_b32 v26,16,v33
v_and_b32 v27,0xffff0000,v33
v_lshlrev_b32 v28,16,v34
v_and_b32 v29,0xffff0000,v34
v_lshlrev_b32 v30,16,v35
v_and_b32 v31,0xffff0000,v35
v_lshlrev_b32 v40,16,v48
v_and_b32 v41,0xffff0000,v48
v_lshlrev_b32 v42,16,v49
v_and_b32 v43,0xffff0000,v49
v_lshlrev_b32 v44,16,v50
v_and_b32 v45,0xffff0000,v50
v_lshlrev_b32 v46,16,v51
v_and_b32 v47,0xffff0000,v51
v_pk_add_f32 v[24:25],v[24:25],v[40:41]
v_pk_add_f32 v[26:27],v[26:27],v[42:43]
v_pk_add_f32 v[28:29],v[28:29],v[44:45]
v_pk_add_f32 v[30:31],v[30:31],v[46:47]
v_cvt_pk_bf16_f32 v108,v24,v25
v_cvt_pk_bf16_f32 v109,v26,v27
v_cvt_pk_bf16_f32 v110,v28,v29
v_cvt_pk_bf16_f32 v111,v30,v31
s_nop 0
v_permlane16_swap_b32 v108,v110
v_permlane16_swap_b32 v109,v111
global_store_dwordx4 v214,v[108:111],s[44:45] offset:192 sc1
s_add_u32 s44,s44,32768
s_addc_u32 s45,s45,0
v_accvgpr_read_b32 v24,a96
v_accvgpr_read_b32 v25,a97
v_accvgpr_read_b32 v26,a98
v_accvgpr_read_b32 v27,a99
v_accvgpr_read_b32 v28,a100
v_accvgpr_read_b32 v29,a101
v_accvgpr_read_b32 v30,a102
v_accvgpr_read_b32 v31,a103
v_accvgpr_read_b32 v48,a176
v_accvgpr_read_b32 v49,a177
v_accvgpr_read_b32 v50,a178
v_accvgpr_read_b32 v51,a179
v_cvt_pk_bf16_f32 v32,v24,v25
v_cvt_pk_bf16_f32 v33,v26,v27
v_cvt_pk_bf16_f32 v34,v28,v29
v_cvt_pk_bf16_f32 v35,v30,v31
v_lshlrev_b32 v24,16,v32
v_and_b32 v25,0xffff0000,v32
v_lshlrev_b32 v26,16,v33
v_and_b32 v27,0xffff0000,v33
v_lshlrev_b32 v28,16,v34
v_and_b32 v29,0xffff0000,v34
v_lshlrev_b32 v30,16,v35
v_and_b32 v31,0xffff0000,v35
v_pk_mul_f32 v[24:25],v[24:25],v[246:247] op_sel_hi:[1,0]
v_pk_mul_f32 v[26:27],v[26:27],v[246:247] op_sel_hi:[1,0]
v_pk_mul_f32 v[28:29],v[28:29],v[246:247] op_sel_hi:[1,0]
v_pk_mul_f32 v[30:31],v[30:31],v[246:247] op_sel_hi:[1,0]
v_cvt_pk_bf16_f32 v32,v24,v25
v_cvt_pk_bf16_f32 v33,v26,v27
v_cvt_pk_bf16_f32 v34,v28,v29
v_cvt_pk_bf16_f32 v35,v30,v31
v_lshlrev_b32 v24,16,v32
v_and_b32 v25,0xffff0000,v32
v_lshlrev_b32 v26,16,v33
v_and_b32 v27,0xffff0000,v33
v_lshlrev_b32 v28,16,v34
v_and_b32 v29,0xffff0000,v34
v_lshlrev_b32 v30,16,v35
v_and_b32 v31,0xffff0000,v35
v_lshlrev_b32 v40,16,v48
v_and_b32 v41,0xffff0000,v48
v_lshlrev_b32 v42,16,v49
v_and_b32 v43,0xffff0000,v49
v_lshlrev_b32 v44,16,v50
v_and_b32 v45,0xffff0000,v50
v_lshlrev_b32 v46,16,v51
v_and_b32 v47,0xffff0000,v51
v_pk_add_f32 v[24:25],v[24:25],v[40:41]
v_pk_add_f32 v[26:27],v[26:27],v[42:43]
v_pk_add_f32 v[28:29],v[28:29],v[44:45]
v_pk_add_f32 v[30:31],v[30:31],v[46:47]
v_cvt_pk_bf16_f32 v112,v24,v25
v_cvt_pk_bf16_f32 v113,v26,v27
v_cvt_pk_bf16_f32 v114,v28,v29
v_cvt_pk_bf16_f32 v115,v30,v31
s_nop 0
v_permlane16_swap_b32 v112,v114
v_permlane16_swap_b32 v113,v115
global_store_dwordx4 v214,v[112:115],s[44:45] offset:0 sc1
v_accvgpr_read_b32 v24,a104
v_accvgpr_read_b32 v25,a105
v_accvgpr_read_b32 v26,a106
v_accvgpr_read_b32 v27,a107
v_accvgpr_read_b32 v28,a108
v_accvgpr_read_b32 v29,a109
v_accvgpr_read_b32 v30,a110
v_accvgpr_read_b32 v31,a111
v_accvgpr_read_b32 v48,a180
v_accvgpr_read_b32 v49,a181
v_accvgpr_read_b32 v50,a182
v_accvgpr_read_b32 v51,a183
v_cvt_pk_bf16_f32 v32,v24,v25
v_cvt_pk_bf16_f32 v33,v26,v27
v_cvt_pk_bf16_f32 v34,v28,v29
v_cvt_pk_bf16_f32 v35,v30,v31
v_lshlrev_b32 v24,16,v32
v_and_b32 v25,0xffff0000,v32
v_lshlrev_b32 v26,16,v33
v_and_b32 v27,0xffff0000,v33
v_lshlrev_b32 v28,16,v34
v_and_b32 v29,0xffff0000,v34
v_lshlrev_b32 v30,16,v35
v_and_b32 v31,0xffff0000,v35
v_pk_mul_f32 v[24:25],v[24:25],v[246:247] op_sel_hi:[1,0]
v_pk_mul_f32 v[26:27],v[26:27],v[246:247] op_sel_hi:[1,0]
v_pk_mul_f32 v[28:29],v[28:29],v[246:247] op_sel_hi:[1,0]
v_pk_mul_f32 v[30:31],v[30:31],v[246:247] op_sel_hi:[1,0]
v_cvt_pk_bf16_f32 v32,v24,v25
v_cvt_pk_bf16_f32 v33,v26,v27
v_cvt_pk_bf16_f32 v34,v28,v29
v_cvt_pk_bf16_f32 v35,v30,v31
v_lshlrev_b32 v24,16,v32
v_and_b32 v25,0xffff0000,v32
v_lshlrev_b32 v26,16,v33
v_and_b32 v27,0xffff0000,v33
v_lshlrev_b32 v28,16,v34
v_and_b32 v29,0xffff0000,v34
v_lshlrev_b32 v30,16,v35
v_and_b32 v31,0xffff0000,v35
v_lshlrev_b32 v40,16,v48
v_and_b32 v41,0xffff0000,v48
v_lshlrev_b32 v42,16,v49
v_and_b32 v43,0xffff0000,v49
v_lshlrev_b32 v44,16,v50
v_and_b32 v45,0xffff0000,v50
v_lshlrev_b32 v46,16,v51
v_and_b32 v47,0xffff0000,v51
v_pk_add_f32 v[24:25],v[24:25],v[40:41]
v_pk_add_f32 v[26:27],v[26:27],v[42:43]
v_pk_add_f32 v[28:29],v[28:29],v[44:45]
v_pk_add_f32 v[30:31],v[30:31],v[46:47]
v_cvt_pk_bf16_f32 v116,v24,v25
v_cvt_pk_bf16_f32 v117,v26,v27
v_cvt_pk_bf16_f32 v118,v28,v29
v_cvt_pk_bf16_f32 v119,v30,v31
s_nop 0
v_permlane16_swap_b32 v116,v118
v_permlane16_swap_b32 v117,v119
global_store_dwordx4 v214,v[116:119],s[44:45] offset:64 sc1
v_accvgpr_read_b32 v24,a112
v_accvgpr_read_b32 v25,a113
v_accvgpr_read_b32 v26,a114
v_accvgpr_read_b32 v27,a115
v_accvgpr_read_b32 v28,a116
v_accvgpr_read_b32 v29,a117
v_accvgpr_read_b32 v30,a118
v_accvgpr_read_b32 v31,a119
v_accvgpr_read_b32 v48,a184
v_accvgpr_read_b32 v49,a185
v_accvgpr_read_b32 v50,a186
v_accvgpr_read_b32 v51,a187
v_cvt_pk_bf16_f32 v32,v24,v25
v_cvt_pk_bf16_f32 v33,v26,v27
v_cvt_pk_bf16_f32 v34,v28,v29
v_cvt_pk_bf16_f32 v35,v30,v31
v_lshlrev_b32 v24,16,v32
v_and_b32 v25,0xffff0000,v32
v_lshlrev_b32 v26,16,v33
v_and_b32 v27,0xffff0000,v33
v_lshlrev_b32 v28,16,v34
v_and_b32 v29,0xffff0000,v34
v_lshlrev_b32 v30,16,v35
v_and_b32 v31,0xffff0000,v35
v_pk_mul_f32 v[24:25],v[24:25],v[246:247] op_sel_hi:[1,0]
v_pk_mul_f32 v[26:27],v[26:27],v[246:247] op_sel_hi:[1,0]
v_pk_mul_f32 v[28:29],v[28:29],v[246:247] op_sel_hi:[1,0]
v_pk_mul_f32 v[30:31],v[30:31],v[246:247] op_sel_hi:[1,0]
v_cvt_pk_bf16_f32 v32,v24,v25
v_cvt_pk_bf16_f32 v33,v26,v27
v_cvt_pk_bf16_f32 v34,v28,v29
v_cvt_pk_bf16_f32 v35,v30,v31
v_lshlrev_b32 v24,16,v32
v_and_b32 v25,0xffff0000,v32
v_lshlrev_b32 v26,16,v33
v_and_b32 v27,0xffff0000,v33
v_lshlrev_b32 v28,16,v34
v_and_b32 v29,0xffff0000,v34
v_lshlrev_b32 v30,16,v35
v_and_b32 v31,0xffff0000,v35
v_lshlrev_b32 v40,16,v48
v_and_b32 v41,0xffff0000,v48
v_lshlrev_b32 v42,16,v49
v_and_b32 v43,0xffff0000,v49
v_lshlrev_b32 v44,16,v50
v_and_b32 v45,0xffff0000,v50
v_lshlrev_b32 v46,16,v51
v_and_b32 v47,0xffff0000,v51
v_pk_add_f32 v[24:25],v[24:25],v[40:41]
v_pk_add_f32 v[26:27],v[26:27],v[42:43]
v_pk_add_f32 v[28:29],v[28:29],v[44:45]
v_pk_add_f32 v[30:31],v[30:31],v[46:47]
v_cvt_pk_bf16_f32 v120,v24,v25
v_cvt_pk_bf16_f32 v121,v26,v27
v_cvt_pk_bf16_f32 v122,v28,v29
v_cvt_pk_bf16_f32 v123,v30,v31
s_nop 0
v_permlane16_swap_b32 v120,v122
v_permlane16_swap_b32 v121,v123
global_store_dwordx4 v214,v[120:123],s[44:45] offset:128 sc1
v_accvgpr_read_b32 v24,a120
v_accvgpr_read_b32 v25,a121
v_accvgpr_read_b32 v26,a122
v_accvgpr_read_b32 v27,a123
v_accvgpr_read_b32 v28,a124
v_accvgpr_read_b32 v29,a125
v_accvgpr_read_b32 v30,a126
v_accvgpr_read_b32 v31,a127
v_accvgpr_read_b32 v48,a188
v_accvgpr_read_b32 v49,a189
v_accvgpr_read_b32 v50,a190
v_accvgpr_read_b32 v51,a191
v_cvt_pk_bf16_f32 v32,v24,v25
v_cvt_pk_bf16_f32 v33,v26,v27
v_cvt_pk_bf16_f32 v34,v28,v29
v_cvt_pk_bf16_f32 v35,v30,v31
v_lshlrev_b32 v24,16,v32
v_and_b32 v25,0xffff0000,v32
v_lshlrev_b32 v26,16,v33
v_and_b32 v27,0xffff0000,v33
v_lshlrev_b32 v28,16,v34
v_and_b32 v29,0xffff0000,v34
v_lshlrev_b32 v30,16,v35
v_and_b32 v31,0xffff0000,v35
v_pk_mul_f32 v[24:25],v[24:25],v[246:247] op_sel_hi:[1,0]
v_pk_mul_f32 v[26:27],v[26:27],v[246:247] op_sel_hi:[1,0]
v_pk_mul_f32 v[28:29],v[28:29],v[246:247] op_sel_hi:[1,0]
v_pk_mul_f32 v[30:31],v[30:31],v[246:247] op_sel_hi:[1,0]
v_cvt_pk_bf16_f32 v32,v24,v25
v_cvt_pk_bf16_f32 v33,v26,v27
v_cvt_pk_bf16_f32 v34,v28,v29
v_cvt_pk_bf16_f32 v35,v30,v31
v_lshlrev_b32 v24,16,v32
v_and_b32 v25,0xffff0000,v32
v_lshlrev_b32 v26,16,v33
v_and_b32 v27,0xffff0000,v33
v_lshlrev_b32 v28,16,v34
v_and_b32 v29,0xffff0000,v34
v_lshlrev_b32 v30,16,v35
v_and_b32 v31,0xffff0000,v35
v_lshlrev_b32 v40,16,v48
v_and_b32 v41,0xffff0000,v48
v_lshlrev_b32 v42,16,v49
v_and_b32 v43,0xffff0000,v49
v_lshlrev_b32 v44,16,v50
v_and_b32 v45,0xffff0000,v50
v_lshlrev_b32 v46,16,v51
v_and_b32 v47,0xffff0000,v51
v_pk_add_f32 v[24:25],v[24:25],v[40:41]
v_pk_add_f32 v[26:27],v[26:27],v[42:43]
v_pk_add_f32 v[28:29],v[28:29],v[44:45]
v_pk_add_f32 v[30:31],v[30:31],v[46:47]
v_cvt_pk_bf16_f32 v124,v24,v25
v_cvt_pk_bf16_f32 v125,v26,v27
v_cvt_pk_bf16_f32 v126,v28,v29
v_cvt_pk_bf16_f32 v127,v30,v31
s_nop 0
v_permlane16_swap_b32 v124,v126
v_permlane16_swap_b32 v125,v127
global_store_dwordx4 v214,v[124:127],s[44:45] offset:192 sc1
s_lshl_b32 s54,s32,7
s_add_u32 s54,s54,94437376
v_mov_b32 v233,s54
s_cmp_eq_u32 s32,63
s_cselect_b32 s39,0,s38
s_cmp_le_u32 s36,3
s_cselect_b32 s54,2,1
s_cmp_eq_u32 s36,5
s_cselect_b32 s54,2,s54
v_mov_b32 v252,s54
s_waitcnt vmcnt(16)
s_branch L_bulk_adv
L_e_db4:
v_accvgpr_read_b32 v24,a0
v_accvgpr_read_b32 v25,a1
v_accvgpr_read_b32 v26,a2
v_accvgpr_read_b32 v27,a3
v_accvgpr_read_b32 v28,a4
v_accvgpr_read_b32 v29,a5
v_accvgpr_read_b32 v30,a6
v_accvgpr_read_b32 v31,a7
v_cvt_pk_bf16_f32 v32,v24,v25
v_cvt_pk_bf16_f32 v33,v26,v27
v_cvt_pk_bf16_f32 v34,v28,v29
v_cvt_pk_bf16_f32 v35,v30,v31
v_lshlrev_b32 v24,16,v32
v_and_b32 v25,0xffff0000,v32
v_lshlrev_b32 v26,16,v33
v_and_b32 v27,0xffff0000,v33
v_lshlrev_b32 v28,16,v34
v_and_b32 v29,0xffff0000,v34
v_lshlrev_b32 v30,16,v35
v_and_b32 v31,0xffff0000,v35
v_pk_mul_f32 v[24:25],v[24:25],v[240:241] op_sel:[0,1] op_sel_hi:[1,1]
v_pk_mul_f32 v[26:27],v[26:27],v[240:241] op_sel:[0,1] op_sel_hi:[1,1]
v_pk_mul_f32 v[28:29],v[28:29],v[240:241] op_sel:[0,1] op_sel_hi:[1,1]
v_pk_mul_f32 v[30:31],v[30:31],v[240:241] op_sel:[0,1] op_sel_hi:[1,1]
v_cvt_pk_bf16_f32 v64,v24,v25
v_cvt_pk_bf16_f32 v65,v26,v27
v_cvt_pk_bf16_f32 v66,v28,v29
v_cvt_pk_bf16_f32 v67,v30,v31
global_store_dwordx4 v2,v[64:67],s[30:31] offset:0 sc1
v_accvgpr_read_b32 v24,a8
v_accvgpr_read_b32 v25,a9
v_accvgpr_read_b32 v26,a10
v_accvgpr_read_b32 v27,a11
v_accvgpr_read_b32 v28,a12
v_accvgpr_read_b32 v29,a13
v_accvgpr_read_b32 v30,a14
v_accvgpr_read_b32 v31,a15
v_cvt_pk_bf16_f32 v32,v24,v25
v_cvt_pk_bf16_f32 v33,v26,v27
v_cvt_pk_bf16_f32 v34,v28,v29
v_cvt_pk_bf16_f32 v35,v30,v31
v_lshlrev_b32 v24,16,v32
v_and_b32 v25,0xffff0000,v32
v_lshlrev_b32 v26,16,v33
v_and_b32 v27,0xffff0000,v33
v_lshlrev_b32 v28,16,v34
v_and_b32 v29,0xffff0000,v34
v_lshlrev_b32 v30,16,v35
v_and_b32 v31,0xffff0000,v35
v_pk_mul_f32 v[24:25],v[24:25],v[240:241] op_sel:[0,1] op_sel_hi:[1,1]
v_pk_mul_f32 v[26:27],v[26:27],v[240:241] op_sel:[0,1] op_sel_hi:[1,1]
v_pk_mul_f32 v[28:29],v[28:29],v[240:241] op_sel:[0,1] op_sel_hi:[1,1]
v_pk_mul_f32 v[30:31],v[30:31],v[240:241] op_sel:[0,1] op_sel_hi:[1,1]
v_cvt_pk_bf16_f32 v68,v24,v25
v_cvt_pk_bf16_f32 v69,v26,v27
v_cvt_pk_bf16_f32 v70,v28,v29
v_cvt_pk_bf16_f32 v71,v30,v31
global_store_dwordx4 v2,v[68:71],s[30:31] offset:1024 sc1
v_accvgpr_read_b32 v24,a16
v_accvgpr_read_b32 v25,a17
v_accvgpr_read_b32 v26,a18
v_accvgpr_read_b32 v27,a19
v_accvgpr_read_b32 v28,a20
v_accvgpr_read_b32 v29,a21
v_accvgpr_read_b32 v30,a22
v_accvgpr_read_b32 v31,a23
v_cvt_pk_bf16_f32 v32,v24,v25
v_cvt_pk_bf16_f32 v33,v26,v27
v_cvt_pk_bf16_f32 v34,v28,v29
v_cvt_pk_bf16_f32 v35,v30,v31
v_lshlrev_b32 v24,16,v32
v_and_b32 v25,0xffff0000,v32
v_lshlrev_b32 v26,16,v33
v_and_b32 v27,0xffff0000,v33
v_lshlrev_b32 v28,16,v34
v_and_b32 v29,0xffff0000,v34
v_lshlrev_b32 v30,16,v35
v_and_b32 v31,0xffff0000,v35
v_pk_mul_f32 v[24:25],v[24:25],v[240:241] op_sel:[0,1] op_sel_hi:[1,1]
v_pk_mul_f32 v[26:27],v[26:27],v[240:241] op_sel:[0,1] op_sel_hi:[1,1]
v_pk_mul_f32 v[28:29],v[28:29],v[240:241] op_sel:[0,1] op_sel_hi:[1,1]
v_pk_mul_f32 v[30:31],v[30:31],v[240:241] op_sel:[0,1] op_sel_hi:[1,1]
v_cvt_pk_bf16_f32 v72,v24,v25
v_cvt_pk_bf16_f32 v73,v26,v27
v_cvt_pk_bf16_f32 v74,v28,v29
v_cvt_pk_bf16_f32 v75,v30,v31
global_store_dwordx4 v2,v[72:75],s[30:31] offset:2048 sc1
v_accvgpr_read_b32 v24,a24
v_accvgpr_read_b32 v25,a25
v_accvgpr_read_b32 v26,a26
v_accvgpr_read_b32 v27,a27
v_accvgpr_read_b32 v28,a28
v_accvgpr_read_b32 v29,a29
v_accvgpr_read_b32 v30,a30
v_accvgpr_read_b32 v31,a31
v_cvt_pk_bf16_f32 v32,v24,v25
v_cvt_pk_bf16_f32 v33,v26,v27
v_cvt_pk_bf16_f32 v34,v28,v29
v_cvt_pk_bf16_f32 v35,v30,v31
v_lshlrev_b32 v24,16,v32
v_and_b32 v25,0xffff0000,v32
v_lshlrev_b32 v26,16,v33
v_and_b32 v27,0xffff0000,v33
v_lshlrev_b32 v28,16,v34
v_and_b32 v29,0xffff0000,v34
v_lshlrev_b32 v30,16,v35
v_and_b32 v31,0xffff0000,v35
v_pk_mul_f32 v[24:25],v[24:25],v[240:241] op_sel:[0,1] op_sel_hi:[1,1]
v_pk_mul_f32 v[26:27],v[26:27],v[240:241] op_sel:[0,1] op_sel_hi:[1,1]
v_pk_mul_f32 v[28:29],v[28:29],v[240:241] op_sel:[0,1] op_sel_hi:[1,1]
v_pk_mul_f32 v[30:31],v[30:31],v[240:241] op_sel:[0,1] op_sel_hi:[1,1]
v_cvt_pk_bf16_f32 v76,v24,v25
v_cvt_pk_bf16_f32 v77,v26,v27
v_cvt_pk_bf16_f32 v78,v28,v29
v_cvt_pk_bf16_f32 v79,v30,v31
global_store_dwordx4 v2,v[76:79],s[30:31] offset:3072 sc1
s_add_u32 s30,s30,32768
s_addc_u32 s31,s31,0
v_accvgpr_read_b32 v24,a32
v_accvgpr_read_b32 v25,a33
v_accvgpr_read_b32 v26,a34
v_accvgpr_read_b32 v27,a35
v_accvgpr_read_b32 v28,a36
v_accvgpr_read_b32 v29,a37
v_accvgpr_read_b32 v30,a38
v_accvgpr_read_b32 v31,a39
v_cvt_pk_bf16_f32 v32,v24,v25
v_cvt_pk_bf16_f32 v33,v26,v27
v_cvt_pk_bf16_f32 v34,v28,v29
v_cvt_pk_bf16_f32 v35,v30,v31
v_lshlrev_b32 v24,16,v32
v_and_b32 v25,0xffff0000,v32
v_lshlrev_b32 v26,16,v33
v_and_b32 v27,0xffff0000,v33
v_lshlrev_b32 v28,16,v34
v_and_b32 v29,0xffff0000,v34
v_lshlrev_b32 v30,16,v35
v_and_b32 v31,0xffff0000,v35
v_pk_mul_f32 v[24:25],v[24:25],v[242:243] op_sel:[0,1] op_sel_hi:[1,1]
v_pk_mul_f32 v[26:27],v[26:27],v[242:243] op_sel:[0,1] op_sel_hi:[1,1]
v_pk_mul_f32 v[28:29],v[28:29],v[242:243] op_sel:[0,1] op_sel_hi:[1,1]
v_pk_mul_f32 v[30:31],v[30:31],v[242:243] op_sel:[0,1] op_sel_hi:[1,1]
v_cvt_pk_bf16_f32 v80,v24,v25
v_cvt_pk_bf16_f32 v81,v26,v27
v_cvt_pk_bf16_f32 v82,v28,v29
v_cvt_pk_bf16_f32 v83,v30,v31
global_store_dwordx4 v2,v[80:83],s[30:31] offset:0 sc1
v_accvgpr_read_b32 v24,a40
v_accvgpr_read_b32 v25,a41
v_accvgpr_read_b32 v26,a42
v_accvgpr_read_b32 v27,a43
v_accvgpr_read_b32 v28,a44
v_accvgpr_read_b32 v29,a45
v_accvgpr_read_b32 v30,a46
v_accvgpr_read_b32 v31,a47
v_cvt_pk_bf16_f32 v32,v24,v25
v_cvt_pk_bf16_f32 v33,v26,v27
v_cvt_pk_bf16_f32 v34,v28,v29
v_cvt_pk_bf16_f32 v35,v30,v31
v_lshlrev_b32 v24,16,v32
v_and_b32 v25,0xffff0000,v32
v_lshlrev_b32 v26,16,v33
v_and_b32 v27,0xffff0000,v33
v_lshlrev_b32 v28,16,v34
v_and_b32 v29,0xffff0000,v34
v_lshlrev_b32 v30,16,v35
v_and_b32 v31,0xffff0000,v35
v_pk_mul_f32 v[24:25],v[24:25],v[242:243] op_sel:[0,1] op_sel_hi:[1,1]
v_pk_mul_f32 v[26:27],v[26:27],v[242:243] op_sel:[0,1] op_sel_hi:[1,1]
v_pk_mul_f32 v[28:29],v[28:29],v[242:243] op_sel:[0,1] op_sel_hi:[1,1]
v_pk_mul_f32 v[30:31],v[30:31],v[242:243] op_sel:[0,1] op_sel_hi:[1,1]
v_cvt_pk_bf16_f32 v84,v24,v25
v_cvt_pk_bf16_f32 v85,v26,v27
v_cvt_pk_bf16_f32 v86,v28,v29
v_cvt_pk_bf16_f32 v87,v30,v31
global_store_dwordx4 v2,v[84:87],s[30:31] offset:1024 sc1
v_accvgpr_read_b32 v24,a48
v_accvgpr_read_b32 v25,a49
v_accvgpr_read_b32 v26,a50
v_accvgpr_read_b32 v27,a51
v_accvgpr_read_b32 v28,a52
v_accvgpr_read_b32 v29,a53
v_accvgpr_read_b32 v30,a54
v_accvgpr_read_b32 v31,a55
v_cvt_pk_bf16_f32 v32,v24,v25
v_cvt_pk_bf16_f32 v33,v26,v27
v_cvt_pk_bf16_f32 v34,v28,v29
v_cvt_pk_bf16_f32 v35,v30,v31
v_lshlrev_b32 v24,16,v32
v_and_b32 v25,0xffff0000,v32
v_lshlrev_b32 v26,16,v33
v_and_b32 v27,0xffff0000,v33
v_lshlrev_b32 v28,16,v34
v_and_b32 v29,0xffff0000,v34
v_lshlrev_b32 v30,16,v35
v_and_b32 v31,0xffff0000,v35
v_pk_mul_f32 v[24:25],v[24:25],v[242:243] op_sel:[0,1] op_sel_hi:[1,1]
v_pk_mul_f32 v[26:27],v[26:27],v[242:243] op_sel:[0,1] op_sel_hi:[1,1]
v_pk_mul_f32 v[28:29],v[28:29],v[242:243] op_sel:[0,1] op_sel_hi:[1,1]
v_pk_mul_f32 v[30:31],v[30:31],v[242:243] op_sel:[0,1] op_sel_hi:[1,1]
v_cvt_pk_bf16_f32 v88,v24,v25
v_cvt_pk_bf16_f32 v89,v26,v27
v_cvt_pk_bf16_f32 v90,v28,v29
v_cvt_pk_bf16_f32 v91,v30,v31
global_store_dwordx4 v2,v[88:91],s[30:31] offset:2048 sc1
v_accvgpr_read_b32 v24,a56
v_accvgpr_read_b32 v25,a57
v_accvgpr_read_b32 v26,a58
v_accvgpr_read_b32 v27,a59
v_accvgpr_read_b32 v28,a60
v_accvgpr_read_b32 v29,a61
v_accvgpr_read_b32 v30,a62
v_accvgpr_read_b32 v31,a63
v_cvt_pk_bf16_f32 v32,v24,v25
v_cvt_pk_bf16_f32 v33,v26,v27
v_cvt_pk_bf16_f32 v34,v28,v29
v_cvt_pk_bf16_f32 v35,v30,v31
v_lshlrev_b32 v24,16,v32
v_and_b32 v25,0xffff0000,v32
v_lshlrev_b32 v26,16,v33
v_and_b32 v27,0xffff0000,v33
v_lshlrev_b32 v28,16,v34
v_and_b32 v29,0xffff0000,v34
v_lshlrev_b32 v30,16,v35
v_and_b32 v31,0xffff0000,v35
v_pk_mul_f32 v[24:25],v[24:25],v[242:243] op_sel:[0,1] op_sel_hi:[1,1]
v_pk_mul_f32 v[26:27],v[26:27],v[242:243] op_sel:[0,1] op_sel_hi:[1,1]
v_pk_mul_f32 v[28:29],v[28:29],v[242:243] op_sel:[0,1] op_sel_hi:[1,1]
v_pk_mul_f32 v[30:31],v[30:31],v[242:243] op_sel:[0,1] op_sel_hi:[1,1]
v_cvt_pk_bf16_f32 v92,v24,v25
v_cvt_pk_bf16_f32 v93,v26,v27
v_cvt_pk_bf16_f32 v94,v28,v29
v_cvt_pk_bf16_f32 v95,v30,v31
global_store_dwordx4 v2,v[92:95],s[30:31] offset:3072 sc1
s_add_u32 s30,s30,32768
s_addc_u32 s31,s31,0
v_accvgpr_read_b32 v24,a64
v_accvgpr_read_b32 v25,a65
v_accvgpr_read_b32 v26,a66
v_accvgpr_read_b32 v27,a67
v_accvgpr_read_b32 v28,a68
v_accvgpr_read_b32 v29,a69
v_accvgpr_read_b32 v30,a70
v_accvgpr_read_b32 v31,a71
v_cvt_pk_bf16_f32 v32,v24,v25
v_cvt_pk_bf16_f32 v33,v26,v27
v_cvt_pk_bf16_f32 v34,v28,v29
v_cvt_pk_bf16_f32 v35,v30,v31
v_lshlrev_b32 v24,16,v32
v_and_b32 v25,0xffff0000,v32
v_lshlrev_b32 v26,16,v33
v_and_b32 v27,0xffff0000,v33
v_lshlrev_b32 v28,16,v34
v_and_b32 v29,0xffff0000,v34
v_lshlrev_b32 v30,16,v35
v_and_b32 v31,0xffff0000,v35
v_pk_mul_f32 v[24:25],v[24:25],v[244:245] op_sel:[0,1] op_sel_hi:[1,1]
v_pk_mul_f32 v[26:27],v[26:27],v[244:245] op_sel:[0,1] op_sel_hi:[1,1]
v_pk_mul_f32 v[28:29],v[28:29],v[244:245] op_sel:[0,1] op_sel_hi:[1,1]
v_pk_mul_f32 v[30:31],v[30:31],v[244:245] op_sel:[0,1] op_sel_hi:[1,1]
v_cvt_pk_bf16_f32 v96,v24,v25
v_cvt_pk_bf16_f32 v97,v26,v27
v_cvt_pk_bf16_f32 v98,v28,v29
v_cvt_pk_bf16_f32 v99,v30,v31
global_store_dwordx4 v2,v[96:99],s[30:31] offset:0 sc1
v_accvgpr_read_b32 v24,a72
v_accvgpr_read_b32 v25,a73
v_accvgpr_read_b32 v26,a74
v_accvgpr_read_b32 v27,a75
v_accvgpr_read_b32 v28,a76
v_accvgpr_read_b32 v29,a77
v_accvgpr_read_b32 v30,a78
v_accvgpr_read_b32 v31,a79
v_cvt_pk_bf16_f32 v32,v24,v25
v_cvt_pk_bf16_f32 v33,v26,v27
v_cvt_pk_bf16_f32 v34,v28,v29
v_cvt_pk_bf16_f32 v35,v30,v31
v_lshlrev_b32 v24,16,v32
v_and_b32 v25,0xffff0000,v32
v_lshlrev_b32 v26,16,v33
v_and_b32 v27,0xffff0000,v33
v_lshlrev_b32 v28,16,v34
v_and_b32 v29,0xffff0000,v34
v_lshlrev_b32 v30,16,v35
v_and_b32 v31,0xffff0000,v35
v_pk_mul_f32 v[24:25],v[24:25],v[244:245] op_sel:[0,1] op_sel_hi:[1,1]
v_pk_mul_f32 v[26:27],v[26:27],v[244:245] op_sel:[0,1] op_sel_hi:[1,1]
v_pk_mul_f32 v[28:29],v[28:29],v[244:245] op_sel:[0,1] op_sel_hi:[1,1]
v_pk_mul_f32 v[30:31],v[30:31],v[244:245] op_sel:[0,1] op_sel_hi:[1,1]
v_cvt_pk_bf16_f32 v100,v24,v25
v_cvt_pk_bf16_f32 v101,v26,v27
v_cvt_pk_bf16_f32 v102,v28,v29
v_cvt_pk_bf16_f32 v103,v30,v31
global_store_dwordx4 v2,v[100:103],s[30:31] offset:1024 sc1
v_accvgpr_read_b32 v24,a80
v_accvgpr_read_b32 v25,a81
v_accvgpr_read_b32 v26,a82
v_accvgpr_read_b32 v27,a83
v_accvgpr_read_b32 v28,a84
v_accvgpr_read_b32 v29,a85
v_accvgpr_read_b32 v30,a86
v_accvgpr_read_b32 v31,a87
v_cvt_pk_bf16_f32 v32,v24,v25
v_cvt_pk_bf16_f32 v33,v26,v27
v_cvt_pk_bf16_f32 v34,v28,v29
v_cvt_pk_bf16_f32 v35,v30,v31
v_lshlrev_b32 v24,16,v32
v_and_b32 v25,0xffff0000,v32
v_lshlrev_b32 v26,16,v33
v_and_b32 v27,0xffff0000,v33
v_lshlrev_b32 v28,16,v34
v_and_b32 v29,0xffff0000,v34
v_lshlrev_b32 v30,16,v35
v_and_b32 v31,0xffff0000,v35
v_pk_mul_f32 v[24:25],v[24:25],v[244:245] op_sel:[0,1] op_sel_hi:[1,1]
v_pk_mul_f32 v[26:27],v[26:27],v[244:245] op_sel:[0,1] op_sel_hi:[1,1]
v_pk_mul_f32 v[28:29],v[28:29],v[244:245] op_sel:[0,1] op_sel_hi:[1,1]
v_pk_mul_f32 v[30:31],v[30:31],v[244:245] op_sel:[0,1] op_sel_hi:[1,1]
v_cvt_pk_bf16_f32 v104,v24,v25
v_cvt_pk_bf16_f32 v105,v26,v27
v_cvt_pk_bf16_f32 v106,v28,v29
v_cvt_pk_bf16_f32 v107,v30,v31
global_store_dwordx4 v2,v[104:107],s[30:31] offset:2048 sc1
v_accvgpr_read_b32 v24,a88
v_accvgpr_read_b32 v25,a89
v_accvgpr_read_b32 v26,a90
v_accvgpr_read_b32 v27,a91
v_accvgpr_read_b32 v28,a92
v_accvgpr_read_b32 v29,a93
v_accvgpr_read_b32 v30,a94
v_accvgpr_read_b32 v31,a95
v_cvt_pk_bf16_f32 v32,v24,v25
v_cvt_pk_bf16_f32 v33,v26,v27
v_cvt_pk_bf16_f32 v34,v28,v29
v_cvt_pk_bf16_f32 v35,v30,v31
v_lshlrev_b32 v24,16,v32
v_and_b32 v25,0xffff0000,v32
v_lshlrev_b32 v26,16,v33
v_and_b32 v27,0xffff0000,v33
v_lshlrev_b32 v28,16,v34
v_and_b32 v29,0xffff0000,v34
v_lshlrev_b32 v30,16,v35
v_and_b32 v31,0xffff0000,v35
v_pk_mul_f32 v[24:25],v[24:25],v[244:245] op_sel:[0,1] op_sel_hi:[1,1]
v_pk_mul_f32 v[26:27],v[26:27],v[244:245] op_sel:[0,1] op_sel_hi:[1,1]
v_pk_mul_f32 v[28:29],v[28:29],v[244:245] op_sel:[0,1] op_sel_hi:[1,1]
v_pk_mul_f32 v[30:31],v[30:31],v[244:245] op_sel:[0,1] op_sel_hi:[1,1]
v_cvt_pk_bf16_f32 v108,v24,v25
v_cvt_pk_bf16_f32 v109,v26,v27
v_cvt_pk_bf16_f32 v110,v28,v29
v_cvt_pk_bf16_f32 v111,v30,v31
global_store_dwordx4 v2,v[108:111],s[30:31] offset:3072 sc1
s_add_u32 s30,s30,32768
s_addc_u32 s31,s31,0
v_accvgpr_read_b32 v24,a96
v_accvgpr_read_b32 v25,a97
v_accvgpr_read_b32 v26,a98
v_accvgpr_read_b32 v27,a99
v_accvgpr_read_b32 v28,a100
v_accvgpr_read_b32 v29,a101
v_accvgpr_read_b32 v30,a102
v_accvgpr_read_b32 v31,a103
v_cvt_pk_bf16_f32 v32,v24,v25
v_cvt_pk_bf16_f32 v33,v26,v27
v_cvt_pk_bf16_f32 v34,v28,v29
v_cvt_pk_bf16_f32 v35,v30,v31
v_lshlrev_b32 v24,16,v32
v_and_b32 v25,0xffff0000,v32
v_lshlrev_b32 v26,16,v33
v_and_b32 v27,0xffff0000,v33
v_lshlrev_b32 v28,16,v34
v_and_b32 v29,0xffff0000,v34
v_lshlrev_b32 v30,16,v35
v_and_b32 v31,0xffff0000,v35
v_pk_mul_f32 v[24:25],v[24:25],v[246:247] op_sel:[0,1] op_sel_hi:[1,1]
v_pk_mul_f32 v[26:27],v[26:27],v[246:247] op_sel:[0,1] op_sel_hi:[1,1]
v_pk_mul_f32 v[28:29],v[28:29],v[246:247] op_sel:[0,1] op_sel_hi:[1,1]
v_pk_mul_f32 v[30:31],v[30:31],v[246:247] op_sel:[0,1] op_sel_hi:[1,1]
v_cvt_pk_bf16_f32 v112,v24,v25
v_cvt_pk_bf16_f32 v113,v26,v27
v_cvt_pk_bf16_f32 v114,v28,v29
v_cvt_pk_bf16_f32 v115,v30,v31
global_store_dwordx4 v2,v[112:115],s[30:31] offset:0 sc1
v_accvgpr_read_b32 v24,a104
v_accvgpr_read_b32 v25,a105
v_accvgpr_read_b32 v26,a106
v_accvgpr_read_b32 v27,a107
v_accvgpr_read_b32 v28,a108
v_accvgpr_read_b32 v29,a109
v_accvgpr_read_b32 v30,a110
v_accvgpr_read_b32 v31,a111
v_cvt_pk_bf16_f32 v32,v24,v25
v_cvt_pk_bf16_f32 v33,v26,v27
v_cvt_pk_bf16_f32 v34,v28,v29
v_cvt_pk_bf16_f32 v35,v30,v31
v_lshlrev_b32 v24,16,v32
v_and_b32 v25,0xffff0000,v32
v_lshlrev_b32 v26,16,v33
v_and_b32 v27,0xffff0000,v33
v_lshlrev_b32 v28,16,v34
v_and_b32 v29,0xffff0000,v34
v_lshlrev_b32 v30,16,v35
v_and_b32 v31,0xffff0000,v35
v_pk_mul_f32 v[24:25],v[24:25],v[246:247] op_sel:[0,1] op_sel_hi:[1,1]
v_pk_mul_f32 v[26:27],v[26:27],v[246:247] op_sel:[0,1] op_sel_hi:[1,1]
v_pk_mul_f32 v[28:29],v[28:29],v[246:247] op_sel:[0,1] op_sel_hi:[1,1]
v_pk_mul_f32 v[30:31],v[30:31],v[246:247] op_sel:[0,1] op_sel_hi:[1,1]
v_cvt_pk_bf16_f32 v116,v24,v25
v_cvt_pk_bf16_f32 v117,v26,v27
v_cvt_pk_bf16_f32 v118,v28,v29
v_cvt_pk_bf16_f32 v119,v30,v31
global_store_dwordx4 v2,v[116:119],s[30:31] offset:1024 sc1
v_accvgpr_read_b32 v24,a112
v_accvgpr_read_b32 v25,a113
v_accvgpr_read_b32 v26,a114
v_accvgpr_read_b32 v27,a115
v_accvgpr_read_b32 v28,a116
v_accvgpr_read_b32 v29,a117
v_accvgpr_read_b32 v30,a118
v_accvgpr_read_b32 v31,a119
v_cvt_pk_bf16_f32 v32,v24,v25
v_cvt_pk_bf16_f32 v33,v26,v27
v_cvt_pk_bf16_f32 v34,v28,v29
v_cvt_pk_bf16_f32 v35,v30,v31
v_lshlrev_b32 v24,16,v32
v_and_b32 v25,0xffff0000,v32
v_lshlrev_b32 v26,16,v33
v_and_b32 v27,0xffff0000,v33
v_lshlrev_b32 v28,16,v34
v_and_b32 v29,0xffff0000,v34
v_lshlrev_b32 v30,16,v35
v_and_b32 v31,0xffff0000,v35
v_pk_mul_f32 v[24:25],v[24:25],v[246:247] op_sel:[0,1] op_sel_hi:[1,1]
v_pk_mul_f32 v[26:27],v[26:27],v[246:247] op_sel:[0,1] op_sel_hi:[1,1]
v_pk_mul_f32 v[28:29],v[28:29],v[246:247] op_sel:[0,1] op_sel_hi:[1,1]
v_pk_mul_f32 v[30:31],v[30:31],v[246:247] op_sel:[0,1] op_sel_hi:[1,1]
v_cvt_pk_bf16_f32 v120,v24,v25
v_cvt_pk_bf16_f32 v121,v26,v27
v_cvt_pk_bf16_f32 v122,v28,v29
v_cvt_pk_bf16_f32 v123,v30,v31
global_store_dwordx4 v2,v[120:123],s[30:31] offset:2048 sc1
v_accvgpr_read_b32 v24,a120
v_accvgpr_read_b32 v25,a121
v_accvgpr_read_b32 v26,a122
v_accvgpr_read_b32 v27,a123
v_accvgpr_read_b32 v28,a124
v_accvgpr_read_b32 v29,a125
v_accvgpr_read_b32 v30,a126
v_accvgpr_read_b32 v31,a127
v_cvt_pk_bf16_f32 v32,v24,v25
v_cvt_pk_bf16_f32 v33,v26,v27
v_cvt_pk_bf16_f32 v34,v28,v29
v_cvt_pk_bf16_f32 v35,v30,v31
v_lshlrev_b32 v24,16,v32
v_and_b32 v25,0xffff0000,v32
v_lshlrev_b32 v26,16,v33
v_and_b32 v27,0xffff0000,v33
v_lshlrev_b32 v28,16,v34
v_and_b32 v29,0xffff0000,v34
v_lshlrev_b32 v30,16,v35
v_and_b32 v31,0xffff0000,v35
v_pk_mul_f32 v[24:25],v[24:25],v[246:247] op_sel:[0,1] op_sel_hi:[1,1]
v_pk_mul_f32 v[26:27],v[26:27],v[246:247] op_sel:[0,1] op_sel_hi:[1,1]
v_pk_mul_f32 v[28:29],v[28:29],v[246:247] op_sel:[0,1] op_sel_hi:[1,1]
v_pk_mul_f32 v[30:31],v[30:31],v[246:247] op_sel:[0,1] op_sel_hi:[1,1]
v_cvt_pk_bf16_f32 v124,v24,v25
v_cvt_pk_bf16_f32 v125,v26,v27
v_cvt_pk_bf16_f32 v126,v28,v29
v_cvt_pk_bf16_f32 v127,v30,v31
global_store_dwordx4 v2,v[124:127],s[30:31] offset:3072 sc1
s_lshl_b32 s54,s32,7
s_add_u32 s54,s54,94437376
v_mov_b32 v233,s54
s_cmp_eq_u32 s32,63
s_cselect_b32 s39,0,s38
s_cmp_le_u32 s36,3
s_cselect_b32 s54,2,1
s_cmp_eq_u32 s36,5
s_cselect_b32 s54,2,s54
v_mov_b32 v252,s54
s_waitcnt vmcnt(16)
s_branch L_bulk_adv
L_g_vs:
s_waitcnt vmcnt(6)
s_barrier
ds_read_b128 v[64:67],v12 offset:0
ds_read_b64_tr_b16 v[96:97],v16 offset:0
ds_read_b64_tr_b16 v[98:99],v16 offset:4096
ds_read_b128 v[68:71],v12 offset:1024
ds_read_b64_tr_b16 v[100:101],v17 offset:0
ds_read_b64_tr_b16 v[102:103],v17 offset:4096
ds_read_b128 v[72:75],v12 offset:4096
ds_read_b64_tr_b16 v[104:105],v18 offset:0
ds_read_b64_tr_b16 v[106:107],v18 offset:4096
ds_read_b128 v[76:79],v12 offset:5120
ds_read_b64_tr_b16 v[108:109],v19 offset:0
ds_read_b64_tr_b16 v[110:111],v19 offset:4096
ds_read_b64_tr_b16 v[112:113],v20 offset:0
ds_read_b64_tr_b16 v[114:115],v20 offset:4096
ds_read_b64_tr_b16 v[116:117],v21 offset:0
ds_read_b64_tr_b16 v[118:119],v21 offset:4096
ds_read_b64_tr_b16 v[120:121],v22 offset:0
ds_read_b64_tr_b16 v[122:123],v22 offset:4096
ds_read_b64_tr_b16 v[124:125],v23 offset:0
ds_read_b64_tr_b16 v[126:127],v23 offset:4096
s_waitcnt vmcnt(4) lgkmcnt(0)
s_barrier
v_mfma_f32_16x16x32_bf16 a[0:3],v[64:67],v[96:99],0
ds_read_b128 v[128:131],v12 offset:16384
v_mfma_f32_16x16x32_bf16 a[4:7],v[64:67],v[100:103],0
ds_read_b64_tr_b16 v[160:161],v16 offset:16384
s_add_u32 m0,s23,0
v_mfma_f32_16x16x32_bf16 a[8:11],v[64:67],v[104:107],0
ds_read_b64_tr_b16 v[162:163],v16 offset:20480
global_load_lds_dwordx4 v4,s[16:17] offset:0 sc1
v_mfma_f32_16x16x32_bf16 a[12:15],v[64:67],v[108:111],0
ds_read_b128 v[132:135],v12 offset:17408
v_mfma_f32_16x16x32_bf16 a[16:19],v[64:67],v[112:115],0
ds_read_b64_tr_b16 v[164:165],v17 offset:16384
global_load_lds_dwordx4 v5,s[16:17] offset:1024 sc1
v_mfma_f32_16x16x32_bf16 a[20:23],v[64:67],v[116:119],0
ds_read_b64_tr_b16 v[166:167],v17 offset:20480
v_mfma_f32_16x16x32_bf16 a[24:27],v[64:67],v[120:123],0
ds_read_b128 v[136:139],v12 offset:20480
s_add_u32 m0,s23,65536
v_mfma_f32_16x16x32_bf16 a[28:31],v[64:67],v[124:127],0
ds_read_b64_tr_b16 v[168:169],v18 offset:16384
s_add_u32 s16,s16,s20
v_mfma_f32_16x16x32_bf16 a[32:35],v[68:71],v[96:99],0
ds_read_b64_tr_b16 v[170:171],v18 offset:20480
s_addc_u32 s17,s17,0
v_mfma_f32_16x16x32_bf16 a[36:39],v[68:71],v[100:103],0
ds_read_b128 v[140:143],v12 offset:21504
global_load_lds_dwordx4 v8,s[18:19] offset:0
v_mfma_f32_16x16x32_bf16 a[40:43],v[68:71],v[104:107],0
ds_read_b64_tr_b16 v[172:173],v19 offset:16384
v_mfma_f32_16x16x32_bf16 a[44:47],v[68:71],v[108:111],0
ds_read_b64_tr_b16 v[174:175],v19 offset:20480
global_load_lds_dwordx4 v9,s[18:19] offset:1024
v_mfma_f32_16x16x32_bf16 a[48:51],v[68:71],v[112:115],0
ds_read_b64_tr_b16 v[176:177],v20 offset:16384
v_mfma_f32_16x16x32_bf16 a[52:55],v[68:71],v[116:119],0
ds_read_b64_tr_b16 v[178:179],v20 offset:20480
global_load_lds_dwordx4 v10,s[18:19] offset:2048
v_mfma_f32_16x16x32_bf16 a[56:59],v[68:71],v[120:123],0
ds_read_b64_tr_b16 v[180:181],v21 offset:16384
v_mfma_f32_16x16x32_bf16 a[60:63],v[68:71],v[124:127],0
ds_read_b64_tr_b16 v[182:183],v21 offset:20480
global_load_lds_dwordx4 v11,s[18:19] offset:3072
v_mfma_f32_16x16x32_bf16 a[64:67],v[72:75],v[96:99],0
ds_read_b64_tr_b16 v[184:185],v22 offset:16384
v_mfma_f32_16x16x32_bf16 a[68:71],v[72:75],v[100:103],0
ds_read_b64_tr_b16 v[186:187],v22 offset:20480
s_add_u32 s18,s18,s21
v_mfma_f32_16x16x32_bf16 a[72:75],v[72:75],v[104:107],0
ds_read_b64_tr_b16 v[188:189],v23 offset:16384
s_addc_u32 s19,s19,0
v_mfma_f32_16x16x32_bf16 a[76:79],v[72:75],v[108:111],0
ds_read_b64_tr_b16 v[190:191],v23 offset:20480
v_mfma_f32_16x16x32_bf16 a[80:83],v[72:75],v[112:115],0
v_mfma_f32_16x16x32_bf16 a[84:87],v[72:75],v[116:119],0
v_mfma_f32_16x16x32_bf16 a[88:91],v[72:75],v[120:123],0
v_mfma_f32_16x16x32_bf16 a[92:95],v[72:75],v[124:127],0
v_mfma_f32_16x16x32_bf16 a[96:99],v[76:79],v[96:99],0
v_mfma_f32_16x16x32_bf16 a[100:103],v[76:79],v[100:103],0
v_mfma_f32_16x16x32_bf16 a[104:107],v[76:79],v[104:107],0
v_mfma_f32_16x16x32_bf16 a[108:111],v[76:79],v[108:111],0
v_mfma_f32_16x16x32_bf16 a[112:115],v[76:79],v[112:115],0
v_mfma_f32_16x16x32_bf16 a[116:119],v[76:79],v[116:119],0
v_mfma_f32_16x16x32_bf16 a[120:123],v[76:79],v[120:123],0
v_mfma_f32_16x16x32_bf16 a[124:127],v[76:79],v[124:127],0
s_waitcnt vmcnt(8) lgkmcnt(0)
s_barrier
v_mfma_f32_16x16x32_bf16 a[0:3],v[128:131],v[160:163],a[0:3]
ds_read_b128 v[64:67],v12 offset:32768
v_mfma_f32_16x16x32_bf16 a[4:7],v[128:131],v[164:167],a[4:7]
ds_read_b64_tr_b16 v[96:97],v16 offset:32768
s_add_u32 m0,s23,16384
v_mfma_f32_16x16x32_bf16 a[8:11],v[128:131],v[168:171],a[8:11]
ds_read_b64_tr_b16 v[98:99],v16 offset:36864
global_load_lds_dwordx4 v4,s[16:17] offset:0 sc1
v_mfma_f32_16x16x32_bf16 a[12:15],v[128:131],v[172:175],a[12:15]
ds_read_b128 v[68:71],v12 offset:33792
v_mfma_f32_16x16x32_bf16 a[16:19],v[128:131],v[176:179],a[16:19]
ds_read_b64_tr_b16 v[100:101],v17 offset:32768
global_load_lds_dwordx4 v5,s[16:17] offset:1024 sc1
v_mfma_f32_16x16x32_bf16 a[20:23],v[128:131],v[180:183],a[20:23]
ds_read_b64_tr_b16 v[102:103],v17 offset:36864
v_mfma_f32_16x16x32_bf16 a[24:27],v[128:131],v[184:187],a[24:27]
ds_read_b128 v[72:75],v12 offset:36864
s_add_u32 m0,s23,81920
v_mfma_f32_16x16x32_bf16 a[28:31],v[128:131],v[188:191],a[28:31]
ds_read_b64_tr_b16 v[104:105],v18 offset:32768
s_add_u32 s16,s16,s20
v_mfma_f32_16x16x32_bf16 a[32:35],v[132:135],v[160:163],a[32:35]
ds_read_b64_tr_b16 v[106:107],v18 offset:36864
s_addc_u32 s17,s17,0
v_mfma_f32_16x16x32_bf16 a[36:39],v[132:135],v[164:167],a[36:39]
ds_read_b128 v[76:79],v12 offset:37888
global_load_lds_dwordx4 v8,s[18:19] offset:0
v_mfma_f32_16x16x32_bf16 a[40:43],v[132:135],v[168:171],a[40:43]
ds_read_b64_tr_b16 v[108:109],v19 offset:32768
v_mfma_f32_16x16x32_bf16 a[44:47],v[132:135],v[172:175],a[44:47]
ds_read_b64_tr_b16 v[110:111],v19 offset:36864
global_load_lds_dwordx4 v9,s[18:19] offset:1024
v_mfma_f32_16x16x32_bf16 a[48:51],v[132:135],v[176:179],a[48:51]
ds_read_b64_tr_b16 v[112:113],v20 offset:32768
v_mfma_f32_16x16x32_bf16 a[52:55],v[132:135],v[180:183],a[52:55]
ds_read_b64_tr_b16 v[114:115],v20 offset:36864
global_load_lds_dwordx4 v10,s[18:19] offset:2048
v_mfma_f32_16x16x32_bf16 a[56:59],v[132:135],v[184:187],a[56:59]
ds_read_b64_tr_b16 v[116:117],v21 offset:32768
v_mfma_f32_16x16x32_bf16 a[60:63],v[132:135],v[188:191],a[60:63]
ds_read_b64_tr_b16 v[118:119],v21 offset:36864
global_load_lds_dwordx4 v11,s[18:19] offset:3072
v_mfma_f32_16x16x32_bf16 a[64:67],v[136:139],v[160:163],a[64:67]
ds_read_b64_tr_b16 v[120:121],v22 offset:32768
v_mfma_f32_16x16x32_bf16 a[68:71],v[136:139],v[164:167],a[68:71]
ds_read_b64_tr_b16 v[122:123],v22 offset:36864
s_add_u32 s18,s18,s21
v_mfma_f32_16x16x32_bf16 a[72:75],v[136:139],v[168:171],a[72:75]
ds_read_b64_tr_b16 v[124:125],v23 offset:32768
s_addc_u32 s19,s19,0
v_mfma_f32_16x16x32_bf16 a[76:79],v[136:139],v[172:175],a[76:79]
ds_read_b64_tr_b16 v[126:127],v23 offset:36864
v_mfma_f32_16x16x32_bf16 a[80:83],v[136:139],v[176:179],a[80:83]
v_mfma_f32_16x16x32_bf16 a[84:87],v[136:139],v[180:183],a[84:87]
v_mfma_f32_16x16x32_bf16 a[88:91],v[136:139],v[184:187],a[88:91]
v_mfma_f32_16x16x32_bf16 a[92:95],v[136:139],v[188:191],a[92:95]
v_mfma_f32_16x16x32_bf16 a[96:99],v[140:143],v[160:163],a[96:99]
v_mfma_f32_16x16x32_bf16 a[100:103],v[140:143],v[164:167],a[100:103]
v_mfma_f32_16x16x32_bf16 a[104:107],v[140:143],v[168:171],a[104:107]
v_mfma_f32_16x16x32_bf16 a[108:111],v[140:143],v[172:175],a[108:111]
v_mfma_f32_16x16x32_bf16 a[112:115],v[140:143],v[176:179],a[112:115]
v_mfma_f32_16x16x32_bf16 a[116:119],v[140:143],v[180:183],a[116:119]
v_mfma_f32_16x16x32_bf16 a[120:123],v[140:143],v[184:187],a[120:123]
v_mfma_f32_16x16x32_bf16 a[124:127],v[140:143],v[188:191],a[124:127]
s_waitcnt vmcnt(12) lgkmcnt(0)
s_barrier
v_mfma_f32_16x16x32_bf16 a[0:3],v[64:67],v[96:99],a[0:3]
ds_read_b128 v[128:131],v12 offset:49152
v_mfma_f32_16x16x32_bf16 a[4:7],v[64:67],v[100:103],a[4:7]
ds_read_b64_tr_b16 v[160:161],v16 offset:49152
s_add_u32 m0,s23,32768
v_mfma_f32_16x16x32_bf16 a[8:11],v[64:67],v[104:107],a[8:11]
ds_read_b64_tr_b16 v[162:163],v16 offset:53248
global_load_lds_dwordx4 v4,s[16:17] offset:0 sc1
v_mfma_f32_16x16x32_bf16 a[12:15],v[64:67],v[108:111],a[12:15]
ds_read_b128 v[132:135],v12 offset:50176
v_mfma_f32_16x16x32_bf16 a[16:19],v[64:67],v[112:115],a[16:19]
ds_read_b64_tr_b16 v[164:165],v17 offset:49152
global_load_lds_dwordx4 v5,s[16:17] offset:1024 sc1
v_mfma_f32_16x16x32_bf16 a[20:23],v[64:67],v[116:119],a[20:23]
ds_read_b64_tr_b16 v[166:167],v17 offset:53248
v_mfma_f32_16x16x32_bf16 a[24:27],v[64:67],v[120:123],a[24:27]
ds_read_b128 v[136:139],v12 offset:53248
s_add_u32 m0,s23,98304
v_mfma_f32_16x16x32_bf16 a[28:31],v[64:67],v[124:127],a[28:31]
ds_read_b64_tr_b16 v[168:169],v18 offset:49152
s_add_u32 s16,s16,s20
v_mfma_f32_16x16x32_bf16 a[32:35],v[68:71],v[96:99],a[32:35]
ds_read_b64_tr_b16 v[170:171],v18 offset:53248
s_addc_u32 s17,s17,0
v_mfma_f32_16x16x32_bf16 a[36:39],v[68:71],v[100:103],a[36:39]
ds_read_b128 v[140:143],v12 offset:54272
global_load_lds_dwordx4 v8,s[18:19] offset:0
v_mfma_f32_16x16x32_bf16 a[40:43],v[68:71],v[104:107],a[40:43]
ds_read_b64_tr_b16 v[172:173],v19 offset:49152
v_mfma_f32_16x16x32_bf16 a[44:47],v[68:71],v[108:111],a[44:47]
ds_read_b64_tr_b16 v[174:175],v19 offset:53248
global_load_lds_dwordx4 v9,s[18:19] offset:1024
v_mfma_f32_16x16x32_bf16 a[48:51],v[68:71],v[112:115],a[48:51]
ds_read_b64_tr_b16 v[176:177],v20 offset:49152
v_mfma_f32_16x16x32_bf16 a[52:55],v[68:71],v[116:119],a[52:55]
ds_read_b64_tr_b16 v[178:179],v20 offset:53248
global_load_lds_dwordx4 v10,s[18:19] offset:2048
v_mfma_f32_16x16x32_bf16 a[56:59],v[68:71],v[120:123],a[56:59]
ds_read_b64_tr_b16 v[180:181],v21 offset:49152
v_mfma_f32_16x16x32_bf16 a[60:63],v[68:71],v[124:127],a[60:63]
ds_read_b64_tr_b16 v[182:183],v21 offset:53248
global_load_lds_dwordx4 v11,s[18:19] offset:3072
v_mfma_f32_16x16x32_bf16 a[64:67],v[72:75],v[96:99],a[64:67]
ds_read_b64_tr_b16 v[184:185],v22 offset:49152
v_mfma_f32_16x16x32_bf16 a[68:71],v[72:75],v[100:103],a[68:71]
ds_read_b64_tr_b16 v[186:187],v22 offset:53248
s_add_u32 s18,s18,s21
v_mfma_f32_16x16x32_bf16 a[72:75],v[72:75],v[104:107],a[72:75]
ds_read_b64_tr_b16 v[188:189],v23 offset:49152
s_addc_u32 s19,s19,0
v_mfma_f32_16x16x32_bf16 a[76:79],v[72:75],v[108:111],a[76:79]
ds_read_b64_tr_b16 v[190:191],v23 offset:53248
v_mfma_f32_16x16x32_bf16 a[80:83],v[72:75],v[112:115],a[80:83]
v_mfma_f32_16x16x32_bf16 a[84:87],v[72:75],v[116:119],a[84:87]
v_mfma_f32_16x16x32_bf16 a[88:91],v[72:75],v[120:123],a[88:91]
v_mfma_f32_16x16x32_bf16 a[92:95],v[72:75],v[124:127],a[92:95]
v_mfma_f32_16x16x32_bf16 a[96:99],v[76:79],v[96:99],a[96:99]
v_mfma_f32_16x16x32_bf16 a[100:103],v[76:79],v[100:103],a[100:103]
v_mfma_f32_16x16x32_bf16 a[104:107],v[76:79],v[104:107],a[104:107]
v_mfma_f32_16x16x32_bf16 a[108:111],v[76:79],v[108:111],a[108:111]
v_mfma_f32_16x16x32_bf16 a[112:115],v[76:79],v[112:115],a[112:115]
v_mfma_f32_16x16x32_bf16 a[116:119],v[76:79],v[116:119],a[116:119]
v_mfma_f32_16x16x32_bf16 a[120:123],v[76:79],v[120:123],a[120:123]
v_mfma_f32_16x16x32_bf16 a[124:127],v[76:79],v[124:127],a[124:127]
s_waitcnt vmcnt(12) lgkmcnt(0)
s_barrier
v_mfma_f32_16x16x32_bf16 a[0:3],v[128:131],v[160:163],a[0:3]
ds_read_b128 v[64:67],v12 offset:0
v_mfma_f32_16x16x32_bf16 a[4:7],v[128:131],v[164:167],a[4:7]
ds_read_b64_tr_b16 v[96:97],v16 offset:0
s_add_u32 m0,s23,49152
v_mfma_f32_16x16x32_bf16 a[8:11],v[128:131],v[168:171],a[8:11]
ds_read_b64_tr_b16 v[98:99],v16 offset:4096
global_load_lds_dwordx4 v4,s[16:17] offset:0 sc1
v_mfma_f32_16x16x32_bf16 a[12:15],v[128:131],v[172:175],a[12:15]
ds_read_b128 v[68:71],v12 offset:1024
v_mfma_f32_16x16x32_bf16 a[16:19],v[128:131],v[176:179],a[16:19]
ds_read_b64_tr_b16 v[100:101],v17 offset:0
global_load_lds_dwordx4 v5,s[16:17] offset:1024 sc1
v_mfma_f32_16x16x32_bf16 a[20:23],v[128:131],v[180:183],a[20:23]
ds_read_b64_tr_b16 v[102:103],v17 offset:4096
v_mfma_f32_16x16x32_bf16 a[24:27],v[128:131],v[184:187],a[24:27]
ds_read_b128 v[72:75],v12 offset:4096
s_add_u32 m0,s23,114688
v_mfma_f32_16x16x32_bf16 a[28:31],v[128:131],v[188:191],a[28:31]
ds_read_b64_tr_b16 v[104:105],v18 offset:0
s_add_u32 s16,s16,s20
v_mfma_f32_16x16x32_bf16 a[32:35],v[132:135],v[160:163],a[32:35]
ds_read_b64_tr_b16 v[106:107],v18 offset:4096
s_addc_u32 s17,s17,0
v_mfma_f32_16x16x32_bf16 a[36:39],v[132:135],v[164:167],a[36:39]
ds_read_b128 v[76:79],v12 offset:5120
global_load_lds_dwordx4 v8,s[18:19] offset:0
v_mfma_f32_16x16x32_bf16 a[40:43],v[132:135],v[168:171],a[40:43]
ds_read_b64_tr_b16 v[108:109],v19 offset:0
v_mfma_f32_16x16x32_bf16 a[44:47],v[132:135],v[172:175],a[44:47]
ds_read_b64_tr_b16 v[110:111],v19 offset:4096
global_load_lds_dwordx4 v9,s[18:19] offset:1024
v_mfma_f32_16x16x32_bf16 a[48:51],v[132:135],v[176:179],a[48:51]
ds_read_b64_tr_b16 v[112:113],v20 offset:0
v_mfma_f32_16x16x32_bf16 a[52:55],v[132:135],v[180:183],a[52:55]
ds_read_b64_tr_b16 v[114:115],v20 offset:4096
global_load_lds_dwordx4 v10,s[18:19] offset:2048
v_mfma_f32_16x16x32_bf16 a[56:59],v[132:135],v[184:187],a[56:59]
ds_read_b64_tr_b16 v[116:117],v21 offset:0
v_mfma_f32_16x16x32_bf16 a[60:63],v[132:135],v[188:191],a[60:63]
ds_read_b64_tr_b16 v[118:119],v21 offset:4096
global_load_lds_dwordx4 v11,s[18:19] offset:3072
v_mfma_f32_16x16x32_bf16 a[64:67],v[136:139],v[160:163],a[64:67]
ds_read_b64_tr_b16 v[120:121],v22 offset:0
v_mfma_f32_16x16x32_bf16 a[68:71],v[136:139],v[164:167],a[68:71]
ds_read_b64_tr_b16 v[122:123],v22 offset:4096
s_add_u32 s18,s18,s21
v_mfma_f32_16x16x32_bf16 a[72:75],v[136:139],v[168:171],a[72:75]
ds_read_b64_tr_b16 v[124:125],v23 offset:0
s_addc_u32 s19,s19,0
v_mfma_f32_16x16x32_bf16 a[76:79],v[136:139],v[172:175],a[76:79]
ds_read_b64_tr_b16 v[126:127],v23 offset:4096
s_cmp_eq_u32 s39,0
s_cbranch_scc1 L_sig5
s_mov_b32 s39,0
s_mov_b64 exec,1
global_atomic_add v233,v252,s[4:5]
s_mov_b64 exec,-1
v_mov_b32 v252,1
L_sig5:
s_nop 0
v_mfma_f32_16x16x32_bf16 a[80:83],v[136:139],v[176:179],a[80:83]
global_load_dword v236,v238,s[4:5] sc1
v_mfma_f32_16x16x32_bf16 a[84:87],v[136:139],v[180:183],a[84:87]
v_mfma_f32_16x16x32_bf16 a[88:91],v[136:139],v[184:187],a[88:91]
v_mfma_f32_16x16x32_bf16 a[92:95],v[136:139],v[188:191],a[92:95]
v_mfma_f32_16x16x32_bf16 a[96:99],v[140:143],v[160:163],a[96:99]
v_mfma_f32_16x16x32_bf16 a[100:103],v[140:143],v[164:167],a[100:103]
v_mfma_f32_16x16x32_bf16 a[104:107],v[140:143],v[168:171],a[104:107]
v_mfma_f32_16x16x32_bf16 a[108:111],v[140:143],v[172:175],a[108:111]
v_mfma_f32_16x16x32_bf16 a[112:115],v[140:143],v[176:179],a[112:115]
v_mfma_f32_16x16x32_bf16 a[116:119],v[140:143],v[180:183],a[116:119]
v_mfma_f32_16x16x32_bf16 a[120:123],v[140:143],v[184:187],a[120:123]
v_mfma_f32_16x16x32_bf16 a[124:127],v[140:143],v[188:191],a[124:127]
L_g_vs_mid:
s_waitcnt vmcnt(12) lgkmcnt(0)
s_barrier
v_mfma_f32_16x16x32_bf16 a[0:3],v[64:67],v[96:99],a[0:3]
ds_read_b128 v[128:131],v12 offset:16384
v_mfma_f32_16x16x32_bf16 a[4:7],v[64:67],v[100:103],a[4:7]
ds_read_b64_tr_b16 v[160:161],v16 offset:16384
s_add_u32 m0,s23,0
v_mfma_f32_16x16x32_bf16 a[8:11],v[64:67],v[104:107],a[8:11]
ds_read_b64_tr_b16 v[162:163],v16 offset:20480
global_load_lds_dwordx4 v4,s[16:17] offset:0 sc1
v_mfma_f32_16x16x32_bf16 a[12:15],v[64:67],v[108:111],a[12:15]
ds_read_b128 v[132:135],v12 offset:17408
v_mfma_f32_16x16x32_bf16 a[16:19],v[64:67],v[112:115],a[16:19]
ds_read_b64_tr_b16 v[164:165],v17 offset:16384
global_load_lds_dwordx4 v5,s[16:17] offset:1024 sc1
v_mfma_f32_16x16x32_bf16 a[20:23],v[64:67],v[116:119],a[20:23]
ds_read_b64_tr_b16 v[166:167],v17 offset:20480
v_mfma_f32_16x16x32_bf16 a[24:27],v[64:67],v[120:123],a[24:27]
ds_read_b128 v[136:139],v12 offset:20480
s_add_u32 m0,s23,65536
v_mfma_f32_16x16x32_bf16 a[28:31],v[64:67],v[124:127],a[28:31]
ds_read_b64_tr_b16 v[168:169],v18 offset:16384
s_add_u32 s16,s16,s20
v_mfma_f32_16x16x32_bf16 a[32:35],v[68:71],v[96:99],a[32:35]
ds_read_b64_tr_b16 v[170:171],v18 offset:20480
s_addc_u32 s17,s17,0
v_mfma_f32_16x16x32_bf16 a[36:39],v[68:71],v[100:103],a[36:39]
ds_read_b128 v[140:143],v12 offset:21504
global_load_lds_dwordx4 v8,s[18:19] offset:0
v_mfma_f32_16x16x32_bf16 a[40:43],v[68:71],v[104:107],a[40:43]
ds_read_b64_tr_b16 v[172:173],v19 offset:16384
v_mfma_f32_16x16x32_bf16 a[44:47],v[68:71],v[108:111],a[44:47]
ds_read_b64_tr_b16 v[174:175],v19 offset:20480
global_load_lds_dwordx4 v9,s[18:19] offset:1024
v_mfma_f32_16x16x32_bf16 a[48:51],v[68:71],v[112:115],a[48:51]
ds_read_b64_tr_b16 v[176:177],v20 offset:16384
v_mfma_f32_16x16x32_bf16 a[52:55],v[68:71],v[116:119],a[52:55]
ds_read_b64_tr_b16 v[178:179],v20 offset:20480
global_load_lds_dwordx4 v10,s[18:19] offset:2048
v_mfma_f32_16x16x32_bf16 a[56:59],v[68:71],v[120:123],a[56:59]
ds_read_b64_tr_b16 v[180:181],v21 offset:16384
v_mfma_f32_16x16x32_bf16 a[60:63],v[68:71],v[124:127],a[60:63]
ds_read_b64_tr_b16 v[182:183],v21 offset:20480
global_load_lds_dwordx4 v11,s[18:19] offset:3072
v_mfma_f32_16x16x32_bf16 a[64:67],v[72:75],v[96:99],a[64:67]
ds_read_b64_tr_b16 v[184:185],v22 offset:16384
v_mfma_f32_16x16x32_bf16 a[68:71],v[72:75],v[100:103],a[68:71]
ds_read_b64_tr_b16 v[186:187],v22 offset:20480
s_add_u32 s18,s18,s21
v_mfma_f32_16x16x32_bf16 a[72:75],v[72:75],v[104:107],a[72:75]
ds_read_b64_tr_b16 v[188:189],v23 offset:16384
s_addc_u32 s19,s19,0
v_mfma_f32_16x16x32_bf16 a[76:79],v[72:75],v[108:111],a[76:79]
ds_read_b64_tr_b16 v[190:191],v23 offset:20480
v_mfma_f32_16x16x32_bf16 a[80:83],v[72:75],v[112:115],a[80:83]
v_mfma_f32_16x16x32_bf16 a[84:87],v[72:75],v[116:119],a[84:87]
v_mfma_f32_16x16x32_bf16 a[88:91],v[72:75],v[120:123],a[88:91]
v_mfma_f32_16x16x32_bf16 a[92:95],v[72:75],v[124:127],a[92:95]
v_mfma_f32_16x16x32_bf16 a[96:99],v[76:79],v[96:99],a[96:99]
v_mfma_f32_16x16x32_bf16 a[100:103],v[76:79],v[100:103],a[100:103]
v_mfma_f32_16x16x32_bf16 a[104:107],v[76:79],v[104:107],a[104:107]
v_mfma_f32_16x16x32_bf16 a[108:111],v[76:79],v[108:111],a[108:111]
v_mfma_f32_16x16x32_bf16 a[112:115],v[76:79],v[112:115],a[112:115]
v_mfma_f32_16x16x32_bf16 a[116:119],v[76:79],v[116:119],a[116:119]
v_mfma_f32_16x16x32_bf16 a[120:123],v[76:79],v[120:123],a[120:123]
v_mfma_f32_16x16x32_bf16 a[124:127],v[76:79],v[124:127],a[124:127]
s_waitcnt vmcnt(12) lgkmcnt(0)
s_barrier
v_mfma_f32_16x16x32_bf16 a[0:3],v[128:131],v[160:163],a[0:3]
ds_read_b128 v[64:67],v12 offset:32768
v_mfma_f32_16x16x32_bf16 a[4:7],v[128:131],v[164:167],a[4:7]
ds_read_b64_tr_b16 v[96:97],v16 offset:32768
s_add_u32 m0,s23,16384
v_mfma_f32_16x16x32_bf16 a[8:11],v[128:131],v[168:171],a[8:11]
ds_read_b64_tr_b16 v[98:99],v16 offset:36864
global_load_lds_dwordx4 v4,s[16:17] offset:0 sc1
v_mfma_f32_16x16x32_bf16 a[12:15],v[128:131],v[172:175],a[12:15]
ds_read_b128 v[68:71],v12 offset:33792
v_mfma_f32_16x16x32_bf16 a[16:19],v[128:131],v[176:179],a[16:19]
ds_read_b64_tr_b16 v[100:101],v17 offset:32768
global_load_lds_dwordx4 v5,s[16:17] offset:1024 sc1
v_mfma_f32_16x16x32_bf16 a[20:23],v[128:131],v[180:183],a[20:23]
ds_read_b64_tr_b16 v[102:103],v17 offset:36864
v_mfma_f32_16x16x32_bf16 a[24:27],v[128:131],v[184:187],a[24:27]
ds_read_b128 v[72:75],v12 offset:36864
s_add_u32 m0,s23,81920
v_mfma_f32_16x16x32_bf16 a[28:31],v[128:131],v[188:191],a[28:31]
ds_read_b64_tr_b16 v[104:105],v18 offset:32768
s_add_u32 s16,s16,s20
v_mfma_f32_16x16x32_bf16 a[32:35],v[132:135],v[160:163],a[32:35]
ds_read_b64_tr_b16 v[106:107],v18 offset:36864
s_addc_u32 s17,s17,0
v_mfma_f32_16x16x32_bf16 a[36:39],v[132:135],v[164:167],a[36:39]
ds_read_b128 v[76:79],v12 offset:37888
global_load_lds_dwordx4 v8,s[18:19] offset:0
v_mfma_f32_16x16x32_bf16 a[40:43],v[132:135],v[168:171],a[40:43]
ds_read_b64_tr_b16 v[108:109],v19 offset:32768
v_mfma_f32_16x16x32_bf16 a[44:47],v[132:135],v[172:175],a[44:47]
ds_read_b64_tr_b16 v[110:111],v19 offset:36864
global_load_lds_dwordx4 v9,s[18:19] offset:1024
v_mfma_f32_16x16x32_bf16 a[48:51],v[132:135],v[176:179],a[48:51]
ds_read_b64_tr_b16 v[112:113],v20 offset:32768
v_mfma_f32_16x16x32_bf16 a[52:55],v[132:135],v[180:183],a[52:55]
ds_read_b64_tr_b16 v[114:115],v20 offset:36864
global_load_lds_dwordx4 v10,s[18:19] offset:2048
v_mfma_f32_16x16x32_bf16 a[56:59],v[132:135],v[184:187],a[56:59]
ds_read_b64_tr_b16 v[116:117],v21 offset:32768
v_mfma_f32_16x16x32_bf16 a[60:63],v[132:135],v[188:191],a[60:63]
ds_read_b64_tr_b16 v[118:119],v21 offset:36864
global_load_lds_dwordx4 v11,s[18:19] offset:3072
v_mfma_f32_16x16x32_bf16 a[64:67],v[136:139],v[160:163],a[64:67]
ds_read_b64_tr_b16 v[120:121],v22 offset:32768
v_mfma_f32_16x16x32_bf16 a[68:71],v[136:139],v[164:167],a[68:71]
ds_read_b64_tr_b16 v[122:123],v22 offset:36864
s_add_u32 s18,s18,s21
v_mfma_f32_16x16x32_bf16 a[72:75],v[136:139],v[168:171],a[72:75]
ds_read_b64_tr_b16 v[124:125],v23 offset:32768
s_addc_u32 s19,s19,0
v_mfma_f32_16x16x32_bf16 a[76:79],v[136:139],v[172:175],a[76:79]
ds_read_b64_tr_b16 v[126:127],v23 offset:36864
v_mfma_f32_16x16x32_bf16 a[80:83],v[136:139],v[176:179],a[80:83]
v_mfma_f32_16x16x32_bf16 a[84:87],v[136:139],v[180:183],a[84:87]
v_mfma_f32_16x16x32_bf16 a[88:91],v[136:139],v[184:187],a[88:91]
v_mfma_f32_16x16x32_bf16 a[92:95],v[136:139],v[188:191],a[92:95]
v_mfma_f32_16x16x32_bf16 a[96:99],v[140:143],v[160:163],a[96:99]
v_mfma_f32_16x16x32_bf16 a[100:103],v[140:143],v[164:167],a[100:103]
v_mfma_f32_16x16x32_bf16 a[104:107],v[140:143],v[168:171],a[104:107]
v_mfma_f32_16x16x32_bf16 a[108:111],v[140:143],v[172:175],a[108:111]
v_mfma_f32_16x16x32_bf16 a[112:115],v[140:143],v[176:179],a[112:115]
v_mfma_f32_16x16x32_bf16 a[116:119],v[140:143],v[180:183],a[116:119]
v_mfma_f32_16x16x32_bf16 a[120:123],v[140:143],v[184:187],a[120:123]
v_mfma_f32_16x16x32_bf16 a[124:127],v[140:143],v[188:191],a[124:127]
s_waitcnt vmcnt(12) lgkmcnt(0)
s_barrier
v_mfma_f32_16x16x32_bf16 a[0:3],v[64:67],v[96:99],a[0:3]
ds_read_b128 v[128:131],v12 offset:49152
v_mfma_f32_16x16x32_bf16 a[4:7],v[64:67],v[100:103],a[4:7]
ds_read_b64_tr_b16 v[160:161],v16 offset:49152
s_add_u32 m0,s23,32768
v_mfma_f32_16x16x32_bf16 a[8:11],v[64:67],v[104:107],a[8:11]
ds_read_b64_tr_b16 v[162:163],v16 offset:53248
global_load_lds_dwordx4 v4,s[16:17] offset:0 sc1
v_mfma_f32_16x16x32_bf16 a[12:15],v[64:67],v[108:111],a[12:15]
ds_read_b128 v[132:135],v12 offset:50176
v_mfma_f32_16x16x32_bf16 a[16:19],v[64:67],v[112:115],a[16:19]
ds_read_b64_tr_b16 v[164:165],v17 offset:49152
global_load_lds_dwordx4 v5,s[16:17] offset:1024 sc1
v_mfma_f32_16x16x32_bf16 a[20:23],v[64:67],v[116:119],a[20:23]
ds_read_b64_tr_b16 v[166:167],v17 offset:53248
v_mfma_f32_16x16x32_bf16 a[24:27],v[64:67],v[120:123],a[24:27]
ds_read_b128 v[136:139],v12 offset:53248
s_add_u32 m0,s23,98304
v_mfma_f32_16x16x32_bf16 a[28:31],v[64:67],v[124:127],a[28:31]
ds_read_b64_tr_b16 v[168:169],v18 offset:49152
s_add_u32 s16,s16,s20
v_mfma_f32_16x16x32_bf16 a[32:35],v[68:71],v[96:99],a[32:35]
ds_read_b64_tr_b16 v[170:171],v18 offset:53248
s_addc_u32 s17,s17,0
v_mfma_f32_16x16x32_bf16 a[36:39],v[68:71],v[100:103],a[36:39]
ds_read_b128 v[140:143],v12 offset:54272
global_load_lds_dwordx4 v8,s[18:19] offset:0
v_mfma_f32_16x16x32_bf16 a[40:43],v[68:71],v[104:107],a[40:43]
ds_read_b64_tr_b16 v[172:173],v19 offset:49152
v_mfma_f32_16x16x32_bf16 a[44:47],v[68:71],v[108:111],a[44:47]
ds_read_b64_tr_b16 v[174:175],v19 offset:53248
global_load_lds_dwordx4 v9,s[18:19] offset:1024
v_mfma_f32_16x16x32_bf16 a[48:51],v[68:71],v[112:115],a[48:51]
ds_read_b64_tr_b16 v[176:177],v20 offset:49152
v_mfma_f32_16x16x32_bf16 a[52:55],v[68:71],v[116:119],a[52:55]
ds_read_b64_tr_b16 v[178:179],v20 offset:53248
global_load_lds_dwordx4 v10,s[18:19] offset:2048
v_mfma_f32_16x16x32_bf16 a[56:59],v[68:71],v[120:123],a[56:59]
ds_read_b64_tr_b16 v[180:181],v21 offset:49152
v_mfma_f32_16x16x32_bf16 a[60:63],v[68:71],v[124:127],a[60:63]
ds_read_b64_tr_b16 v[182:183],v21 offset:53248
global_load_lds_dwordx4 v11,s[18:19] offset:3072
v_mfma_f32_16x16x32_bf16 a[64:67],v[72:75],v[96:99],a[64:67]
ds_read_b64_tr_b16 v[184:185],v22 offset:49152
v_mfma_f32_16x16x32_bf16 a[68:71],v[72:75],v[100:103],a[68:71]
ds_read_b64_tr_b16 v[186:187],v22 offset:53248
s_add_u32 s18,s18,s21
v_mfma_f32_16x16x32_bf16 a[72:75],v[72:75],v[104:107],a[72:75]
ds_read_b64_tr_b16 v[188:189],v23 offset:49152
s_addc_u32 s19,s19,0
v_mfma_f32_16x16x32_bf16 a[76:79],v[72:75],v[108:111],a[76:79]
ds_read_b64_tr_b16 v[190:191],v23 offset:53248
ds_write_b32 v239,v236
v_mfma_f32_16x16x32_bf16 a[80:83],v[72:75],v[112:115],a[80:83]
v_mfma_f32_16x16x32_bf16 a[84:87],v[72:75],v[116:119],a[84:87]
v_mfma_f32_16x16x32_bf16 a[88:91],v[72:75],v[120:123],a[88:91]
v_mfma_f32_16x16x32_bf16 a[92:95],v[72:75],v[124:127],a[92:95]
v_mfma_f32_16x16x32_bf16 a[96:99],v[76:79],v[96:99],a[96:99]
v_mfma_f32_16x16x32_bf16 a[100:103],v[76:79],v[100:103],a[100:103]
v_mfma_f32_16x16x32_bf16 a[104:107],v[76:79],v[104:107],a[104:107]
v_mfma_f32_16x16x32_bf16 a[108:111],v[76:79],v[108:111],a[108:111]
v_mfma_f32_16x16x32_bf16 a[112:115],v[76:79],v[112:115],a[112:115]
v_mfma_f32_16x16x32_bf16 a[116:119],v[76:79],v[116:119],a[116:119]
v_mfma_f32_16x16x32_bf16 a[120:123],v[76:79],v[120:123],a[120:123]
v_mfma_f32_16x16x32_bf16 a[124:127],v[76:79],v[124:127],a[124:127]
s_waitcnt vmcnt(12) lgkmcnt(0)
s_barrier
v_mfma_f32_16x16x32_bf16 a[0:3],v[128:131],v[160:163],a[0:3]
ds_read_b128 v[64:67],v12 offset:0
v_mfma_f32_16x16x32_bf16 a[4:7],v[128:131],v[164:167],a[4:7]
ds_read_b64_tr_b16 v[96:97],v16 offset:0
s_add_u32 m0,s23,49152
v_mfma_f32_16x16x32_bf16 a[8:11],v[128:131],v[168:171],a[8:11]
ds_read_b64_tr_b16 v[98:99],v16 offset:4096
global_load_lds_dwordx4 v4,s[16:17] offset:0 sc1
v_mfma_f32_16x16x32_bf16 a[12:15],v[128:131],v[172:175],a[12:15]
ds_read_b128 v[68:71],v12 offset:1024
v_mfma_f32_16x16x32_bf16 a[16:19],v[128:131],v[176:179],a[16:19]
ds_read_b64_tr_b16 v[100:101],v17 offset:0
global_load_lds_dwordx4 v5,s[16:17] offset:1024 sc1
v_mfma_f32_16x16x32_bf16 a[20:23],v[128:131],v[180:183],a[20:23]
ds_read_b64_tr_b16 v[102:103],v17 offset:4096
v_mfma_f32_16x16x32_bf16 a[24:27],v[128:131],v[184:187],a[24:27]
ds_read_b128 v[72:75],v12 offset:4096
s_add_u32 m0,s23,114688
v_mfma_f32_16x16x32_bf16 a[28:31],v[128:131],v[188:191],a[28:31]
ds_read_b64_tr_b16 v[104:105],v18 offset:0
s_add_u32 s16,s16,s20
v_mfma_f32_16x16x32_bf16 a[32:35],v[132:135],v[160:163],a[32:35]
ds_read_b64_tr_b16 v[106:107],v18 offset:4096
s_addc_u32 s17,s17,0
v_mfma_f32_16x16x32_bf16 a[36:39],v[132:135],v[164:167],a[36:39]
ds_read_b128 v[76:79],v12 offset:5120
global_load_lds_dwordx4 v8,s[18:19] offset:0
v_mfma_f32_16x16x32_bf16 a[40:43],v[132:135],v[168:171],a[40:43]
ds_read_b64_tr_b16 v[108:109],v19 offset:0
v_mfma_f32_16x16x32_bf16 a[44:47],v[132:135],v[172:175],a[44:47]
ds_read_b64_tr_b16 v[110:111],v19 offset:4096
global_load_lds_dwordx4 v9,s[18:19] offset:1024
v_mfma_f32_16x16x32_bf16 a[48:51],v[132:135],v[176:179],a[48:51]
ds_read_b64_tr_b16 v[112:113],v20 offset:0
v_mfma_f32_16x16x32_bf16 a[52:55],v[132:135],v[180:183],a[52:55]
ds_read_b64_tr_b16 v[114:115],v20 offset:4096
global_load_lds_dwordx4 v10,s[18:19] offset:2048
v_mfma_f32_16x16x32_bf16 a[56:59],v[132:135],v[184:187],a[56:59]
ds_read_b64_tr_b16 v[116:117],v21 offset:0
v_mfma_f32_16x16x32_bf16 a[60:63],v[132:135],v[188:191],a[60:63]
ds_read_b64_tr_b16 v[118:119],v21 offset:4096
global_load_lds_dwordx4 v11,s[18:19] offset:3072
v_mfma_f32_16x16x32_bf16 a[64:67],v[136:139],v[160:163],a[64:67]
ds_read_b64_tr_b16 v[120:121],v22 offset:0
v_mfma_f32_16x16x32_bf16 a[68:71],v[136:139],v[164:167],a[68:71]
ds_read_b64_tr_b16 v[122:123],v22 offset:4096
s_add_u32 s18,s18,s21
v_mfma_f32_16x16x32_bf16 a[72:75],v[136:139],v[168:171],a[72:75]
ds_read_b64_tr_b16 v[124:125],v23 offset:0
s_addc_u32 s19,s19,0
v_mfma_f32_16x16x32_bf16 a[76:79],v[136:139],v[172:175],a[76:79]
ds_read_b64_tr_b16 v[126:127],v23 offset:4096
global_load_dword v236,v238,s[4:5] sc1
v_mfma_f32_16x16x32_bf16 a[80:83],v[136:139],v[176:179],a[80:83]
v_mfma_f32_16x16x32_bf16 a[84:87],v[136:139],v[180:183],a[84:87]
v_mfma_f32_16x16x32_bf16 a[88:91],v[136:139],v[184:187],a[88:91]
v_mfma_f32_16x16x32_bf16 a[92:95],v[136:139],v[188:191],a[92:95]
v_mfma_f32_16x16x32_bf16 a[96:99],v[140:143],v[160:163],a[96:99]
v_mfma_f32_16x16x32_bf16 a[100:103],v[140:143],v[164:167],a[100:103]
v_mfma_f32_16x16x32_bf16 a[104:107],v[140:143],v[168:171],a[104:107]
v_mfma_f32_16x16x32_bf16 a[108:111],v[140:143],v[172:175],a[108:111]
v_mfma_f32_16x16x32_bf16 a[112:115],v[140:143],v[176:179],a[112:115]
v_mfma_f32_16x16x32_bf16 a[116:119],v[140:143],v[180:183],a[116:119]
v_mfma_f32_16x16x32_bf16 a[120:123],v[140:143],v[184:187],a[120:123]
v_mfma_f32_16x16x32_bf16 a[124:127],v[140:143],v[188:191],a[124:127]
s_sub_u32 s22,s22,1
s_cmp_lg_u32 s22,0
s_cbranch_scc1 L_g_vs_mid
s_mov_b32 s36,s33
s_and_b32 s33,s27,15
s_bfe_u32 s34,s27,0x40004
s_bfe_u32 s35,s27,0x60008
s_mov_b32 s28,1
s_sub_u32 s54,s33,1
s_cmp_lt_u32 s54,5
s_cbranch_scc1 L_g_vs_h_ck
s_sub_u32 s54,s33,9
s_cmp_lt_u32 s54,4
s_cbranch_scc0 L_g_vs_h_no
L_g_vs_h_ck:
ds_read_b128 v[24:27],v15
s_bfe_u32 s55,s27,0x60014
s_waitcnt lgkmcnt(0)
v_min3_u32 v24,v24,v25,v26
v_min_u32 v24,v24,v27
s_nop 0
v_readfirstlane_b32 s54,v24
s_nop 0
s_cmp_ge_u32 s54,s55
s_cbranch_scc1 L_g_vs_h_pf
L_g_vs_h_no:
s_mov_b32 s28,0
s_mov_b32 s33,1
s_mov_b32 s34,0
s_mov_b32 s35,0
L_g_vs_h_pf:
s_lshr_b32 s55,s14,1
s_mov_b32 s24,-1
s_cmp_eq_u32 s33,5
s_cbranch_scc1 L_g_vs_h_sd_d8
s_cmp_eq_u32 s33,8
s_cbranch_scc1 L_g_vs_h_sd_d4
s_cmp_eq_u32 s33,12
s_cbranch_scc1 L_g_vs_h_sd_d4
s_sub_u32 s54,s33,6
s_cmp_lt_u32 s54,2
s_cbranch_scc1 L_g_vs_h_sd_db
s_lshl_b32 s54,s34,19
s_add_u32 s54,s54,104857600
s_add_u32 s16,s4,s54
s_addc_u32 s17,s5,0
s_mov_b32 s20,1024
v_mov_b32 v4,v192
v_mov_b32 v5,v193
v_mov_b32 v6,v194
v_mov_b32 v7,v195
s_cmp_lt_u32 s33,9
s_cbranch_scc1 L_g_vs_h_sd_big
s_lshl_b32 s54,s34,18
s_lshl_b32 s59,s14,16
s_add_u32 s54,s54,s59
s_add_u32 s54,s54,104857600
s_add_u32 s16,s4,s54
s_addc_u32 s17,s5,0
v_mov_b32 v4,v2
v_add_u32 v5,31744,v2
v_mov_b32 v6,0
v_mov_b32 v7,0
L_g_vs_h_sd_big:
s_cmp_eq_u32 s33,4
s_cbranch_scc1 L_g_vs_h_sd_up
s_cmp_eq_u32 s33,1
s_cselect_b64 s[56:57],s[66:67],s[68:69]
s_cmp_eq_u32 s33,3
s_cselect_b64 s[56:57],s[70:71],s[56:57]
s_cmp_eq_u32 s33,11
s_cselect_b64 s[56:57],s[70:71],s[56:57]
s_cmp_eq_u32 s33,9
s_cselect_b64 s[56:57],s[66:67],s[56:57]
s_lshl_b32 s54,s35,9
s_lshl_b32 s59,s55,8
s_add_u32 s54,s54,s59
s_add_u32 s18,s56,s54
s_addc_u32 s19,s57,0
s_mov_b32 s21,262144
v_mov_b32 v8,v200
v_mov_b32 v9,v201
v_mov_b32 v10,v202
v_mov_b32 v11,v203
s_branch L_g_vs_h_sd_e
L_g_vs_h_sd_up:
s_cmp_eq_u32 s55,1
s_cselect_b64 s[56:57],s[74:75],s[72:73]
s_and_b32 s54,s35,31
s_lshl_b32 s54,s54,8
s_add_u32 s18,s56,s54
s_addc_u32 s19,s57,0
s_mov_b32 s21,229376
v_mov_b32 v8,v204
v_mov_b32 v9,v205
v_mov_b32 v10,v206
v_mov_b32 v11,v207
s_bitcmp1_b32 s35,5
s_cbranch_scc0 L_g_vs_h_sd_e
s_and_b32 s54,s34,3
s_mul_i32 s24,s54,2
s_mul_i32 s25,s20,32
s_mul_i32 s3,s21,32
s_lshl_b32 s54,s24,2
s_mul_i32 s57,s54,s20
s_add_u32 s16,s16,s57
s_addc_u32 s17,s17,0
s_mul_i32 s57,s54,s21
s_add_u32 s18,s18,s57
s_addc_u32 s19,s19,0
s_branch L_g_vs_h_sd_e
L_g_vs_h_sd_d8:
s_mul_i32 s54,s34,1835008
s_add_u32 s54,s54,50331648
s_add_u32 s16,s4,s54
s_addc_u32 s17,s5,0
s_mov_b32 s20,1024
s_and_b32 s54,s35,31
s_lshl_b32 s54,s54,9
s_lshl_b32 s59,s55,8
s_add_u32 s54,s54,s59
s_add_u32 s18,s76,s54
s_addc_u32 s19,s77,0
s_mov_b32 s21,65536
v_mov_b32 v4,v196
v_add_u32 v5,113664,v196
v_add_u32 v6,227328,v196
v_add_u32 v7,340992,v196
v_mov_b32 v8,v208
v_mov_b32 v9,v209
v_mov_b32 v10,v210
v_mov_b32 v11,v211
s_bitcmp1_b32 s35,5
s_cbranch_scc0 L_g_vs_h_sd_e
s_and_b32 s54,s34,3
s_mul_i32 s24,s54,7
s_mul_i32 s25,s20,112
s_mul_i32 s3,s21,112
s_lshl_b32 s54,s24,2
s_mul_i32 s57,s54,s20
s_add_u32 s16,s16,s57
s_addc_u32 s17,s17,0
s_mul_i32 s57,s54,s21
s_add_u32 s18,s18,s57
s_addc_u32 s19,s19,0
s_branch L_g_vs_h_sd_e
L_g_vs_h_sd_d4:
s_lshl_b32 s54,s34,20
s_lshl_b32 s59,s14,18
s_add_u32 s54,s54,s59
s_add_u32 s54,s54,67108864
s_mul_i32 s58,s34,917504
s_mul_i32 s59,s14,229376
s_add_u32 s58,s58,s59
s_add_u32 s58,s58,50331648
s_cmp_eq_u32 s33,8
s_cselect_b32 s54,s54,s58
s_cselect_b32 s58,16,0
s_cselect_b64 s[56:57],s[60:61],s[76:77]
s_add_u32 s16,s4,s54
s_addc_u32 s17,s5,0
s_mov_b32 s20,1024
s_lshl_b32 s54,s35,9
s_lshl_b32 s59,s55,8
s_add_u32 s54,s54,s59
s_add_u32 s18,s56,s54
s_addc_u32 s19,s57,0
s_mov_b32 s21,65536
v_mov_b32 v4,v2
s_lshl_b32 s58,s58,10
s_add_u32 s58,s58,113664
v_add_u32 v5,s58,v2
v_mov_b32 v6,0
v_mov_b32 v7,0
v_mov_b32 v8,v208
v_mov_b32 v9,v209
v_mov_b32 v10,v210
v_mov_b32 v11,v211
s_branch L_g_vs_h_sd_e
L_g_vs_h_sd_db:
s_lshr_b32 s57,s35,3
s_lshl_b32 s54,s34,20
s_lshl_b32 s59,s57,15
s_add_u32 s54,s54,s59
s_add_u32 s54,s54,67106816
s_and_b32 s12,s35,7
s_lshl_b32 s12,s12,8
s_lshl_b32 s59,s55,16
s_add_u32 s12,s12,s59
s_lshl_b32 s59,s57,21
s_add_u32 s12,s12,s59
s_add_u32 s16,s4,s54
s_addc_u32 s17,s5,0
s_mov_b32 s20,2048
s_add_u32 s18,s60,s12
s_addc_u32 s19,s61,0
s_mov_b32 s21,131072
s_lshl_b32 s54,s14,1
s_add_u32 s54,s54,s57
s_and_b32 s54,s54,3
s_lshl_b32 s54,s54,17
s_lshl_b32 s59,s55,19
s_add_u32 s54,s54,s59
s_add_u32 s54,s54,2048
v_add_u32 v4,s54,v2
v_mov_b32 v5,v4
s_lshl_b32 s54,s14,1
s_add_u32 s54,s54,s57
s_add_u32 s54,s54,1
s_and_b32 s54,s54,3
s_lshl_b32 s54,s54,17
s_lshl_b32 s59,s55,19
s_add_u32 s54,s54,s59
v_add_u32 v6,s54,v2
v_mov_b32 v7,v6
v_mov_b32 v8,v208
v_mov_b32 v9,v209
v_mov_b32 v10,v210
v_mov_b32 v11,v211
L_g_vs_h_sd_e:
s_cmp_eq_u32 s28,0
s_cselect_b64 s[16:17],s[64:65],s[16:17]
s_cselect_b32 s54,0,-1
s_and_b32 s21,s21,s54
v_and_b32 v4,s54,v4
v_and_b32 v5,s54,v5
v_and_b32 v6,s54,v6
v_and_b32 v7,s54,v7
v_and_b32 v8,s54,v8
v_and_b32 v9,s54,v9
v_and_b32 v10,s54,v10
v_and_b32 v11,s54,v11
s_waitcnt vmcnt(12) lgkmcnt(0)
s_barrier
v_mfma_f32_16x16x32_bf16 a[0:3],v[64:67],v[96:99],a[0:3]
ds_read_b128 v[128:131],v12 offset:16384
v_mfma_f32_16x16x32_bf16 a[4:7],v[64:67],v[100:103],a[4:7]
ds_read_b64_tr_b16 v[160:161],v16 offset:16384
s_add_u32 m0,s23,0
v_mfma_f32_16x16x32_bf16 a[8:11],v[64:67],v[104:107],a[8:11]
ds_read_b64_tr_b16 v[162:163],v16 offset:20480
global_load_lds_dwordx4 v4,s[16:17] offset:0 sc1
v_mfma_f32_16x16x32_bf16 a[12:15],v[64:67],v[108:111],a[12:15]
ds_read_b128 v[132:135],v12 offset:17408
v_mfma_f32_16x16x32_bf16 a[16:19],v[64:67],v[112:115],a[16:19]
ds_read_b64_tr_b16 v[164:165],v17 offset:16384
global_load_lds_dwordx4 v5,s[16:17] offset:1024 sc1
v_mfma_f32_16x16x32_bf16 a[20:23],v[64:67],v[116:119],a[20:23]
ds_read_b64_tr_b16 v[166:167],v17 offset:20480
v_mfma_f32_16x16x32_bf16 a[24:27],v[64:67],v[120:123],a[24:27]
ds_read_b128 v[136:139],v12 offset:20480
global_load_lds_dwordx4 v6,s[16:17] offset:2048 sc1
v_mfma_f32_16x16x32_bf16 a[28:31],v[64:67],v[124:127],a[28:31]
ds_read_b64_tr_b16 v[168:169],v18 offset:16384
v_mfma_f32_16x16x32_bf16 a[32:35],v[68:71],v[96:99],a[32:35]
ds_read_b64_tr_b16 v[170:171],v18 offset:20480
global_load_lds_dwordx4 v7,s[16:17] offset:3072 sc1
v_mfma_f32_16x16x32_bf16 a[36:39],v[68:71],v[100:103],a[36:39]
ds_read_b128 v[140:143],v12 offset:21504
v_mfma_f32_16x16x32_bf16 a[40:43],v[68:71],v[104:107],a[40:43]
ds_read_b64_tr_b16 v[172:173],v19 offset:16384
s_add_u32 m0,s23,65536
v_mfma_f32_16x16x32_bf16 a[44:47],v[68:71],v[108:111],a[44:47]
ds_read_b64_tr_b16 v[174:175],v19 offset:20480
s_add_u32 s16,s16,s20
v_mfma_f32_16x16x32_bf16 a[48:51],v[68:71],v[112:115],a[48:51]
ds_read_b64_tr_b16 v[176:177],v20 offset:16384
s_addc_u32 s17,s17,0
v_mfma_f32_16x16x32_bf16 a[52:55],v[68:71],v[116:119],a[52:55]
ds_read_b64_tr_b16 v[178:179],v20 offset:20480
global_load_lds_dwordx4 v8,s[18:19] offset:0
v_mfma_f32_16x16x32_bf16 a[56:59],v[68:71],v[120:123],a[56:59]
ds_read_b64_tr_b16 v[180:181],v21 offset:16384
v_mfma_f32_16x16x32_bf16 a[60:63],v[68:71],v[124:127],a[60:63]
ds_read_b64_tr_b16 v[182:183],v21 offset:20480
global_load_lds_dwordx4 v9,s[18:19] offset:1024
v_mfma_f32_16x16x32_bf16 a[64:67],v[72:75],v[96:99],a[64:67]
ds_read_b64_tr_b16 v[184:185],v22 offset:16384
v_mfma_f32_16x16x32_bf16 a[68:71],v[72:75],v[100:103],a[68:71]
ds_read_b64_tr_b16 v[186:187],v22 offset:20480
global_load_lds_dwordx4 v10,s[18:19] offset:2048
v_mfma_f32_16x16x32_bf16 a[72:75],v[72:75],v[104:107],a[72:75]
ds_read_b64_tr_b16 v[188:189],v23 offset:16384
v_mfma_f32_16x16x32_bf16 a[76:79],v[72:75],v[108:111],a[76:79]
ds_read_b64_tr_b16 v[190:191],v23 offset:20480
global_load_lds_dwordx4 v11,s[18:19] offset:3072
v_mfma_f32_16x16x32_bf16 a[80:83],v[72:75],v[112:115],a[80:83]
v_mfma_f32_16x16x32_bf16 a[84:87],v[72:75],v[116:119],a[84:87]
s_add_u32 s18,s18,s21
v_mfma_f32_16x16x32_bf16 a[88:91],v[72:75],v[120:123],a[88:91]
s_addc_u32 s19,s19,0
v_mfma_f32_16x16x32_bf16 a[92:95],v[72:75],v[124:127],a[92:95]
v_mfma_f32_16x16x32_bf16 a[96:99],v[76:79],v[96:99],a[96:99]
v_mfma_f32_16x16x32_bf16 a[100:103],v[76:79],v[100:103],a[100:103]
v_mfma_f32_16x16x32_bf16 a[104:107],v[76:79],v[104:107],a[104:107]
v_mfma_f32_16x16x32_bf16 a[108:111],v[76:79],v[108:111],a[108:111]
v_mfma_f32_16x16x32_bf16 a[112:115],v[76:79],v[112:115],a[112:115]
v_mfma_f32_16x16x32_bf16 a[116:119],v[76:79],v[116:119],a[116:119]
v_mfma_f32_16x16x32_bf16 a[120:123],v[76:79],v[120:123],a[120:123]
v_mfma_f32_16x16x32_bf16 a[124:127],v[76:79],v[124:127],a[124:127]
s_waitcnt vmcnt(14) lgkmcnt(0)
s_barrier
v_mfma_f32_16x16x32_bf16 a[0:3],v[128:131],v[160:163],a[0:3]
ds_read_b128 v[64:67],v12 offset:32768
v_mfma_f32_16x16x32_bf16 a[4:7],v[128:131],v[164:167],a[4:7]
ds_read_b64_tr_b16 v[96:97],v16 offset:32768
s_add_u32 m0,s23,16384
v_mfma_f32_16x16x32_bf16 a[8:11],v[128:131],v[168:171],a[8:11]
ds_read_b64_tr_b16 v[98:99],v16 offset:36864
global_load_lds_dwordx4 v4,s[16:17] offset:0 sc1
v_mfma_f32_16x16x32_bf16 a[12:15],v[128:131],v[172:175],a[12:15]
ds_read_b128 v[68:71],v12 offset:33792
v_mfma_f32_16x16x32_bf16 a[16:19],v[128:131],v[176:179],a[16:19]
ds_read_b64_tr_b16 v[100:101],v17 offset:32768
global_load_lds_dwordx4 v5,s[16:17] offset:1024 sc1
v_mfma_f32_16x16x32_bf16 a[20:23],v[128:131],v[180:183],a[20:23]
ds_read_b64_tr_b16 v[102:103],v17 offset:36864
v_mfma_f32_16x16x32_bf16 a[24:27],v[128:131],v[184:187],a[24:27]
ds_read_b128 v[72:75],v12 offset:36864
global_load_lds_dwordx4 v6,s[16:17] offset:2048 sc1
v_mfma_f32_16x16x32_bf16 a[28:31],v[128:131],v[188:191],a[28:31]
ds_read_b64_tr_b16 v[104:105],v18 offset:32768
v_mfma_f32_16x16x32_bf16 a[32:35],v[132:135],v[160:163],a[32:35]
ds_read_b64_tr_b16 v[106:107],v18 offset:36864
global_load_lds_dwordx4 v7,s[16:17] offset:3072 sc1
v_mfma_f32_16x16x32_bf16 a[36:39],v[132:135],v[164:167],a[36:39]
ds_read_b128 v[76:79],v12 offset:37888
v_mfma_f32_16x16x32_bf16 a[40:43],v[132:135],v[168:171],a[40:43]
ds_read_b64_tr_b16 v[108:109],v19 offset:32768
s_add_u32 m0,s23,81920
v_mfma_f32_16x16x32_bf16 a[44:47],v[132:135],v[172:175],a[44:47]
ds_read_b64_tr_b16 v[110:111],v19 offset:36864
s_add_u32 s16,s16,s20
v_mfma_f32_16x16x32_bf16 a[48:51],v[132:135],v[176:179],a[48:51]
ds_read_b64_tr_b16 v[112:113],v20 offset:32768
s_addc_u32 s17,s17,0
v_mfma_f32_16x16x32_bf16 a[52:55],v[132:135],v[180:183],a[52:55]
ds_read_b64_tr_b16 v[114:115],v20 offset:36864
global_load_lds_dwordx4 v8,s[18:19] offset:0
v_mfma_f32_16x16x32_bf16 a[56:59],v[132:135],v[184:187],a[56:59]
ds_read_b64_tr_b16 v[116:117],v21 offset:32768
v_mfma_f32_16x16x32_bf16 a[60:63],v[132:135],v[188:191],a[60:63]
ds_read_b64_tr_b16 v[118:119],v21 offset:36864
global_load_lds_dwordx4 v9,s[18:19] offset:1024
v_mfma_f32_16x16x32_bf16 a[64:67],v[136:139],v[160:163],a[64:67]
ds_read_b64_tr_b16 v[120:121],v22 offset:32768
v_mfma_f32_16x16x32_bf16 a[68:71],v[136:139],v[164:167],a[68:71]
ds_read_b64_tr_b16 v[122:123],v22 offset:36864
global_load_lds_dwordx4 v10,s[18:19] offset:2048
v_mfma_f32_16x16x32_bf16 a[72:75],v[136:139],v[168:171],a[72:75]
ds_read_b64_tr_b16 v[124:125],v23 offset:32768
v_mfma_f32_16x16x32_bf16 a[76:79],v[136:139],v[172:175],a[76:79]
ds_read_b64_tr_b16 v[126:127],v23 offset:36864
global_load_lds_dwordx4 v11,s[18:19] offset:3072
v_mfma_f32_16x16x32_bf16 a[80:83],v[136:139],v[176:179],a[80:83]
v_mfma_f32_16x16x32_bf16 a[84:87],v[136:139],v[180:183],a[84:87]
s_add_u32 s18,s18,s21
v_mfma_f32_16x16x32_bf16 a[88:91],v[136:139],v[184:187],a[88:91]
s_addc_u32 s19,s19,0
v_mfma_f32_16x16x32_bf16 a[92:95],v[136:139],v[188:191],a[92:95]
v_mfma_f32_16x16x32_bf16 a[96:99],v[140:143],v[160:163],a[96:99]
v_mfma_f32_16x16x32_bf16 a[100:103],v[140:143],v[164:167],a[100:103]
v_mfma_f32_16x16x32_bf16 a[104:107],v[140:143],v[168:171],a[104:107]
v_mfma_f32_16x16x32_bf16 a[108:111],v[140:143],v[172:175],a[108:111]
v_mfma_f32_16x16x32_bf16 a[112:115],v[140:143],v[176:179],a[112:115]
v_mfma_f32_16x16x32_bf16 a[116:119],v[140:143],v[180:183],a[116:119]
v_mfma_f32_16x16x32_bf16 a[120:123],v[140:143],v[184:187],a[120:123]
v_mfma_f32_16x16x32_bf16 a[124:127],v[140:143],v[188:191],a[124:127]
s_waitcnt vmcnt(16) lgkmcnt(0)
s_barrier
v_mfma_f32_16x16x32_bf16 a[0:3],v[64:67],v[96:99],a[0:3]
ds_read_b128 v[128:131],v12 offset:49152
v_mfma_f32_16x16x32_bf16 a[4:7],v[64:67],v[100:103],a[4:7]
ds_read_b64_tr_b16 v[160:161],v16 offset:49152
s_add_u32 m0,s23,32768
v_mfma_f32_16x16x32_bf16 a[8:11],v[64:67],v[104:107],a[8:11]
ds_read_b64_tr_b16 v[162:163],v16 offset:53248
global_load_lds_dwordx4 v4,s[16:17] offset:0 sc1
v_mfma_f32_16x16x32_bf16 a[12:15],v[64:67],v[108:111],a[12:15]
ds_read_b128 v[132:135],v12 offset:50176
v_mfma_f32_16x16x32_bf16 a[16:19],v[64:67],v[112:115],a[16:19]
ds_read_b64_tr_b16 v[164:165],v17 offset:49152
global_load_lds_dwordx4 v5,s[16:17] offset:1024 sc1
v_mfma_f32_16x16x32_bf16 a[20:23],v[64:67],v[116:119],a[20:23]
ds_read_b64_tr_b16 v[166:167],v17 offset:53248
v_mfma_f32_16x16x32_bf16 a[24:27],v[64:67],v[120:123],a[24:27]
ds_read_b128 v[136:139],v12 offset:53248
global_load_lds_dwordx4 v6,s[16:17] offset:2048 sc1
v_mfma_f32_16x16x32_bf16 a[28:31],v[64:67],v[124:127],a[28:31]
ds_read_b64_tr_b16 v[168:169],v18 offset:49152
v_mfma_f32_16x16x32_bf16 a[32:35],v[68:71],v[96:99],a[32:35]
ds_read_b64_tr_b16 v[170:171],v18 offset:53248
global_load_lds_dwordx4 v7,s[16:17] offset:3072 sc1
v_mfma_f32_16x16x32_bf16 a[36:39],v[68:71],v[100:103],a[36:39]
ds_read_b128 v[140:143],v12 offset:54272
v_mfma_f32_16x16x32_bf16 a[40:43],v[68:71],v[104:107],a[40:43]
ds_read_b64_tr_b16 v[172:173],v19 offset:49152
s_add_u32 m0,s23,98304
v_mfma_f32_16x16x32_bf16 a[44:47],v[68:71],v[108:111],a[44:47]
ds_read_b64_tr_b16 v[174:175],v19 offset:53248
s_add_u32 s16,s16,s20
v_mfma_f32_16x16x32_bf16 a[48:51],v[68:71],v[112:115],a[48:51]
ds_read_b64_tr_b16 v[176:177],v20 offset:49152
s_addc_u32 s17,s17,0
v_mfma_f32_16x16x32_bf16 a[52:55],v[68:71],v[116:119],a[52:55]
ds_read_b64_tr_b16 v[178:179],v20 offset:53248
global_load_lds_dwordx4 v8,s[18:19] offset:0
v_mfma_f32_16x16x32_bf16 a[56:59],v[68:71],v[120:123],a[56:59]
ds_read_b64_tr_b16 v[180:181],v21 offset:49152
v_mfma_f32_16x16x32_bf16 a[60:63],v[68:71],v[124:127],a[60:63]
ds_read_b64_tr_b16 v[182:183],v21 offset:53248
global_load_lds_dwordx4 v9,s[18:19] offset:1024
v_mfma_f32_16x16x32_bf16 a[64:67],v[72:75],v[96:99],a[64:67]
ds_read_b64_tr_b16 v[184:185],v22 offset:49152
v_mfma_f32_16x16x32_bf16 a[68:71],v[72:75],v[100:103],a[68:71]
ds_read_b64_tr_b16 v[186:187],v22 offset:53248
global_load_lds_dwordx4 v10,s[18:19] offset:2048
v_mfma_f32_16x16x32_bf16 a[72:75],v[72:75],v[104:107],a[72:75]
ds_read_b64_tr_b16 v[188:189],v23 offset:49152
v_mfma_f32_16x16x32_bf16 a[76:79],v[72:75],v[108:111],a[76:79]
ds_read_b64_tr_b16 v[190:191],v23 offset:53248
global_load_lds_dwordx4 v11,s[18:19] offset:3072
v_mfma_f32_16x16x32_bf16 a[80:83],v[72:75],v[112:115],a[80:83]
v_mfma_f32_16x16x32_bf16 a[84:87],v[72:75],v[116:119],a[84:87]
s_add_u32 s18,s18,s21
v_mfma_f32_16x16x32_bf16 a[88:91],v[72:75],v[120:123],a[88:91]
s_addc_u32 s19,s19,0
v_mfma_f32_16x16x32_bf16 a[92:95],v[72:75],v[124:127],a[92:95]
v_mfma_f32_16x16x32_bf16 a[96:99],v[76:79],v[96:99],a[96:99]
v_mfma_f32_16x16x32_bf16 a[100:103],v[76:79],v[100:103],a[100:103]
v_mfma_f32_16x16x32_bf16 a[104:107],v[76:79],v[104:107],a[104:107]
v_mfma_f32_16x16x32_bf16 a[108:111],v[76:79],v[108:111],a[108:111]
v_mfma_f32_16x16x32_bf16 a[112:115],v[76:79],v[112:115],a[112:115]
v_mfma_f32_16x16x32_bf16 a[116:119],v[76:79],v[116:119],a[116:119]
v_mfma_f32_16x16x32_bf16 a[120:123],v[76:79],v[120:123],a[120:123]
v_mfma_f32_16x16x32_bf16 a[124:127],v[76:79],v[124:127],a[124:127]
s_waitcnt vmcnt(63) lgkmcnt(0)
s_barrier
v_mfma_f32_16x16x32_bf16 a[0:3],v[128:131],v[160:163],a[0:3]
v_mfma_f32_16x16x32_bf16 a[4:7],v[128:131],v[164:167],a[4:7]
s_add_u32 m0,s23,49152
v_mfma_f32_16x16x32_bf16 a[8:11],v[128:131],v[168:171],a[8:11]
global_load_lds_dwordx4 v4,s[16:17] offset:0 sc1
v_mfma_f32_16x16x32_bf16 a[12:15],v[128:131],v[172:175],a[12:15]
v_mfma_f32_16x16x32_bf16 a[16:19],v[128:131],v[176:179],a[16:19]
global_load_lds_dwordx4 v5,s[16:17] offset:1024 sc1
v_mfma_f32_16x16x32_bf16 a[20:23],v[128:131],v[180:183],a[20:23]
v_mfma_f32_16x16x32_bf16 a[24:27],v[128:131],v[184:187],a[24:27]
global_load_lds_dwordx4 v6,s[16:17] offset:2048 sc1
v_mfma_f32_16x16x32_bf16 a[28:31],v[128:131],v[188:191],a[28:31]
v_mfma_f32_16x16x32_bf16 a[32:35],v[132:135],v[160:163],a[32:35]
global_load_lds_dwordx4 v7,s[16:17] offset:3072 sc1
v_mfma_f32_16x16x32_bf16 a[36:39],v[132:135],v[164:167],a[36:39]
v_mfma_f32_16x16x32_bf16 a[40:43],v[132:135],v[168:171],a[40:43]
s_add_u32 m0,s23,114688
v_mfma_f32_16x16x32_bf16 a[44:47],v[132:135],v[172:175],a[44:47]
s_add_u32 s16,s16,s20
v_mfma_f32_16x16x32_bf16 a[48:51],v[132:135],v[176:179],a[48:51]
s_addc_u32 s17,s17,0
v_mfma_f32_16x16x32_bf16 a[52:55],v[132:135],v[180:183],a[52:55]
global_load_lds_dwordx4 v8,s[18:19] offset:0
v_mfma_f32_16x16x32_bf16 a[56:59],v[132:135],v[184:187],a[56:59]
v_mfma_f32_16x16x32_bf16 a[60:63],v[132:135],v[188:191],a[60:63]
global_load_lds_dwordx4 v9,s[18:19] offset:1024
v_mfma_f32_16x16x32_bf16 a[64:67],v[136:139],v[160:163],a[64:67]
v_mfma_f32_16x16x32_bf16 a[68:71],v[136:139],v[164:167],a[68:71]
global_load_lds_dwordx4 v10,s[18:19] offset:2048
v_mfma_f32_16x16x32_bf16 a[72:75],v[136:139],v[168:171],a[72:75]
v_mfma_f32_16x16x32_bf16 a[76:79],v[136:139],v[172:175],a[76:79]
global_load_lds_dwordx4 v11,s[18:19] offset:3072
v_mfma_f32_16x16x32_bf16 a[80:83],v[136:139],v[176:179],a[80:83]
v_mfma_f32_16x16x32_bf16 a[84:87],v[136:139],v[180:183],a[84:87]
s_add_u32 s18,s18,s21
v_mfma_f32_16x16x32_bf16 a[88:91],v[136:139],v[184:187],a[88:91]
s_addc_u32 s19,s19,0
v_mfma_f32_16x16x32_bf16 a[92:95],v[136:139],v[188:191],a[92:95]
v_mfma_f32_16x16x32_bf16 a[96:99],v[140:143],v[160:163],a[96:99]
v_mfma_f32_16x16x32_bf16 a[100:103],v[140:143],v[164:167],a[100:103]
v_mfma_f32_16x16x32_bf16 a[104:107],v[140:143],v[168:171],a[104:107]
v_mfma_f32_16x16x32_bf16 a[108:111],v[140:143],v[172:175],a[108:111]
v_mfma_f32_16x16x32_bf16 a[112:115],v[140:143],v[176:179],a[112:115]
v_mfma_f32_16x16x32_bf16 a[116:119],v[140:143],v[180:183],a[116:119]
v_mfma_f32_16x16x32_bf16 a[120:123],v[140:143],v[184:187],a[120:123]
v_mfma_f32_16x16x32_bf16 a[124:127],v[140:143],v[188:191],a[124:127]
v_accvgpr_read_b32 v32,a0
v_accvgpr_read_b32 v33,a1
v_accvgpr_read_b32 v34,a2
v_accvgpr_read_b32 v35,a3
v_accvgpr_read_b32 v36,a32
v_accvgpr_read_b32 v37,a33
v_accvgpr_read_b32 v38,a34
v_accvgpr_read_b32 v39,a35
v_cvt_pk_bf16_f32 v64,v32,v33
v_cvt_pk_bf16_f32 v65,v34,v35
v_cvt_pk_bf16_f32 v66,v36,v37
v_cvt_pk_bf16_f32 v67,v38,v39
global_store_dwordx4 v2,v[64:67],s[30:31] offset:0 sc1
v_accvgpr_read_b32 v24,a4
v_accvgpr_read_b32 v25,a5
v_accvgpr_read_b32 v26,a6
v_accvgpr_read_b32 v27,a7
v_accvgpr_read_b32 v28,a36
v_accvgpr_read_b32 v29,a37
v_accvgpr_read_b32 v30,a38
v_accvgpr_read_b32 v31,a39
v_cvt_pk_bf16_f32 v68,v24,v25
v_cvt_pk_bf16_f32 v69,v26,v27
v_cvt_pk_bf16_f32 v70,v28,v29
v_cvt_pk_bf16_f32 v71,v30,v31
global_store_dwordx4 v2,v[68:71],s[30:31] offset:1024 sc1
v_accvgpr_read_b32 v32,a8
v_accvgpr_read_b32 v33,a9
v_accvgpr_read_b32 v34,a10
v_accvgpr_read_b32 v35,a11
v_accvgpr_read_b32 v36,a40
v_accvgpr_read_b32 v37,a41
v_accvgpr_read_b32 v38,a42
v_accvgpr_read_b32 v39,a43
v_cvt_pk_bf16_f32 v72,v32,v33
v_cvt_pk_bf16_f32 v73,v34,v35
v_cvt_pk_bf16_f32 v74,v36,v37
v_cvt_pk_bf16_f32 v75,v38,v39
global_store_dwordx4 v2,v[72:75],s[30:31] offset:2048 sc1
v_accvgpr_read_b32 v24,a12
v_accvgpr_read_b32 v25,a13
v_accvgpr_read_b32 v26,a14
v_accvgpr_read_b32 v27,a15
v_accvgpr_read_b32 v28,a44
v_accvgpr_read_b32 v29,a45
v_accvgpr_read_b32 v30,a46
v_accvgpr_read_b32 v31,a47
v_cvt_pk_bf16_f32 v76,v24,v25
v_cvt_pk_bf16_f32 v77,v26,v27
v_cvt_pk_bf16_f32 v78,v28,v29
v_cvt_pk_bf16_f32 v79,v30,v31
global_store_dwordx4 v2,v[76:79],s[30:31] offset:3072 sc1
v_accvgpr_read_b32 v32,a16
v_accvgpr_read_b32 v33,a17
v_accvgpr_read_b32 v34,a18
v_accvgpr_read_b32 v35,a19
v_accvgpr_read_b32 v36,a48
v_accvgpr_read_b32 v37,a49
v_accvgpr_read_b32 v38,a50
v_accvgpr_read_b32 v39,a51
v_cvt_pk_bf16_f32 v80,v32,v33
v_cvt_pk_bf16_f32 v81,v34,v35
v_cvt_pk_bf16_f32 v82,v36,v37
v_cvt_pk_bf16_f32 v83,v38,v39
global_store_dwordx4 v3,v[80:83],s[30:31] offset:0 sc1
v_accvgpr_read_b32 v24,a20
v_accvgpr_read_b32 v25,a21
v_accvgpr_read_b32 v26,a22
v_accvgpr_read_b32 v27,a23
v_accvgpr_read_b32 v28,a52
v_accvgpr_read_b32 v29,a53
v_accvgpr_read_b32 v30,a54
v_accvgpr_read_b32 v31,a55
v_cvt_pk_bf16_f32 v84,v24,v25
v_cvt_pk_bf16_f32 v85,v26,v27
v_cvt_pk_bf16_f32 v86,v28,v29
v_cvt_pk_bf16_f32 v87,v30,v31
global_store_dwordx4 v3,v[84:87],s[30:31] offset:1024 sc1
v_accvgpr_read_b32 v32,a24
v_accvgpr_read_b32 v33,a25
v_accvgpr_read_b32 v34,a26
v_accvgpr_read_b32 v35,a27
v_accvgpr_read_b32 v36,a56
v_accvgpr_read_b32 v37,a57
v_accvgpr_read_b32 v38,a58
v_accvgpr_read_b32 v39,a59
v_cvt_pk_bf16_f32 v88,v32,v33
v_cvt_pk_bf16_f32 v89,v34,v35
v_cvt_pk_bf16_f32 v90,v36,v37
v_cvt_pk_bf16_f32 v91,v38,v39
global_store_dwordx4 v3,v[88:91],s[30:31] offset:2048 sc1
v_accvgpr_read_b32 v24,a28
v_accvgpr_read_b32 v25,a29
v_accvgpr_read_b32 v26,a30
v_accvgpr_read_b32 v27,a31
v_accvgpr_read_b32 v28,a60
v_accvgpr_read_b32 v29,a61
v_accvgpr_read_b32 v30,a62
v_accvgpr_read_b32 v31,a63
v_cvt_pk_bf16_f32 v92,v24,v25
v_cvt_pk_bf16_f32 v93,v26,v27
v_cvt_pk_bf16_f32 v94,v28,v29
v_cvt_pk_bf16_f32 v95,v30,v31
global_store_dwordx4 v3,v[92:95],s[30:31] offset:3072 sc1
s_add_u32 s30,s30,8192
s_addc_u32 s31,s31,0
v_accvgpr_read_b32 v32,a64
v_accvgpr_read_b32 v33,a65
v_accvgpr_read_b32 v34,a66
v_accvgpr_read_b32 v35,a67
v_accvgpr_read_b32 v36,a96
v_accvgpr_read_b32 v37,a97
v_accvgpr_read_b32 v38,a98
v_accvgpr_read_b32 v39,a99
v_cvt_pk_bf16_f32 v96,v32,v33
v_cvt_pk_bf16_f32 v97,v34,v35
v_cvt_pk_bf16_f32 v98,v36,v37
v_cvt_pk_bf16_f32 v99,v38,v39
global_store_dwordx4 v2,v[96:99],s[30:31] offset:0 sc1
v_accvgpr_read_b32 v24,a68
v_accvgpr_read_b32 v25,a69
v_accvgpr_read_b32 v26,a70
v_accvgpr_read_b32 v27,a71
v_accvgpr_read_b32 v28,a100
v_accvgpr_read_b32 v29,a101
v_accvgpr_read_b32 v30,a102
v_accvgpr_read_b32 v31,a103
v_cvt_pk_bf16_f32 v100,v24,v25
v_cvt_pk_bf16_f32 v101,v26,v27
v_cvt_pk_bf16_f32 v102,v28,v29
v_cvt_pk_bf16_f32 v103,v30,v31
global_store_dwordx4 v2,v[100:103],s[30:31] offset:1024 sc1
v_accvgpr_read_b32 v32,a72
v_accvgpr_read_b32 v33,a73
v_accvgpr_read_b32 v34,a74
v_accvgpr_read_b32 v35,a75
v_accvgpr_read_b32 v36,a104
v_accvgpr_read_b32 v37,a105
v_accvgpr_read_b32 v38,a106
v_accvgpr_read_b32 v39,a107
v_cvt_pk_bf16_f32 v104,v32,v33
v_cvt_pk_bf16_f32 v105,v34,v35
v_cvt_pk_bf16_f32 v106,v36,v37
v_cvt_pk_bf16_f32 v107,v38,v39
global_store_dwordx4 v2,v[104:107],s[30:31] offset:2048 sc1
v_accvgpr_read_b32 v24,a76
v_accvgpr_read_b32 v25,a77
v_accvgpr_read_b32 v26,a78
v_accvgpr_read_b32 v27,a79
v_accvgpr_read_b32 v28,a108
v_accvgpr_read_b32 v29,a109
v_accvgpr_read_b32 v30,a110
v_accvgpr_read_b32 v31,a111
v_cvt_pk_bf16_f32 v108,v24,v25
v_cvt_pk_bf16_f32 v109,v26,v27
v_cvt_pk_bf16_f32 v110,v28,v29
v_cvt_pk_bf16_f32 v111,v30,v31
global_store_dwordx4 v2,v[108:111],s[30:31] offset:3072 sc1
v_accvgpr_read_b32 v32,a80
v_accvgpr_read_b32 v33,a81
v_accvgpr_read_b32 v34,a82
v_accvgpr_read_b32 v35,a83
v_accvgpr_read_b32 v36,a112
v_accvgpr_read_b32 v37,a113
v_accvgpr_read_b32 v38,a114
v_accvgpr_read_b32 v39,a115
v_cvt_pk_bf16_f32 v112,v32,v33
v_cvt_pk_bf16_f32 v113,v34,v35
v_cvt_pk_bf16_f32 v114,v36,v37
v_cvt_pk_bf16_f32 v115,v38,v39
global_store_dwordx4 v3,v[112:115],s[30:31] offset:0 sc1
v_accvgpr_read_b32 v24,a84
v_accvgpr_read_b32 v25,a85
v_accvgpr_read_b32 v26,a86
v_accvgpr_read_b32 v27,a87
v_accvgpr_read_b32 v28,a116
v_accvgpr_read_b32 v29,a117
v_accvgpr_read_b32 v30,a118
v_accvgpr_read_b32 v31,a119
v_cvt_pk_bf16_f32 v116,v24,v25
v_cvt_pk_bf16_f32 v117,v26,v27
v_cvt_pk_bf16_f32 v118,v28,v29
v_cvt_pk_bf16_f32 v119,v30,v31
global_store_dwordx4 v3,v[116:119],s[30:31] offset:1024 sc1
v_accvgpr_read_b32 v32,a88
v_accvgpr_read_b32 v33,a89
v_accvgpr_read_b32 v34,a90
v_accvgpr_read_b32 v35,a91
v_accvgpr_read_b32 v36,a120
v_accvgpr_read_b32 v37,a121
v_accvgpr_read_b32 v38,a122
v_accvgpr_read_b32 v39,a123
v_cvt_pk_bf16_f32 v120,v32,v33
v_cvt_pk_bf16_f32 v121,v34,v35
v_cvt_pk_bf16_f32 v122,v36,v37
v_cvt_pk_bf16_f32 v123,v38,v39
global_store_dwordx4 v3,v[120:123],s[30:31] offset:2048 sc1
v_accvgpr_read_b32 v24,a92
v_accvgpr_read_b32 v25,a93
v_accvgpr_read_b32 v26,a94
v_accvgpr_read_b32 v27,a95
v_accvgpr_read_b32 v28,a124
v_accvgpr_read_b32 v29,a125
v_accvgpr_read_b32 v30,a126
v_accvgpr_read_b32 v31,a127
v_cvt_pk_bf16_f32 v124,v24,v25
v_cvt_pk_bf16_f32 v125,v26,v27
v_cvt_pk_bf16_f32 v126,v28,v29
v_cvt_pk_bf16_f32 v127,v30,v31
global_store_dwordx4 v3,v[124:127],s[30:31] offset:3072 sc1
s_lshl_b32 s54,s32,7
s_add_u32 s54,s54,94437376
v_mov_b32 v233,s54
s_cmp_eq_u32 s32,63
s_cselect_b32 s39,0,s38
s_cmp_le_u32 s36,3
s_cselect_b32 s54,2,1
s_cmp_eq_u32 s36,5
s_cselect_b32 s54,2,s54
v_mov_b32 v252,s54
s_waitcnt vmcnt(16)
s_branch L_bulk_adv
L_g_db:
v_mov_b32 v12,v213
v_mov_b32 v16,v224
v_mov_b32 v17,v225
v_mov_b32 v18,v226
v_mov_b32 v19,v227
v_mov_b32 v20,v228
v_mov_b32 v21,v229
v_mov_b32 v22,v230
v_mov_b32 v23,v231
s_lshr_b32 s13,s35,3
s_and_b32 s12,s35,7
s_lshl_b32 s54,s34,18
s_lshl_b32 s59,s55,17
s_add_u32 s54,s54,s59
s_lshl_b32 s59,s12,12
s_add_u32 s54,s54,s59
s_lshl_b32 s59,s56,11
s_add_u32 s54,s54,s59
s_lshl_b32 s59,s13,15
s_add_u32 s54,s54,s59
s_add_u32 s54,s54,100663296
s_add_u32 s30,s4,s54
s_addc_u32 s31,s5,0
s_lshl_b32 s54,s34,18
s_lshl_b32 s59,s12,8
s_add_u32 s54,s54,s59
s_lshl_b32 s59,s13,15
s_add_u32 s54,s54,s59
s_add_u32 s44,s62,s54
s_addc_u32 s45,s63,0
s_lshl_b32 s15,s34,3
s_add_u32 s15,s15,s12
s_cmp_eq_u32 s33,7
s_cselect_b32 s54,2,14
s_mov_b32 s22,s54
s_lshl_b32 s54,s34,10
s_lshl_b32 s59,s13,7
s_add_u32 s54,s54,s59
s_add_u32 s46,s4,s54
s_addc_u32 s47,s5,0
global_load_dwordx2 v[240:241],v237,s[46:47] offset:0 sc1
global_load_dwordx2 v[242:243],v237,s[46:47] offset:128 sc1
global_load_dwordx2 v[244:245],v237,s[46:47] offset:256 sc1
global_load_dwordx2 v[246:247],v237,s[46:47] offset:384 sc1
s_waitcnt vmcnt(16)
s_barrier
ds_read_b128 v[64:67],v12 offset:0
ds_read_b64_tr_b16 v[96:97],v16 offset:0
ds_read_b64_tr_b16 v[98:99],v16 offset:4096
ds_read_b128 v[68:71],v12 offset:1024
ds_read_b64_tr_b16 v[100:101],v17 offset:0
ds_read_b64_tr_b16 v[102:103],v17 offset:4096
ds_read_b128 v[72:75],v12 offset:2048
ds_read_b64_tr_b16 v[104:105],v18 offset:0
ds_read_b64_tr_b16 v[106:107],v18 offset:4096
ds_read_b128 v[76:79],v12 offset:3072
ds_read_b64_tr_b16 v[108:109],v19 offset:0
ds_read_b64_tr_b16 v[110:111],v19 offset:4096
ds_read_b128 v[80:83],v12 offset:4096
ds_read_b64_tr_b16 v[112:113],v20 offset:0
ds_read_b64_tr_b16 v[114:115],v20 offset:4096
ds_read_b128 v[84:87],v12 offset:5120
ds_read_b64_tr_b16 v[116:117],v21 offset:0
ds_read_b64_tr_b16 v[118:119],v21 offset:4096
ds_read_b128 v[88:91],v12 offset:6144
ds_read_b64_tr_b16 v[120:121],v22 offset:0
ds_read_b64_tr_b16 v[122:123],v22 offset:4096
ds_read_b128 v[92:95],v12 offset:7168
ds_read_b64_tr_b16 v[124:125],v23 offset:0
ds_read_b64_tr_b16 v[126:127],v23 offset:4096
s_waitcnt vmcnt(12) lgkmcnt(0)
s_barrier
v_mfma_f32_16x16x32_bf16 a[0:3],v[96:99],v[64:67],0
ds_read_b128 v[128:131],v12 offset:16384
v_mfma_f32_16x16x32_bf16 a[4:7],v[100:103],v[64:67],0
ds_read_b64_tr_b16 v[160:161],v16 offset:16384
s_add_u32 m0,s23,0
v_mfma_f32_16x16x32_bf16 a[8:11],v[104:107],v[64:67],0
ds_read_b64_tr_b16 v[162:163],v16 offset:20480
global_load_lds_dwordx4 v4,s[16:17] offset:0 sc1
v_mfma_f32_16x16x32_bf16 a[12:15],v[108:111],v[64:67],0
ds_read_b128 v[132:135],v12 offset:17408
v_mfma_f32_16x16x32_bf16 a[16:19],v[96:99],v[72:75],0
ds_read_b64_tr_b16 v[164:165],v17 offset:16384
global_load_lds_dwordx4 v5,s[16:17] offset:1024 sc1
v_mfma_f32_16x16x32_bf16 a[20:23],v[100:103],v[72:75],0
ds_read_b64_tr_b16 v[166:167],v17 offset:20480
v_mfma_f32_16x16x32_bf16 a[24:27],v[104:107],v[72:75],0
ds_read_b128 v[136:139],v12 offset:18432
global_load_lds_dwordx4 v6,s[16:17] offset:2048 sc1
v_mfma_f32_16x16x32_bf16 a[28:31],v[108:111],v[72:75],0
ds_read_b64_tr_b16 v[168:169],v18 offset:16384
v_mfma_f32_16x16x32_bf16 a[32:35],v[96:99],v[80:83],0
ds_read_b64_tr_b16 v[170:171],v18 offset:20480
global_load_lds_dwordx4 v7,s[16:17] offset:3072 sc1
v_mfma_f32_16x16x32_bf16 a[36:39],v[100:103],v[80:83],0
ds_read_b128 v[140:143],v12 offset:19456
v_mfma_f32_16x16x32_bf16 a[40:43],v[104:107],v[80:83],0
ds_read_b64_tr_b16 v[172:173],v19 offset:16384
s_add_u32 m0,s23,65536
v_mfma_f32_16x16x32_bf16 a[44:47],v[108:111],v[80:83],0
ds_read_b64_tr_b16 v[174:175],v19 offset:20480
s_add_u32 s16,s16,s20
v_mfma_f32_16x16x32_bf16 a[48:51],v[96:99],v[88:91],0
ds_read_b128 v[144:147],v12 offset:20480
s_addc_u32 s17,s17,0
v_mfma_f32_16x16x32_bf16 a[52:55],v[100:103],v[88:91],0
ds_read_b64_tr_b16 v[176:177],v20 offset:16384
global_load_lds_dwordx4 v8,s[18:19] offset:0
v_mfma_f32_16x16x32_bf16 a[56:59],v[104:107],v[88:91],0
ds_read_b64_tr_b16 v[178:179],v20 offset:20480
v_mfma_f32_16x16x32_bf16 a[60:63],v[108:111],v[88:91],0
ds_read_b128 v[148:151],v12 offset:21504
global_load_lds_dwordx4 v9,s[18:19] offset:1024
v_mfma_f32_16x16x32_bf16 a[0:3],v[112:115],v[68:71],a[0:3]
ds_read_b64_tr_b16 v[180:181],v21 offset:16384
v_mfma_f32_16x16x32_bf16 a[4:7],v[116:119],v[68:71],a[4:7]
ds_read_b64_tr_b16 v[182:183],v21 offset:20480
global_load_lds_dwordx4 v10,s[18:19] offset:2048
v_mfma_f32_16x16x32_bf16 a[8:11],v[120:123],v[68:71],a[8:11]
ds_read_b128 v[152:155],v12 offset:22528
v_mfma_f32_16x16x32_bf16 a[12:15],v[124:127],v[68:71],a[12:15]
ds_read_b64_tr_b16 v[184:185],v22 offset:16384
global_load_lds_dwordx4 v11,s[18:19] offset:3072
v_mfma_f32_16x16x32_bf16 a[16:19],v[112:115],v[76:79],a[16:19]
ds_read_b64_tr_b16 v[186:187],v22 offset:20480
v_mfma_f32_16x16x32_bf16 a[20:23],v[116:119],v[76:79],a[20:23]
ds_read_b128 v[156:159],v12 offset:23552
s_add_u32 s18,s18,s21
v_mfma_f32_16x16x32_bf16 a[24:27],v[120:123],v[76:79],a[24:27]
ds_read_b64_tr_b16 v[188:189],v23 offset:16384
s_addc_u32 s19,s19,0
v_mfma_f32_16x16x32_bf16 a[28:31],v[124:127],v[76:79],a[28:31]
ds_read_b64_tr_b16 v[190:191],v23 offset:20480
v_mfma_f32_16x16x32_bf16 a[32:35],v[112:115],v[84:87],a[32:35]
v_mfma_f32_16x16x32_bf16 a[36:39],v[116:119],v[84:87],a[36:39]
v_mfma_f32_16x16x32_bf16 a[40:43],v[120:123],v[84:87],a[40:43]
v_mfma_f32_16x16x32_bf16 a[44:47],v[124:127],v[84:87],a[44:47]
v_mfma_f32_16x16x32_bf16 a[48:51],v[112:115],v[92:95],a[48:51]
v_mfma_f32_16x16x32_bf16 a[52:55],v[116:119],v[92:95],a[52:55]
v_mfma_f32_16x16x32_bf16 a[56:59],v[120:123],v[92:95],a[56:59]
v_mfma_f32_16x16x32_bf16 a[60:63],v[124:127],v[92:95],a[60:63]
s_waitcnt vmcnt(16) lgkmcnt(0)
s_barrier
v_mfma_f32_16x16x32_bf16 a[0:3],v[160:163],v[128:131],a[0:3]
ds_read_b128 v[64:67],v12 offset:32768
v_mfma_f32_16x16x32_bf16 a[4:7],v[164:167],v[128:131],a[4:7]
ds_read_b64_tr_b16 v[96:97],v16 offset:32768
s_add_u32 m0,s23,16384
v_mfma_f32_16x16x32_bf16 a[8:11],v[168:171],v[128:131],a[8:11]
ds_read_b64_tr_b16 v[98:99],v16 offset:36864
global_load_lds_dwordx4 v4,s[16:17] offset:0 sc1
v_mfma_f32_16x16x32_bf16 a[12:15],v[172:175],v[128:131],a[12:15]
ds_read_b128 v[68:71],v12 offset:33792
v_mfma_f32_16x16x32_bf16 a[16:19],v[160:163],v[136:139],a[16:19]
ds_read_b64_tr_b16 v[100:101],v17 offset:32768
global_load_lds_dwordx4 v5,s[16:17] offset:1024 sc1
v_mfma_f32_16x16x32_bf16 a[20:23],v[164:167],v[136:139],a[20:23]
ds_read_b64_tr_b16 v[102:103],v17 offset:36864
v_mfma_f32_16x16x32_bf16 a[24:27],v[168:171],v[136:139],a[24:27]
ds_read_b128 v[72:75],v12 offset:34816
global_load_lds_dwordx4 v6,s[16:17] offset:2048 sc1
v_mfma_f32_16x16x32_bf16 a[28:31],v[172:175],v[136:139],a[28:31]
ds_read_b64_tr_b16 v[104:105],v18 offset:32768
v_mfma_f32_16x16x32_bf16 a[32:35],v[160:163],v[144:147],a[32:35]
ds_read_b64_tr_b16 v[106:107],v18 offset:36864
global_load_lds_dwordx4 v7,s[16:17] offset:3072 sc1
v_mfma_f32_16x16x32_bf16 a[36:39],v[164:167],v[144:147],a[36:39]
ds_read_b128 v[76:79],v12 offset:35840
v_mfma_f32_16x16x32_bf16 a[40:43],v[168:171],v[144:147],a[40:43]
ds_read_b64_tr_b16 v[108:109],v19 offset:32768
s_add_u32 m0,s23,81920
v_mfma_f32_16x16x32_bf16 a[44:47],v[172:175],v[144:147],a[44:47]
ds_read_b64_tr_b16 v[110:111],v19 offset:36864
s_add_u32 s16,s16,s20
v_mfma_f32_16x16x32_bf16 a[48:51],v[160:163],v[152:155],a[48:51]
ds_read_b128 v[80:83],v12 offset:36864
s_addc_u32 s17,s17,0
v_mfma_f32_16x16x32_bf16 a[52:55],v[164:167],v[152:155],a[52:55]
ds_read_b64_tr_b16 v[112:113],v20 offset:32768
global_load_lds_dwordx4 v8,s[18:19] offset:0
v_mfma_f32_16x16x32_bf16 a[56:59],v[168:171],v[152:155],a[56:59]
ds_read_b64_tr_b16 v[114:115],v20 offset:36864
v_mfma_f32_16x16x32_bf16 a[60:63],v[172:175],v[152:155],a[60:63]
ds_read_b128 v[84:87],v12 offset:37888
global_load_lds_dwordx4 v9,s[18:19] offset:1024
v_mfma_f32_16x16x32_bf16 a[0:3],v[176:179],v[132:135],a[0:3]
ds_read_b64_tr_b16 v[116:117],v21 offset:32768
v_mfma_f32_16x16x32_bf16 a[4:7],v[180:183],v[132:135],a[4:7]
ds_read_b64_tr_b16 v[118:119],v21 offset:36864
global_load_lds_dwordx4 v10,s[18:19] offset:2048
v_mfma_f32_16x16x32_bf16 a[8:11],v[184:187],v[132:135],a[8:11]
ds_read_b128 v[88:91],v12 offset:38912
v_mfma_f32_16x16x32_bf16 a[12:15],v[188:191],v[132:135],a[12:15]
ds_read_b64_tr_b16 v[120:121],v22 offset:32768
global_load_lds_dwordx4 v11,s[18:19] offset:3072
v_mfma_f32_16x16x32_bf16 a[16:19],v[176:179],v[140:143],a[16:19]
ds_read_b64_tr_b16 v[122:123],v22 offset:36864
v_mfma_f32_16x16x32_bf16 a[20:23],v[180:183],v[140:143],a[20:23]
ds_read_b128 v[92:95],v12 offset:39936
s_add_u32 s18,s18,s21
v_mfma_f32_16x16x32_bf16 a[24:27],v[184:187],v[140:143],a[24:27]
ds_read_b64_tr_b16 v[124:125],v23 offset:32768
s_addc_u32 s19,s19,0
v_mfma_f32_16x16x32_bf16 a[28:31],v[188:191],v[140:143],a[28:31]
ds_read_b64_tr_b16 v[126:127],v23 offset:36864
v_mfma_f32_16x16x32_bf16 a[32:35],v[176:179],v[148:151],a[32:35]
v_mfma_f32_16x16x32_bf16 a[36:39],v[180:183],v[148:151],a[36:39]
v_mfma_f32_16x16x32_bf16 a[40:43],v[184:187],v[148:151],a[40:43]
v_mfma_f32_16x16x32_bf16 a[44:47],v[188:191],v[148:151],a[44:47]
v_mfma_f32_16x16x32_bf16 a[48:51],v[176:179],v[156:159],a[48:51]
v_mfma_f32_16x16x32_bf16 a[52:55],v[180:183],v[156:159],a[52:55]
v_mfma_f32_16x16x32_bf16 a[56:59],v[184:187],v[156:159],a[56:59]
v_mfma_f32_16x16x32_bf16 a[60:63],v[188:191],v[156:159],a[60:63]
s_waitcnt vmcnt(20) lgkmcnt(0)
s_barrier
v_mfma_f32_16x16x32_bf16 a[0:3],v[96:99],v[64:67],a[0:3]
ds_read_b128 v[128:131],v12 offset:49152
v_mfma_f32_16x16x32_bf16 a[4:7],v[100:103],v[64:67],a[4:7]
ds_read_b64_tr_b16 v[160:161],v16 offset:49152
s_add_u32 m0,s23,32768
v_mfma_f32_16x16x32_bf16 a[8:11],v[104:107],v[64:67],a[8:11]
ds_read_b64_tr_b16 v[162:163],v16 offset:53248
global_load_lds_dwordx4 v4,s[16:17] offset:0 sc1
v_mfma_f32_16x16x32_bf16 a[12:15],v[108:111],v[64:67],a[12:15]
ds_read_b128 v[132:135],v12 offset:50176
v_mfma_f32_16x16x32_bf16 a[16:19],v[96:99],v[72:75],a[16:19]
ds_read_b64_tr_b16 v[164:165],v17 offset:49152
global_load_lds_dwordx4 v5,s[16:17] offset:1024 sc1
v_mfma_f32_16x16x32_bf16 a[20:23],v[100:103],v[72:75],a[20:23]
ds_read_b64_tr_b16 v[166:167],v17 offset:53248
v_mfma_f32_16x16x32_bf16 a[24:27],v[104:107],v[72:75],a[24:27]
ds_read_b128 v[136:139],v12 offset:51200
global_load_lds_dwordx4 v6,s[16:17] offset:2048 sc1
v_mfma_f32_16x16x32_bf16 a[28:31],v[108:111],v[72:75],a[28:31]
ds_read_b64_tr_b16 v[168:169],v18 offset:49152
v_mfma_f32_16x16x32_bf16 a[32:35],v[96:99],v[80:83],a[32:35]
ds_read_b64_tr_b16 v[170:171],v18 offset:53248
global_load_lds_dwordx4 v7,s[16:17] offset:3072 sc1
v_mfma_f32_16x16x32_bf16 a[36:39],v[100:103],v[80:83],a[36:39]
ds_read_b128 v[140:143],v12 offset:52224
v_mfma_f32_16x16x32_bf16 a[40:43],v[104:107],v[80:83],a[40:43]
ds_read_b64_tr_b16 v[172:173],v19 offset:49152
s_add_u32 m0,s23,98304
v_mfma_f32_16x16x32_bf16 a[44:47],v[108:111],v[80:83],a[44:47]
ds_read_b64_tr_b16 v[174:175],v19 offset:53248
s_add_u32 s16,s16,s20
v_mfma_f32_16x16x32_bf16 a[48:51],v[96:99],v[88:91],a[48:51]
ds_read_b128 v[144:147],v12 offset:53248
s_addc_u32 s17,s17,0
v_mfma_f32_16x16x32_bf16 a[52:55],v[100:103],v[88:91],a[52:55]
ds_read_b64_tr_b16 v[176:177],v20 offset:49152
global_load_lds_dwordx4 v8,s[18:19] offset:0
v_mfma_f32_16x16x32_bf16 a[56:59],v[104:107],v[88:91],a[56:59]
ds_read_b64_tr_b16 v[178:179],v20 offset:53248
v_mfma_f32_16x16x32_bf16 a[60:63],v[108:111],v[88:91],a[60:63]
ds_read_b128 v[148:151],v12 offset:54272
global_load_lds_dwordx4 v9,s[18:19] offset:1024
v_mfma_f32_16x16x32_bf16 a[0:3],v[112:115],v[68:71],a[0:3]
ds_read_b64_tr_b16 v[180:181],v21 offset:49152
v_mfma_f32_16x16x32_bf16 a[4:7],v[116:119],v[68:71],a[4:7]
ds_read_b64_tr_b16 v[182:183],v21 offset:53248
global_load_lds_dwordx4 v10,s[18:19] offset:2048
v_mfma_f32_16x16x32_bf16 a[8:11],v[120:123],v[68:71],a[8:11]
ds_read_b128 v[152:155],v12 offset:55296
v_mfma_f32_16x16x32_bf16 a[12:15],v[124:127],v[68:71],a[12:15]
ds_read_b64_tr_b16 v[184:185],v22 offset:49152
global_load_lds_dwordx4 v11,s[18:19] offset:3072
v_mfma_f32_16x16x32_bf16 a[16:19],v[112:115],v[76:79],a[16:19]
ds_read_b64_tr_b16 v[186:187],v22 offset:53248
v_mfma_f32_16x16x32_bf16 a[20:23],v[116:119],v[76:79],a[20:23]
ds_read_b128 v[156:159],v12 offset:56320
s_add_u32 s18,s18,s21
v_mfma_f32_16x16x32_bf16 a[24:27],v[120:123],v[76:79],a[24:27]
ds_read_b64_tr_b16 v[188:189],v23 offset:49152
s_addc_u32 s19,s19,0
v_mfma_f32_16x16x32_bf16 a[28:31],v[124:127],v[76:79],a[28:31]
ds_read_b64_tr_b16 v[190:191],v23 offset:53248
v_mfma_f32_16x16x32_bf16 a[32:35],v[112:115],v[84:87],a[32:35]
v_mfma_f32_16x16x32_bf16 a[36:39],v[116:119],v[84:87],a[36:39]
v_mfma_f32_16x16x32_bf16 a[40:43],v[120:123],v[84:87],a[40:43]
v_mfma_f32_16x16x32_bf16 a[44:47],v[124:127],v[84:87],a[44:47]
v_mfma_f32_16x16x32_bf16 a[48:51],v[112:115],v[92:95],a[48:51]
v_mfma_f32_16x16x32_bf16 a[52:55],v[116:119],v[92:95],a[52:55]
v_mfma_f32_16x16x32_bf16 a[56:59],v[120:123],v[92:95],a[56:59]
v_mfma_f32_16x16x32_bf16 a[60:63],v[124:127],v[92:95],a[60:63]
s_waitcnt vmcnt(16) lgkmcnt(0)
s_barrier
v_mfma_f32_16x16x32_bf16 a[0:3],v[160:163],v[128:131],a[0:3]
ds_read_b128 v[64:67],v12 offset:0
v_mfma_f32_16x16x32_bf16 a[4:7],v[164:167],v[128:131],a[4:7]
ds_read_b64_tr_b16 v[96:97],v16 offset:0
s_add_u32 m0,s23,49152
v_mfma_f32_16x16x32_bf16 a[8:11],v[168:171],v[128:131],a[8:11]
ds_read_b64_tr_b16 v[98:99],v16 offset:4096
global_load_lds_dwordx4 v4,s[16:17] offset:0 sc1
v_mfma_f32_16x16x32_bf16 a[12:15],v[172:175],v[128:131],a[12:15]
ds_read_b128 v[68:71],v12 offset:1024
v_mfma_f32_16x16x32_bf16 a[16:19],v[160:163],v[136:139],a[16:19]
ds_read_b64_tr_b16 v[100:101],v17 offset:0
global_load_lds_dwordx4 v5,s[16:17] offset:1024 sc1
v_mfma_f32_16x16x32_bf16 a[20:23],v[164:167],v[136:139],a[20:23]
ds_read_b64_tr_b16 v[102:103],v17 offset:4096
v_mfma_f32_16x16x32_bf16 a[24:27],v[168:171],v[136:139],a[24:27]
ds_read_b128 v[72:75],v12 offset:2048
global_load_lds_dwordx4 v6,s[16:17] offset:2048 sc1
v_mfma_f32_16x16x32_bf16 a[28:31],v[172:175],v[136:139],a[28:31]
ds_read_b64_tr_b16 v[104:105],v18 offset:0
v_mfma_f32_16x16x32_bf16 a[32:35],v[160:163],v[144:147],a[32:35]
ds_read_b64_tr_b16 v[106:107],v18 offset:4096
global_load_lds_dwordx4 v7,s[16:17] offset:3072 sc1
v_mfma_f32_16x16x32_bf16 a[36:39],v[164:167],v[144:147],a[36:39]
ds_read_b128 v[76:79],v12 offset:3072
v_mfma_f32_16x16x32_bf16 a[40:43],v[168:171],v[144:147],a[40:43]
ds_read_b64_tr_b16 v[108:109],v19 offset:0
s_add_u32 m0,s23,114688
v_mfma_f32_16x16x32_bf16 a[44:47],v[172:175],v[144:147],a[44:47]
ds_read_b64_tr_b16 v[110:111],v19 offset:4096
s_add_u32 s16,s16,s20
v_mfma_f32_16x16x32_bf16 a[48:51],v[160:163],v[152:155],a[48:51]
ds_read_b128 v[80:83],v12 offset:4096
s_addc_u32 s17,s17,0
v_mfma_f32_16x16x32_bf16 a[52:55],v[164:167],v[152:155],a[52:55]
ds_read_b64_tr_b16 v[112:113],v20 offset:0
global_load_lds_dwordx4 v8,s[18:19] offset:0
v_mfma_f32_16x16x32_bf16 a[56:59],v[168:171],v[152:155],a[56:59]
ds_read_b64_tr_b16 v[114:115],v20 offset:4096
v_mfma_f32_16x16x32_bf16 a[60:63],v[172:175],v[152:155],a[60:63]
ds_read_b128 v[84:87],v12 offset:5120
global_load_lds_dwordx4 v9,s[18:19] offset:1024
v_mfma_f32_16x16x32_bf16 a[0:3],v[176:179],v[132:135],a[0:3]
ds_read_b64_tr_b16 v[116:117],v21 offset:0
v_mfma_f32_16x16x32_bf16 a[4:7],v[180:183],v[132:135],a[4:7]
ds_read_b64_tr_b16 v[118:119],v21 offset:4096
global_load_lds_dwordx4 v10,s[18:19] offset:2048
v_mfma_f32_16x16x32_bf16 a[8:11],v[184:187],v[132:135],a[8:11]
ds_read_b128 v[88:91],v12 offset:6144
v_mfma_f32_16x16x32_bf16 a[12:15],v[188:191],v[132:135],a[12:15]
ds_read_b64_tr_b16 v[120:121],v22 offset:0
global_load_lds_dwordx4 v11,s[18:19] offset:3072
v_mfma_f32_16x16x32_bf16 a[16:19],v[176:179],v[140:143],a[16:19]
ds_read_b64_tr_b16 v[122:123],v22 offset:4096
v_mfma_f32_16x16x32_bf16 a[20:23],v[180:183],v[140:143],a[20:23]
ds_read_b128 v[92:95],v12 offset:7168
s_add_u32 s18,s18,s21
v_mfma_f32_16x16x32_bf16 a[24:27],v[184:187],v[140:143],a[24:27]
ds_read_b64_tr_b16 v[124:125],v23 offset:0
s_addc_u32 s19,s19,0
v_mfma_f32_16x16x32_bf16 a[28:31],v[188:191],v[140:143],a[28:31]
ds_read_b64_tr_b16 v[126:127],v23 offset:4096
s_cmp_eq_u32 s39,0
s_cbranch_scc1 L_sig6
s_mov_b32 s39,0
s_mov_b64 exec,1
global_atomic_add v233,v252,s[4:5]
s_mov_b64 exec,-1
v_mov_b32 v252,1
L_sig6:
s_nop 0
v_mfma_f32_16x16x32_bf16 a[32:35],v[176:179],v[148:151],a[32:35]
global_load_dword v236,v238,s[4:5] sc1
v_mfma_f32_16x16x32_bf16 a[36:39],v[180:183],v[148:151],a[36:39]
v_mfma_f32_16x16x32_bf16 a[40:43],v[184:187],v[148:151],a[40:43]
v_mfma_f32_16x16x32_bf16 a[44:47],v[188:191],v[148:151],a[44:47]
v_mfma_f32_16x16x32_bf16 a[48:51],v[176:179],v[156:159],a[48:51]
v_mfma_f32_16x16x32_bf16 a[52:55],v[180:183],v[156:159],a[52:55]
v_mfma_f32_16x16x32_bf16 a[56:59],v[184:187],v[156:159],a[56:59]
v_mfma_f32_16x16x32_bf16 a[60:63],v[188:191],v[156:159],a[60:63]
L_g_d_mid:
s_waitcnt vmcnt(16) lgkmcnt(0)
s_barrier
v_mfma_f32_16x16x32_bf16 a[0:3],v[96:99],v[64:67],a[0:3]
ds_read_b128 v[128:131],v12 offset:16384
v_mfma_f32_16x16x32_bf16 a[4:7],v[100:103],v[64:67],a[4:7]
ds_read_b64_tr_b16 v[160:161],v16 offset:16384
s_add_u32 m0,s23,0
v_mfma_f32_16x16x32_bf16 a[8:11],v[104:107],v[64:67],a[8:11]
ds_read_b64_tr_b16 v[162:163],v16 offset:20480
global_load_lds_dwordx4 v4,s[16:17] offset:0 sc1
v_mfma_f32_16x16x32_bf16 a[12:15],v[108:111],v[64:67],a[12:15]
ds_read_b128 v[132:135],v12 offset:17408
v_mfma_f32_16x16x32_bf16 a[16:19],v[96:99],v[72:75],a[16:19]
ds_read_b64_tr_b16 v[164:165],v17 offset:16384
global_load_lds_dwordx4 v5,s[16:17] offset:1024 sc1
v_mfma_f32_16x16x32_bf16 a[20:23],v[100:103],v[72:75],a[20:23]
ds_read_b64_tr_b16 v[166:167],v17 offset:20480
v_mfma_f32_16x16x32_bf16 a[24:27],v[104:107],v[72:75],a[24:27]
ds_read_b128 v[136:139],v12 offset:18432
global_load_lds_dwordx4 v6,s[16:17] offset:2048 sc1
v_mfma_f32_16x16x32_bf16 a[28:31],v[108:111],v[72:75],a[28:31]
ds_read_b64_tr_b16 v[168:169],v18 offset:16384
v_mfma_f32_16x16x32_bf16 a[32:35],v[96:99],v[80:83],a[32:35]
ds_read_b64_tr_b16 v[170:171],v18 offset:20480
global_load_lds_dwordx4 v7,s[16:17] offset:3072 sc1
v_mfma_f32_16x16x32_bf16 a[36:39],v[100:103],v[80:83],a[36:39]
ds_read_b128 v[140:143],v12 offset:19456
v_mfma_f32_16x16x32_bf16 a[40:43],v[104:107],v[80:83],a[40:43]
ds_read_b64_tr_b16 v[172:173],v19 offset:16384
s_add_u32 m0,s23,65536
v_mfma_f32_16x16x32_bf16 a[44:47],v[108:111],v[80:83],a[44:47]
ds_read_b64_tr_b16 v[174:175],v19 offset:20480
s_add_u32 s16,s16,s20
v_mfma_f32_16x16x32_bf16 a[48:51],v[96:99],v[88:91],a[48:51]
ds_read_b128 v[144:147],v12 offset:20480
s_addc_u32 s17,s17,0
v_mfma_f32_16x16x32_bf16 a[52:55],v[100:103],v[88:91],a[52:55]
ds_read_b64_tr_b16 v[176:177],v20 offset:16384
global_load_lds_dwordx4 v8,s[18:19] offset:0
v_mfma_f32_16x16x32_bf16 a[56:59],v[104:107],v[88:91],a[56:59]
ds_read_b64_tr_b16 v[178:179],v20 offset:20480
v_mfma_f32_16x16x32_bf16 a[60:63],v[108:111],v[88:91],a[60:63]
ds_read_b128 v[148:151],v12 offset:21504
global_load_lds_dwordx4 v9,s[18:19] offset:1024
v_mfma_f32_16x16x32_bf16 a[0:3],v[112:115],v[68:71],a[0:3]
ds_read_b64_tr_b16 v[180:181],v21 offset:16384
v_mfma_f32_16x16x32_bf16 a[4:7],v[116:119],v[68:71],a[4:7]
ds_read_b64_tr_b16 v[182:183],v21 offset:20480
global_load_lds_dwordx4 v10,s[18:19] offset:2048
v_mfma_f32_16x16x32_bf16 a[8:11],v[120:123],v[68:71],a[8:11]
ds_read_b128 v[152:155],v12 offset:22528
v_mfma_f32_16x16x32_bf16 a[12:15],v[124:127],v[68:71],a[12:15]
ds_read_b64_tr_b16 v[184:185],v22 offset:16384
global_load_lds_dwordx4 v11,s[18:19] offset:3072
v_mfma_f32_16x16x32_bf16 a[16:19],v[112:115],v[76:79],a[16:19]
ds_read_b64_tr_b16 v[186:187],v22 offset:20480
v_mfma_f32_16x16x32_bf16 a[20:23],v[116:119],v[76:79],a[20:23]
ds_read_b128 v[156:159],v12 offset:23552
s_add_u32 s18,s18,s21
v_mfma_f32_16x16x32_bf16 a[24:27],v[120:123],v[76:79],a[24:27]
ds_read_b64_tr_b16 v[188:189],v23 offset:16384
s_addc_u32 s19,s19,0
v_mfma_f32_16x16x32_bf16 a[28:31],v[124:127],v[76:79],a[28:31]
ds_read_b64_tr_b16 v[190:191],v23 offset:20480
v_mfma_f32_16x16x32_bf16 a[32:35],v[112:115],v[84:87],a[32:35]
v_mfma_f32_16x16x32_bf16 a[36:39],v[116:119],v[84:87],a[36:39]
v_mfma_f32_16x16x32_bf16 a[40:43],v[120:123],v[84:87],a[40:43]
v_mfma_f32_16x16x32_bf16 a[44:47],v[124:127],v[84:87],a[44:47]
v_mfma_f32_16x16x32_bf16 a[48:51],v[112:115],v[92:95],a[48:51]
v_mfma_f32_16x16x32_bf16 a[52:55],v[116:119],v[92:95],a[52:55]
v_mfma_f32_16x16x32_bf16 a[56:59],v[120:123],v[92:95],a[56:59]
v_mfma_f32_16x16x32_bf16 a[60:63],v[124:127],v[92:95],a[60:63]
s_waitcnt vmcnt(16) lgkmcnt(0)
s_barrier
v_mfma_f32_16x16x32_bf16 a[0:3],v[160:163],v[128:131],a[0:3]
ds_read_b128 v[64:67],v12 offset:32768
v_mfma_f32_16x16x32_bf16 a[4:7],v[164:167],v[128:131],a[4:7]
ds_read_b64_tr_b16 v[96:97],v16 offset:32768
s_add_u32 m0,s23,16384
v_mfma_f32_16x16x32_bf16 a[8:11],v[168:171],v[128:131],a[8:11]
ds_read_b64_tr_b16 v[98:99],v16 offset:36864
global_load_lds_dwordx4 v4,s[16:17] offset:0 sc1
v_mfma_f32_16x16x32_bf16 a[12:15],v[172:175],v[128:131],a[12:15]
ds_read_b128 v[68:71],v12 offset:33792
v_mfma_f32_16x16x32_bf16 a[16:19],v[160:163],v[136:139],a[16:19]
ds_read_b64_tr_b16 v[100:101],v17 offset:32768
global_load_lds_dwordx4 v5,s[16:17] offset:1024 sc1
v_mfma_f32_16x16x32_bf16 a[20:23],v[164:167],v[136:139],a[20:23]
ds_read_b64_tr_b16 v[102:103],v17 offset:36864
v_mfma_f32_16x16x32_bf16 a[24:27],v[168:171],v[136:139],a[24:27]
ds_read_b128 v[72:75],v12 offset:34816
global_load_lds_dwordx4 v6,s[16:17] offset:2048 sc1
v_mfma_f32_16x16x32_bf16 a[28:31],v[172:175],v[136:139],a[28:31]
ds_read_b64_tr_b16 v[104:105],v18 offset:32768
v_mfma_f32_16x16x32_bf16 a[32:35],v[160:163],v[144:147],a[32:35]
ds_read_b64_tr_b16 v[106:107],v18 offset:36864
global_load_lds_dwordx4 v7,s[16:17] offset:3072 sc1
v_mfma_f32_16x16x32_bf16 a[36:39],v[164:167],v[144:147],a[36:39]
ds_read_b128 v[76:79],v12 offset:35840
v_mfma_f32_16x16x32_bf16 a[40:43],v[168:171],v[144:147],a[40:43]
ds_read_b64_tr_b16 v[108:109],v19 offset:32768
s_add_u32 m0,s23,81920
v_mfma_f32_16x16x32_bf16 a[44:47],v[172:175],v[144:147],a[44:47]
ds_read_b64_tr_b16 v[110:111],v19 offset:36864
s_add_u32 s16,s16,s20
v_mfma_f32_16x16x32_bf16 a[48:51],v[160:163],v[152:155],a[48:51]
ds_read_b128 v[80:83],v12 offset:36864
s_addc_u32 s17,s17,0
v_mfma_f32_16x16x32_bf16 a[52:55],v[164:167],v[152:155],a[52:55]
ds_read_b64_tr_b16 v[112:113],v20 offset:32768
global_load_lds_dwordx4 v8,s[18:19] offset:0
v_mfma_f32_16x16x32_bf16 a[56:59],v[168:171],v[152:155],a[56:59]
ds_read_b64_tr_b16 v[114:115],v20 offset:36864
v_mfma_f32_16x16x32_bf16 a[60:63],v[172:175],v[152:155],a[60:63]
ds_read_b128 v[84:87],v12 offset:37888
global_load_lds_dwordx4 v9,s[18:19] offset:1024
v_mfma_f32_16x16x32_bf16 a[0:3],v[176:179],v[132:135],a[0:3]
ds_read_b64_tr_b16 v[116:117],v21 offset:32768
v_mfma_f32_16x16x32_bf16 a[4:7],v[180:183],v[132:135],a[4:7]
ds_read_b64_tr_b16 v[118:119],v21 offset:36864
global_load_lds_dwordx4 v10,s[18:19] offset:2048
v_mfma_f32_16x16x32_bf16 a[8:11],v[184:187],v[132:135],a[8:11]
ds_read_b128 v[88:91],v12 offset:38912
v_mfma_f32_16x16x32_bf16 a[12:15],v[188:191],v[132:135],a[12:15]
ds_read_b64_tr_b16 v[120:121],v22 offset:32768
global_load_lds_dwordx4 v11,s[18:19] offset:3072
v_mfma_f32_16x16x32_bf16 a[16:19],v[176:179],v[140:143],a[16:19]
ds_read_b64_tr_b16 v[122:123],v22 offset:36864
v_mfma_f32_16x16x32_bf16 a[20:23],v[180:183],v[140:143],a[20:23]
ds_read_b128 v[92:95],v12 offset:39936
s_add_u32 s18,s18,s21
v_mfma_f32_16x16x32_bf16 a[24:27],v[184:187],v[140:143],a[24:27]
ds_read_b64_tr_b16 v[124:125],v23 offset:32768
s_addc_u32 s19,s19,0
v_mfma_f32_16x16x32_bf16 a[28:31],v[188:191],v[140:143],a[28:31]
ds_read_b64_tr_b16 v[126:127],v23 offset:36864
v_mfma_f32_16x16x32_bf16 a[32:35],v[176:179],v[148:151],a[32:35]
v_mfma_f32_16x16x32_bf16 a[36:39],v[180:183],v[148:151],a[36:39]
v_mfma_f32_16x16x32_bf16 a[40:43],v[184:187],v[148:151],a[40:43]
v_mfma_f32_16x16x32_bf16 a[44:47],v[188:191],v[148:151],a[44:47]
v_mfma_f32_16x16x32_bf16 a[48:51],v[176:179],v[156:159],a[48:51]
v_mfma_f32_16x16x32_bf16 a[52:55],v[180:183],v[156:159],a[52:55]
v_mfma_f32_16x16x32_bf16 a[56:59],v[184:187],v[156:159],a[56:59]
v_mfma_f32_16x16x32_bf16 a[60:63],v[188:191],v[156:159],a[60:63]
s_waitcnt vmcnt(16) lgkmcnt(0)
s_barrier
v_mfma_f32_16x16x32_bf16 a[0:3],v[96:99],v[64:67],a[0:3]
ds_read_b128 v[128:131],v12 offset:49152
v_mfma_f32_16x16x32_bf16 a[4:7],v[100:103],v[64:67],a[4:7]
ds_read_b64_tr_b16 v[160:161],v16 offset:49152
s_add_u32 m0,s23,32768
v_mfma_f32_16x16x32_bf16 a[8:11],v[104:107],v[64:67],a[8:11]
ds_read_b64_tr_b16 v[162:163],v16 offset:53248
global_load_lds_dwordx4 v4,s[16:17] offset:0 sc1
v_mfma_f32_16x16x32_bf16 a[12:15],v[108:111],v[64:67],a[12:15]
ds_read_b128 v[132:135],v12 offset:50176
v_mfma_f32_16x16x32_bf16 a[16:19],v[96:99],v[72:75],a[16:19]
ds_read_b64_tr_b16 v[164:165],v17 offset:49152
global_load_lds_dwordx4 v5,s[16:17] offset:1024 sc1
v_mfma_f32_16x16x32_bf16 a[20:23],v[100:103],v[72:75],a[20:23]
ds_read_b64_tr_b16 v[166:167],v17 offset:53248
v_mfma_f32_16x16x32_bf16 a[24:27],v[104:107],v[72:75],a[24:27]
ds_read_b128 v[136:139],v12 offset:51200
global_load_lds_dwordx4 v6,s[16:17] offset:2048 sc1
v_mfma_f32_16x16x32_bf16 a[28:31],v[108:111],v[72:75],a[28:31]
ds_read_b64_tr_b16 v[168:169],v18 offset:49152
v_mfma_f32_16x16x32_bf16 a[32:35],v[96:99],v[80:83],a[32:35]
ds_read_b64_tr_b16 v[170:171],v18 offset:53248
global_load_lds_dwordx4 v7,s[16:17] offset:3072 sc1
v_mfma_f32_16x16x32_bf16 a[36:39],v[100:103],v[80:83],a[36:39]
ds_read_b128 v[140:143],v12 offset:52224
v_mfma_f32_16x16x32_bf16 a[40:43],v[104:107],v[80:83],a[40:43]
ds_read_b64_tr_b16 v[172:173],v19 offset:49152
s_add_u32 m0,s23,98304
v_mfma_f32_16x16x32_bf16 a[44:47],v[108:111],v[80:83],a[44:47]
ds_read_b64_tr_b16 v[174:175],v19 offset:53248
s_add_u32 s16,s16,s20
v_mfma_f32_16x16x32_bf16 a[48:51],v[96:99],v[88:91],a[48:51]
ds_read_b128 v[144:147],v12 offset:53248
s_addc_u32 s17,s17,0
v_mfma_f32_16x16x32_bf16 a[52:55],v[100:103],v[88:91],a[52:55]
ds_read_b64_tr_b16 v[176:177],v20 offset:49152
global_load_lds_dwordx4 v8,s[18:19] offset:0
v_mfma_f32_16x16x32_bf16 a[56:59],v[104:107],v[88:91],a[56:59]
ds_read_b64_tr_b16 v[178:179],v20 offset:53248
v_mfma_f32_16x16x32_bf16 a[60:63],v[108:111],v[88:91],a[60:63]
ds_read_b128 v[148:151],v12 offset:54272
global_load_lds_dwordx4 v9,s[18:19] offset:1024
v_mfma_f32_16x16x32_bf16 a[0:3],v[112:115],v[68:71],a[0:3]
ds_read_b64_tr_b16 v[180:181],v21 offset:49152
v_mfma_f32_16x16x32_bf16 a[4:7],v[116:119],v[68:71],a[4:7]
ds_read_b64_tr_b16 v[182:183],v21 offset:53248
global_load_lds_dwordx4 v10,s[18:19] offset:2048
v_mfma_f32_16x16x32_bf16 a[8:11],v[120:123],v[68:71],a[8:11]
ds_read_b128 v[152:155],v12 offset:55296
v_mfma_f32_16x16x32_bf16 a[12:15],v[124:127],v[68:71],a[12:15]
ds_read_b64_tr_b16 v[184:185],v22 offset:49152
global_load_lds_dwordx4 v11,s[18:19] offset:3072
v_mfma_f32_16x16x32_bf16 a[16:19],v[112:115],v[76:79],a[16:19]
ds_read_b64_tr_b16 v[186:187],v22 offset:53248
v_mfma_f32_16x16x32_bf16 a[20:23],v[116:119],v[76:79],a[20:23]
ds_read_b128 v[156:159],v12 offset:56320
s_add_u32 s18,s18,s21
v_mfma_f32_16x16x32_bf16 a[24:27],v[120:123],v[76:79],a[24:27]
ds_read_b64_tr_b16 v[188:189],v23 offset:49152
s_addc_u32 s19,s19,0
v_mfma_f32_16x16x32_bf16 a[28:31],v[124:127],v[76:79],a[28:31]
ds_read_b64_tr_b16 v[190:191],v23 offset:53248
ds_write_b32 v239,v236
v_mfma_f32_16x16x32_bf16 a[32:35],v[112:115],v[84:87],a[32:35]
v_mfma_f32_16x16x32_bf16 a[36:39],v[116:119],v[84:87],a[36:39]
v_mfma_f32_16x16x32_bf16 a[40:43],v[120:123],v[84:87],a[40:43]
v_mfma_f32_16x16x32_bf16 a[44:47],v[124:127],v[84:87],a[44:47]
v_mfma_f32_16x16x32_bf16 a[48:51],v[112:115],v[92:95],a[48:51]
v_mfma_f32_16x16x32_bf16 a[52:55],v[116:119],v[92:95],a[52:55]
v_mfma_f32_16x16x32_bf16 a[56:59],v[120:123],v[92:95],a[56:59]
v_mfma_f32_16x16x32_bf16 a[60:63],v[124:127],v[92:95],a[60:63]
s_waitcnt vmcnt(16) lgkmcnt(0)
s_barrier
v_mfma_f32_16x16x32_bf16 a[0:3],v[160:163],v[128:131],a[0:3]
ds_read_b128 v[64:67],v12 offset:0
v_mfma_f32_16x16x32_bf16 a[4:7],v[164:167],v[128:131],a[4:7]
ds_read_b64_tr_b16 v[96:97],v16 offset:0
s_add_u32 m0,s23,49152
v_mfma_f32_16x16x32_bf16 a[8:11],v[168:171],v[128:131],a[8:11]
ds_read_b64_tr_b16 v[98:99],v16 offset:4096
global_load_lds_dwordx4 v4,s[16:17] offset:0 sc1
v_mfma_f32_16x16x32_bf16 a[12:15],v[172:175],v[128:131],a[12:15]
ds_read_b128 v[68:71],v12 offset:1024
v_mfma_f32_16x16x32_bf16 a[16:19],v[160:163],v[136:139],a[16:19]
ds_read_b64_tr_b16 v[100:101],v17 offset:0
global_load_lds_dwordx4 v5,s[16:17] offset:1024 sc1
v_mfma_f32_16x16x32_bf16 a[20:23],v[164:167],v[136:139],a[20:23]
ds_read_b64_tr_b16 v[102:103],v17 offset:4096
v_mfma_f32_16x16x32_bf16 a[24:27],v[168:171],v[136:139],a[24:27]
ds_read_b128 v[72:75],v12 offset:2048
global_load_lds_dwordx4 v6,s[16:17] offset:2048 sc1
v_mfma_f32_16x16x32_bf16 a[28:31],v[172:175],v[136:139],a[28:31]
ds_read_b64_tr_b16 v[104:105],v18 offset:0
v_mfma_f32_16x16x32_bf16 a[32:35],v[160:163],v[144:147],a[32:35]
ds_read_b64_tr_b16 v[106:107],v18 offset:4096
global_load_lds_dwordx4 v7,s[16:17] offset:3072 sc1
v_mfma_f32_16x16x32_bf16 a[36:39],v[164:167],v[144:147],a[36:39]
ds_read_b128 v[76:79],v12 offset:3072
v_mfma_f32_16x16x32_bf16 a[40:43],v[168:171],v[144:147],a[40:43]
ds_read_b64_tr_b16 v[108:109],v19 offset:0
s_add_u32 m0,s23,114688
v_mfma_f32_16x16x32_bf16 a[44:47],v[172:175],v[144:147],a[44:47]
ds_read_b64_tr_b16 v[110:111],v19 offset:4096
s_add_u32 s16,s16,s20
v_mfma_f32_16x16x32_bf16 a[48:51],v[160:163],v[152:155],a[48:51]
ds_read_b128 v[80:83],v12 offset:4096
s_addc_u32 s17,s17,0
v_mfma_f32_16x16x32_bf16 a[52:55],v[164:167],v[152:155],a[52:55]
ds_read_b64_tr_b16 v[112:113],v20 offset:0
global_load_lds_dwordx4 v8,s[18:19] offset:0
v_mfma_f32_16x16x32_bf16 a[56:59],v[168:171],v[152:155],a[56:59]
ds_read_b64_tr_b16 v[114:115],v20 offset:4096
v_mfma_f32_16x16x32_bf16 a[60:63],v[172:175],v[152:155],a[60:63]
ds_read_b128 v[84:87],v12 offset:5120
global_load_lds_dwordx4 v9,s[18:19] offset:1024
v_mfma_f32_16x16x32_bf16 a[0:3],v[176:179],v[132:135],a[0:3]
ds_read_b64_tr_b16 v[116:117],v21 offset:0
v_mfma_f32_16x16x32_bf16 a[4:7],v[180:183],v[132:135],a[4:7]
ds_read_b64_tr_b16 v[118:119],v21 offset:4096
global_load_lds_dwordx4 v10,s[18:19] offset:2048
v_mfma_f32_16x16x32_bf16 a[8:11],v[184:187],v[132:135],a[8:11]
ds_read_b128 v[88:91],v12 offset:6144
v_mfma_f32_16x16x32_bf16 a[12:15],v[188:191],v[132:135],a[12:15]
ds_read_b64_tr_b16 v[120:121],v22 offset:0
global_load_lds_dwordx4 v11,s[18:19] offset:3072
v_mfma_f32_16x16x32_bf16 a[16:19],v[176:179],v[140:143],a[16:19]
ds_read_b64_tr_b16 v[122:123],v22 offset:4096
v_mfma_f32_16x16x32_bf16 a[20:23],v[180:183],v[140:143],a[20:23]
ds_read_b128 v[92:95],v12 offset:7168
s_add_u32 s18,s18,s21
v_mfma_f32_16x16x32_bf16 a[24:27],v[184:187],v[140:143],a[24:27]
ds_read_b64_tr_b16 v[124:125],v23 offset:0
s_addc_u32 s19,s19,0
v_mfma_f32_16x16x32_bf16 a[28:31],v[188:191],v[140:143],a[28:31]
ds_read_b64_tr_b16 v[126:127],v23 offset:4096
global_load_dword v236,v238,s[4:5] sc1
v_mfma_f32_16x16x32_bf16 a[32:35],v[176:179],v[148:151],a[32:35]
v_mfma_f32_16x16x32_bf16 a[36:39],v[180:183],v[148:151],a[36:39]
v_mfma_f32_16x16x32_bf16 a[40:43],v[184:187],v[148:151],a[40:43]
v_mfma_f32_16x16x32_bf16 a[44:47],v[188:191],v[148:151],a[44:47]
v_mfma_f32_16x16x32_bf16 a[48:51],v[176:179],v[156:159],a[48:51]
v_mfma_f32_16x16x32_bf16 a[52:55],v[180:183],v[156:159],a[52:55]
v_mfma_f32_16x16x32_bf16 a[56:59],v[184:187],v[156:159],a[56:59]
v_mfma_f32_16x16x32_bf16 a[60:63],v[188:191],v[156:159],a[60:63]
s_sub_u32 s22,s22,1
s_cmp_lg_u32 s22,0
s_cbranch_scc1 L_g_d_mid
s_cmp_eq_u32 s33,6
s_cbranch_scc0 L_g_d3
s_lshr_b32 s54,s34,1
s_lshl_b32 s54,s54,7
s_add_u32 s54,s54,94442496
v_mov_b32 v24,s54
L_bulk_dep2:
global_load_dword v236,v24,s[4:5] offset:0 sc1
s_sub_u32 s40,s40,1
s_cbranch_scc1 L_bulk_bail
s_waitcnt vmcnt(0)
v_cmp_gt_u32 vcc,8,v236
s_cbranch_vccz L_bulk_dep2_ok
s_sleep 4
s_branch L_bulk_dep2
L_bulk_dep2_ok:
global_load_dwordx4 a[64:67],v2,s[30:31] offset:0 sc1
global_load_dwordx4 a[68:71],v2,s[30:31] offset:1024 sc1
s_add_u32 s30,s30,32768
s_addc_u32 s31,s31,0
global_load_dwordx4 a[72:75],v2,s[30:31] offset:0 sc1
global_load_dwordx4 a[76:79],v2,s[30:31] offset:1024 sc1
s_add_u32 s30,s30,32768
s_addc_u32 s31,s31,0
global_load_dwordx4 a[80:83],v2,s[30:31] offset:0 sc1
global_load_dwordx4 a[84:87],v2,s[30:31] offset:1024 sc1
s_add_u32 s30,s30,32768
s_addc_u32 s31,s31,0
global_load_dwordx4 a[88:91],v2,s[30:31] offset:0 sc1
global_load_dwordx4 a[92:95],v2,s[30:31] offset:1024 sc1
L_g_d3:
s_mov_b32 s36,s33
s_and_b32 s33,s27,15
s_bfe_u32 s34,s27,0x40004
s_bfe_u32 s35,s27,0x60008
s_mov_b32 s28,1
s_sub_u32 s54,s33,1
s_cmp_lt_u32 s54,5
s_cbranch_scc1 L_g_d_h_ck
s_sub_u32 s54,s33,9
s_cmp_lt_u32 s54,4
s_cbranch_scc0 L_g_d_h_no
L_g_d_h_ck:
ds_read_b128 v[24:27],v15
s_bfe_u32 s55,s27,0x60014
s_waitcnt lgkmcnt(0)
v_min3_u32 v24,v24,v25,v26
v_min_u32 v24,v24,v27
s_nop 0
v_readfirstlane_b32 s54,v24
s_nop 0
s_cmp_ge_u32 s54,s55
s_cbranch_scc1 L_g_d_h_pf
L_g_d_h_no:
s_mov_b32 s28,0
s_mov_b32 s33,1
s_mov_b32 s34,0
s_mov_b32 s35,0
L_g_d_h_pf:
s_lshr_b32 s55,s14,1
s_mov_b32 s24,-1
s_cmp_eq_u32 s33,5
s_cbranch_scc1 L_g_d_h_sd_d8
s_cmp_eq_u32 s33,8
s_cbranch_scc1 L_g_d_h_sd_d4
s_cmp_eq_u32 s33,12
s_cbranch_scc1 L_g_d_h_sd_d4
s_sub_u32 s54,s33,6
s_cmp_lt_u32 s54,2
s_cbranch_scc1 L_g_d_h_sd_db
s_lshl_b32 s54,s34,19
s_add_u32 s54,s54,104857600
s_add_u32 s16,s4,s54
s_addc_u32 s17,s5,0
s_mov_b32 s20,1024
v_mov_b32 v4,v192
v_mov_b32 v5,v193
v_mov_b32 v6,v194
v_mov_b32 v7,v195
s_cmp_lt_u32 s33,9
s_cbranch_scc1 L_g_d_h_sd_big
s_lshl_b32 s54,s34,18
s_lshl_b32 s59,s14,16
s_add_u32 s54,s54,s59
s_add_u32 s54,s54,104857600
s_add_u32 s16,s4,s54
s_addc_u32 s17,s5,0
v_mov_b32 v4,v2
v_add_u32 v5,31744,v2
v_mov_b32 v6,0
v_mov_b32 v7,0
L_g_d_h_sd_big:
s_cmp_eq_u32 s33,4
s_cbranch_scc1 L_g_d_h_sd_up
s_cmp_eq_u32 s33,1
s_cselect_b64 s[56:57],s[66:67],s[68:69]
s_cmp_eq_u32 s33,3
s_cselect_b64 s[56:57],s[70:71],s[56:57]
s_cmp_eq_u32 s33,11
s_cselect_b64 s[56:57],s[70:71],s[56:57]
s_cmp_eq_u32 s33,9
s_cselect_b64 s[56:57],s[66:67],s[56:57]
s_lshl_b32 s54,s35,9
s_lshl_b32 s59,s55,8
s_add_u32 s54,s54,s59
s_add_u32 s18,s56,s54
s_addc_u32 s19,s57,0
s_mov_b32 s21,262144
v_mov_b32 v8,v200
v_mov_b32 v9,v201
v_mov_b32 v10,v202
v_mov_b32 v11,v203
s_branch L_g_d_h_sd_e
L_g_d_h_sd_up:
s_cmp_eq_u32 s55,1
s_cselect_b64 s[56:57],s[74:75],s[72:73]
s_and_b32 s54,s35,31
s_lshl_b32 s54,s54,8
s_add_u32 s18,s56,s54
s_addc_u32 s19,s57,0
s_mov_b32 s21,229376
v_mov_b32 v8,v204
v_mov_b32 v9,v205
v_mov_b32 v10,v206
v_mov_b32 v11,v207
s_bitcmp1_b32 s35,5
s_cbranch_scc0 L_g_d_h_sd_e
s_and_b32 s54,s34,3
s_mul_i32 s24,s54,2
s_mul_i32 s25,s20,32
s_mul_i32 s3,s21,32
s_lshl_b32 s54,s24,2
s_mul_i32 s57,s54,s20
s_add_u32 s16,s16,s57
s_addc_u32 s17,s17,0
s_mul_i32 s57,s54,s21
s_add_u32 s18,s18,s57
s_addc_u32 s19,s19,0
s_branch L_g_d_h_sd_e
L_g_d_h_sd_d8:
s_mul_i32 s54,s34,1835008
s_add_u32 s54,s54,50331648
s_add_u32 s16,s4,s54
s_addc_u32 s17,s5,0
s_mov_b32 s20,1024
s_and_b32 s54,s35,31
s_lshl_b32 s54,s54,9
s_lshl_b32 s59,s55,8
s_add_u32 s54,s54,s59
s_add_u32 s18,s76,s54
s_addc_u32 s19,s77,0
s_mov_b32 s21,65536
v_mov_b32 v4,v196
v_add_u32 v5,113664,v196
v_add_u32 v6,227328,v196
v_add_u32 v7,340992,v196
v_mov_b32 v8,v208
v_mov_b32 v9,v209
v_mov_b32 v10,v210
v_mov_b32 v11,v211
s_bitcmp1_b32 s35,5
s_cbranch_scc0 L_g_d_h_sd_e
s_and_b32 s54,s34,3
s_mul_i32 s24,s54,7
s_mul_i32 s25,s20,112
s_mul_i32 s3,s21,112
s_lshl_b32 s54,s24,2
s_mul_i32 s57,s54,s20
s_add_u32 s16,s16,s57
s_addc_u32 s17,s17,0
s_mul_i32 s57,s54,s21
s_add_u32 s18,s18,s57
s_addc_u32 s19,s19,0
s_branch L_g_d_h_sd_e
L_g_d_h_sd_d4:
s_lshl_b32 s54,s34,20
s_lshl_b32 s59,s14,18
s_add_u32 s54,s54,s59
s_add_u32 s54,s54,67108864
s_mul_i32 s58,s34,917504
s_mul_i32 s59,s14,229376
s_add_u32 s58,s58,s59
s_add_u32 s58,s58,50331648
s_cmp_eq_u32 s33,8
s_cselect_b32 s54,s54,s58
s_cselect_b32 s58,16,0
s_cselect_b64 s[56:57],s[60:61],s[76:77]
s_add_u32 s16,s4,s54
s_addc_u32 s17,s5,0
s_mov_b32 s20,1024
s_lshl_b32 s54,s35,9
s_lshl_b32 s59,s55,8
s_add_u32 s54,s54,s59
s_add_u32 s18,s56,s54
s_addc_u32 s19,s57,0
s_mov_b32 s21,65536
v_mov_b32 v4,v2
s_lshl_b32 s58,s58,10
s_add_u32 s58,s58,113664
v_add_u32 v5,s58,v2
v_mov_b32 v6,0
v_mov_b32 v7,0
v_mov_b32 v8,v208
v_mov_b32 v9,v209
v_mov_b32 v10,v210
v_mov_b32 v11,v211
s_branch L_g_d_h_sd_e
L_g_d_h_sd_db:
s_lshr_b32 s57,s35,3
s_lshl_b32 s54,s34,20
s_lshl_b32 s59,s57,15
s_add_u32 s54,s54,s59
s_add_u32 s54,s54,67106816
s_and_b32 s12,s35,7
s_lshl_b32 s12,s12,8
s_lshl_b32 s59,s55,16
s_add_u32 s12,s12,s59
s_lshl_b32 s59,s57,21
s_add_u32 s12,s12,s59
s_add_u32 s16,s4,s54
s_addc_u32 s17,s5,0
s_mov_b32 s20,2048
s_add_u32 s18,s60,s12
s_addc_u32 s19,s61,0
s_mov_b32 s21,131072
s_lshl_b32 s54,s14,1
s_add_u32 s54,s54,s57
s_and_b32 s54,s54,3
s_lshl_b32 s54,s54,17
s_lshl_b32 s59,s55,19
s_add_u32 s54,s54,s59
s_add_u32 s54,s54,2048
v_add_u32 v4,s54,v2
v_mov_b32 v5,v4
s_lshl_b32 s54,s14,1
s_add_u32 s54,s54,s57
s_add_u32 s54,s54,1
s_and_b32 s54,s54,3
s_lshl_b32 s54,s54,17
s_lshl_b32 s59,s55,19
s_add_u32 s54,s54,s59
v_add_u32 v6,s54,v2
v_mov_b32 v7,v6
v_mov_b32 v8,v208
v_mov_b32 v9,v209
v_mov_b32 v10,v210
v_mov_b32 v11,v211
L_g_d_h_sd_e:
s_cmp_eq_u32 s28,0
s_cselect_b64 s[16:17],s[64:65],s[16:17]
s_cselect_b32 s54,0,-1
s_and_b32 s21,s21,s54
v_and_b32 v4,s54,v4
v_and_b32 v5,s54,v5
v_and_b32 v6,s54,v6
v_and_b32 v7,s54,v7
v_and_b32 v8,s54,v8
v_and_b32 v9,s54,v9
v_and_b32 v10,s54,v10
v_and_b32 v11,s54,v11
s_waitcnt vmcnt(16) lgkmcnt(0)
s_barrier
v_mfma_f32_16x16x32_bf16 a[0:3],v[96:99],v[64:67],a[0:3]
ds_read_b128 v[128:131],v12 offset:16384
v_mfma_f32_16x16x32_bf16 a[4:7],v[100:103],v[64:67],a[4:7]
ds_read_b64_tr_b16 v[160:161],v16 offset:16384
s_add_u32 m0,s23,0
v_mfma_f32_16x16x32_bf16 a[8:11],v[104:107],v[64:67],a[8:11]
ds_read_b64_tr_b16 v[162:163],v16 offset:20480
global_load_lds_dwordx4 v4,s[16:17] offset:0 sc1
v_mfma_f32_16x16x32_bf16 a[12:15],v[108:111],v[64:67],a[12:15]
ds_read_b128 v[132:135],v12 offset:17408
v_mfma_f32_16x16x32_bf16 a[16:19],v[96:99],v[72:75],a[16:19]
ds_read_b64_tr_b16 v[164:165],v17 offset:16384
global_load_lds_dwordx4 v5,s[16:17] offset:1024 sc1
v_mfma_f32_16x16x32_bf16 a[20:23],v[100:103],v[72:75],a[20:23]
ds_read_b64_tr_b16 v[166:167],v17 offset:20480
v_mfma_f32_16x16x32_bf16 a[24:27],v[104:107],v[72:75],a[24:27]
ds_read_b128 v[136:139],v12 offset:18432
global_load_lds_dwordx4 v6,s[16:17] offset:2048 sc1
v_mfma_f32_16x16x32_bf16 a[28:31],v[108:111],v[72:75],a[28:31]
ds_read_b64_tr_b16 v[168:169],v18 offset:16384
v_mfma_f32_16x16x32_bf16 a[32:35],v[96:99],v[80:83],a[32:35]
ds_read_b64_tr_b16 v[170:171],v18 offset:20480
global_load_lds_dwordx4 v7,s[16:17] offset:3072 sc1
v_mfma_f32_16x16x32_bf16 a[36:39],v[100:103],v[80:83],a[36:39]
ds_read_b128 v[140:143],v12 offset:19456
v_mfma_f32_16x16x32_bf16 a[40:43],v[104:107],v[80:83],a[40:43]
ds_read_b64_tr_b16 v[172:173],v19 offset:16384
s_add_u32 m0,s23,65536
v_mfma_f32_16x16x32_bf16 a[44:47],v[108:111],v[80:83],a[44:47]
ds_read_b64_tr_b16 v[174:175],v19 offset:20480
s_add_u32 s16,s16,s20
v_mfma_f32_16x16x32_bf16 a[48:51],v[96:99],v[88:91],a[48:51]
ds_read_b128 v[144:147],v12 offset:20480
s_addc_u32 s17,s17,0
v_mfma_f32_16x16x32_bf16 a[52:55],v[100:103],v[88:91],a[52:55]
ds_read_b64_tr_b16 v[176:177],v20 offset:16384
global_load_lds_dwordx4 v8,s[18:19] offset:0
v_mfma_f32_16x16x32_bf16 a[56:59],v[104:107],v[88:91],a[56:59]
ds_read_b64_tr_b16 v[178:179],v20 offset:20480
v_mfma_f32_16x16x32_bf16 a[60:63],v[108:111],v[88:91],a[60:63]
ds_read_b128 v[148:151],v12 offset:21504
global_load_lds_dwordx4 v9,s[18:19] offset:1024
v_mfma_f32_16x16x32_bf16 a[0:3],v[112:115],v[68:71],a[0:3]
ds_read_b64_tr_b16 v[180:181],v21 offset:16384
v_mfma_f32_16x16x32_bf16 a[4:7],v[116:119],v[68:71],a[4:7]
ds_read_b64_tr_b16 v[182:183],v21 offset:20480
global_load_lds_dwordx4 v10,s[18:19] offset:2048
v_mfma_f32_16x16x32_bf16 a[8:11],v[120:123],v[68:71],a[8:11]
ds_read_b128 v[152:155],v12 offset:22528
v_mfma_f32_16x16x32_bf16 a[12:15],v[124:127],v[68:71],a[12:15]
ds_read_b64_tr_b16 v[184:185],v22 offset:16384
global_load_lds_dwordx4 v11,s[18:19] offset:3072
v_mfma_f32_16x16x32_bf16 a[16:19],v[112:115],v[76:79],a[16:19]
ds_read_b64_tr_b16 v[186:187],v22 offset:20480
v_mfma_f32_16x16x32_bf16 a[20:23],v[116:119],v[76:79],a[20:23]
ds_read_b128 v[156:159],v12 offset:23552
s_add_u32 s18,s18,s21
v_mfma_f32_16x16x32_bf16 a[24:27],v[120:123],v[76:79],a[24:27]
ds_read_b64_tr_b16 v[188:189],v23 offset:16384
s_addc_u32 s19,s19,0
v_mfma_f32_16x16x32_bf16 a[28:31],v[124:127],v[76:79],a[28:31]
ds_read_b64_tr_b16 v[190:191],v23 offset:20480
v_mfma_f32_16x16x32_bf16 a[32:35],v[112:115],v[84:87],a[32:35]
v_mfma_f32_16x16x32_bf16 a[36:39],v[116:119],v[84:87],a[36:39]
v_mfma_f32_16x16x32_bf16 a[40:43],v[120:123],v[84:87],a[40:43]
v_mfma_f32_16x16x32_bf16 a[44:47],v[124:127],v[84:87],a[44:47]
v_mfma_f32_16x16x32_bf16 a[48:51],v[112:115],v[92:95],a[48:51]
v_mfma_f32_16x16x32_bf16 a[52:55],v[116:119],v[92:95],a[52:55]
v_mfma_f32_16x16x32_bf16 a[56:59],v[120:123],v[92:95],a[56:59]
v_mfma_f32_16x16x32_bf16 a[60:63],v[124:127],v[92:95],a[60:63]
s_waitcnt vmcnt(16) lgkmcnt(0)
s_barrier
v_mfma_f32_16x16x32_bf16 a[0:3],v[160:163],v[128:131],a[0:3]
ds_read_b128 v[64:67],v12 offset:32768
v_mfma_f32_16x16x32_bf16 a[4:7],v[164:167],v[128:131],a[4:7]
ds_read_b64_tr_b16 v[96:97],v16 offset:32768
s_add_u32 m0,s23,16384
v_mfma_f32_16x16x32_bf16 a[8:11],v[168:171],v[128:131],a[8:11]
ds_read_b64_tr_b16 v[98:99],v16 offset:36864
global_load_lds_dwordx4 v4,s[16:17] offset:0 sc1
v_mfma_f32_16x16x32_bf16 a[12:15],v[172:175],v[128:131],a[12:15]
ds_read_b128 v[68:71],v12 offset:33792
v_mfma_f32_16x16x32_bf16 a[16:19],v[160:163],v[136:139],a[16:19]
ds_read_b64_tr_b16 v[100:101],v17 offset:32768
global_load_lds_dwordx4 v5,s[16:17] offset:1024 sc1
v_mfma_f32_16x16x32_bf16 a[20:23],v[164:167],v[136:139],a[20:23]
ds_read_b64_tr_b16 v[102:103],v17 offset:36864
v_mfma_f32_16x16x32_bf16 a[24:27],v[168:171],v[136:139],a[24:27]
ds_read_b128 v[72:75],v12 offset:34816
global_load_lds_dwordx4 v6,s[16:17] offset:2048 sc1
v_mfma_f32_16x16x32_bf16 a[28:31],v[172:175],v[136:139],a[28:31]
ds_read_b64_tr_b16 v[104:105],v18 offset:32768
v_mfma_f32_16x16x32_bf16 a[32:35],v[160:163],v[144:147],a[32:35]
ds_read_b64_tr_b16 v[106:107],v18 offset:36864
global_load_lds_dwordx4 v7,s[16:17] offset:3072 sc1
v_mfma_f32_16x16x32_bf16 a[36:39],v[164:167],v[144:147],a[36:39]
ds_read_b128 v[76:79],v12 offset:35840
v_mfma_f32_16x16x32_bf16 a[40:43],v[168:171],v[144:147],a[40:43]
ds_read_b64_tr_b16 v[108:109],v19 offset:32768
s_add_u32 m0,s23,81920
v_mfma_f32_16x16x32_bf16 a[44:47],v[172:175],v[144:147],a[44:47]
ds_read_b64_tr_b16 v[110:111],v19 offset:36864
s_add_u32 s16,s16,s20
v_mfma_f32_16x16x32_bf16 a[48:51],v[160:163],v[152:155],a[48:51]
ds_read_b128 v[80:83],v12 offset:36864
s_addc_u32 s17,s17,0
v_mfma_f32_16x16x32_bf16 a[52:55],v[164:167],v[152:155],a[52:55]
ds_read_b64_tr_b16 v[112:113],v20 offset:32768
global_load_lds_dwordx4 v8,s[18:19] offset:0
v_mfma_f32_16x16x32_bf16 a[56:59],v[168:171],v[152:155],a[56:59]
ds_read_b64_tr_b16 v[114:115],v20 offset:36864
v_mfma_f32_16x16x32_bf16 a[60:63],v[172:175],v[152:155],a[60:63]
ds_read_b128 v[84:87],v12 offset:37888
global_load_lds_dwordx4 v9,s[18:19] offset:1024
v_mfma_f32_16x16x32_bf16 a[0:3],v[176:179],v[132:135],a[0:3]
ds_read_b64_tr_b16 v[116:117],v21 offset:32768
v_mfma_f32_16x16x32_bf16 a[4:7],v[180:183],v[132:135],a[4:7]
ds_read_b64_tr_b16 v[118:119],v21 offset:36864
global_load_lds_dwordx4 v10,s[18:19] offset:2048
v_mfma_f32_16x16x32_bf16 a[8:11],v[184:187],v[132:135],a[8:11]
ds_read_b128 v[88:91],v12 offset:38912
v_mfma_f32_16x16x32_bf16 a[12:15],v[188:191],v[132:135],a[12:15]
ds_read_b64_tr_b16 v[120:121],v22 offset:32768
global_load_lds_dwordx4 v11,s[18:19] offset:3072
v_mfma_f32_16x16x32_bf16 a[16:19],v[176:179],v[140:143],a[16:19]
ds_read_b64_tr_b16 v[122:123],v22 offset:36864
v_mfma_f32_16x16x32_bf16 a[20:23],v[180:183],v[140:143],a[20:23]
ds_read_b128 v[92:95],v12 offset:39936
s_add_u32 s18,s18,s21
v_mfma_f32_16x16x32_bf16 a[24:27],v[184:187],v[140:143],a[24:27]
ds_read_b64_tr_b16 v[124:125],v23 offset:32768
s_addc_u32 s19,s19,0
v_mfma_f32_16x16x32_bf16 a[28:31],v[188:191],v[140:143],a[28:31]
ds_read_b64_tr_b16 v[126:127],v23 offset:36864
v_mfma_f32_16x16x32_bf16 a[32:35],v[176:179],v[148:151],a[32:35]
v_mfma_f32_16x16x32_bf16 a[36:39],v[180:183],v[148:151],a[36:39]
v_mfma_f32_16x16x32_bf16 a[40:43],v[184:187],v[148:151],a[40:43]
v_mfma_f32_16x16x32_bf16 a[44:47],v[188:191],v[148:151],a[44:47]
v_mfma_f32_16x16x32_bf16 a[48:51],v[176:179],v[156:159],a[48:51]
v_mfma_f32_16x16x32_bf16 a[52:55],v[180:183],v[156:159],a[52:55]
v_mfma_f32_16x16x32_bf16 a[56:59],v[184:187],v[156:159],a[56:59]
v_mfma_f32_16x16x32_bf16 a[60:63],v[188:191],v[156:159],a[60:63]
s_waitcnt vmcnt(16) lgkmcnt(0)
s_barrier
v_mfma_f32_16x16x32_bf16 a[0:3],v[96:99],v[64:67],a[0:3]
ds_read_b128 v[128:131],v12 offset:49152
v_mfma_f32_16x16x32_bf16 a[4:7],v[100:103],v[64:67],a[4:7]
ds_read_b64_tr_b16 v[160:161],v16 offset:49152
s_add_u32 m0,s23,32768
v_mfma_f32_16x16x32_bf16 a[8:11],v[104:107],v[64:67],a[8:11]
ds_read_b64_tr_b16 v[162:163],v16 offset:53248
global_load_lds_dwordx4 v4,s[16:17] offset:0 sc1
v_mfma_f32_16x16x32_bf16 a[12:15],v[108:111],v[64:67],a[12:15]
ds_read_b128 v[132:135],v12 offset:50176
v_mfma_f32_16x16x32_bf16 a[16:19],v[96:99],v[72:75],a[16:19]
ds_read_b64_tr_b16 v[164:165],v17 offset:49152
global_load_lds_dwordx4 v5,s[16:17] offset:1024 sc1
v_mfma_f32_16x16x32_bf16 a[20:23],v[100:103],v[72:75],a[20:23]
ds_read_b64_tr_b16 v[166:167],v17 offset:53248
v_mfma_f32_16x16x32_bf16 a[24:27],v[104:107],v[72:75],a[24:27]
ds_read_b128 v[136:139],v12 offset:51200
global_load_lds_dwordx4 v6,s[16:17] offset:2048 sc1
v_mfma_f32_16x16x32_bf16 a[28:31],v[108:111],v[72:75],a[28:31]
ds_read_b64_tr_b16 v[168:169],v18 offset:49152
v_mfma_f32_16x16x32_bf16 a[32:35],v[96:99],v[80:83],a[32:35]
ds_read_b64_tr_b16 v[170:171],v18 offset:53248
global_load_lds_dwordx4 v7,s[16:17] offset:3072 sc1
v_mfma_f32_16x16x32_bf16 a[36:39],v[100:103],v[80:83],a[36:39]
ds_read_b128 v[140:143],v12 offset:52224
v_mfma_f32_16x16x32_bf16 a[40:43],v[104:107],v[80:83],a[40:43]
ds_read_b64_tr_b16 v[172:173],v19 offset:49152
s_add_u32 m0,s23,98304
v_mfma_f32_16x16x32_bf16 a[44:47],v[108:111],v[80:83],a[44:47]
ds_read_b64_tr_b16 v[174:175],v19 offset:53248
s_add_u32 s16,s16,s20
v_mfma_f32_16x16x32_bf16 a[48:51],v[96:99],v[88:91],a[48:51]
ds_read_b128 v[144:147],v12 offset:53248
s_addc_u32 s17,s17,0
v_mfma_f32_16x16x32_bf16 a[52:55],v[100:103],v[88:91],a[52:55]
ds_read_b64_tr_b16 v[176:177],v20 offset:49152
global_load_lds_dwordx4 v8,s[18:19] offset:0
v_mfma_f32_16x16x32_bf16 a[56:59],v[104:107],v[88:91],a[56:59]
ds_read_b64_tr_b16 v[178:179],v20 offset:53248
v_mfma_f32_16x16x32_bf16 a[60:63],v[108:111],v[88:91],a[60:63]
ds_read_b128 v[148:151],v12 offset:54272
global_load_lds_dwordx4 v9,s[18:19] offset:1024
v_mfma_f32_16x16x32_bf16 a[0:3],v[112:115],v[68:71],a[0:3]
ds_read_b64_tr_b16 v[180:181],v21 offset:49152
v_mfma_f32_16x16x32_bf16 a[4:7],v[116:119],v[68:71],a[4:7]
ds_read_b64_tr_b16 v[182:183],v21 offset:53248
global_load_lds_dwordx4 v10,s[18:19] offset:2048
v_mfma_f32_16x16x32_bf16 a[8:11],v[120:123],v[68:71],a[8:11]
ds_read_b128 v[152:155],v12 offset:55296
v_mfma_f32_16x16x32_bf16 a[12:15],v[124:127],v[68:71],a[12:15]
ds_read_b64_tr_b16 v[184:185],v22 offset:49152
global_load_lds_dwordx4 v11,s[18:19] offset:3072
v_mfma_f32_16x16x32_bf16 a[16:19],v[112:115],v[76:79],a[16:19]
ds_read_b64_tr_b16 v[186:187],v22 offset:53248
v_mfma_f32_16x16x32_bf16 a[20:23],v[116:119],v[76:79],a[20:23]
ds_read_b128 v[156:159],v12 offset:56320
s_add_u32 s18,s18,s21
v_mfma_f32_16x16x32_bf16 a[24:27],v[120:123],v[76:79],a[24:27]
ds_read_b64_tr_b16 v[188:189],v23 offset:49152
s_addc_u32 s19,s19,0
v_mfma_f32_16x16x32_bf16 a[28:31],v[124:127],v[76:79],a[28:31]
ds_read_b64_tr_b16 v[190:191],v23 offset:53248
v_mfma_f32_16x16x32_bf16 a[32:35],v[112:115],v[84:87],a[32:35]
v_mfma_f32_16x16x32_bf16 a[36:39],v[116:119],v[84:87],a[36:39]
v_mfma_f32_16x16x32_bf16 a[40:43],v[120:123],v[84:87],a[40:43]
v_mfma_f32_16x16x32_bf16 a[44:47],v[124:127],v[84:87],a[44:47]
v_mfma_f32_16x16x32_bf16 a[48:51],v[112:115],v[92:95],a[48:51]
v_mfma_f32_16x16x32_bf16 a[52:55],v[116:119],v[92:95],a[52:55]
v_mfma_f32_16x16x32_bf16 a[56:59],v[120:123],v[92:95],a[56:59]
v_mfma_f32_16x16x32_bf16 a[60:63],v[124:127],v[92:95],a[60:63]
s_waitcnt vmcnt(63) lgkmcnt(0)
s_barrier
v_mfma_f32_16x16x32_bf16 a[0:3],v[160:163],v[128:131],a[0:3]
v_mfma_f32_16x16x32_bf16 a[4:7],v[164:167],v[128:131],a[4:7]
s_add_u32 m0,s23,49152
v_mfma_f32_16x16x32_bf16 a[8:11],v[168:171],v[128:131],a[8:11]
global_load_lds_dwordx4 v4,s[16:17] offset:0 sc1
v_mfma_f32_16x16x32_bf16 a[12:15],v[172:175],v[128:131],a[12:15]
v_mfma_f32_16x16x32_bf16 a[16:19],v[160:163],v[136:139],a[16:19]
global_load_lds_dwordx4 v5,s[16:17] offset:1024 sc1
v_mfma_f32_16x16x32_bf16 a[20:23],v[164:167],v[136:139],a[20:23]
v_mfma_f32_16x16x32_bf16 a[24:27],v[168:171],v[136:139],a[24:27]
global_load_lds_dwordx4 v6,s[16:17] offset:2048 sc1
v_mfma_f32_16x16x32_bf16 a[28:31],v[172:175],v[136:139],a[28:31]
v_mfma_f32_16x16x32_bf16 a[32:35],v[160:163],v[144:147],a[32:35]
global_load_lds_dwordx4 v7,s[16:17] offset:3072 sc1
v_mfma_f32_16x16x32_bf16 a[36:39],v[164:167],v[144:147],a[36:39]
v_mfma_f32_16x16x32_bf16 a[40:43],v[168:171],v[144:147],a[40:43]
s_add_u32 m0,s23,114688
v_mfma_f32_16x16x32_bf16 a[44:47],v[172:175],v[144:147],a[44:47]
s_add_u32 s16,s16,s20
v_mfma_f32_16x16x32_bf16 a[48:51],v[160:163],v[152:155],a[48:51]
s_addc_u32 s17,s17,0
v_mfma_f32_16x16x32_bf16 a[52:55],v[164:167],v[152:155],a[52:55]
global_load_lds_dwordx4 v8,s[18:19] offset:0
v_mfma_f32_16x16x32_bf16 a[56:59],v[168:171],v[152:155],a[56:59]
v_mfma_f32_16x16x32_bf16 a[60:63],v[172:175],v[152:155],a[60:63]
global_load_lds_dwordx4 v9,s[18:19] offset:1024
v_mfma_f32_16x16x32_bf16 a[0:3],v[176:179],v[132:135],a[0:3]
v_mfma_f32_16x16x32_bf16 a[4:7],v[180:183],v[132:135],a[4:7]
global_load_lds_dwordx4 v10,s[18:19] offset:2048
v_mfma_f32_16x16x32_bf16 a[8:11],v[184:187],v[132:135],a[8:11]
v_mfma_f32_16x16x32_bf16 a[12:15],v[188:191],v[132:135],a[12:15]
global_load_lds_dwordx4 v11,s[18:19] offset:3072
v_mfma_f32_16x16x32_bf16 a[16:19],v[176:179],v[140:143],a[16:19]
v_mfma_f32_16x16x32_bf16 a[20:23],v[180:183],v[140:143],a[20:23]
s_add_u32 s18,s18,s21
v_mfma_f32_16x16x32_bf16 a[24:27],v[184:187],v[140:143],a[24:27]
s_addc_u32 s19,s19,0
v_mfma_f32_16x16x32_bf16 a[28:31],v[188:191],v[140:143],a[28:31]
v_mfma_f32_16x16x32_bf16 a[32:35],v[176:179],v[148:151],a[32:35]
v_mfma_f32_16x16x32_bf16 a[36:39],v[180:183],v[148:151],a[36:39]
v_mfma_f32_16x16x32_bf16 a[40:43],v[184:187],v[148:151],a[40:43]
v_mfma_f32_16x16x32_bf16 a[44:47],v[188:191],v[148:151],a[44:47]
v_mfma_f32_16x16x32_bf16 a[48:51],v[176:179],v[156:159],a[48:51]
v_mfma_f32_16x16x32_bf16 a[52:55],v[180:183],v[156:159],a[52:55]
v_mfma_f32_16x16x32_bf16 a[56:59],v[184:187],v[156:159],a[56:59]
v_mfma_f32_16x16x32_bf16 a[60:63],v[188:191],v[156:159],a[60:63]
s_cmp_eq_u32 s36,6
s_cbranch_scc1 L_e_da
s_branch L_e_dk
L_e_da:
s_waitcnt vmcnt(32)
v_accvgpr_read_b32 v24,a0
v_accvgpr_read_b32 v25,a1
v_accvgpr_read_b32 v26,a2
v_accvgpr_read_b32 v27,a3
v_accvgpr_read_b32 v28,a4
v_accvgpr_read_b32 v29,a5
v_accvgpr_read_b32 v30,a6
v_accvgpr_read_b32 v31,a7
v_accvgpr_read_b32 v48,a64
v_accvgpr_read_b32 v49,a65
v_accvgpr_read_b32 v50,a66
v_accvgpr_read_b32 v51,a67
v_cvt_pk_bf16_f32 v32,v24,v25
v_cvt_pk_bf16_f32 v33,v26,v27
v_cvt_pk_bf16_f32 v34,v28,v29
v_cvt_pk_bf16_f32 v35,v30,v31
v_lshlrev_b32 v24,16,v32
v_and_b32 v25,0xffff0000,v32
v_lshlrev_b32 v26,16,v33
v_and_b32 v27,0xffff0000,v33
v_lshlrev_b32 v28,16,v34
v_and_b32 v29,0xffff0000,v34
v_lshlrev_b32 v30,16,v35
v_and_b32 v31,0xffff0000,v35
v_pk_mul_f32 v[24:25],v[24:25],v[240:241] op_sel_hi:[1,0]
v_pk_mul_f32 v[26:27],v[26:27],v[240:241] op_sel_hi:[1,0]
v_pk_mul_f32 v[28:29],v[28:29],v[240:241] op_sel_hi:[1,0]
v_pk_mul_f32 v[30:31],v[30:31],v[240:241] op_sel_hi:[1,0]
v_cvt_pk_bf16_f32 v32,v24,v25
v_cvt_pk_bf16_f32 v33,v26,v27
v_cvt_pk_bf16_f32 v34,v28,v29
v_cvt_pk_bf16_f32 v35,v30,v31
v_lshlrev_b32 v24,16,v32
v_and_b32 v25,0xffff0000,v32
v_lshlrev_b32 v26,16,v33
v_and_b32 v27,0xffff0000,v33
v_lshlrev_b32 v28,16,v34
v_and_b32 v29,0xffff0000,v34
v_lshlrev_b32 v30,16,v35
v_and_b32 v31,0xffff0000,v35
v_lshlrev_b32 v40,16,v48
v_and_b32 v41,0xffff0000,v48
v_lshlrev_b32 v42,16,v49
v_and_b32 v43,0xffff0000,v49
v_lshlrev_b32 v44,16,v50
v_and_b32 v45,0xffff0000,v50
v_lshlrev_b32 v46,16,v51
v_and_b32 v47,0xffff0000,v51
v_pk_add_f32 v[24:25],v[24:25],v[40:41]
v_pk_add_f32 v[26:27],v[26:27],v[42:43]
v_pk_add_f32 v[28:29],v[28:29],v[44:45]
v_pk_add_f32 v[30:31],v[30:31],v[46:47]
v_cvt_pk_bf16_f32 v64,v24,v25
v_cvt_pk_bf16_f32 v65,v26,v27
v_cvt_pk_bf16_f32 v66,v28,v29
v_cvt_pk_bf16_f32 v67,v30,v31
s_nop 0
v_permlane16_swap_b32 v64,v66
v_permlane16_swap_b32 v65,v67
global_store_dwordx4 v214,v[64:67],s[44:45] offset:0 sc1
v_accvgpr_read_b32 v24,a8
v_accvgpr_read_b32 v25,a9
v_accvgpr_read_b32 v26,a10
v_accvgpr_read_b32 v27,a11
v_accvgpr_read_b32 v28,a12
v_accvgpr_read_b32 v29,a13
v_accvgpr_read_b32 v30,a14
v_accvgpr_read_b32 v31,a15
v_accvgpr_read_b32 v48,a68
v_accvgpr_read_b32 v49,a69
v_accvgpr_read_b32 v50,a70
v_accvgpr_read_b32 v51,a71
v_cvt_pk_bf16_f32 v32,v24,v25
v_cvt_pk_bf16_f32 v33,v26,v27
v_cvt_pk_bf16_f32 v34,v28,v29
v_cvt_pk_bf16_f32 v35,v30,v31
v_lshlrev_b32 v24,16,v32
v_and_b32 v25,0xffff0000,v32
v_lshlrev_b32 v26,16,v33
v_and_b32 v27,0xffff0000,v33
v_lshlrev_b32 v28,16,v34
v_and_b32 v29,0xffff0000,v34
v_lshlrev_b32 v30,16,v35
v_and_b32 v31,0xffff0000,v35
v_pk_mul_f32 v[24:25],v[24:25],v[240:241] op_sel_hi:[1,0]
v_pk_mul_f32 v[26:27],v[26:27],v[240:241] op_sel_hi:[1,0]
v_pk_mul_f32 v[28:29],v[28:29],v[240:241] op_sel_hi:[1,0]
v_pk_mul_f32 v[30:31],v[30:31],v[240:241] op_sel_hi:[1,0]
v_cvt_pk_bf16_f32 v32,v24,v25
v_cvt_pk_bf16_f32 v33,v26,v27
v_cvt_pk_bf16_f32 v34,v28,v29
v_cvt_pk_bf16_f32 v35,v30,v31
v_lshlrev_b32 v24,16,v32
v_and_b32 v25,0xffff0000,v32
v_lshlrev_b32 v26,16,v33
v_and_b32 v27,0xffff0000,v33
v_lshlrev_b32 v28,16,v34
v_and_b32 v29,0xffff0000,v34
v_lshlrev_b32 v30,16,v35
v_and_b32 v31,0xffff0000,v35
v_lshlrev_b32 v40,16,v48
v_and_b32 v41,0xffff0000,v48
v_lshlrev_b32 v42,16,v49
v_and_b32 v43,0xffff0000,v49
v_lshlrev_b32 v44,16,v50
v_and_b32 v45,0xffff0000,v50
v_lshlrev_b32 v46,16,v51
v_and_b32 v47,0xffff0000,v51
v_pk_add_f32 v[24:25],v[24:25],v[40:41]
v_pk_add_f32 v[26:27],v[26:27],v[42:43]
v_pk_add_f32 v[28:29],v[28:29],v[44:45]
v_pk_add_f32 v[30:31],v[30:31],v[46:47]
v_cvt_pk_bf16_f32 v68,v24,v25
v_cvt_pk_bf16_f32 v69,v26,v27
v_cvt_pk_bf16_f32 v70,v28,v29
v_cvt_pk_bf16_f32 v71,v30,v31
s_nop 0
v_permlane16_swap_b32 v68,v70
v_permlane16_swap_b32 v69,v71
global_store_dwordx4 v214,v[68:71],s[44:45] offset:64 sc1
s_add_u32 s44,s44,32768
s_addc_u32 s45,s45,0
v_accvgpr_read_b32 v24,a16
v_accvgpr_read_b32 v25,a17
v_accvgpr_read_b32 v26,a18
v_accvgpr_read_b32 v27,a19
v_accvgpr_read_b32 v28,a20
v_accvgpr_read_b32 v29,a21
v_accvgpr_read_b32 v30,a22
v_accvgpr_read_b32 v31,a23
v_accvgpr_read_b32 v48,a72
v_accvgpr_read_b32 v49,a73
v_accvgpr_read_b32 v50,a74
v_accvgpr_read_b32 v51,a75
v_cvt_pk_bf16_f32 v32,v24,v25
v_cvt_pk_bf16_f32 v33,v26,v27
v_cvt_pk_bf16_f32 v34,v28,v29
v_cvt_pk_bf16_f32 v35,v30,v31
v_lshlrev_b32 v24,16,v32
v_and_b32 v25,0xffff0000,v32
v_lshlrev_b32 v26,16,v33
v_and_b32 v27,0xffff0000,v33
v_lshlrev_b32 v28,16,v34
v_and_b32 v29,0xffff0000,v34
v_lshlrev_b32 v30,16,v35
v_and_b32 v31,0xffff0000,v35
v_pk_mul_f32 v[24:25],v[24:25],v[242:243] op_sel_hi:[1,0]
v_pk_mul_f32 v[26:27],v[26:27],v[242:243] op_sel_hi:[1,0]
v_pk_mul_f32 v[28:29],v[28:29],v[242:243] op_sel_hi:[1,0]
v_pk_mul_f32 v[30:31],v[30:31],v[242:243] op_sel_hi:[1,0]
v_cvt_pk_bf16_f32 v32,v24,v25
v_cvt_pk_bf16_f32 v33,v26,v27
v_cvt_pk_bf16_f32 v34,v28,v29
v_cvt_pk_bf16_f32 v35,v30,v31
v_lshlrev_b32 v24,16,v32
v_and_b32 v25,0xffff0000,v32
v_lshlrev_b32 v26,16,v33
v_and_b32 v27,0xffff0000,v33
v_lshlrev_b32 v28,16,v34
v_and_b32 v29,0xffff0000,v34
v_lshlrev_b32 v30,16,v35
v_and_b32 v31,0xffff0000,v35
v_lshlrev_b32 v40,16,v48
v_and_b32 v41,0xffff0000,v48
v_lshlrev_b32 v42,16,v49
v_and_b32 v43,0xffff0000,v49
v_lshlrev_b32 v44,16,v50
v_and_b32 v45,0xffff0000,v50
v_lshlrev_b32 v46,16,v51
v_and_b32 v47,0xffff0000,v51
v_pk_add_f32 v[24:25],v[24:25],v[40:41]
v_pk_add_f32 v[26:27],v[26:27],v[42:43]
v_pk_add_f32 v[28:29],v[28:29],v[44:45]
v_pk_add_f32 v[30:31],v[30:31],v[46:47]
v_cvt_pk_bf16_f32 v72,v24,v25
v_cvt_pk_bf16_f32 v73,v26,v27
v_cvt_pk_bf16_f32 v74,v28,v29
v_cvt_pk_bf16_f32 v75,v30,v31
s_nop 0
v_permlane16_swap_b32 v72,v74
v_permlane16_swap_b32 v73,v75
global_store_dwordx4 v214,v[72:75],s[44:45] offset:0 sc1
v_accvgpr_read_b32 v24,a24
v_accvgpr_read_b32 v25,a25
v_accvgpr_read_b32 v26,a26
v_accvgpr_read_b32 v27,a27
v_accvgpr_read_b32 v28,a28
v_accvgpr_read_b32 v29,a29
v_accvgpr_read_b32 v30,a30
v_accvgpr_read_b32 v31,a31
v_accvgpr_read_b32 v48,a76
v_accvgpr_read_b32 v49,a77
v_accvgpr_read_b32 v50,a78
v_accvgpr_read_b32 v51,a79
v_cvt_pk_bf16_f32 v32,v24,v25
v_cvt_pk_bf16_f32 v33,v26,v27
v_cvt_pk_bf16_f32 v34,v28,v29
v_cvt_pk_bf16_f32 v35,v30,v31
v_lshlrev_b32 v24,16,v32
v_and_b32 v25,0xffff0000,v32
v_lshlrev_b32 v26,16,v33
v_and_b32 v27,0xffff0000,v33
v_lshlrev_b32 v28,16,v34
v_and_b32 v29,0xffff0000,v34
v_lshlrev_b32 v30,16,v35
v_and_b32 v31,0xffff0000,v35
v_pk_mul_f32 v[24:25],v[24:25],v[242:243] op_sel_hi:[1,0]
v_pk_mul_f32 v[26:27],v[26:27],v[242:243] op_sel_hi:[1,0]
v_pk_mul_f32 v[28:29],v[28:29],v[242:243] op_sel_hi:[1,0]
v_pk_mul_f32 v[30:31],v[30:31],v[242:243] op_sel_hi:[1,0]
v_cvt_pk_bf16_f32 v32,v24,v25
v_cvt_pk_bf16_f32 v33,v26,v27
v_cvt_pk_bf16_f32 v34,v28,v29
v_cvt_pk_bf16_f32 v35,v30,v31
v_lshlrev_b32 v24,16,v32
v_and_b32 v25,0xffff0000,v32
v_lshlrev_b32 v26,16,v33
v_and_b32 v27,0xffff0000,v33
v_lshlrev_b32 v28,16,v34
v_and_b32 v29,0xffff0000,v34
v_lshlrev_b32 v30,16,v35
v_and_b32 v31,0xffff0000,v35
v_lshlrev_b32 v40,16,v48
v_and_b32 v41,0xffff0000,v48
v_lshlrev_b32 v42,16,v49
v_and_b32 v43,0xffff0000,v49
v_lshlrev_b32 v44,16,v50
v_and_b32 v45,0xffff0000,v50
v_lshlrev_b32 v46,16,v51
v_and_b32 v47,0xffff0000,v51
v_pk_add_f32 v[24:25],v[24:25],v[40:41]
v_pk_add_f32 v[26:27],v[26:27],v[42:43]
v_pk_add_f32 v[28:29],v[28:29],v[44:45]
v_pk_add_f32 v[30:31],v[30:31],v[46:47]
v_cvt_pk_bf16_f32 v76,v24,v25
v_cvt_pk_bf16_f32 v77,v26,v27
v_cvt_pk_bf16_f32 v78,v28,v29
v_cvt_pk_bf16_f32 v79,v30,v31
s_nop 0
v_permlane16_swap_b32 v76,v78
v_permlane16_swap_b32 v77,v79
global_store_dwordx4 v214,v[76:79],s[44:45] offset:64 sc1
s_add_u32 s44,s44,32768
s_addc_u32 s45,s45,0
v_accvgpr_read_b32 v24,a32
v_accvgpr_read_b32 v25,a33
v_accvgpr_read_b32 v26,a34
v_accvgpr_read_b32 v27,a35
v_accvgpr_read_b32 v28,a36
v_accvgpr_read_b32 v29,a37
v_accvgpr_read_b32 v30,a38
v_accvgpr_read_b32 v31,a39
v_accvgpr_read_b32 v48,a80
v_accvgpr_read_b32 v49,a81
v_accvgpr_read_b32 v50,a82
v_accvgpr_read_b32 v51,a83
v_cvt_pk_bf16_f32 v32,v24,v25
v_cvt_pk_bf16_f32 v33,v26,v27
v_cvt_pk_bf16_f32 v34,v28,v29
v_cvt_pk_bf16_f32 v35,v30,v31
v_lshlrev_b32 v24,16,v32
v_and_b32 v25,0xffff0000,v32
v_lshlrev_b32 v26,16,v33
v_and_b32 v27,0xffff0000,v33
v_lshlrev_b32 v28,16,v34
v_and_b32 v29,0xffff0000,v34
v_lshlrev_b32 v30,16,v35
v_and_b32 v31,0xffff0000,v35
v_pk_mul_f32 v[24:25],v[24:25],v[244:245] op_sel_hi:[1,0]
v_pk_mul_f32 v[26:27],v[26:27],v[244:245] op_sel_hi:[1,0]
v_pk_mul_f32 v[28:29],v[28:29],v[244:245] op_sel_hi:[1,0]
v_pk_mul_f32 v[30:31],v[30:31],v[244:245] op_sel_hi:[1,0]
v_cvt_pk_bf16_f32 v32,v24,v25
v_cvt_pk_bf16_f32 v33,v26,v27
v_cvt_pk_bf16_f32 v34,v28,v29
v_cvt_pk_bf16_f32 v35,v30,v31
v_lshlrev_b32 v24,16,v32
v_and_b32 v25,0xffff0000,v32
v_lshlrev_b32 v26,16,v33
v_and_b32 v27,0xffff0000,v33
v_lshlrev_b32 v28,16,v34
v_and_b32 v29,0xffff0000,v34
v_lshlrev_b32 v30,16,v35
v_and_b32 v31,0xffff0000,v35
v_lshlrev_b32 v40,16,v48
v_and_b32 v41,0xffff0000,v48
v_lshlrev_b32 v42,16,v49
v_and_b32 v43,0xffff0000,v49
v_lshlrev_b32 v44,16,v50
v_and_b32 v45,0xffff0000,v50
v_lshlrev_b32 v46,16,v51
v_and_b32 v47,0xffff0000,v51
v_pk_add_f32 v[24:25],v[24:25],v[40:41]
v_pk_add_f32 v[26:27],v[26:27],v[42:43]
v_pk_add_f32 v[28:29],v[28:29],v[44:45]
v_pk_add_f32 v[30:31],v[30:31],v[46:47]
v_cvt_pk_bf16_f32 v80,v24,v25
v_cvt_pk_bf16_f32 v81,v26,v27
v_cvt_pk_bf16_f32 v82,v28,v29
v_cvt_pk_bf16_f32 v83,v30,v31
s_nop 0
v_permlane16_swap_b32 v80,v82
v_permlane16_swap_b32 v81,v83
global_store_dwordx4 v214,v[80:83],s[44:45] offset:0 sc1
v_accvgpr_read_b32 v24,a40
v_accvgpr_read_b32 v25,a41
v_accvgpr_read_b32 v26,a42
v_accvgpr_read_b32 v27,a43
v_accvgpr_read_b32 v28,a44
v_accvgpr_read_b32 v29,a45
v_accvgpr_read_b32 v30,a46
v_accvgpr_read_b32 v31,a47
v_accvgpr_read_b32 v48,a84
v_accvgpr_read_b32 v49,a85
v_accvgpr_read_b32 v50,a86
v_accvgpr_read_b32 v51,a87
v_cvt_pk_bf16_f32 v32,v24,v25
v_cvt_pk_bf16_f32 v33,v26,v27
v_cvt_pk_bf16_f32 v34,v28,v29
v_cvt_pk_bf16_f32 v35,v30,v31
v_lshlrev_b32 v24,16,v32
v_and_b32 v25,0xffff0000,v32
v_lshlrev_b32 v26,16,v33
v_and_b32 v27,0xffff0000,v33
v_lshlrev_b32 v28,16,v34
v_and_b32 v29,0xffff0000,v34
v_lshlrev_b32 v30,16,v35
v_and_b32 v31,0xffff0000,v35
v_pk_mul_f32 v[24:25],v[24:25],v[244:245] op_sel_hi:[1,0]
v_pk_mul_f32 v[26:27],v[26:27],v[244:245] op_sel_hi:[1,0]
v_pk_mul_f32 v[28:29],v[28:29],v[244:245] op_sel_hi:[1,0]
v_pk_mul_f32 v[30:31],v[30:31],v[244:245] op_sel_hi:[1,0]
v_cvt_pk_bf16_f32 v32,v24,v25
v_cvt_pk_bf16_f32 v33,v26,v27
v_cvt_pk_bf16_f32 v34,v28,v29
v_cvt_pk_bf16_f32 v35,v30,v31
v_lshlrev_b32 v24,16,v32
v_and_b32 v25,0xffff0000,v32
v_lshlrev_b32 v26,16,v33
v_and_b32 v27,0xffff0000,v33
v_lshlrev_b32 v28,16,v34
v_and_b32 v29,0xffff0000,v34
v_lshlrev_b32 v30,16,v35
v_and_b32 v31,0xffff0000,v35
v_lshlrev_b32 v40,16,v48
v_and_b32 v41,0xffff0000,v48
v_lshlrev_b32 v42,16,v49
v_and_b32 v43,0xffff0000,v49
v_lshlrev_b32 v44,16,v50
v_and_b32 v45,0xffff0000,v50
v_lshlrev_b32 v46,16,v51
v_and_b32 v47,0xffff0000,v51
v_pk_add_f32 v[24:25],v[24:25],v[40:41]
v_pk_add_f32 v[26:27],v[26:27],v[42:43]
v_pk_add_f32 v[28:29],v[28:29],v[44:45]
v_pk_add_f32 v[30:31],v[30:31],v[46:47]
v_cvt_pk_bf16_f32 v84,v24,v25
v_cvt_pk_bf16_f32 v85,v26,v27
v_cvt_pk_bf16_f32 v86,v28,v29
v_cvt_pk_bf16_f32 v87,v30,v31
s_nop 0
v_permlane16_swap_b32 v84,v86
v_permlane16_swap_b32 v85,v87
global_store_dwordx4 v214,v[84:87],s[44:45] offset:64 sc1
s_add_u32 s44,s44,32768
s_addc_u32 s45,s45,0
v_accvgpr_read_b32 v24,a48
v_accvgpr_read_b32 v25,a49
v_accvgpr_read_b32 v26,a50
v_accvgpr_read_b32 v27,a51
v_accvgpr_read_b32 v28,a52
v_accvgpr_read_b32 v29,a53
v_accvgpr_read_b32 v30,a54
v_accvgpr_read_b32 v31,a55
v_accvgpr_read_b32 v48,a88
v_accvgpr_read_b32 v49,a89
v_accvgpr_read_b32 v50,a90
v_accvgpr_read_b32 v51,a91
v_cvt_pk_bf16_f32 v32,v24,v25
v_cvt_pk_bf16_f32 v33,v26,v27
v_cvt_pk_bf16_f32 v34,v28,v29
v_cvt_pk_bf16_f32 v35,v30,v31
v_lshlrev_b32 v24,16,v32
v_and_b32 v25,0xffff0000,v32
v_lshlrev_b32 v26,16,v33
v_and_b32 v27,0xffff0000,v33
v_lshlrev_b32 v28,16,v34
v_and_b32 v29,0xffff0000,v34
v_lshlrev_b32 v30,16,v35
v_and_b32 v31,0xffff0000,v35
v_pk_mul_f32 v[24:25],v[24:25],v[246:247] op_sel_hi:[1,0]
v_pk_mul_f32 v[26:27],v[26:27],v[246:247] op_sel_hi:[1,0]
v_pk_mul_f32 v[28:29],v[28:29],v[246:247] op_sel_hi:[1,0]
v_pk_mul_f32 v[30:31],v[30:31],v[246:247] op_sel_hi:[1,0]
v_cvt_pk_bf16_f32 v32,v24,v25
v_cvt_pk_bf16_f32 v33,v26,v27
v_cvt_pk_bf16_f32 v34,v28,v29
v_cvt_pk_bf16_f32 v35,v30,v31
v_lshlrev_b32 v24,16,v32
v_and_b32 v25,0xffff0000,v32
v_lshlrev_b32 v26,16,v33
v_and_b32 v27,0xffff0000,v33
v_lshlrev_b32 v28,16,v34
v_and_b32 v29,0xffff0000,v34
v_lshlrev_b32 v30,16,v35
v_and_b32 v31,0xffff0000,v35
v_lshlrev_b32 v40,16,v48
v_and_b32 v41,0xffff0000,v48
v_lshlrev_b32 v42,16,v49
v_and_b32 v43,0xffff0000,v49
v_lshlrev_b32 v44,16,v50
v_and_b32 v45,0xffff0000,v50
v_lshlrev_b32 v46,16,v51
v_and_b32 v47,0xffff0000,v51
v_pk_add_f32 v[24:25],v[24:25],v[40:41]
v_pk_add_f32 v[26:27],v[26:27],v[42:43]
v_pk_add_f32 v[28:29],v[28:29],v[44:45]
v_pk_add_f32 v[30:31],v[30:31],v[46:47]
v_cvt_pk_bf16_f32 v88,v24,v25
v_cvt_pk_bf16_f32 v89,v26,v27
v_cvt_pk_bf16_f32 v90,v28,v29
v_cvt_pk_bf16_f32 v91,v30,v31
s_nop 0
v_permlane16_swap_b32 v88,v90
v_permlane16_swap_b32 v89,v91
global_store_dwordx4 v214,v[88:91],s[44:45] offset:0 sc1
v_accvgpr_read_b32 v24,a56
v_accvgpr_read_b32 v25,a57
v_accvgpr_read_b32 v26,a58
v_accvgpr_read_b32 v27,a59
v_accvgpr_read_b32 v28,a60
v_accvgpr_read_b32 v29,a61
v_accvgpr_read_b32 v30,a62
v_accvgpr_read_b32 v31,a63
v_accvgpr_read_b32 v48,a92
v_accvgpr_read_b32 v49,a93
v_accvgpr_read_b32 v50,a94
v_accvgpr_read_b32 v51,a95
v_cvt_pk_bf16_f32 v32,v24,v25
v_cvt_pk_bf16_f32 v33,v26,v27
v_cvt_pk_bf16_f32 v34,v28,v29
v_cvt_pk_bf16_f32 v35,v30,v31
v_lshlrev_b32 v24,16,v32
v_and_b32 v25,0xffff0000,v32
v_lshlrev_b32 v26,16,v33
v_and_b32 v27,0xffff0000,v33
v_lshlrev_b32 v28,16,v34
v_and_b32 v29,0xffff0000,v34
v_lshlrev_b32 v30,16,v35
v_and_b32 v31,0xffff0000,v35
v_pk_mul_f32 v[24:25],v[24:25],v[246:247] op_sel_hi:[1,0]
v_pk_mul_f32 v[26:27],v[26:27],v[246:247] op_sel_hi:[1,0]
v_pk_mul_f32 v[28:29],v[28:29],v[246:247] op_sel_hi:[1,0]
v_pk_mul_f32 v[30:31],v[30:31],v[246:247] op_sel_hi:[1,0]
v_cvt_pk_bf16_f32 v32,v24,v25
v_cvt_pk_bf16_f32 v33,v26,v27
v_cvt_pk_bf16_f32 v34,v28,v29
v_cvt_pk_bf16_f32 v35,v30,v31
v_lshlrev_b32 v24,16,v32
v_and_b32 v25,0xffff0000,v32
v_lshlrev_b32 v26,16,v33
v_and_b32 v27,0xffff0000,v33
v_lshlrev_b32 v28,16,v34
v_and_b32 v29,0xffff0000,v34
v_lshlrev_b32 v30,16,v35
v_and_b32 v31,0xffff0000,v35
v_lshlrev_b32 v40,16,v48
v_and_b32 v41,0xffff0000,v48
v_lshlrev_b32 v42,16,v49
v_and_b32 v43,0xffff0000,v49
v_lshlrev_b32 v44,16,v50
v_and_b32 v45,0xffff0000,v50
v_lshlrev_b32 v46,16,v51
v_and_b32 v47,0xffff0000,v51
v_pk_add_f32 v[24:25],v[24:25],v[40:41]
v_pk_add_f32 v[26:27],v[26:27],v[42:43]
v_pk_add_f32 v[28:29],v[28:29],v[44:45]
v_pk_add_f32 v[30:31],v[30:31],v[46:47]
v_cvt_pk_bf16_f32 v92,v24,v25
v_cvt_pk_bf16_f32 v93,v26,v27
v_cvt_pk_bf16_f32 v94,v28,v29
v_cvt_pk_bf16_f32 v95,v30,v31
s_nop 0
v_permlane16_swap_b32 v92,v94
v_permlane16_swap_b32 v93,v95
global_store_dwordx4 v214,v[92:95],s[44:45] offset:64 sc1
s_lshl_b32 s54,s32,7
s_add_u32 s54,s54,94437376
v_mov_b32 v233,s54
s_cmp_eq_u32 s32,63
s_cselect_b32 s39,0,s38
s_cmp_le_u32 s36,3
s_cselect_b32 s54,2,1
s_cmp_eq_u32 s36,5
s_cselect_b32 s54,2,s54
v_mov_b32 v252,s54
s_waitcnt vmcnt(8)
s_branch L_bulk_adv
L_e_dk:
s_lshl_b32 s54,s15,18
s_lshl_b32 s59,s14,12
s_add_u32 s54,s54,s59
s_add_u32 s54,s54,109051904
s_add_u32 s46,s4,s54
s_addc_u32 s47,s5,0
s_add_u32 s54,s13,1
s_and_b32 s54,s54,3
s_lshl_b32 s54,s54,16
s_add_u32 s50,s46,s54
s_addc_u32 s51,s47,0
global_store_dwordx4 v2,a[16:19],s[50:51] offset:0 sc1
global_store_dwordx4 v2,a[20:23],s[50:51] offset:1024 sc1
global_store_dwordx4 v2,a[24:27],s[50:51] offset:2048 sc1
global_store_dwordx4 v2,a[28:31],s[50:51] offset:3072 sc1
s_add_u32 s54,s13,2
s_and_b32 s54,s54,3
s_lshl_b32 s54,s54,16
s_add_u32 s54,s54,16384
s_add_u32 s50,s46,s54
s_addc_u32 s51,s47,0
global_store_dwordx4 v2,a[32:35],s[50:51] offset:0 sc1
global_store_dwordx4 v2,a[36:39],s[50:51] offset:1024 sc1
global_store_dwordx4 v2,a[40:43],s[50:51] offset:2048 sc1
global_store_dwordx4 v2,a[44:47],s[50:51] offset:3072 sc1
s_add_u32 s54,s13,3
s_and_b32 s54,s54,3
s_lshl_b32 s54,s54,16
s_add_u32 s54,s54,32768
s_add_u32 s50,s46,s54
s_addc_u32 s51,s47,0
global_store_dwordx4 v2,a[48:51],s[50:51] offset:0 sc1
global_store_dwordx4 v2,a[52:55],s[50:51] offset:1024 sc1
global_store_dwordx4 v2,a[56:59],s[50:51] offset:2048 sc1
global_store_dwordx4 v2,a[60:63],s[50:51] offset:3072 sc1
s_lshl_b32 s54,s15,7
s_add_u32 s54,s54,94445568
v_mov_b32 v233,s54
s_lshr_b32 s54,s15,4
s_lshl_b32 s54,s54,7
s_add_u32 s54,s54,94442496
v_mov_b32 v24,s54
global_load_dword v25,v24,s[4:5] sc1
s_waitcnt vmcnt(0)
s_barrier
s_cmp_lg_u32 s14,0
s_cbranch_scc1 L_dk_w_ok
s_mov_b64 exec,1
global_atomic_add v236,v233,v234,s[4:5] sc0
s_waitcnt vmcnt(0)
v_cmp_gt_u32 vcc,3,v236
s_mov_b64 exec,-1
s_cbranch_vccz L_dk_w_ok
L_dk_w:
global_load_dword v236,v233,s[4:5] offset:0 sc1
s_sub_u32 s40,s40,1
s_cbranch_scc1 L_bulk_bail
s_waitcnt vmcnt(0)
v_cmp_gt_u32 vcc,4,v236
s_cbranch_vccz L_dk_w_ok
s_sleep 0
s_branch L_dk_w
L_dk_w_ok:
v_cmp_gt_u32 vcc,8,v25
s_cbranch_vccz L_dk_b_ok
L_dk_b:
global_load_dword v236,v24,s[4:5] offset:0 sc1
s_sub_u32 s40,s40,1
s_cbranch_scc1 L_bulk_bail
s_waitcnt vmcnt(0)
v_cmp_gt_u32 vcc,8,v236
s_cbranch_vccz L_dk_b_ok
s_sleep 2
s_branch L_dk_b
L_dk_b_ok:
global_load_dwordx4 a[64:67],v2,s[30:31] offset:0 sc1
global_load_dwordx4 a[68:71],v2,s[30:31] offset:1024 sc1
s_lshl_b32 s54,s13,16
s_add_u32 s46,s46,s54
s_addc_u32 s47,s47,0
s_barrier
global_load_dwordx4 v[144:147],v2,s[46:47] offset:0 sc1
global_load_dwordx4 v[148:151],v2,s[46:47] offset:1024 sc1
global_load_dwordx4 v[152:155],v2,s[46:47] offset:2048 sc1
global_load_dwordx4 v[156:159],v2,s[46:47] offset:3072 sc1
s_add_u32 s46,s46,16384
s_addc_u32 s47,s47,0
global_load_dwordx4 v[160:163],v2,s[46:47] offset:0 sc1
global_load_dwordx4 v[164:167],v2,s[46:47] offset:1024 sc1
global_load_dwordx4 v[168:171],v2,s[46:47] offset:2048 sc1
global_load_dwordx4 v[172:175],v2,s[46:47] offset:3072 sc1
s_add_u32 s46,s46,16384
s_addc_u32 s47,s47,0
global_load_dwordx4 v[176:179],v2,s[46:47] offset:0 sc1
global_load_dwordx4 v[180:183],v2,s[46:47] offset:1024 sc1
global_load_dwordx4 v[184:187],v2,s[46:47] offset:2048 sc1
global_load_dwordx4 v[188:191],v2,s[46:47] offset:3072 sc1
v_accvgpr_read_b32 v128,a0
v_accvgpr_read_b32 v129,a1
v_accvgpr_read_b32 v130,a2
v_accvgpr_read_b32 v131,a3
v_accvgpr_read_b32 v132,a4
v_accvgpr_read_b32 v133,a5
v_accvgpr_read_b32 v134,a6
v_accvgpr_read_b32 v135,a7
v_accvgpr_read_b32 v136,a8
v_accvgpr_read_b32 v137,a9
v_accvgpr_read_b32 v138,a10
v_accvgpr_read_b32 v139,a11
v_accvgpr_read_b32 v140,a12
v_accvgpr_read_b32 v141,a13
v_accvgpr_read_b32 v142,a14
v_accvgpr_read_b32 v143,a15
s_waitcnt vmcnt(8)
v_pk_add_f32 v[128:129],v[128:129],v[144:145]
v_pk_add_f32 v[130:131],v[130:131],v[146:147]
v_pk_add_f32 v[132:133],v[132:133],v[148:149]
v_pk_add_f32 v[134:135],v[134:135],v[150:151]
v_pk_add_f32 v[136:137],v[136:137],v[152:153]
v_pk_add_f32 v[138:139],v[138:139],v[154:155]
v_pk_add_f32 v[140:141],v[140:141],v[156:157]
v_pk_add_f32 v[142:143],v[142:143],v[158:159]
s_waitcnt vmcnt(0)
v_pk_add_f32 v[160:161],v[160:161],v[176:177]
v_pk_add_f32 v[162:163],v[162:163],v[178:179]
v_pk_add_f32 v[164:165],v[164:165],v[180:181]
v_pk_add_f32 v[166:167],v[166:167],v[182:183]
v_pk_add_f32 v[168:169],v[168:169],v[184:185]
v_pk_add_f32 v[170:171],v[170:171],v[186:187]
v_pk_add_f32 v[172:173],v[172:173],v[188:189]
v_pk_add_f32 v[174:175],v[174:175],v[190:191]
v_pk_add_f32 v[128:129],v[128:129],v[160:161]
v_pk_add_f32 v[130:131],v[130:131],v[162:163]
v_pk_add_f32 v[132:133],v[132:133],v[164:165]
v_pk_add_f32 v[134:135],v[134:135],v[166:167]
v_pk_add_f32 v[136:137],v[136:137],v[168:169]
v_pk_add_f32 v[138:139],v[138:139],v[170:171]
v_pk_add_f32 v[140:141],v[140:141],v[172:173]
v_pk_add_f32 v[142:143],v[142:143],v[174:175]
v_accvgpr_write_b32 a0,v128
v_accvgpr_write_b32 a1,v129
v_accvgpr_write_b32 a2,v130
v_accvgpr_write_b32 a3,v131
v_accvgpr_write_b32 a4,v132
v_accvgpr_write_b32 a5,v133
v_accvgpr_write_b32 a6,v134
v_accvgpr_write_b32 a7,v135
v_accvgpr_write_b32 a8,v136
v_accvgpr_write_b32 a9,v137
v_accvgpr_write_b32 a10,v138
v_accvgpr_write_b32 a11,v139
v_accvgpr_write_b32 a12,v140
v_accvgpr_write_b32 a13,v141
v_accvgpr_write_b32 a14,v142
v_accvgpr_write_b32 a15,v143
v_accvgpr_read_b32 v24,a0
v_accvgpr_read_b32 v25,a1
v_accvgpr_read_b32 v26,a2
v_accvgpr_read_b32 v27,a3
v_accvgpr_read_b32 v28,a4
v_accvgpr_read_b32 v29,a5
v_accvgpr_read_b32 v30,a6
v_accvgpr_read_b32 v31,a7
v_accvgpr_read_b32 v48,a64
v_accvgpr_read_b32 v49,a65
v_accvgpr_read_b32 v50,a66
v_accvgpr_read_b32 v51,a67
v_cvt_pk_bf16_f32 v32,v24,v25
v_cvt_pk_bf16_f32 v33,v26,v27
v_cvt_pk_bf16_f32 v34,v28,v29
v_cvt_pk_bf16_f32 v35,v30,v31
v_lshlrev_b32 v24,16,v32
v_and_b32 v25,0xffff0000,v32
v_lshlrev_b32 v26,16,v33
v_and_b32 v27,0xffff0000,v33
v_lshlrev_b32 v28,16,v34
v_and_b32 v29,0xffff0000,v34
v_lshlrev_b32 v30,16,v35
v_and_b32 v31,0xffff0000,v35
v_pk_mul_f32 v[24:25],v[24:25],v[240:241] op_sel_hi:[1,0]
v_pk_mul_f32 v[26:27],v[26:27],v[240:241] op_sel_hi:[1,0]
v_pk_mul_f32 v[28:29],v[28:29],v[240:241] op_sel_hi:[1,0]
v_pk_mul_f32 v[30:31],v[30:31],v[240:241] op_sel_hi:[1,0]
v_cvt_pk_bf16_f32 v32,v24,v25
v_cvt_pk_bf16_f32 v33,v26,v27
v_cvt_pk_bf16_f32 v34,v28,v29
v_cvt_pk_bf16_f32 v35,v30,v31
v_lshlrev_b32 v24,16,v32
v_and_b32 v25,0xffff0000,v32
v_lshlrev_b32 v26,16,v33
v_and_b32 v27,0xffff0000,v33
v_lshlrev_b32 v28,16,v34
v_and_b32 v29,0xffff0000,v34
v_lshlrev_b32 v30,16,v35
v_and_b32 v31,0xffff0000,v35
v_lshlrev_b32 v40,16,v48
v_and_b32 v41,0xffff0000,v48
v_lshlrev_b32 v42,16,v49
v_and_b32 v43,0xffff0000,v49
v_lshlrev_b32 v44,16,v50
v_and_b32 v45,0xffff0000,v50
v_lshlrev_b32 v46,16,v51
v_and_b32 v47,0xffff0000,v51
v_pk_add_f32 v[24:25],v[24:25],v[40:41]
v_pk_add_f32 v[26:27],v[26:27],v[42:43]
v_pk_add_f32 v[28:29],v[28:29],v[44:45]
v_pk_add_f32 v[30:31],v[30:31],v[46:47]
v_cvt_pk_bf16_f32 v64,v24,v25
v_cvt_pk_bf16_f32 v65,v26,v27
v_cvt_pk_bf16_f32 v66,v28,v29
v_cvt_pk_bf16_f32 v67,v30,v31
s_nop 0
v_permlane16_swap_b32 v64,v66
v_permlane16_swap_b32 v65,v67
global_store_dwordx4 v214,v[64:67],s[44:45] offset:0 sc1
v_accvgpr_read_b32 v24,a8
v_accvgpr_read_b32 v25,a9
v_accvgpr_read_b32 v26,a10
v_accvgpr_read_b32 v27,a11
v_accvgpr_read_b32 v28,a12
v_accvgpr_read_b32 v29,a13
v_accvgpr_read_b32 v30,a14
v_accvgpr_read_b32 v31,a15
v_accvgpr_read_b32 v48,a68
v_accvgpr_read_b32 v49,a69
v_accvgpr_read_b32 v50,a70
v_accvgpr_read_b32 v51,a71
v_cvt_pk_bf16_f32 v32,v24,v25
v_cvt_pk_bf16_f32 v33,v26,v27
v_cvt_pk_bf16_f32 v34,v28,v29
v_cvt_pk_bf16_f32 v35,v30,v31
v_lshlrev_b32 v24,16,v32
v_and_b32 v25,0xffff0000,v32
v_lshlrev_b32 v26,16,v33
v_and_b32 v27,0xffff0000,v33
v_lshlrev_b32 v28,16,v34
v_and_b32 v29,0xffff0000,v34
v_lshlrev_b32 v30,16,v35
v_and_b32 v31,0xffff0000,v35
v_pk_mul_f32 v[24:25],v[24:25],v[240:241] op_sel_hi:[1,0]
v_pk_mul_f32 v[26:27],v[26:27],v[240:241] op_sel_hi:[1,0]
v_pk_mul_f32 v[28:29],v[28:29],v[240:241] op_sel_hi:[1,0]
v_pk_mul_f32 v[30:31],v[30:31],v[240:241] op_sel_hi:[1,0]
v_cvt_pk_bf16_f32 v32,v24,v25
v_cvt_pk_bf16_f32 v33,v26,v27
v_cvt_pk_bf16_f32 v34,v28,v29
v_cvt_pk_bf16_f32 v35,v30,v31
v_lshlrev_b32 v24,16,v32
v_and_b32 v25,0xffff0000,v32
v_lshlrev_b32 v26,16,v33
v_and_b32 v27,0xffff0000,v33
v_lshlrev_b32 v28,16,v34
v_and_b32 v29,0xffff0000,v34
v_lshlrev_b32 v30,16,v35
v_and_b32 v31,0xffff0000,v35
v_lshlrev_b32 v40,16,v48
v_and_b32 v41,0xffff0000,v48
v_lshlrev_b32 v42,16,v49
v_and_b32 v43,0xffff0000,v49
v_lshlrev_b32 v44,16,v50
v_and_b32 v45,0xffff0000,v50
v_lshlrev_b32 v46,16,v51
v_and_b32 v47,0xffff0000,v51
v_pk_add_f32 v[24:25],v[24:25],v[40:41]
v_pk_add_f32 v[26:27],v[26:27],v[42:43]
v_pk_add_f32 v[28:29],v[28:29],v[44:45]
v_pk_add_f32 v[30:31],v[30:31],v[46:47]
v_cvt_pk_bf16_f32 v68,v24,v25
v_cvt_pk_bf16_f32 v69,v26,v27
v_cvt_pk_bf16_f32 v70,v28,v29
v_cvt_pk_bf16_f32 v71,v30,v31
s_nop 0
v_permlane16_swap_b32 v68,v70
v_permlane16_swap_b32 v69,v71
global_store_dwordx4 v214,v[68:71],s[44:45] offset:64 sc1
s_lshl_b32 s54,s32,7
s_add_u32 s54,s54,94437376
v_mov_b32 v233,s54
s_cmp_eq_u32 s32,63
s_cselect_b32 s39,0,s38
s_cmp_le_u32 s36,3
s_cselect_b32 s54,2,1
s_cmp_eq_u32 s36,5
s_cselect_b32 s54,2,s54
v_mov_b32 v252,s54
s_waitcnt vmcnt(2)
s_branch L_bulk_adv
L_bulk_adv:
s_sub_u32 s54,s36,9
s_cmp_lt_u32 s54,3
s_cbranch_scc0 L_bulk_adv2
s_waitcnt vmcnt(0)
s_barrier
s_cmp_eq_u32 s39,0
s_cbranch_scc1 L_sig7
s_mov_b32 s39,0
s_mov_b64 exec,1
global_atomic_add v233,v252,s[4:5]
s_mov_b64 exec,-1
v_mov_b32 v252,1
L_sig7:
s_nop 0
L_bulk_adv2:
s_mov_b32 s26,s27
s_add_u32 s78,s78,4
s_addc_u32 s79,s79,0
s_load_dword s27,s[78:79],4
s_waitcnt lgkmcnt(0)
s_branch L_bulk_item
L_bulk_bail:
global_atomic_add v235,v234,s[6:7] offset:64
s_endpgm
L_bulk_end:
s_waitcnt vmcnt(0)
s_barrier
s_cmp_eq_u32 s39,0
s_cbranch_scc1 L_sig8
s_mov_b32 s39,0
s_mov_b64 exec,1
global_atomic_add v233,v252,s[4:5]
s_mov_b64 exec,-1
v_mov_b32 v252,1
L_sig8:
s_nop 0
s_waitcnt vmcnt(0)
s_endpgm
L_chain:
s_load_dwordx2 s[64:65],s[0:1],16
s_load_dwordx2 s[66:67],s[0:1],24
s_load_dwordx2 s[68:69],s[0:1],32
s_load_dwordx2 s[70:71],s[0:1],40
s_load_dwordx2 s[72:73],s[0:1],8
s_lshr_b32 s12,s11,2
s_lshl_b32 s54,s10,3
s_add_u32 s12,s12,s54
s_and_b32 s13,s11,3
s_mov_b32 s40,0x200000
s_xor_b32 s46,s11,8
s_xor_b32 s47,s13,2
s_lshl_b32 s54,s12,8
s_lshl_b32 s59,s13,6
s_add_u32 s54,s54,s59
v_bfe_u32 v31,v0,6,2
v_lshlrev_b32 v128,21,v31
v_bfe_u32 v31,v0,2,4
v_lshl_add_u32 v128,v31,13,v128
v_bfe_u32 v31,v0,0,2
v_lshl_add_u32 v128,v31,4,v128
v_add_u32 v128,s54,v128
v_xor_b32 v126,256,v128
v_xor_b32 v125,128,v128
s_lshl_b32 s54,s10,21
s_lshl_b32 s59,s46,6
s_add_u32 s54,s54,s59
v_bfe_u32 v31,v0,6,2
v_lshlrev_b32 v129,19,v31
v_bfe_u32 v31,v0,2,4
v_lshl_add_u32 v129,v31,11,v129
v_bfe_u32 v31,v0,0,2
v_lshl_add_u32 v129,v31,4,v129
v_add_u32 v129,s54,v129
s_lshl_b32 s76,s14,14
s_add_u32 s76,s76,32768
s_waitcnt lgkmcnt(0)
v_mov_b32 v130,v126
s_add_u32 m0,s76,0
s_nop 0
global_load_lds_dwordx4 v130,s[66:67]
v_add_u32 v130,131072,v130
s_add_u32 m0,s76,1024
s_nop 0
global_load_lds_dwordx4 v130,s[66:67]
v_add_u32 v130,131072,v130
s_add_u32 m0,s76,2048
s_nop 0
global_load_lds_dwordx4 v130,s[66:67]
v_add_u32 v130,131072,v130
s_add_u32 m0,s76,3072
s_nop 0
global_load_lds_dwordx4 v130,s[66:67]
v_add_u32 v130,131072,v130
s_add_u32 m0,s76,4096
s_nop 0
global_load_lds_dwordx4 v130,s[66:67]
v_add_u32 v130,131072,v130
s_add_u32 m0,s76,5120
s_nop 0
global_load_lds_dwordx4 v130,s[66:67]
v_add_u32 v130,131072,v130
s_add_u32 m0,s76,6144
s_nop 0
global_load_lds_dwordx4 v130,s[66:67]
v_add_u32 v130,131072,v130
s_add_u32 m0,s76,7168
s_nop 0
global_load_lds_dwordx4 v130,s[66:67]
v_add_u32 v130,131072,v130
s_add_u32 m0,s76,8192
s_nop 0
global_load_lds_dwordx4 v130,s[66:67]
v_add_u32 v130,131072,v130
s_add_u32 m0,s76,9216
s_nop 0
global_load_lds_dwordx4 v130,s[66:67]
v_add_u32 v130,131072,v130
s_add_u32 m0,s76,10240
s_nop 0
global_load_lds_dwordx4 v130,s[66:67]
v_add_u32 v130,131072,v130
s_add_u32 m0,s76,11264
s_nop 0
global_load_lds_dwordx4 v130,s[66:67]
v_add_u32 v130,131072,v130
s_add_u32 m0,s76,12288
s_nop 0
global_load_lds_dwordx4 v130,s[66:67]
v_add_u32 v130,131072,v130
s_add_u32 m0,s76,13312
s_nop 0
global_load_lds_dwordx4 v130,s[66:67]
v_add_u32 v130,131072,v130
s_add_u32 m0,s76,14336
s_nop 0
global_load_lds_dwordx4 v130,s[66:67]
v_add_u32 v130,131072,v130
s_add_u32 m0,s76,15360
s_nop 0
global_load_lds_dwordx4 v130,s[66:67]
v_bfe_u32 v31,v0,0,6
v_lshlrev_b32 v30,4,v31
s_lshl_b32 s54,s10,14
v_bfe_u32 v31,v0,6,2
v_lshlrev_b32 v1,12,v31
v_bfe_u32 v31,v0,0,6
v_lshl_add_u32 v1,v31,4,v1
v_add_u32 v1,s54,v1
v_add_u32 v2,196608,v1
s_lshl_b32 s55,s12,12
s_add_u32 s55,s55,65536
v_add_u32 v4,s55,v30
s_lshl_b32 s56,s13,10
v_bfe_u32 v31,v0,0,8
v_lshlrev_b32 v3,2,v31
v_add_u32 v3,s55,v3
v_add_u32 v3,s56,v3
v_bfe_u32 v31,v0,3,1
v_lshlrev_b32 v24,11,v31
v_add_u32 v24,2048,v24
v_xor_b32 v3,v24,v3
s_lshl_b32 s54,s10,14
s_lshl_b32 s59,s11,9
s_add_u32 s54,s54,s59
v_bfe_u32 v31,v0,6,1
v_lshlrev_b32 v5,8,v31
v_bfe_u32 v31,v0,0,4
v_lshl_add_u32 v5,v31,4,v5
v_bfe_u32 v31,v0,5,1
v_lshl_add_u32 v5,v31,5,v5
v_bfe_u32 v31,v0,4,1
v_lshl_add_u32 v5,v31,3,v5
v_add_u32 v5,196608,v5
v_add_u32 v5,s54,v5
s_lshl_b32 s54,s10,14
s_lshl_b32 s59,s46,9
s_add_u32 s54,s54,s59
v_bfe_u32 v31,v0,0,6
v_lshlrev_b32 v10,3,v31
v_add_u32 v10,s54,v10
s_lshr_b32 s54,s11,1
s_and_b32 s55,s11,1
s_lshl_b32 s56,s54,14
s_lshl_b32 s59,s55,12
s_add_u32 s56,s56,s59
s_lshl_b32 s59,s10,10
s_add_u32 s56,s56,s59
s_add_u32 s56,s56,4194304
v_bfe_u32 v31,v0,0,8
v_lshlrev_b32 v6,2,v31
v_add_u32 v6,s56,v6
v_add_u32 v9,s56,v30
v_xor_b32 v7,1024,v9
v_xor_b32 v8,2048,v9
v_xor_b32 v9,3072,v9
v_bfe_u32 v31,v0,6,2
v_mul_u32_u24 v11,2304,v31
v_bfe_u32 v31,v0,4,2
s_mov_b32 s59,288
v_mad_u32_u24 v11,v31,s59,v11
v_bfe_u32 v31,v0,0,4
v_lshl_add_u32 v11,v31,2,v11
v_add_u32 v12,1152,v11
v_bfe_u32 v31,v0,3,1
v_mul_u32_u24 v13,1152,v31
v_bfe_u32 v31,v0,4,2
s_mov_b32 s59,288
v_mad_u32_u24 v13,v31,s59,v13
v_bfe_u32 v31,v0,2,1
s_mov_b32 s59,144
v_mad_u32_u24 v13,v31,s59,v13
v_bfe_u32 v31,v0,1,1
v_lshl_add_u32 v13,v31,6,v13
v_bfe_u32 v31,v0,6,2
v_lshl_add_u32 v13,v31,4,v13
v_bfe_u32 v31,v0,0,1
v_lshl_add_u32 v13,v31,3,v13
v_bfe_u32 v31,v0,0,6
v_lshlrev_b32 v29,2,v31
v_add_u32 v29,18432,v29
v_bfe_u32 v31,v0,6,2
v_lshlrev_b32 v15,10,v31
v_bfe_u32 v31,v0,0,6
v_lshl_add_u32 v15,v31,3,v15
v_add_u32 v15,9216,v15
v_bfe_u32 v31,v0,6,1
v_lshlrev_b32 v16,9,v31
v_bfe_u32 v31,v0,0,6
v_lshl_add_u32 v16,v31,3,v16
v_add_u32 v16,9216,v16
v_bfe_u32 v31,v0,0,7
v_lshlrev_b32 v20,2,v31
v_add_u32 v20,18432,v20
v_bfe_u32 v31,v0,1,1
v_lshlrev_b32 v24,8,v31
v_bfe_u32 v31,v0,4,2
v_lshl_add_u32 v24,v31,6,v24
v_bfe_u32 v31,v0,6,1
v_lshl_add_u32 v24,v31,5,v24
v_bfe_u32 v31,v0,2,1
v_lshl_add_u32 v24,v31,4,v24
v_bfe_u32 v31,v0,3,1
v_lshl_add_u32 v24,v31,3,v24
v_bfe_u32 v31,v0,0,1
v_lshl_add_u32 v24,v31,2,v24
v_add_u32 v24,18432,v24
v_cmp_gt_u32 vcc,128,v0
s_nop 1
v_cndmask_b32 v20,v20,v24,vcc
v_bfe_u32 v31,v0,6,2
v_mul_u32_u24 v17,1280,v31
v_bfe_u32 v31,v0,4,2
s_mov_b32 s59,288
v_mad_u32_u24 v17,v31,s59,v17
v_bfe_u32 v31,v0,0,4
v_lshl_add_u32 v17,v31,2,v17
v_add_u32 v17,13312,v17
v_bfe_u32 v31,v0,3,2
v_mul_u32_u24 v18,288,v31
v_bfe_u32 v31,v0,1,1
s_mov_b32 s59,144
v_mad_u32_u24 v18,v31,s59,v18
v_bfe_u32 v31,v0,5,1
v_lshl_add_u32 v18,v31,6,v18
v_bfe_u32 v31,v0,0,1
v_lshl_add_u32 v18,v31,5,v18
v_bfe_u32 v31,v0,2,1
v_lshl_add_u32 v18,v31,3,v18
v_add_u32 v18,13312,v18
v_add_u32 v19,2560,v18
v_bfe_u32 v31,v0,5,2
v_mul_u32_u24 v22,288,v31
v_bfe_u32 v31,v0,3,1
s_mov_b32 s59,144
v_mad_u32_u24 v22,v31,s59,v22
v_bfe_u32 v31,v0,7,1
v_lshl_add_u32 v22,v31,6,v22
v_bfe_u32 v31,v0,2,1
v_lshl_add_u32 v22,v31,5,v22
v_bfe_u32 v31,v0,4,1
v_lshl_add_u32 v22,v31,3,v22
v_bfe_u32 v31,v0,0,1
v_lshl_add_u32 v22,v31,2,v22
v_bfe_u32 v31,v0,1,1
v_lshl_add_u32 v22,v31,4,v22
v_add_u32 v22,13312,v22
s_lshl_b32 s54,s12,19
v_add_u32 v150,s54,v30
s_lshl_b32 s55,s13,11
v_add_u32 v151,s55,v150
v_add_u32 v34,65536,v30
v_bfe_u32 v31,v0,6,2
v_lshlrev_b32 v157,11,v31
v_add_u32 v157,v157,v150
v_bfe_u32 v31,v0,6,1
v_lshlrev_b32 v158,10,v31
v_add_u32 v158,16777216,v158
v_add_u32 v158,v158,v151
v_subrev_u32 v193,16777216,v157
v_add_u32 v193,16777216,v193
v_add_u32 v157,16777216,v157
v_add_u32 v158,16777216,v158
v_bfe_u32 v31,v0,6,1
v_lshlrev_b32 v194,12,v31
v_bfe_u32 v31,v0,0,6
v_lshl_add_u32 v194,v31,4,v194
v_add_u32 v194,75776,v194
s_lshl_b32 s54,s12,12
s_lshl_b32 s59,s13,10
s_add_u32 s54,s54,s59
s_add_u32 s54,s54,67108864
v_bfe_u32 v31,v0,6,1
v_lshlrev_b32 v195,17,v31
v_bfe_u32 v31,v0,0,6
v_lshl_add_u32 v195,v31,4,v195
v_add_u32 v195,s54,v195
v_bfe_u32 v31,v0,4,2
v_lshlrev_b32 v24,2,v31
v_bfe_u32 v31,v0,0,4
v_lshlrev_b32 v25,0,v31
v_bfe_u32 v31,v0,6,1
v_lshl_add_u32 v25,v31,4,v25
v_mov_b32 v26,0xff800000
v_add_u32 v31,0,v24
v_cmp_le_u32 vcc,v31,v25
s_nop 1
v_cndmask_b32 v224,v26,0,vcc
v_add_u32 v31,1,v24
v_cmp_le_u32 vcc,v31,v25
s_nop 1
v_cndmask_b32 v225,v26,0,vcc
v_add_u32 v31,2,v24
v_cmp_le_u32 vcc,v31,v25
s_nop 1
v_cndmask_b32 v226,v26,0,vcc
v_add_u32 v31,3,v24
v_cmp_le_u32 vcc,v31,v25
s_nop 1
v_cndmask_b32 v227,v26,0,vcc
v_add_u32 v31,16,v24
v_cmp_le_u32 vcc,v31,v25
s_nop 1
v_cndmask_b32 v228,v26,0,vcc
v_add_u32 v31,17,v24
v_cmp_le_u32 vcc,v31,v25
s_nop 1
v_cndmask_b32 v229,v26,0,vcc
v_add_u32 v31,18,v24
v_cmp_le_u32 vcc,v31,v25
s_nop 1
v_cndmask_b32 v230,v26,0,vcc
v_add_u32 v31,19,v24
v_cmp_le_u32 vcc,v31,v25
s_nop 1
v_cndmask_b32 v231,v26,0,vcc
v_mov_b32 v220,0
v_mov_b32 v222,0
v_mov_b32 v248,0
s_lshl_b32 s52,s14,11
s_add_u32 s52,s52,65536
s_and_b32 s53,s14,1
s_lshl_b32 s53,s53,10
s_add_u32 s53,s53,73728
v_bfe_u32 v31,v0,1,1
v_lshlrev_b32 v35,10,v31
v_bfe_u32 v31,v0,4,2
v_lshl_add_u32 v35,v31,8,v35
v_bfe_u32 v31,v0,6,1
v_lshl_add_u32 v35,v31,7,v35
v_bfe_u32 v31,v0,2,1
v_lshl_add_u32 v35,v31,6,v35
v_bfe_u32 v31,v0,3,1
v_lshl_add_u32 v35,v31,5,v35
v_bfe_u32 v31,v0,0,1
v_lshl_add_u32 v35,v31,4,v35
v_add_u32 v35,73728,v35
s_lshl_b32 s54,s12,9
s_lshl_b32 s59,s13,7
s_add_u32 s54,s54,s59
s_add_u32 s54,s54,94371840
v_mov_b32 v28,s54
v_bfe_u32 v24,v0,1,1
v_cmp_eq_u32 vcc,0,v24
v_mov_b32 v24,0xeeee
v_mov_b32 v25,0x4444
v_cndmask_b32 v21,v24,v25,vcc
v_mov_b32 v32,-1
v_mov_b32 v33,-1
v_mov_b32 v36,0x3f803f80
v_mov_b32 v37,0x3f803f80
v_mov_b32 v38,0x3f803f80
v_mov_b32 v39,0x3f803f80
s_mov_b32 s32,0x33333333
s_mov_b32 s34,0x11111111
s_mov_b32 s35,0x11111111
v_mov_b32 v252,-1
v_mov_b32 v253,-1
v_mov_b32 v254,-1
v_mov_b32 v255,-1
s_mov_b32 s33,0x33333333
s_mov_b32 s36,0x3e0293ee
s_mov_b32 s37,0xfffffffe
v_mov_b32 v138,s36
v_mov_b32 v139,s36
v_mov_b32 v148,0
s_add_u32 s42,s4,92274688
s_addc_u32 s43,s5,0
v_bfe_u32 v31,v0,4,2
v_lshlrev_b32 v131,9,v31
v_bfe_u32 v31,v0,2,2
v_lshl_add_u32 v131,v31,6,v131
v_bfe_u32 v31,v0,0,2
v_lshl_add_u32 v131,v31,3,v131
v_bfe_u32 v31,v0,2,4
v_lshlrev_b32 v132,6,v31
v_bfe_u32 v31,v0,0,2
v_lshl_add_u32 v132,v31,3,v132
v_add_u32 v132,65536,v132
v_add_u32 v132,s76,v132
v_add_u32 v131,s76,v131
v_add_u32 v133,65536,v131
v_subrev_u32 v134,65536,v132
v_mov_b32 v130,v128
s_add_u32 m0,s76,65536
s_nop 0
global_load_lds_dwordx4 v130,s[68:69]
v_add_u32 v130,131072,v130
s_add_u32 m0,s76,66560
s_nop 0
global_load_lds_dwordx4 v130,s[68:69]
v_add_u32 v130,131072,v130
s_add_u32 m0,s76,67584
s_nop 0
global_load_lds_dwordx4 v130,s[68:69]
v_add_u32 v130,131072,v130
s_add_u32 m0,s76,68608
s_nop 0
global_load_lds_dwordx4 v130,s[68:69]
v_add_u32 v130,131072,v130
s_add_u32 m0,s76,69632
s_nop 0
global_load_lds_dwordx4 v130,s[68:69]
v_add_u32 v130,131072,v130
s_add_u32 m0,s76,70656
s_nop 0
global_load_lds_dwordx4 v130,s[68:69]
v_add_u32 v130,131072,v130
s_add_u32 m0,s76,71680
s_nop 0
global_load_lds_dwordx4 v130,s[68:69]
v_add_u32 v130,131072,v130
s_add_u32 m0,s76,72704
s_nop 0
global_load_lds_dwordx4 v130,s[68:69]
v_add_u32 v130,131072,v130
s_add_u32 m0,s76,73728
s_nop 0
global_load_lds_dwordx4 v130,s[68:69]
v_add_u32 v130,131072,v130
s_add_u32 m0,s76,74752
s_nop 0
global_load_lds_dwordx4 v130,s[68:69]
v_add_u32 v130,131072,v130
s_add_u32 m0,s76,75776
s_nop 0
global_load_lds_dwordx4 v130,s[68:69]
v_add_u32 v130,131072,v130
s_add_u32 m0,s76,76800
s_nop 0
global_load_lds_dwordx4 v130,s[68:69]
v_add_u32 v130,131072,v130
s_add_u32 m0,s76,77824
s_nop 0
global_load_lds_dwordx4 v130,s[68:69]
v_add_u32 v130,131072,v130
s_add_u32 m0,s76,78848
s_nop 0
global_load_lds_dwordx4 v130,s[68:69]
v_add_u32 v130,131072,v130
s_add_u32 m0,s76,79872
s_nop 0
global_load_lds_dwordx4 v130,s[68:69]
v_add_u32 v130,131072,v130
s_add_u32 m0,s76,80896
s_nop 0
global_load_lds_dwordx4 v130,s[68:69]
s_waitcnt vmcnt(16)
ds_read_b64_tr_b16 a[64:65],v131 offset:0
ds_read_b64_tr_b16 a[66:67],v131 offset:256
ds_read_b64_tr_b16 a[68:69],v131 offset:2048
ds_read_b64_tr_b16 a[70:71],v131 offset:2304
s_waitcnt lgkmcnt(8)
ds_read_b64_tr_b16 a[72:73],v131 offset:4096
ds_read_b64_tr_b16 a[74:75],v131 offset:4352
ds_read_b64_tr_b16 a[76:77],v131 offset:6144
ds_read_b64_tr_b16 a[78:79],v131 offset:6400
s_waitcnt lgkmcnt(8)
ds_read_b64_tr_b16 a[80:81],v131 offset:8192
ds_read_b64_tr_b16 a[82:83],v131 offset:8448
ds_read_b64_tr_b16 a[84:85],v131 offset:10240
ds_read_b64_tr_b16 a[86:87],v131 offset:10496
s_waitcnt lgkmcnt(8)
ds_read_b64_tr_b16 a[88:89],v131 offset:12288
ds_read_b64_tr_b16 a[90:91],v131 offset:12544
ds_read_b64_tr_b16 a[92:93],v131 offset:14336
ds_read_b64_tr_b16 a[94:95],v131 offset:14592
s_waitcnt lgkmcnt(8)
ds_read_b64_tr_b16 a[96:97],v131 offset:32
ds_read_b64_tr_b16 a[98:99],v131 offset:288
ds_read_b64_tr_b16 a[100:101],v131 offset:2080
ds_read_b64_tr_b16 a[102:103],v131 offset:2336
s_waitcnt lgkmcnt(8)
ds_read_b64_tr_b16 a[104:105],v131 offset:4128
ds_read_b64_tr_b16 a[106:107],v131 offset:4384
ds_read_b64_tr_b16 a[108:109],v131 offset:6176
ds_read_b64_tr_b16 a[110:111],v131 offset:6432
s_waitcnt lgkmcnt(8)
ds_read_b64_tr_b16 a[112:113],v131 offset:8224
ds_read_b64_tr_b16 a[114:115],v131 offset:8480
ds_read_b64_tr_b16 a[116:117],v131 offset:10272
ds_read_b64_tr_b16 a[118:119],v131 offset:10528
s_waitcnt lgkmcnt(8)
ds_read_b64_tr_b16 a[120:121],v131 offset:12320
ds_read_b64_tr_b16 a[122:123],v131 offset:12576
ds_read_b64_tr_b16 a[124:125],v131 offset:14368
ds_read_b64_tr_b16 a[126:127],v131 offset:14624
s_waitcnt lgkmcnt(8)
s_waitcnt lgkmcnt(0)
v_mov_b32 v130,v125
s_add_u32 m0,s76,0
s_nop 0
global_load_lds_dwordx4 v130,s[64:65]
v_add_u32 v130,131072,v130
s_add_u32 m0,s76,1024
s_nop 0
global_load_lds_dwordx4 v130,s[64:65]
v_add_u32 v130,131072,v130
s_add_u32 m0,s76,2048
s_nop 0
global_load_lds_dwordx4 v130,s[64:65]
v_add_u32 v130,131072,v130
s_add_u32 m0,s76,3072
s_nop 0
global_load_lds_dwordx4 v130,s[64:65]
v_add_u32 v130,131072,v130
s_add_u32 m0,s76,4096
s_nop 0
global_load_lds_dwordx4 v130,s[64:65]
v_add_u32 v130,131072,v130
s_add_u32 m0,s76,5120
s_nop 0
global_load_lds_dwordx4 v130,s[64:65]
v_add_u32 v130,131072,v130
s_add_u32 m0,s76,6144
s_nop 0
global_load_lds_dwordx4 v130,s[64:65]
v_add_u32 v130,131072,v130
s_add_u32 m0,s76,7168
s_nop 0
global_load_lds_dwordx4 v130,s[64:65]
v_add_u32 v130,131072,v130
s_add_u32 m0,s76,8192
s_nop 0
global_load_lds_dwordx4 v130,s[64:65]
v_add_u32 v130,131072,v130
s_add_u32 m0,s76,9216
s_nop 0
global_load_lds_dwordx4 v130,s[64:65]
v_add_u32 v130,131072,v130
s_add_u32 m0,s76,10240
s_nop 0
global_load_lds_dwordx4 v130,s[64:65]
v_add_u32 v130,131072,v130
s_add_u32 m0,s76,11264
s_nop 0
global_load_lds_dwordx4 v130,s[64:65]
v_add_u32 v130,131072,v130
s_add_u32 m0,s76,12288
s_nop 0
global_load_lds_dwordx4 v130,s[64:65]
v_add_u32 v130,131072,v130
s_add_u32 m0,s76,13312
s_nop 0
global_load_lds_dwordx4 v130,s[64:65]
v_add_u32 v130,131072,v130
s_add_u32 m0,s76,14336
s_nop 0
global_load_lds_dwordx4 v130,s[64:65]
v_add_u32 v130,131072,v130
s_add_u32 m0,s76,15360
s_nop 0
global_load_lds_dwordx4 v130,s[64:65]
s_waitcnt vmcnt(16)
ds_read_b64_tr_b16 a[128:129],v133 offset:0
ds_read_b64_tr_b16 a[130:131],v133 offset:256
ds_read_b64_tr_b16 a[132:133],v133 offset:2048
ds_read_b64_tr_b16 a[134:135],v133 offset:2304
s_waitcnt lgkmcnt(8)
ds_read_b64_tr_b16 a[136:137],v133 offset:4096
ds_read_b64_tr_b16 a[138:139],v133 offset:4352
ds_read_b64_tr_b16 a[140:141],v133 offset:6144
ds_read_b64_tr_b16 a[142:143],v133 offset:6400
s_waitcnt lgkmcnt(8)
ds_read_b64_tr_b16 a[144:145],v133 offset:8192
ds_read_b64_tr_b16 a[146:147],v133 offset:8448
ds_read_b64_tr_b16 a[148:149],v133 offset:10240
ds_read_b64_tr_b16 a[150:151],v133 offset:10496
s_waitcnt lgkmcnt(8)
ds_read_b64_tr_b16 a[152:153],v133 offset:12288
ds_read_b64_tr_b16 a[154:155],v133 offset:12544
ds_read_b64_tr_b16 a[156:157],v133 offset:14336
ds_read_b64_tr_b16 a[158:159],v133 offset:14592
s_waitcnt lgkmcnt(8)
ds_read_b64_tr_b16 a[160:161],v133 offset:32
ds_read_b64_tr_b16 a[162:163],v133 offset:288
ds_read_b64_tr_b16 a[164:165],v133 offset:2080
ds_read_b64_tr_b16 a[166:167],v133 offset:2336
s_waitcnt lgkmcnt(8)
ds_read_b64_tr_b16 a[168:169],v133 offset:4128
ds_read_b64_tr_b16 a[170:171],v133 offset:4384
ds_read_b64_tr_b16 a[172:173],v133 offset:6176
ds_read_b64_tr_b16 a[174:175],v133 offset:6432
s_waitcnt lgkmcnt(8)
ds_read_b64_tr_b16 a[176:177],v133 offset:8224
ds_read_b64_tr_b16 a[178:179],v133 offset:8480
ds_read_b64_tr_b16 a[180:181],v133 offset:10272
ds_read_b64_tr_b16 a[182:183],v133 offset:10528
s_waitcnt lgkmcnt(8)
ds_read_b64_tr_b16 a[184:185],v133 offset:12320
ds_read_b64_tr_b16 a[186:187],v133 offset:12576
ds_read_b64_tr_b16 a[188:189],v133 offset:14368
ds_read_b64_tr_b16 a[190:191],v133 offset:14624
s_waitcnt lgkmcnt(8)
s_waitcnt vmcnt(16) lgkmcnt(0)
v_mov_b32 v130,v129
s_add_u32 m0,s76,65536
s_nop 0
global_load_lds_dwordx4 v130,s[70:71]
v_add_u32 v130,32768,v130
s_add_u32 m0,s76,66560
s_nop 0
global_load_lds_dwordx4 v130,s[70:71]
v_add_u32 v130,32768,v130
s_add_u32 m0,s76,67584
s_nop 0
global_load_lds_dwordx4 v130,s[70:71]
v_add_u32 v130,32768,v130
s_add_u32 m0,s76,68608
s_nop 0
global_load_lds_dwordx4 v130,s[70:71]
v_add_u32 v130,32768,v130
s_add_u32 m0,s76,69632
s_nop 0
global_load_lds_dwordx4 v130,s[70:71]
v_add_u32 v130,32768,v130
s_add_u32 m0,s76,70656
s_nop 0
global_load_lds_dwordx4 v130,s[70:71]
v_add_u32 v130,32768,v130
s_add_u32 m0,s76,71680
s_nop 0
global_load_lds_dwordx4 v130,s[70:71]
v_add_u32 v130,32768,v130
s_add_u32 m0,s76,72704
s_nop 0
global_load_lds_dwordx4 v130,s[70:71]
v_add_u32 v130,32768,v130
s_add_u32 m0,s76,73728
s_nop 0
global_load_lds_dwordx4 v130,s[70:71]
v_add_u32 v130,32768,v130
s_add_u32 m0,s76,74752
s_nop 0
global_load_lds_dwordx4 v130,s[70:71]
v_add_u32 v130,32768,v130
s_add_u32 m0,s76,75776
s_nop 0
global_load_lds_dwordx4 v130,s[70:71]
v_add_u32 v130,32768,v130
s_add_u32 m0,s76,76800
s_nop 0
global_load_lds_dwordx4 v130,s[70:71]
v_add_u32 v130,32768,v130
s_add_u32 m0,s76,77824
s_nop 0
global_load_lds_dwordx4 v130,s[70:71]
v_add_u32 v130,32768,v130
s_add_u32 m0,s76,78848
s_nop 0
global_load_lds_dwordx4 v130,s[70:71]
v_add_u32 v130,32768,v130
s_add_u32 m0,s76,79872
s_nop 0
global_load_lds_dwordx4 v130,s[70:71]
v_add_u32 v130,32768,v130
s_add_u32 m0,s76,80896
s_nop 0
global_load_lds_dwordx4 v130,s[70:71]
s_waitcnt vmcnt(16)
v_mov_b32 v124,127
s_cmp_eq_u32 s14,1
s_cbranch_scc0 L_ci_v
v_mov_b32 v24,1
s_mov_b64 exec,1
global_atomic_add v124,v148,v24,s[6:7] offset:4 sc0
s_getreg_b32 s54,hwreg(HW_REG_XCC_ID)
s_and_b32 s54,s54,7
s_lshl_b32 s54,1,s54
s_lshl_b32 s55,s10,2
v_mov_b32 v25,s54
v_mov_b32 v26,s55
global_atomic_or v26,v25,s[6:7] offset:16
s_mov_b64 exec,-1
L_ci_v:
ds_read_b64_tr_b16 a[0:1],v131 offset:0
ds_read_b64_tr_b16 a[2:3],v131 offset:256
ds_read_b64_tr_b16 a[4:5],v131 offset:2048
ds_read_b64_tr_b16 a[6:7],v131 offset:2304
s_waitcnt lgkmcnt(8)
ds_read_b64_tr_b16 a[8:9],v131 offset:4096
ds_read_b64_tr_b16 a[10:11],v131 offset:4352
ds_read_b64_tr_b16 a[12:13],v131 offset:6144
ds_read_b64_tr_b16 a[14:15],v131 offset:6400
s_waitcnt lgkmcnt(8)
ds_read_b64_tr_b16 a[16:17],v131 offset:8192
ds_read_b64_tr_b16 a[18:19],v131 offset:8448
ds_read_b64_tr_b16 a[20:21],v131 offset:10240
ds_read_b64_tr_b16 a[22:23],v131 offset:10496
s_waitcnt lgkmcnt(8)
ds_read_b64_tr_b16 a[24:25],v131 offset:12288
ds_read_b64_tr_b16 a[26:27],v131 offset:12544
ds_read_b64_tr_b16 a[28:29],v131 offset:14336
ds_read_b64_tr_b16 a[30:31],v131 offset:14592
s_waitcnt lgkmcnt(8)
ds_read_b64_tr_b16 a[32:33],v131 offset:32
ds_read_b64_tr_b16 a[34:35],v131 offset:288
ds_read_b64_tr_b16 a[36:37],v131 offset:2080
ds_read_b64_tr_b16 a[38:39],v131 offset:2336
s_waitcnt lgkmcnt(8)
ds_read_b64_tr_b16 a[40:41],v131 offset:4128
ds_read_b64_tr_b16 a[42:43],v131 offset:4384
ds_read_b64_tr_b16 a[44:45],v131 offset:6176
ds_read_b64_tr_b16 a[46:47],v131 offset:6432
s_waitcnt lgkmcnt(8)
ds_read_b64_tr_b16 a[48:49],v131 offset:8224
ds_read_b64_tr_b16 a[50:51],v131 offset:8480
ds_read_b64_tr_b16 a[52:53],v131 offset:10272
ds_read_b64_tr_b16 a[54:55],v131 offset:10528
s_waitcnt lgkmcnt(8)
ds_read_b64_tr_b16 a[56:57],v131 offset:12320
ds_read_b64_tr_b16 a[58:59],v131 offset:12576
ds_read_b64_tr_b16 a[60:61],v131 offset:14368
ds_read_b64_tr_b16 a[62:63],v131 offset:14624
s_waitcnt lgkmcnt(8)
v_bfe_u32 v31,v0,2,2
v_lshlrev_b32 v24,12,v31
v_bfe_u32 v31,v0,0,1
v_lshl_add_u32 v24,v31,11,v24
v_bfe_u32 v31,v0,6,2
v_lshl_add_u32 v24,v31,9,v24
v_bfe_u32 v31,v0,4,2
v_lshl_add_u32 v24,v31,5,v24
v_bfe_u32 v31,v0,1,1
v_lshl_add_u32 v24,v31,2,v24
global_load_dword v40,v24,s[72:73] offset:0
global_load_dword v41,v24,s[72:73] offset:8
global_load_dword v42,v24,s[72:73] offset:16
global_load_dword v43,v24,s[72:73] offset:24
global_load_dword v44,v24,s[72:73] offset:128
global_load_dword v45,v24,s[72:73] offset:136
global_load_dword v46,v24,s[72:73] offset:144
global_load_dword v47,v24,s[72:73] offset:152
global_load_dword v48,v24,s[72:73] offset:256
global_load_dword v49,v24,s[72:73] offset:264
global_load_dword v50,v24,s[72:73] offset:272
global_load_dword v51,v24,s[72:73] offset:280
global_load_dword v52,v24,s[72:73] offset:384
global_load_dword v53,v24,s[72:73] offset:392
global_load_dword v54,v24,s[72:73] offset:400
global_load_dword v55,v24,s[72:73] offset:408
s_waitcnt vmcnt(16)
ds_read_b64_tr_b16 a[192:193],v132 offset:0
ds_read_b64_tr_b16 a[194:195],v132 offset:1024
ds_read_b64_tr_b16 a[196:197],v132 offset:2048
ds_read_b64_tr_b16 a[198:199],v132 offset:3072
s_waitcnt lgkmcnt(8)
ds_read_b64_tr_b16 a[200:201],v132 offset:4096
ds_read_b64_tr_b16 a[202:203],v132 offset:5120
ds_read_b64_tr_b16 a[204:205],v132 offset:6144
ds_read_b64_tr_b16 a[206:207],v132 offset:7168
s_waitcnt lgkmcnt(8)
ds_read_b64_tr_b16 a[208:209],v132 offset:8192
ds_read_b64_tr_b16 a[210:211],v132 offset:9216
ds_read_b64_tr_b16 a[212:213],v132 offset:10240
ds_read_b64_tr_b16 a[214:215],v132 offset:11264
s_waitcnt lgkmcnt(8)
ds_read_b64_tr_b16 a[216:217],v132 offset:12288
ds_read_b64_tr_b16 a[218:219],v132 offset:13312
ds_read_b64_tr_b16 a[220:221],v132 offset:14336
ds_read_b64_tr_b16 a[222:223],v132 offset:15360
s_waitcnt lgkmcnt(8)
ds_read_b64_tr_b16 a[224:225],v132 offset:32
ds_read_b64_tr_b16 a[226:227],v132 offset:1056
ds_read_b64_tr_b16 a[228:229],v132 offset:2080
ds_read_b64_tr_b16 a[230:231],v132 offset:3104
s_waitcnt lgkmcnt(8)
ds_read_b64_tr_b16 a[232:233],v132 offset:4128
ds_read_b64_tr_b16 a[234:235],v132 offset:5152
ds_read_b64_tr_b16 a[236:237],v132 offset:6176
ds_read_b64_tr_b16 a[238:239],v132 offset:7200
s_waitcnt lgkmcnt(8)
ds_read_b64_tr_b16 a[240:241],v132 offset:8224
ds_read_b64_tr_b16 a[242:243],v132 offset:9248
ds_read_b64_tr_b16 a[244:245],v132 offset:10272
ds_read_b64_tr_b16 a[246:247],v132 offset:11296
s_waitcnt lgkmcnt(8)
ds_read_b64_tr_b16 a[248:249],v132 offset:12320
ds_read_b64_tr_b16 a[250:251],v132 offset:13344
ds_read_b64_tr_b16 a[252:253],v132 offset:14368
ds_read_b64_tr_b16 a[254:255],v132 offset:15392
s_waitcnt lgkmcnt(8)
s_waitcnt vmcnt(0) lgkmcnt(0)
v_readfirstlane_b32 s54,v124
s_nop 0
s_cmp_lt_u32 s54,48
s_cbranch_scc0 L_ci_nc
s_mov_b64 exec,1
s_and_b32 s58,s11,1
s_lshl_b32 s54,s11,7
s_lshl_b32 s59,s10,14
s_add_u32 s54,s54,s59
s_lshl_b32 s59,s58,13
s_add_u32 s54,s54,s59
s_add_u32 s54,s54,96731136
v_mov_b32 v24,s54
v_xor_b32 v26,8192,v24
s_mov_b32 s54,-1
s_mov_b32 s55,-1
s_mov_b32 s59,0
L_ci_cal:
s_memtime s[16:17]
global_store_dword v24,v32,s[4:5] sc1
s_waitcnt vmcnt(0)
s_memtime s[18:19]
global_store_dword v26,v32,s[4:5] sc1
s_waitcnt vmcnt(0)
s_memtime s[20:21]
s_waitcnt lgkmcnt(0)
s_sub_u32 s56,s18,s16
s_sub_u32 s57,s20,s18
s_min_u32 s54,s54,s56
s_min_u32 s55,s55,s57
s_add_u32 s59,s59,1
s_cmp_lt_u32 s59,3
s_cbranch_scc1 L_ci_cal
s_sub_i32 s56,s54,s55
s_sub_i32 s57,s55,s54
s_cmp_eq_u32 s58,1
s_cselect_b32 s54,s57,s56
s_max_i32 s54,s54,-400
s_min_i32 s54,s54,400
v_mov_b32 v24,s54
global_atomic_add v148,v24,s[6:7] offset:68
s_waitcnt vmcnt(0)
s_mov_b64 exec,-1
L_ci_nc:
s_barrier
s_cmp_eq_u32 s14,0
s_cbranch_scc0 L_ci_e
s_mov_b64 exec,1
v_mov_b32 v24,1
v_mov_b32 v25,0
global_atomic_add v25,v24,s[6:7] offset:128
s_mov_b64 exec,-1
L_ci_e:
s_mov_b64 s[22:23],s[4:5]
s_mov_b64 s[26:27],s[4:5]
v_mov_b32 v136,0
v_mov_b32 v192,0
v_mov_b32 v25,0
s_cmp_eq_u32 s14,3
s_cbranch_scc1 L_ci_w3
s_cmp_eq_u32 s14,0
s_cbranch_scc1 L_ci_wait
s_getpc_b64 s[56:57]
L_ci_pc:
s_lshl_b32 s54,s11,11
v_bfe_u32 v31,v0,0,4
v_lshlrev_b32 v26,7,v31
v_add_u32 v26,s54,v26
v_min_u32 v26,L_code_end-L_ci_pc-4,v26
global_load_dword v95,v26,s[56:57]
s_branch L_ci_ok
L_ci_wait:
global_load_dword v92,v25,s[6:7] offset:128 sc1
s_sub_u32 s40,s40,1
s_cbranch_scc1 L_chain_bail
s_waitcnt vmcnt(0)
v_cmp_gt_u32 vcc,128,v92
s_cbranch_vccz L_ci_ok
s_sleep 2
s_branch L_ci_wait
L_ci_w3:
v_bfe_u32 v31,v0,0,2
v_lshlrev_b32 v26,2,v31
v_bfe_u32 v31,v0,2,1
v_lshl_add_u32 v26,v31,7,v26
L_ci_wt:
global_load_dword v94,v26,s[6:7] offset:32 sc1
s_sub_u32 s40,s40,1
s_cbranch_scc1 L_chain_bail
s_waitcnt vmcnt(0)
v_cmp_gt_u32 vcc,32,v94
s_cbranch_vccnz L_ci_wt
s_lshl_b32 s54,s10,14
s_lshl_b32 s59,s11,9
s_add_u32 s54,s54,s59
v_bfe_u32 v31,v0,4,2
v_lshlrev_b32 v24,19,v31
v_bfe_u32 v31,v0,0,2
v_lshl_add_u32 v24,v31,7,v24
v_bfe_u32 v31,v0,2,1
s_mov_b32 s59,196608
v_mad_u32_u24 v24,v31,s59,v24
v_add_u32 v24,s54,v24
s_lshl_b32 s54,s10,15
s_lshl_b32 s59,s11,10
s_add_u32 s54,s54,s59
s_add_u32 s54,s54,65536
v_bfe_u32 v31,v0,4,2
v_lshlrev_b32 v26,19,v31
v_bfe_u32 v31,v0,0,3
v_lshl_add_u32 v26,v31,7,v26
v_add_u32 v26,s54,v26
global_load_dword v95,v24,s[42:43] sc1
global_load_dword v95,v26,s[42:43] sc1
s_lshl_b32 s54,s10,7
s_add_u32 s54,s54,94444544
v_mov_b32 v26,s54
L_ci_wkv:
global_load_dword v92,v26,s[4:5] sc1
s_sub_u32 s40,s40,1
s_cbranch_scc1 L_chain_bail
s_waitcnt vmcnt(0)
v_cmp_gt_u32 vcc,24,v92
s_cbranch_vccz L_ci_kv
s_sleep 2
s_branch L_ci_wkv
L_ci_kv:
L_ci_ok:
s_barrier
global_load_dword v93,v25,s[6:7] offset:68 sc1
global_load_dwordx4 v[88:91],v25,s[6:7] offset:16 sc1
s_mov_b32 m0,s52
s_nop 0
global_load_lds_dwordx4 v157,s[22:23] offset:0 sc1
global_load_lds_dwordx4 v157,s[22:23] offset:1024 sc1
s_mov_b32 m0,s53
s_add_u32 s54,s52,10240
global_load_lds_dwordx4 v158,s[22:23] sc1
s_mov_b32 m0,s54
s_nop 0
global_load_lds_dwordx4 v193,s[22:23] offset:0 sc1
global_load_lds_dwordx4 v193,s[22:23] offset:1024 sc1
s_add_u32 s22,s22,8192
s_addc_u32 s23,s23,0
s_xor_b32 s52,s52,32768
s_xor_b32 s53,s53,32768
s_waitcnt vmcnt(0)
v_bcnt_u32_b32 v24,v88,0
v_bcnt_u32_b32 v24,v89,v24
v_bcnt_u32_b32 v24,v90,v24
v_bcnt_u32_b32 v24,v91,v24
s_nop 0
v_readfirstlane_b32 s30,v24
v_cmp_lt_i32 vcc,0,v93
v_mov_b32 v25,8192
s_nop 0
v_cndmask_b32 v24,0,v25,vcc
v_xor_b32 v6,v24,v6
v_xor_b32 v7,v24,v7
v_xor_b32 v8,v24,v8
v_xor_b32 v9,v24,v9
s_lshl_b32 s54,s11,17
s_lshl_b32 s59,s10,15
s_add_u32 s54,s54,s59
s_add_u32 s54,s54,83886080
v_add_u32 v250,s54,v30
s_mov_b32 s15,0
v_min_u32 v40,s37,v40
v_min_u32 v41,s37,v41
v_min_u32 v42,s37,v42
v_min_u32 v43,s37,v43
v_min_u32 v44,s37,v44
v_min_u32 v45,s37,v45
v_min_u32 v46,s37,v46
v_min_u32 v47,s37,v47
v_min_u32 v48,s37,v48
v_min_u32 v49,s37,v49
v_min_u32 v50,s37,v50
v_min_u32 v51,s37,v51
v_min_u32 v52,s37,v52
v_min_u32 v53,s37,v53
v_min_u32 v54,s37,v54
v_min_u32 v55,s37,v55
v_mov_b32 v56,0
v_mov_b32 v57,0
v_mov_b32 v58,0
v_mov_b32 v59,0
v_mov_b32 v60,0
v_mov_b32 v61,0
v_mov_b32 v62,0
v_mov_b32 v63,0
v_mov_b32 v64,0
v_mov_b32 v65,0
v_mov_b32 v66,0
v_mov_b32 v67,0
v_mov_b32 v68,0
v_mov_b32 v69,0
v_mov_b32 v70,0
v_mov_b32 v71,0
v_mov_b32 v72,0
v_mov_b32 v73,0
v_mov_b32 v74,0
v_mov_b32 v75,0
v_mov_b32 v76,0
v_mov_b32 v77,0
v_mov_b32 v78,0
v_mov_b32 v79,0
s_add_u32 s16,s42,0
s_addc_u32 s17,s43,0
s_add_u32 s18,s42,524288
s_addc_u32 s19,s43,0
s_add_u32 s20,s42,1048576
s_addc_u32 s21,s43,0
s_cmp_eq_u32 s30,4
s_cbranch_scc0 L_cs_a_go
s_branch L_cf_a_go
L_cf_top:
s_barrier
s_nop 7
global_load_dwordx4 v[40:43],v1,s[16:17] offset:0 sc1
s_nop 13
global_load_dwordx4 v[44:47],v1,s[16:17] offset:1024 sc1
s_nop 13
global_load_dwordx4 v[48:51],v1,s[16:17] offset:2048 sc1
s_nop 13
global_load_dwordx4 v[52:55],v1,s[16:17] offset:3072 sc1
L_cf_a_go:
s_waitcnt vmcnt(3)
v_max3_u32 v26,v40,v41,v42
v_max_u32 v26,v26,v43
v_cmp_eq_u32 vcc,-1,v26
L_cf_a_q0123:
s_cbranch_vccnz L_cf_a_q0123x
v_smfmac_f32_16x16x64_bf16 v[56:59],v[40:43],a[0:7],v21
s_waitcnt vmcnt(2)
v_max3_u32 v26,v44,v45,v46
v_smfmac_f32_16x16x64_bf16 v[60:63],v[40:43],a[32:39],v21
v_max_u32 v26,v26,v47
v_cmp_eq_u32 vcc,-1,v26
v_smfmac_f32_16x16x64_bf16 v[64:67],v[40:43],a[64:71],v21
v_smfmac_f32_16x16x64_bf16 v[68:71],v[40:43],a[96:103],v21
L_cf_a_q123:
s_cbranch_vccnz L_cf_a_q123x
v_smfmac_f32_16x16x64_bf16 v[56:59],v[44:47],a[8:15],v21
s_waitcnt vmcnt(1)
v_max3_u32 v26,v48,v49,v50
v_smfmac_f32_16x16x64_bf16 v[60:63],v[44:47],a[40:47],v21
v_max_u32 v26,v26,v51
v_cmp_eq_u32 vcc,-1,v26
v_smfmac_f32_16x16x64_bf16 v[64:67],v[44:47],a[72:79],v21
v_smfmac_f32_16x16x64_bf16 v[68:71],v[44:47],a[104:111],v21
L_cf_a_q23:
s_cbranch_vccnz L_cf_a_q23x
v_smfmac_f32_16x16x64_bf16 v[56:59],v[48:51],a[16:23],v21
s_waitcnt vmcnt(0)
v_max3_u32 v26,v52,v53,v54
v_smfmac_f32_16x16x64_bf16 v[60:63],v[48:51],a[48:55],v21
v_max_u32 v26,v26,v55
v_cmp_eq_u32 vcc,-1,v26
v_smfmac_f32_16x16x64_bf16 v[64:67],v[48:51],a[80:87],v21
v_smfmac_f32_16x16x64_bf16 v[68:71],v[48:51],a[112:119],v21
L_cf_a_q3:
s_cbranch_vccnz L_cf_a_q3x
v_smfmac_f32_16x16x64_bf16 v[56:59],v[52:55],a[24:31],v21
v_smfmac_f32_16x16x64_bf16 v[60:63],v[52:55],a[56:63],v21
v_smfmac_f32_16x16x64_bf16 v[64:67],v[52:55],a[88:95],v21
v_smfmac_f32_16x16x64_bf16 v[68:71],v[52:55],a[120:127],v21
L_cf_a_done:
v_pk_add_f32 v[56:57],v[56:57],v[58:59]
ds_write2_b32 v11,v56,v57 offset0:0 offset1:36
v_pk_add_f32 v[60:61],v[60:61],v[62:63]
ds_write2_b32 v11,v60,v61 offset0:16 offset1:52
v_pk_add_f32 v[64:65],v[64:65],v[66:67]
ds_write2_b32 v12,v64,v65 offset0:0 offset1:36
s_nop 1
v_pk_add_f32 v[68:69],v[68:69],v[70:71]
ds_write2_b32 v12,v68,v69 offset0:16 offset1:52
v_smfmac_f32_16x16x64_bf16 v[72:75],v[40:43],a[128:135],v21
v_smfmac_f32_16x16x64_bf16 v[76:79],v[40:43],a[160:167],v21
v_smfmac_f32_16x16x64_bf16 v[72:75],v[44:47],a[136:143],v21
s_waitcnt lgkmcnt(0)
s_barrier
ds_read_b64 v[88:89],v13 offset:0
ds_read_b64 v[90:91],v13 offset:2304
ds_read_b64 v[92:93],v13 offset:4608
ds_read_b64 v[94:95],v13 offset:6912
v_smfmac_f32_16x16x64_bf16 v[76:79],v[44:47],a[168:175],v21
v_smfmac_f32_16x16x64_bf16 v[72:75],v[48:51],a[144:151],v21
v_smfmac_f32_16x16x64_bf16 v[76:79],v[48:51],a[176:183],v21
v_smfmac_f32_16x16x64_bf16 v[72:75],v[52:55],a[152:159],v21
v_smfmac_f32_16x16x64_bf16 v[76:79],v[52:55],a[184:191],v21
s_waitcnt lgkmcnt(0)
v_pk_add_f32 v[88:89],v[88:89],v[90:91]
v_pk_add_f32 v[92:93],v[92:93],v[94:95]
v_pk_add_f32 v[88:89],v[88:89],v[92:93]
v_cvt_pk_bf16_f32 v88,v88,v89
v_min_u32 v88,s37,v88
global_store_dword v3,v88,s[16:17]
v_pk_add_f32 v[72:73],v[72:73],v[74:75]
ds_write_b64 v15,v[72:73] offset:0
v_pk_add_f32 v[76:77],v[76:77],v[78:79]
ds_write_b64 v15,v[76:77] offset:512
s_cmp_lt_u32 s14,2
s_cbranch_scc0 L_cf_w23
s_waitcnt lgkmcnt(0)
s_barrier
ds_read_b128 v[160:163],v34 offset:0
ds_read_b128 v[164:167],v34 offset:1024
ds_read_b128 v[168:171],v34 offset:2048
ds_read_b128 v[172:175],v34 offset:3072
ds_read_b128 v[176:179],v34 offset:4096
ds_read_b128 v[180:183],v34 offset:5120
ds_read_b128 v[184:187],v34 offset:6144
ds_read_b128 v[188:191],v34 offset:7168
ds_read_b128 v[152:155],v35
global_load_dwordx4 v[104:107],v4,s[16:17] offset:0 sc1
s_nop 7
global_load_dwordx4 v[108:111],v4,s[16:17] offset:1024 sc1
s_nop 7
global_load_dwordx4 v[112:115],v4,s[16:17] offset:2048 sc1
s_nop 7
global_load_dwordx4 v[116:119],v4,s[16:17] offset:3072 sc1
s_barrier
ds_read_b32 v149,v20
v_mov_b32 v120,0
v_mov_b32 v121,0
v_mov_b32 v122,0
v_mov_b32 v123,0
v_mov_b32 v124,0
v_mov_b32 v125,0
v_mov_b32 v126,0
v_mov_b32 v127,0
v_mov_b32 v128,0
v_mov_b32 v129,0
v_mov_b32 v130,0
v_mov_b32 v131,0
s_cmp_eq_u32 s15,63
s_cbranch_scc1 L_cf_last01
s_waitcnt lgkmcnt(1)
L_cf_b_go:
s_waitcnt vmcnt(3)
v_max3_u32 v26,v104,v105,v106
v_max_u32 v26,v26,v107
v_cmp_eq_u32 vcc,-1,v26
L_cf_b_q0123:
s_cbranch_vccnz L_cf_b_q0123x
v_mfma_f32_16x16x32_bf16 v[120:123],v[160:163],v[104:107],v[120:123]
s_waitcnt vmcnt(2)
v_max3_u32 v26,v108,v109,v110
v_mfma_f32_16x16x32_bf16 v[124:127],v[176:179],v[104:107],v[124:127]
v_max_u32 v26,v26,v111
v_cmp_eq_u32 vcc,-1,v26
v_mfma_f32_16x16x32_bf16 v[128:131],v[104:107],v[104:107],v[128:131]
L_cf_b_q123:
s_cbranch_vccnz L_cf_b_q123x
v_mfma_f32_16x16x32_bf16 v[120:123],v[164:167],v[108:111],v[120:123]
s_waitcnt vmcnt(1)
v_max3_u32 v26,v112,v113,v114
v_mfma_f32_16x16x32_bf16 v[124:127],v[180:183],v[108:111],v[124:127]
v_max_u32 v26,v26,v115
v_cmp_eq_u32 vcc,-1,v26
v_mfma_f32_16x16x32_bf16 v[128:131],v[108:111],v[108:111],v[128:131]
L_cf_b_q23:
s_cbranch_vccnz L_cf_b_q23x
v_mfma_f32_16x16x32_bf16 v[120:123],v[168:171],v[112:115],v[120:123]
s_waitcnt vmcnt(0)
v_max3_u32 v26,v116,v117,v118
v_mfma_f32_16x16x32_bf16 v[124:127],v[184:187],v[112:115],v[124:127]
v_max_u32 v26,v26,v119
v_cmp_eq_u32 vcc,-1,v26
v_mfma_f32_16x16x32_bf16 v[128:131],v[112:115],v[112:115],v[128:131]
L_cf_b_q3:
s_cbranch_vccnz L_cf_b_q3x
v_mfma_f32_16x16x32_bf16 v[120:123],v[172:175],v[116:119],v[120:123]
v_mfma_f32_16x16x32_bf16 v[124:127],v[188:191],v[116:119],v[124:127]
v_mfma_f32_16x16x32_bf16 v[128:131],v[116:119],v[116:119],v[128:131]
L_cf_b_done:
v_max3_f32 v24,v120,v121,v122
s_nop 2
v_max3_f32 v24,v24,v123,v124
v_max3_f32 v24,v24,v125,v126
s_nop 1
v_max3_f32 v24,v24,v127,v130
v_max_f32 v24,v24,v131
v_mov_b32 v25,v24
s_nop 1
v_permlane32_swap_b32 v24,v25
v_max_f32 v24,v24,v25
v_mov_b32 v25,v24
s_nop 1
v_permlane16_swap_b32 v24,v25
v_max_f32 v24,v24,v25
v_mul_f32 v24,s36,v24
v_pk_fma_f32 v[120:121],v[120:121],v[138:139],v[24:25] op_sel_hi:[1,1,0] neg_lo:[0,0,1] neg_hi:[0,0,1]
v_pk_fma_f32 v[122:123],v[122:123],v[138:139],v[24:25] op_sel_hi:[1,1,0] neg_lo:[0,0,1] neg_hi:[0,0,1]
v_pk_fma_f32 v[124:125],v[124:125],v[138:139],v[24:25] op_sel_hi:[1,1,0] neg_lo:[0,0,1] neg_hi:[0,0,1]
v_pk_fma_f32 v[126:127],v[126:127],v[138:139],v[24:25] op_sel_hi:[1,1,0] neg_lo:[0,0,1] neg_hi:[0,0,1]
v_pk_fma_f32 v[130:131],v[130:131],v[138:139],v[24:25] op_sel_hi:[1,1,0] neg_lo:[0,0,1] neg_hi:[0,0,1]
v_exp_f32 v120,v120
v_exp_f32 v121,v121
v_exp_f32 v122,v122
v_exp_f32 v123,v123
v_exp_f32 v124,v124
v_exp_f32 v125,v125
v_exp_f32 v126,v126
v_exp_f32 v127,v127
v_cvt_pk_bf16_f32 v132,v120,v121
v_cvt_pk_bf16_f32 v133,v122,v123
v_cvt_pk_bf16_f32 v134,v124,v125
v_cvt_pk_bf16_f32 v135,v126,v127
v_exp_f32 v130,v130
v_exp_f32 v131,v131
v_mfma_f32_16x16x32_bf16 v[144:147],v[36:39],v[132:135],0
v_cvt_pk_bf16_f32 v137,v130,v131
v_mfma_f32_16x16x32_bf16 v[140:143],v[152:155],v[132:135],0
s_waitcnt lgkmcnt(0)
s_nop 0
v_mfma_f32_16x16x16_bf16 v[144:147],v[36:37],v[136:137],v[144:147]
s_nop 1
v_mfma_f32_16x16x16_bf16 v[140:143],v[148:149],v[136:137],v[140:143]
s_mov_b64 exec,s[32:33]
s_nop 2
v_rcp_f32 v24,v144
s_nop 2
v_pk_mul_f32 v[140:141],v[140:141],v[24:25] op_sel_hi:[1,0]
v_pk_mul_f32 v[142:143],v[142:143],v[24:25] op_sel_hi:[1,0]
v_cvt_pk_bf16_f32 v140,v140,v141
v_cvt_pk_bf16_f32 v141,v142,v143
v_min_u32 v140,s37,v140
v_min_u32 v141,s37,v141
global_store_dwordx2 v5,v[140:141],s[16:17]
s_mov_b64 exec,-1
s_branch L_cf_po
L_cf_last01:
L_cf_bl_go:
s_waitcnt vmcnt(0)
v_max3_u32 v26,v104,v105,v106
v_max3_u32 v26,v26,v107,v108
v_max3_u32 v26,v26,v109,v110
v_max3_u32 v26,v26,v111,v112
v_max3_u32 v26,v26,v113,v114
v_max3_u32 v26,v26,v115,v116
v_max3_u32 v26,v26,v117,v118
v_max_u32 v26,v26,v119
v_cmp_eq_u32 vcc,-1,v26
s_cbranch_vccz L_cf_bl_ok
global_load_dwordx4 v[104:107],v4,s[16:17] offset:0 sc1
global_load_dwordx4 v[108:111],v4,s[16:17] offset:1024 sc1
global_load_dwordx4 v[112:115],v4,s[16:17] offset:2048 sc1
global_load_dwordx4 v[116:119],v4,s[16:17] offset:3072 sc1
s_sub_u32 s40,s40,1
s_cbranch_scc0 L_cf_bl_go
s_branch L_chain_bail
L_cf_bl_ok:
global_store_dwordx4 v195,v[240:243],s[26:27] sc1
s_add_u32 s26,s26,262144
s_addc_u32 s27,s27,0
ds_read_b128 v[196:199],v194 offset:0
ds_read_b128 v[200:203],v194 offset:1024
ds_read_b128 v[204:207],v194 offset:2048
ds_read_b128 v[208:211],v194 offset:3072
ds_read_b128 v[212:215],v34 offset:8192
ds_read_b128 v[216:219],v34 offset:9216
ds_read_b32 v221,v29 offset:0
ds_read_b32 v223,v29 offset:256
v_xor_b32 v34,32768,v34
v_xor_b32 v35,32768,v35
v_xor_b32 v194,32768,v194
s_waitcnt lgkmcnt(0)
v_mfma_f32_16x16x32_bf16 v[120:123],v[160:163],v[196:199],v[224:227]
v_mfma_f32_16x16x32_bf16 v[124:127],v[176:179],v[196:199],v[228:231]
v_mfma_f32_16x16x32_bf16 v[128:131],v[104:107],v[196:199],0
v_mfma_f32_16x16x32_bf16 v[120:123],v[164:167],v[200:203],v[120:123]
v_mfma_f32_16x16x32_bf16 v[124:127],v[180:183],v[200:203],v[124:127]
v_mfma_f32_16x16x32_bf16 v[128:131],v[108:111],v[200:203],v[128:131]
v_mfma_f32_16x16x32_bf16 v[120:123],v[168:171],v[204:207],v[120:123]
v_mfma_f32_16x16x32_bf16 v[124:127],v[184:187],v[204:207],v[124:127]
v_mfma_f32_16x16x32_bf16 v[128:131],v[112:115],v[204:207],v[128:131]
v_mfma_f32_16x16x32_bf16 v[120:123],v[172:175],v[208:211],v[120:123]
v_mfma_f32_16x16x32_bf16 v[124:127],v[188:191],v[208:211],v[124:127]
v_mfma_f32_16x16x32_bf16 v[128:131],v[116:119],v[208:211],v[128:131]
v_max3_f32 v24,v120,v121,v122
s_nop 2
v_max3_f32 v24,v24,v123,v124
v_max3_f32 v24,v24,v125,v126
s_nop 1
v_max3_f32 v24,v24,v127,v130
v_max_f32 v24,v24,v131
v_mov_b32 v25,v24
s_nop 1
v_permlane32_swap_b32 v24,v25
v_max_f32 v24,v24,v25
v_mov_b32 v25,v24
s_nop 1
v_permlane16_swap_b32 v24,v25
v_max_f32 v24,v24,v25
v_mul_f32 v24,s36,v24
v_pk_fma_f32 v[120:121],v[120:121],v[138:139],v[24:25] op_sel_hi:[1,1,0] neg_lo:[0,0,1] neg_hi:[0,0,1]
v_pk_fma_f32 v[122:123],v[122:123],v[138:139],v[24:25] op_sel_hi:[1,1,0] neg_lo:[0,0,1] neg_hi:[0,0,1]
v_pk_fma_f32 v[124:125],v[124:125],v[138:139],v[24:25] op_sel_hi:[1,1,0] neg_lo:[0,0,1] neg_hi:[0,0,1]
v_pk_fma_f32 v[126:127],v[126:127],v[138:139],v[24:25] op_sel_hi:[1,1,0] neg_lo:[0,0,1] neg_hi:[0,0,1]
v_pk_fma_f32 v[130:131],v[130:131],v[138:139],v[24:25] op_sel_hi:[1,1,0] neg_lo:[0,0,1] neg_hi:[0,0,1]
v_exp_f32 v120,v120
v_exp_f32 v121,v121
v_exp_f32 v122,v122
v_exp_f32 v123,v123
v_exp_f32 v124,v124
v_exp_f32 v125,v125
v_exp_f32 v126,v126
v_exp_f32 v127,v127
v_exp_f32 v130,v130
v_exp_f32 v131,v131
v_cvt_pk_bf16_f32 v244,v120,v121
v_cvt_pk_bf16_f32 v245,v122,v123
v_cvt_pk_bf16_f32 v246,v124,v125
v_cvt_pk_bf16_f32 v247,v126,v127
v_cvt_pk_bf16_f32 v249,v130,v131
s_nop 0
v_mfma_f32_16x16x32_bf16 v[144:147],v[36:39],v[244:247],0
v_mfma_f32_16x16x32_bf16 v[232:235],v[212:215],v[244:247],0
v_mfma_f32_16x16x32_bf16 v[236:239],v[216:219],v[244:247],0
v_mfma_f32_16x16x16_bf16 v[144:147],v[36:37],v[248:249],v[144:147]
v_mfma_f32_16x16x16_bf16 v[232:235],v[220:221],v[248:249],v[232:235]
v_mfma_f32_16x16x16_bf16 v[236:239],v[222:223],v[248:249],v[236:239]
v_rcp_f32 v24,v144
s_nop 2
v_pk_mul_f32 v[232:233],v[232:233],v[24:25] op_sel_hi:[1,0]
v_pk_mul_f32 v[234:235],v[234:235],v[24:25] op_sel_hi:[1,0]
s_nop 1
v_pk_mul_f32 v[236:237],v[236:237],v[24:25] op_sel_hi:[1,0]
v_pk_mul_f32 v[238:239],v[238:239],v[24:25] op_sel_hi:[1,0]
v_cvt_pk_bf16_f32 v240,v232,v233
v_cvt_pk_bf16_f32 v241,v234,v235
v_cvt_pk_bf16_f32 v242,v236,v237
v_cvt_pk_bf16_f32 v243,v238,v239
global_store_dwordx4 v195,v[240:243],s[26:27] sc1
s_add_u32 s26,s26,262144
s_addc_u32 s27,s27,0
s_waitcnt vmcnt(0)
s_barrier
s_branch L_chain_done
L_cf_w23:
s_waitcnt lgkmcnt(0)
s_barrier
ds_read_b64 v[88:89],v16 offset:0
ds_read_b64 v[90:91],v16 offset:1024
ds_read_b64 v[92:93],v16 offset:2048
ds_read_b64 v[94:95],v16 offset:3072
s_waitcnt lgkmcnt(0)
v_pk_add_f32 v[88:89],v[88:89],v[90:91]
v_pk_add_f32 v[92:93],v[92:93],v[94:95]
v_pk_add_f32 v[88:89],v[88:89],v[92:93]
v_cvt_pk_bf16_f32 v149,v88,v89
ds_write_b32 v20,v149
s_waitcnt lgkmcnt(0)
s_barrier
v_mov_b32 v56,0
v_mov_b32 v57,0
v_mov_b32 v58,0
v_mov_b32 v59,0
v_mov_b32 v60,0
v_mov_b32 v61,0
v_mov_b32 v62,0
v_mov_b32 v63,0
v_mov_b32 v64,0
v_mov_b32 v65,0
v_mov_b32 v66,0
v_mov_b32 v67,0
v_mov_b32 v68,0
v_mov_b32 v69,0
v_mov_b32 v70,0
v_mov_b32 v71,0
v_mov_b32 v72,0
v_mov_b32 v73,0
v_mov_b32 v74,0
v_mov_b32 v75,0
v_mov_b32 v76,0
v_mov_b32 v77,0
v_mov_b32 v78,0
v_mov_b32 v79,0
s_cmp_eq_u32 s15,63
s_cbranch_scc1 L_cf_last23
s_cmp_eq_u32 s14,2
s_cbranch_scc0 L_cf_po
s_cmp_eq_u32 s15,61
s_cbranch_scc0 L_cf_ncw
s_getpc_b64 s[56:57]
L_cf_pc:
s_add_u32 s56,s56,L_chain_done-L_cf_pc
s_addc_u32 s57,s57,0
s_and_b32 s54,s11,1
s_lshl_b32 s54,s54,13
v_bfe_u32 v31,v0,0,6
v_lshlrev_b32 v24,7,v31
v_add_u32 v24,s54,v24
v_min_u32 v24,L_code_end-L_chain_done-4,v24
global_load_dword v25,v24,s[56:57]
L_cf_ncw:
s_add_u32 s54,s15,1
s_and_b32 s55,s54,7
s_cbranch_scc1 L_cf_po
s_cmp_ge_u32 s54,64
s_cbranch_scc1 L_cf_po
v_cmp_gt_u32 vcc,0x60,v192
s_cbranch_vccz L_cf_po
s_lshl_b32 s54,s54,4
s_add_u32 s54,s54,94437376
v_mov_b32 v24,s54
L_cf_kvw:
global_load_dword v25,v24,s[4:5] sc1
s_sub_u32 s40,s40,1
s_cbranch_scc1 L_chain_bail
s_waitcnt vmcnt(0)
v_cmp_gt_u32 vcc,0x60,v25
s_cbranch_vccnz L_cf_kvw
L_cf_po:
s_barrier
v_mov_b32 v80,0
v_mov_b32 v81,0
v_mov_b32 v82,0
v_mov_b32 v83,0
v_mov_b32 v84,0
v_mov_b32 v85,0
v_mov_b32 v86,0
v_mov_b32 v87,0
s_add_u32 s15,s15,1
s_mov_b32 m0,s52
global_load_dwordx4 v[40:43],v2,s[16:17] offset:0 sc1
s_nop 13
global_load_dwordx4 v[44:47],v2,s[16:17] offset:1024 sc1
s_nop 13
global_load_dwordx4 v[48:51],v2,s[16:17] offset:2048 sc1
s_nop 13
global_load_dwordx4 v[52:55],v2,s[16:17] offset:3072 sc1
L_cf_o_go:
s_waitcnt vmcnt(3)
v_max3_u32 v26,v40,v41,v42
v_max_u32 v26,v26,v43
v_cmp_eq_u32 vcc,-1,v26
L_cf_o_q0123:
s_cbranch_vccnz L_cf_o_q0123x
v_smfmac_f32_16x16x64_bf16 v[80:83],v[40:43],a[192:199],v21
s_waitcnt vmcnt(2)
v_max3_u32 v26,v44,v45,v46
v_max_u32 v26,v26,v47
v_cmp_eq_u32 vcc,-1,v26
v_smfmac_f32_16x16x64_bf16 v[84:87],v[40:43],a[224:231],v21
L_cf_o_q123:
s_cbranch_vccnz L_cf_o_q123x
v_smfmac_f32_16x16x64_bf16 v[80:83],v[44:47],a[200:207],v21
s_waitcnt vmcnt(1)
v_max3_u32 v26,v48,v49,v50
v_max_u32 v26,v26,v51
v_cmp_eq_u32 vcc,-1,v26
v_smfmac_f32_16x16x64_bf16 v[84:87],v[44:47],a[232:239],v21
L_cf_o_q23:
s_cbranch_vccnz L_cf_o_q23x
v_smfmac_f32_16x16x64_bf16 v[80:83],v[48:51],a[208:215],v21
s_waitcnt vmcnt(0)
v_max3_u32 v26,v52,v53,v54
v_max_u32 v26,v26,v55
v_cmp_eq_u32 vcc,-1,v26
v_smfmac_f32_16x16x64_bf16 v[84:87],v[48:51],a[240:247],v21
L_cf_o_q3:
s_cbranch_vccnz L_cf_o_q3x
v_smfmac_f32_16x16x64_bf16 v[80:83],v[52:55],a[216:223],v21
v_smfmac_f32_16x16x64_bf16 v[84:87],v[52:55],a[248:255],v21
L_cf_o_done:
s_nop 3
v_pk_add_f32 v[80:81],v[80:81],v[82:83]
ds_write2_b32 v17,v80,v81 offset0:0 offset1:36
s_nop 1
v_pk_add_f32 v[84:85],v[84:85],v[86:87]
ds_write2_b32 v17,v84,v85 offset0:16 offset1:52
global_load_lds_dwordx4 v157,s[22:23] offset:0 sc1
global_load_lds_dwordx4 v157,s[22:23] offset:1024 sc1
s_mov_b32 m0,s53
s_add_u32 s54,s52,10240
global_load_lds_dwordx4 v158,s[22:23] sc1
s_mov_b32 m0,s54
s_nop 0
global_load_lds_dwordx4 v193,s[22:23] offset:0 sc1
global_load_lds_dwordx4 v193,s[22:23] offset:1024 sc1
s_waitcnt lgkmcnt(0)
s_barrier
ds_read2st64_b32 v[80:81],v22 offset0:0 offset1:5
ds_read2st64_b32 v[82:83],v22 offset0:10 offset1:15
s_cmp_lt_u32 s14,2
s_waitcnt lgkmcnt(0)
v_add_f32 v80,v80,v81
v_add_f32 v82,v82,v83
v_add_f32 v80,v80,v82
v_min_u32 v80,s37,v80
global_store_dword v6,v80,s[16:17] sc1
global_store_dword v3,v32,s[20:21]
global_store_dword v6,v32,s[20:21] sc1
s_cbranch_scc0 L_cf_w23c
s_mov_b64 exec,s[32:33]
global_store_dwordx2 v5,v[32:33],s[20:21]
s_mov_b64 exec,-1
s_cmp_eq_u32 s15,1
s_cbranch_scc1 L_cf_nos
global_store_dwordx4 v195,v[240:243],s[26:27] sc1
s_add_u32 s26,s26,262144
s_addc_u32 s27,s27,0
L_cf_nos:
ds_read_b128 v[196:199],v194 offset:0
ds_read_b128 v[200:203],v194 offset:1024
ds_read_b128 v[204:207],v194 offset:2048
ds_read_b128 v[208:211],v194 offset:3072
ds_read_b128 v[212:215],v34 offset:8192
ds_read_b128 v[216:219],v34 offset:9216
ds_read_b32 v221,v29 offset:0
ds_read_b32 v223,v29 offset:256
v_xor_b32 v34,32768,v34
v_xor_b32 v35,32768,v35
v_xor_b32 v194,32768,v194
s_waitcnt lgkmcnt(0)
v_mfma_f32_16x16x32_bf16 v[120:123],v[160:163],v[196:199],v[224:227]
v_mfma_f32_16x16x32_bf16 v[124:127],v[176:179],v[196:199],v[228:231]
v_mfma_f32_16x16x32_bf16 v[128:131],v[104:107],v[196:199],0
v_mfma_f32_16x16x32_bf16 v[120:123],v[164:167],v[200:203],v[120:123]
v_mfma_f32_16x16x32_bf16 v[124:127],v[180:183],v[200:203],v[124:127]
v_mfma_f32_16x16x32_bf16 v[128:131],v[108:111],v[200:203],v[128:131]
v_mfma_f32_16x16x32_bf16 v[120:123],v[168:171],v[204:207],v[120:123]
v_mfma_f32_16x16x32_bf16 v[124:127],v[184:187],v[204:207],v[124:127]
v_mfma_f32_16x16x32_bf16 v[128:131],v[112:115],v[204:207],v[128:131]
v_mfma_f32_16x16x32_bf16 v[120:123],v[172:175],v[208:211],v[120:123]
v_mfma_f32_16x16x32_bf16 v[124:127],v[188:191],v[208:211],v[124:127]
v_mfma_f32_16x16x32_bf16 v[128:131],v[116:119],v[208:211],v[128:131]
v_max3_f32 v24,v120,v121,v122
s_nop 2
v_max3_f32 v24,v24,v123,v124
v_max3_f32 v24,v24,v125,v126
s_nop 1
v_max3_f32 v24,v24,v127,v130
v_max_f32 v24,v24,v131
v_mov_b32 v25,v24
s_nop 1
v_permlane32_swap_b32 v24,v25
v_max_f32 v24,v24,v25
v_mov_b32 v25,v24
s_nop 1
v_permlane16_swap_b32 v24,v25
v_max_f32 v24,v24,v25
v_mul_f32 v24,s36,v24
v_pk_fma_f32 v[120:121],v[120:121],v[138:139],v[24:25] op_sel_hi:[1,1,0] neg_lo:[0,0,1] neg_hi:[0,0,1]
v_pk_fma_f32 v[122:123],v[122:123],v[138:139],v[24:25] op_sel_hi:[1,1,0] neg_lo:[0,0,1] neg_hi:[0,0,1]
v_pk_fma_f32 v[124:125],v[124:125],v[138:139],v[24:25] op_sel_hi:[1,1,0] neg_lo:[0,0,1] neg_hi:[0,0,1]
v_pk_fma_f32 v[126:127],v[126:127],v[138:139],v[24:25] op_sel_hi:[1,1,0] neg_lo:[0,0,1] neg_hi:[0,0,1]
v_pk_fma_f32 v[130:131],v[130:131],v[138:139],v[24:25] op_sel_hi:[1,1,0] neg_lo:[0,0,1] neg_hi:[0,0,1]
v_exp_f32 v120,v120
v_exp_f32 v121,v121
v_exp_f32 v122,v122
v_exp_f32 v123,v123
v_exp_f32 v124,v124
v_exp_f32 v125,v125
v_exp_f32 v126,v126
v_exp_f32 v127,v127
v_exp_f32 v130,v130
v_exp_f32 v131,v131
v_cvt_pk_bf16_f32 v244,v120,v121
v_cvt_pk_bf16_f32 v245,v122,v123
v_cvt_pk_bf16_f32 v246,v124,v125
v_cvt_pk_bf16_f32 v247,v126,v127
v_cvt_pk_bf16_f32 v249,v130,v131
s_nop 0
v_mfma_f32_16x16x32_bf16 v[144:147],v[36:39],v[244:247],0
v_mfma_f32_16x16x32_bf16 v[232:235],v[212:215],v[244:247],0
v_mfma_f32_16x16x32_bf16 v[236:239],v[216:219],v[244:247],0
v_mfma_f32_16x16x16_bf16 v[144:147],v[36:37],v[248:249],v[144:147]
v_mfma_f32_16x16x16_bf16 v[232:235],v[220:221],v[248:249],v[232:235]
v_mfma_f32_16x16x16_bf16 v[236:239],v[222:223],v[248:249],v[236:239]
v_rcp_f32 v24,v144
s_nop 2
v_pk_mul_f32 v[232:233],v[232:233],v[24:25] op_sel_hi:[1,0]
v_pk_mul_f32 v[234:235],v[234:235],v[24:25] op_sel_hi:[1,0]
s_nop 1
v_pk_mul_f32 v[236:237],v[236:237],v[24:25] op_sel_hi:[1,0]
v_pk_mul_f32 v[238:239],v[238:239],v[24:25] op_sel_hi:[1,0]
v_cvt_pk_bf16_f32 v240,v232,v233
v_cvt_pk_bf16_f32 v241,v234,v235
v_cvt_pk_bf16_f32 v242,v236,v237
v_cvt_pk_bf16_f32 v243,v238,v239
v_mov_b32 v56,0
v_mov_b32 v57,0
v_mov_b32 v58,0
v_mov_b32 v59,0
v_mov_b32 v60,0
v_mov_b32 v61,0
v_mov_b32 v62,0
v_mov_b32 v63,0
v_mov_b32 v64,0
v_mov_b32 v65,0
v_mov_b32 v66,0
v_mov_b32 v67,0
v_mov_b32 v68,0
v_mov_b32 v69,0
v_mov_b32 v70,0
v_mov_b32 v71,0
v_mov_b32 v72,0
v_mov_b32 v73,0
v_mov_b32 v74,0
v_mov_b32 v75,0
v_mov_b32 v76,0
v_mov_b32 v77,0
v_mov_b32 v78,0
v_mov_b32 v79,0
s_mov_b64 s[16:17],s[18:19]
s_mov_b64 s[18:19],s[20:21]
s_add_u32 s54,s15,2
s_and_b32 s54,s54,3
s_lshl_b32 s54,s54,19
s_add_u32 s20,s42,s54
s_addc_u32 s21,s43,0
s_add_u32 s22,s22,8192
s_addc_u32 s23,s23,0
s_xor_b32 s52,s52,32768
s_xor_b32 s53,s53,32768
s_branch L_cf_top
L_cf_w23c:
s_cmp_eq_u32 s14,3
s_cbranch_scc0 L_cf_w2c
s_sub_i32 s54,s15,2
s_max_i32 s54,s54,0
v_mov_b32 v24,s54
s_mov_b64 exec,1
global_store_dword v28,v24,s[4:5] sc1
s_mov_b64 exec,-1
s_cmp_gt_u32 s15,32
s_cbranch_scc1 L_cf_ni
global_store_dwordx4 v250,v[252:255],s[4:5] sc1
v_add_u32 v250,1024,v250
L_cf_ni:
s_mov_b64 s[16:17],s[18:19]
s_mov_b64 s[18:19],s[20:21]
s_add_u32 s54,s15,2
s_and_b32 s54,s54,3
s_lshl_b32 s54,s54,19
s_add_u32 s20,s42,s54
s_addc_u32 s21,s43,0
s_add_u32 s22,s22,8192
s_addc_u32 s23,s23,0
s_xor_b32 s52,s52,32768
s_xor_b32 s53,s53,32768
s_branch L_cf_top
L_cf_last23:
s_barrier
s_cmp_eq_u32 s14,3
s_cbranch_scc0 L_chain_done
v_mov_b32 v24,64
s_mov_b64 exec,1
global_store_dword v28,v24,s[4:5] sc1
s_mov_b64 exec,-1
s_branch L_chain_done
L_cf_w2c:
ds_read2_b64 v[88:91],v18 offset0:0 offset1:2
ds_read2_b64 v[92:95],v18 offset0:160 offset1:162
ds_read2_b64 v[96:99],v19 offset0:0 offset1:2
ds_read2_b64 v[100:103],v19 offset0:160 offset1:162
global_store_dwordx2 v10,v[32:33],s[20:21]
s_mov_b64 s[62:63],s[16:17]
s_mov_b64 s[16:17],s[18:19]
s_mov_b64 s[18:19],s[20:21]
s_add_u32 s54,s15,2
s_and_b32 s54,s54,3
s_lshl_b32 s54,s54,19
s_add_u32 s20,s42,s54
s_addc_u32 s21,s43,0
s_add_u32 s22,s22,8192
s_addc_u32 s23,s23,0
s_xor_b32 s52,s52,32768
s_xor_b32 s53,s53,32768
s_waitcnt lgkmcnt(0)
v_pk_add_f32 v[88:89],v[88:89],v[92:93]
v_pk_add_f32 v[96:97],v[96:97],v[100:101]
v_pk_add_f32 v[90:91],v[90:91],v[94:95]
v_pk_add_f32 v[98:99],v[98:99],v[102:103]
v_pk_add_f32 v[88:89],v[88:89],v[96:97]
v_pk_add_f32 v[90:91],v[90:91],v[98:99]
s_add_u32 s54,s15,1
s_and_b32 s55,s54,7
s_cbranch_scc1 L_cf_nf
s_lshl_b32 s54,s54,4
s_add_u32 s54,s54,94437376
v_mov_b32 v159,s54
global_load_dword v192,v159,s[4:5] sc1
L_cf_nf:
s_nop 15
s_nop 15
s_nop 15
s_nop 15
s_nop 15
s_nop 15
s_nop 15
s_nop 15
global_load_dwordx4 v[120:123],v7,s[62:63] sc1
global_load_dwordx4 v[124:127],v8,s[62:63] sc1
global_load_dwordx4 v[128:131],v9,s[62:63] sc1
s_waitcnt vmcnt(2)
v_max3_u32 v26,v120,v121,v122
v_pk_add_f32 v[92:93],v[88:89],v[120:121]
v_pk_add_f32 v[94:95],v[90:91],v[122:123]
s_waitcnt vmcnt(1)
v_max3_u32 v26,v26,v123,v124
v_max3_u32 v26,v26,v125,v126
s_waitcnt vmcnt(0)
v_max3_u32 v26,v26,v127,v128
v_max3_u32 v26,v26,v129,v130
v_max_u32 v26,v26,v131
v_cmp_eq_u32 vcc,-1,v26
v_pk_add_f32 v[96:97],v[124:125],v[128:129]
v_pk_add_f32 v[98:99],v[126:127],v[130:131]
v_pk_add_f32 v[92:93],v[92:93],v[96:97]
v_pk_add_f32 v[94:95],v[94:95],v[98:99]
v_cvt_pk_bf16_f32 v92,v92,v93
v_cvt_pk_bf16_f32 v93,v94,v95
v_min_u32 v92,s37,v92
v_min_u32 v93,s37,v93
s_cbranch_vccnz L_cf_c_go
global_store_dwordx2 v10,v[92:93],s[16:17]
s_branch L_cf_top
L_cf_c_go:
s_waitcnt vmcnt(2)
v_max3_u32 v26,v120,v121,v122
v_max_u32 v26,v26,v123
v_cmp_eq_u32 vcc,-1,v26
L_cf_c_q012:
s_cbranch_vccnz L_cf_c_q012x
v_pk_add_f32 v[88:89],v[88:89],v[120:121]
s_waitcnt vmcnt(1)
v_max3_u32 v26,v124,v125,v126
v_max_u32 v26,v26,v127
v_cmp_eq_u32 vcc,-1,v26
v_pk_add_f32 v[90:91],v[90:91],v[122:123]
L_cf_c_q12:
s_cbranch_vccnz L_cf_c_q12x
s_waitcnt vmcnt(0)
v_max3_u32 v26,v128,v129,v130
v_max_u32 v26,v26,v131
v_cmp_eq_u32 vcc,-1,v26
L_cf_c_q2:
s_cbranch_vccnz L_cf_c_q2x
L_cf_c_done:
v_pk_add_f32 v[124:125],v[124:125],v[128:129]
v_pk_add_f32 v[126:127],v[126:127],v[130:131]
v_pk_add_f32 v[88:89],v[88:89],v[124:125]
v_pk_add_f32 v[90:91],v[90:91],v[126:127]
v_cvt_pk_bf16_f32 v88,v88,v89
v_cvt_pk_bf16_f32 v89,v90,v91
v_min_u32 v88,s37,v88
v_min_u32 v89,s37,v89
global_store_dwordx2 v10,v[88:89],s[16:17]
s_branch L_cf_top
L_cf_a_q0123x:
s_mov_b64 exec,vcc
global_load_dwordx4 v[40:43],v1,s[16:17] offset:0 sc1
s_mov_b64 exec,-1
s_waitcnt vmcnt(3)
v_max3_u32 v26,v44,v45,v46
v_max_u32 v26,v26,v47
v_cmp_eq_u32 vcc,-1,v26
L_cf_a_q1230:
s_cbranch_vccnz L_cf_a_q1230x
v_smfmac_f32_16x16x64_bf16 v[56:59],v[44:47],a[8:15],v21
s_waitcnt vmcnt(2)
v_max3_u32 v26,v48,v49,v50
v_smfmac_f32_16x16x64_bf16 v[60:63],v[44:47],a[40:47],v21
v_max_u32 v26,v26,v51
v_cmp_eq_u32 vcc,-1,v26
v_smfmac_f32_16x16x64_bf16 v[64:67],v[44:47],a[72:79],v21
v_smfmac_f32_16x16x64_bf16 v[68:71],v[44:47],a[104:111],v21
L_cf_a_q230:
s_cbranch_vccnz L_cf_a_q230x
v_smfmac_f32_16x16x64_bf16 v[56:59],v[48:51],a[16:23],v21
s_waitcnt vmcnt(1)
v_max3_u32 v26,v52,v53,v54
v_smfmac_f32_16x16x64_bf16 v[60:63],v[48:51],a[48:55],v21
v_max_u32 v26,v26,v55
v_cmp_eq_u32 vcc,-1,v26
v_smfmac_f32_16x16x64_bf16 v[64:67],v[48:51],a[80:87],v21
v_smfmac_f32_16x16x64_bf16 v[68:71],v[48:51],a[112:119],v21
L_cf_a_q30:
s_cbranch_vccnz L_cf_a_q30x
v_smfmac_f32_16x16x64_bf16 v[56:59],v[52:55],a[24:31],v21
s_waitcnt vmcnt(0)
v_max3_u32 v26,v40,v41,v42
v_smfmac_f32_16x16x64_bf16 v[60:63],v[52:55],a[56:63],v21
v_max_u32 v26,v26,v43
v_cmp_eq_u32 vcc,-1,v26
v_smfmac_f32_16x16x64_bf16 v[64:67],v[52:55],a[88:95],v21
v_smfmac_f32_16x16x64_bf16 v[68:71],v[52:55],a[120:127],v21
L_cf_a_q0:
s_cbranch_vccnz L_cf_a_q0x
v_smfmac_f32_16x16x64_bf16 v[56:59],v[40:43],a[0:7],v21
v_smfmac_f32_16x16x64_bf16 v[60:63],v[40:43],a[32:39],v21
v_smfmac_f32_16x16x64_bf16 v[64:67],v[40:43],a[64:71],v21
v_smfmac_f32_16x16x64_bf16 v[68:71],v[40:43],a[96:103],v21
s_branch L_cf_a_done
L_cf_a_q123x:
s_mov_b64 exec,vcc
global_load_dwordx4 v[44:47],v1,s[16:17] offset:1024 sc1
s_mov_b64 exec,-1
s_waitcnt vmcnt(2)
v_max3_u32 v26,v48,v49,v50
v_max_u32 v26,v26,v51
v_cmp_eq_u32 vcc,-1,v26
L_cf_a_q231:
s_cbranch_vccnz L_cf_a_q231x
v_smfmac_f32_16x16x64_bf16 v[56:59],v[48:51],a[16:23],v21
s_waitcnt vmcnt(1)
v_max3_u32 v26,v52,v53,v54
v_smfmac_f32_16x16x64_bf16 v[60:63],v[48:51],a[48:55],v21
v_max_u32 v26,v26,v55
v_cmp_eq_u32 vcc,-1,v26
v_smfmac_f32_16x16x64_bf16 v[64:67],v[48:51],a[80:87],v21
v_smfmac_f32_16x16x64_bf16 v[68:71],v[48:51],a[112:119],v21
L_cf_a_q31:
s_cbranch_vccnz L_cf_a_q31x
v_smfmac_f32_16x16x64_bf16 v[56:59],v[52:55],a[24:31],v21
s_waitcnt vmcnt(0)
v_max3_u32 v26,v44,v45,v46
v_smfmac_f32_16x16x64_bf16 v[60:63],v[52:55],a[56:63],v21
v_max_u32 v26,v26,v47
v_cmp_eq_u32 vcc,-1,v26
v_smfmac_f32_16x16x64_bf16 v[64:67],v[52:55],a[88:95],v21
v_smfmac_f32_16x16x64_bf16 v[68:71],v[52:55],a[120:127],v21
L_cf_a_q1:
s_cbranch_vccnz L_cf_a_q1x
v_smfmac_f32_16x16x64_bf16 v[56:59],v[44:47],a[8:15],v21
v_smfmac_f32_16x16x64_bf16 v[60:63],v[44:47],a[40:47],v21
v_smfmac_f32_16x16x64_bf16 v[64:67],v[44:47],a[72:79],v21
v_smfmac_f32_16x16x64_bf16 v[68:71],v[44:47],a[104:111],v21
s_branch L_cf_a_done
L_cf_a_q23x:
s_mov_b64 exec,vcc
global_load_dwordx4 v[48:51],v1,s[16:17] offset:2048 sc1
s_mov_b64 exec,-1
s_waitcnt vmcnt(1)
v_max3_u32 v26,v52,v53,v54
v_max_u32 v26,v26,v55
v_cmp_eq_u32 vcc,-1,v26
L_cf_a_q32:
s_cbranch_vccnz L_cf_a_q32x
v_smfmac_f32_16x16x64_bf16 v[56:59],v[52:55],a[24:31],v21
s_waitcnt vmcnt(0)
v_max3_u32 v26,v48,v49,v50
v_smfmac_f32_16x16x64_bf16 v[60:63],v[52:55],a[56:63],v21
v_max_u32 v26,v26,v51
v_cmp_eq_u32 vcc,-1,v26
v_smfmac_f32_16x16x64_bf16 v[64:67],v[52:55],a[88:95],v21
v_smfmac_f32_16x16x64_bf16 v[68:71],v[52:55],a[120:127],v21
L_cf_a_q2:
s_cbranch_vccnz L_cf_a_q2x
v_smfmac_f32_16x16x64_bf16 v[56:59],v[48:51],a[16:23],v21
v_smfmac_f32_16x16x64_bf16 v[60:63],v[48:51],a[48:55],v21
v_smfmac_f32_16x16x64_bf16 v[64:67],v[48:51],a[80:87],v21
v_smfmac_f32_16x16x64_bf16 v[68:71],v[48:51],a[112:119],v21
s_branch L_cf_a_done
L_cf_a_q3x:
s_mov_b64 exec,vcc
global_load_dwordx4 v[52:55],v1,s[16:17] offset:3072 sc1
s_mov_b64 exec,-1
s_sub_u32 s40,s40,1
s_cbranch_scc1 L_chain_bail
s_waitcnt vmcnt(0)
v_max3_u32 v26,v52,v53,v54
v_max_u32 v26,v26,v55
v_cmp_eq_u32 vcc,-1,v26
s_branch L_cf_a_q3
L_cf_a_q1230x:
s_mov_b64 exec,vcc
global_load_dwordx4 v[44:47],v1,s[16:17] offset:1024 sc1
s_mov_b64 exec,-1
s_waitcnt vmcnt(3)
v_max3_u32 v26,v48,v49,v50
v_max_u32 v26,v26,v51
v_cmp_eq_u32 vcc,-1,v26
L_cf_a_q2301:
s_cbranch_vccnz L_cf_a_q2301x
v_smfmac_f32_16x16x64_bf16 v[56:59],v[48:51],a[16:23],v21
s_waitcnt vmcnt(2)
v_max3_u32 v26,v52,v53,v54
v_smfmac_f32_16x16x64_bf16 v[60:63],v[48:51],a[48:55],v21
v_max_u32 v26,v26,v55
v_cmp_eq_u32 vcc,-1,v26
v_smfmac_f32_16x16x64_bf16 v[64:67],v[48:51],a[80:87],v21
v_smfmac_f32_16x16x64_bf16 v[68:71],v[48:51],a[112:119],v21
L_cf_a_q301:
s_cbranch_vccnz L_cf_a_q301x
v_smfmac_f32_16x16x64_bf16 v[56:59],v[52:55],a[24:31],v21
s_waitcnt vmcnt(1)
v_max3_u32 v26,v40,v41,v42
v_smfmac_f32_16x16x64_bf16 v[60:63],v[52:55],a[56:63],v21
v_max_u32 v26,v26,v43
v_cmp_eq_u32 vcc,-1,v26
v_smfmac_f32_16x16x64_bf16 v[64:67],v[52:55],a[88:95],v21
v_smfmac_f32_16x16x64_bf16 v[68:71],v[52:55],a[120:127],v21
L_cf_a_q01:
s_cbranch_vccnz L_cf_a_q01x
v_smfmac_f32_16x16x64_bf16 v[56:59],v[40:43],a[0:7],v21
s_waitcnt vmcnt(0)
v_max3_u32 v26,v44,v45,v46
v_smfmac_f32_16x16x64_bf16 v[60:63],v[40:43],a[32:39],v21
v_max_u32 v26,v26,v47
v_cmp_eq_u32 vcc,-1,v26
v_smfmac_f32_16x16x64_bf16 v[64:67],v[40:43],a[64:71],v21
v_smfmac_f32_16x16x64_bf16 v[68:71],v[40:43],a[96:103],v21
s_branch L_cf_a_q1
L_cf_a_q230x:
s_mov_b64 exec,vcc
global_load_dwordx4 v[48:51],v1,s[16:17] offset:2048 sc1
s_mov_b64 exec,-1
s_waitcnt vmcnt(2)
v_max3_u32 v26,v52,v53,v54
v_max_u32 v26,v26,v55
v_cmp_eq_u32 vcc,-1,v26
L_cf_a_q302:
s_cbranch_vccnz L_cf_a_q302x
v_smfmac_f32_16x16x64_bf16 v[56:59],v[52:55],a[24:31],v21
s_waitcnt vmcnt(1)
v_max3_u32 v26,v40,v41,v42
v_smfmac_f32_16x16x64_bf16 v[60:63],v[52:55],a[56:63],v21
v_max_u32 v26,v26,v43
v_cmp_eq_u32 vcc,-1,v26
v_smfmac_f32_16x16x64_bf16 v[64:67],v[52:55],a[88:95],v21
v_smfmac_f32_16x16x64_bf16 v[68:71],v[52:55],a[120:127],v21
L_cf_a_q02:
s_cbranch_vccnz L_cf_a_q02x
v_smfmac_f32_16x16x64_bf16 v[56:59],v[40:43],a[0:7],v21
s_waitcnt vmcnt(0)
v_max3_u32 v26,v48,v49,v50
v_smfmac_f32_16x16x64_bf16 v[60:63],v[40:43],a[32:39],v21
v_max_u32 v26,v26,v51
v_cmp_eq_u32 vcc,-1,v26
v_smfmac_f32_16x16x64_bf16 v[64:67],v[40:43],a[64:71],v21
v_smfmac_f32_16x16x64_bf16 v[68:71],v[40:43],a[96:103],v21
s_branch L_cf_a_q2
L_cf_a_q30x:
s_mov_b64 exec,vcc
global_load_dwordx4 v[52:55],v1,s[16:17] offset:3072 sc1
s_mov_b64 exec,-1
s_sub_u32 s40,s40,1
s_cbranch_scc1 L_chain_bail
s_waitcnt vmcnt(1)
v_max3_u32 v26,v40,v41,v42
v_max_u32 v26,v26,v43
v_cmp_eq_u32 vcc,-1,v26
L_cf_a_q03:
s_cbranch_vccnz L_cf_a_q03x
v_smfmac_f32_16x16x64_bf16 v[56:59],v[40:43],a[0:7],v21
s_waitcnt vmcnt(0)
v_max3_u32 v26,v52,v53,v54
v_smfmac_f32_16x16x64_bf16 v[60:63],v[40:43],a[32:39],v21
v_max_u32 v26,v26,v55
v_cmp_eq_u32 vcc,-1,v26
v_smfmac_f32_16x16x64_bf16 v[64:67],v[40:43],a[64:71],v21
v_smfmac_f32_16x16x64_bf16 v[68:71],v[40:43],a[96:103],v21
s_branch L_cf_a_q3
L_cf_a_q0x:
s_mov_b64 exec,vcc
global_load_dwordx4 v[40:43],v1,s[16:17] offset:0 sc1
s_mov_b64 exec,-1
s_sub_u32 s40,s40,1
s_cbranch_scc1 L_chain_bail
s_waitcnt vmcnt(0)
v_max3_u32 v26,v40,v41,v42
v_max_u32 v26,v26,v43
v_cmp_eq_u32 vcc,-1,v26
s_branch L_cf_a_q0
L_cf_a_q231x:
s_mov_b64 exec,vcc
global_load_dwordx4 v[48:51],v1,s[16:17] offset:2048 sc1
s_mov_b64 exec,-1
s_waitcnt vmcnt(2)
v_max3_u32 v26,v52,v53,v54
v_max_u32 v26,v26,v55
v_cmp_eq_u32 vcc,-1,v26
L_cf_a_q312:
s_cbranch_vccnz L_cf_a_q312x
v_smfmac_f32_16x16x64_bf16 v[56:59],v[52:55],a[24:31],v21
s_waitcnt vmcnt(1)
v_max3_u32 v26,v44,v45,v46
v_smfmac_f32_16x16x64_bf16 v[60:63],v[52:55],a[56:63],v21
v_max_u32 v26,v26,v47
v_cmp_eq_u32 vcc,-1,v26
v_smfmac_f32_16x16x64_bf16 v[64:67],v[52:55],a[88:95],v21
v_smfmac_f32_16x16x64_bf16 v[68:71],v[52:55],a[120:127],v21
L_cf_a_q12:
s_cbranch_vccnz L_cf_a_q12x
v_smfmac_f32_16x16x64_bf16 v[56:59],v[44:47],a[8:15],v21
s_waitcnt vmcnt(0)
v_max3_u32 v26,v48,v49,v50
v_smfmac_f32_16x16x64_bf16 v[60:63],v[44:47],a[40:47],v21
v_max_u32 v26,v26,v51
v_cmp_eq_u32 vcc,-1,v26
v_smfmac_f32_16x16x64_bf16 v[64:67],v[44:47],a[72:79],v21
v_smfmac_f32_16x16x64_bf16 v[68:71],v[44:47],a[104:111],v21
s_branch L_cf_a_q2
L_cf_a_q31x:
s_mov_b64 exec,vcc
global_load_dwordx4 v[52:55],v1,s[16:17] offset:3072 sc1
s_mov_b64 exec,-1
s_sub_u32 s40,s40,1
s_cbranch_scc1 L_chain_bail
s_waitcnt vmcnt(1)
v_max3_u32 v26,v44,v45,v46
v_max_u32 v26,v26,v47
v_cmp_eq_u32 vcc,-1,v26
L_cf_a_q13:
s_cbranch_vccnz L_cf_a_q13x
v_smfmac_f32_16x16x64_bf16 v[56:59],v[44:47],a[8:15],v21
s_waitcnt vmcnt(0)
v_max3_u32 v26,v52,v53,v54
v_smfmac_f32_16x16x64_bf16 v[60:63],v[44:47],a[40:47],v21
v_max_u32 v26,v26,v55
v_cmp_eq_u32 vcc,-1,v26
v_smfmac_f32_16x16x64_bf16 v[64:67],v[44:47],a[72:79],v21
v_smfmac_f32_16x16x64_bf16 v[68:71],v[44:47],a[104:111],v21
s_branch L_cf_a_q3
L_cf_a_q1x:
s_mov_b64 exec,vcc
global_load_dwordx4 v[44:47],v1,s[16:17] offset:1024 sc1
s_mov_b64 exec,-1
s_sub_u32 s40,s40,1
s_cbranch_scc1 L_chain_bail
s_waitcnt vmcnt(0)
v_max3_u32 v26,v44,v45,v46
v_max_u32 v26,v26,v47
v_cmp_eq_u32 vcc,-1,v26
s_branch L_cf_a_q1
L_cf_a_q32x:
s_mov_b64 exec,vcc
global_load_dwordx4 v[52:55],v1,s[16:17] offset:3072 sc1
s_mov_b64 exec,-1
s_sub_u32 s40,s40,1
s_cbranch_scc1 L_chain_bail
s_waitcnt vmcnt(1)
v_max3_u32 v26,v48,v49,v50
v_max_u32 v26,v26,v51
v_cmp_eq_u32 vcc,-1,v26
s_branch L_cf_a_q23
L_cf_a_q2x:
s_mov_b64 exec,vcc
global_load_dwordx4 v[48:51],v1,s[16:17] offset:2048 sc1
s_mov_b64 exec,-1
s_sub_u32 s40,s40,1
s_cbranch_scc1 L_chain_bail
s_waitcnt vmcnt(0)
v_max3_u32 v26,v48,v49,v50
v_max_u32 v26,v26,v51
v_cmp_eq_u32 vcc,-1,v26
s_branch L_cf_a_q2
L_cf_a_q2301x:
s_mov_b64 exec,vcc
global_load_dwordx4 v[48:51],v1,s[16:17] offset:2048 sc1
s_mov_b64 exec,-1
s_waitcnt vmcnt(3)
v_max3_u32 v26,v52,v53,v54
v_max_u32 v26,v26,v55
v_cmp_eq_u32 vcc,-1,v26
L_cf_a_q3012:
s_cbranch_vccnz L_cf_a_q3012x
v_smfmac_f32_16x16x64_bf16 v[56:59],v[52:55],a[24:31],v21
s_waitcnt vmcnt(2)
v_max3_u32 v26,v40,v41,v42
v_smfmac_f32_16x16x64_bf16 v[60:63],v[52:55],a[56:63],v21
v_max_u32 v26,v26,v43
v_cmp_eq_u32 vcc,-1,v26
v_smfmac_f32_16x16x64_bf16 v[64:67],v[52:55],a[88:95],v21
v_smfmac_f32_16x16x64_bf16 v[68:71],v[52:55],a[120:127],v21
L_cf_a_q012:
s_cbranch_vccnz L_cf_a_q012x
v_smfmac_f32_16x16x64_bf16 v[56:59],v[40:43],a[0:7],v21
s_waitcnt vmcnt(1)
v_max3_u32 v26,v44,v45,v46
v_smfmac_f32_16x16x64_bf16 v[60:63],v[40:43],a[32:39],v21
v_max_u32 v26,v26,v47
v_cmp_eq_u32 vcc,-1,v26
v_smfmac_f32_16x16x64_bf16 v[64:67],v[40:43],a[64:71],v21
v_smfmac_f32_16x16x64_bf16 v[68:71],v[40:43],a[96:103],v21
s_branch L_cf_a_q12
L_cf_a_q301x:
s_mov_b64 exec,vcc
global_load_dwordx4 v[52:55],v1,s[16:17] offset:3072 sc1
s_mov_b64 exec,-1
s_sub_u32 s40,s40,1
s_cbranch_scc1 L_chain_bail
s_waitcnt vmcnt(2)
v_max3_u32 v26,v40,v41,v42
v_max_u32 v26,v26,v43
v_cmp_eq_u32 vcc,-1,v26
L_cf_a_q013:
s_cbranch_vccnz L_cf_a_q013x
v_smfmac_f32_16x16x64_bf16 v[56:59],v[40:43],a[0:7],v21
s_waitcnt vmcnt(1)
v_max3_u32 v26,v44,v45,v46
v_smfmac_f32_16x16x64_bf16 v[60:63],v[40:43],a[32:39],v21
v_max_u32 v26,v26,v47
v_cmp_eq_u32 vcc,-1,v26
v_smfmac_f32_16x16x64_bf16 v[64:67],v[40:43],a[64:71],v21
v_smfmac_f32_16x16x64_bf16 v[68:71],v[40:43],a[96:103],v21
s_branch L_cf_a_q13
L_cf_a_q01x:
s_mov_b64 exec,vcc
global_load_dwordx4 v[40:43],v1,s[16:17] offset:0 sc1
s_mov_b64 exec,-1
s_waitcnt vmcnt(1)
v_max3_u32 v26,v44,v45,v46
v_max_u32 v26,v26,v47
v_cmp_eq_u32 vcc,-1,v26
L_cf_a_q10:
s_cbranch_vccnz L_cf_a_q10x
v_smfmac_f32_16x16x64_bf16 v[56:59],v[44:47],a[8:15],v21
s_waitcnt vmcnt(0)
v_max3_u32 v26,v40,v41,v42
v_smfmac_f32_16x16x64_bf16 v[60:63],v[44:47],a[40:47],v21
v_max_u32 v26,v26,v43
v_cmp_eq_u32 vcc,-1,v26
v_smfmac_f32_16x16x64_bf16 v[64:67],v[44:47],a[72:79],v21
v_smfmac_f32_16x16x64_bf16 v[68:71],v[44:47],a[104:111],v21
s_branch L_cf_a_q0
L_cf_a_q302x:
s_mov_b64 exec,vcc
global_load_dwordx4 v[52:55],v1,s[16:17] offset:3072 sc1
s_mov_b64 exec,-1
s_sub_u32 s40,s40,1
s_cbranch_scc1 L_chain_bail
s_waitcnt vmcnt(2)
v_max3_u32 v26,v40,v41,v42
v_max_u32 v26,v26,v43
v_cmp_eq_u32 vcc,-1,v26
L_cf_a_q023:
s_cbranch_vccnz L_cf_a_q023x
v_smfmac_f32_16x16x64_bf16 v[56:59],v[40:43],a[0:7],v21
s_waitcnt vmcnt(1)
v_max3_u32 v26,v48,v49,v50
v_smfmac_f32_16x16x64_bf16 v[60:63],v[40:43],a[32:39],v21
v_max_u32 v26,v26,v51
v_cmp_eq_u32 vcc,-1,v26
v_smfmac_f32_16x16x64_bf16 v[64:67],v[40:43],a[64:71],v21
v_smfmac_f32_16x16x64_bf16 v[68:71],v[40:43],a[96:103],v21
s_branch L_cf_a_q23
L_cf_a_q02x:
s_mov_b64 exec,vcc
global_load_dwordx4 v[40:43],v1,s[16:17] offset:0 sc1
s_mov_b64 exec,-1
s_waitcnt vmcnt(1)
v_max3_u32 v26,v48,v49,v50
v_max_u32 v26,v26,v51
v_cmp_eq_u32 vcc,-1,v26
L_cf_a_q20:
s_cbranch_vccnz L_cf_a_q20x
v_smfmac_f32_16x16x64_bf16 v[56:59],v[48:51],a[16:23],v21
s_waitcnt vmcnt(0)
v_max3_u32 v26,v40,v41,v42
v_smfmac_f32_16x16x64_bf16 v[60:63],v[48:51],a[48:55],v21
v_max_u32 v26,v26,v43
v_cmp_eq_u32 vcc,-1,v26
v_smfmac_f32_16x16x64_bf16 v[64:67],v[48:51],a[80:87],v21
v_smfmac_f32_16x16x64_bf16 v[68:71],v[48:51],a[112:119],v21
s_branch L_cf_a_q0
L_cf_a_q03x:
s_mov_b64 exec,vcc
global_load_dwordx4 v[40:43],v1,s[16:17] offset:0 sc1
s_mov_b64 exec,-1
s_waitcnt vmcnt(1)
v_max3_u32 v26,v52,v53,v54
v_max_u32 v26,v26,v55
v_cmp_eq_u32 vcc,-1,v26
s_branch L_cf_a_q30
L_cf_a_q312x:
s_mov_b64 exec,vcc
global_load_dwordx4 v[52:55],v1,s[16:17] offset:3072 sc1
s_mov_b64 exec,-1
s_sub_u32 s40,s40,1
s_cbranch_scc1 L_chain_bail
s_waitcnt vmcnt(2)
v_max3_u32 v26,v44,v45,v46
v_max_u32 v26,v26,v47
v_cmp_eq_u32 vcc,-1,v26
s_branch L_cf_a_q123
L_cf_a_q12x:
s_mov_b64 exec,vcc
global_load_dwordx4 v[44:47],v1,s[16:17] offset:1024 sc1
s_mov_b64 exec,-1
s_waitcnt vmcnt(1)
v_max3_u32 v26,v48,v49,v50
v_max_u32 v26,v26,v51
v_cmp_eq_u32 vcc,-1,v26
L_cf_a_q21:
s_cbranch_vccnz L_cf_a_q21x
v_smfmac_f32_16x16x64_bf16 v[56:59],v[48:51],a[16:23],v21
s_waitcnt vmcnt(0)
v_max3_u32 v26,v44,v45,v46
v_smfmac_f32_16x16x64_bf16 v[60:63],v[48:51],a[48:55],v21
v_max_u32 v26,v26,v47
v_cmp_eq_u32 vcc,-1,v26
v_smfmac_f32_16x16x64_bf16 v[64:67],v[48:51],a[80:87],v21
v_smfmac_f32_16x16x64_bf16 v[68:71],v[48:51],a[112:119],v21
s_branch L_cf_a_q1
L_cf_a_q13x:
s_mov_b64 exec,vcc
global_load_dwordx4 v[44:47],v1,s[16:17] offset:1024 sc1
s_mov_b64 exec,-1
s_waitcnt vmcnt(1)
v_max3_u32 v26,v52,v53,v54
v_max_u32 v26,v26,v55
v_cmp_eq_u32 vcc,-1,v26
s_branch L_cf_a_q31
L_cf_a_q3012x:
s_mov_b64 exec,vcc
global_load_dwordx4 v[52:55],v1,s[16:17] offset:3072 sc1
s_mov_b64 exec,-1
s_sub_u32 s40,s40,1
s_cbranch_scc1 L_chain_bail
s_waitcnt vmcnt(3)
v_max3_u32 v26,v40,v41,v42
v_max_u32 v26,v26,v43
v_cmp_eq_u32 vcc,-1,v26
s_branch L_cf_a_q0123
L_cf_a_q012x:
s_mov_b64 exec,vcc
global_load_dwordx4 v[40:43],v1,s[16:17] offset:0 sc1
s_mov_b64 exec,-1
s_waitcnt vmcnt(2)
v_max3_u32 v26,v44,v45,v46
v_max_u32 v26,v26,v47
v_cmp_eq_u32 vcc,-1,v26
L_cf_a_q120:
s_cbranch_vccnz L_cf_a_q120x
v_smfmac_f32_16x16x64_bf16 v[56:59],v[44:47],a[8:15],v21
s_waitcnt vmcnt(1)
v_max3_u32 v26,v48,v49,v50
v_smfmac_f32_16x16x64_bf16 v[60:63],v[44:47],a[40:47],v21
v_max_u32 v26,v26,v51
v_cmp_eq_u32 vcc,-1,v26
v_smfmac_f32_16x16x64_bf16 v[64:67],v[44:47],a[72:79],v21
v_smfmac_f32_16x16x64_bf16 v[68:71],v[44:47],a[104:111],v21
s_branch L_cf_a_q20
L_cf_a_q013x:
s_mov_b64 exec,vcc
global_load_dwordx4 v[40:43],v1,s[16:17] offset:0 sc1
s_mov_b64 exec,-1
s_waitcnt vmcnt(2)
v_max3_u32 v26,v44,v45,v46
v_max_u32 v26,v26,v47
v_cmp_eq_u32 vcc,-1,v26
L_cf_a_q130:
s_cbranch_vccnz L_cf_a_q130x
v_smfmac_f32_16x16x64_bf16 v[56:59],v[44:47],a[8:15],v21
s_waitcnt vmcnt(1)
v_max3_u32 v26,v52,v53,v54
v_smfmac_f32_16x16x64_bf16 v[60:63],v[44:47],a[40:47],v21
v_max_u32 v26,v26,v55
v_cmp_eq_u32 vcc,-1,v26
v_smfmac_f32_16x16x64_bf16 v[64:67],v[44:47],a[72:79],v21
v_smfmac_f32_16x16x64_bf16 v[68:71],v[44:47],a[104:111],v21
s_branch L_cf_a_q30
L_cf_a_q10x:
s_mov_b64 exec,vcc
global_load_dwordx4 v[44:47],v1,s[16:17] offset:1024 sc1
s_mov_b64 exec,-1
s_sub_u32 s40,s40,1
s_cbranch_scc1 L_chain_bail
s_waitcnt vmcnt(1)
v_max3_u32 v26,v40,v41,v42
v_max_u32 v26,v26,v43
v_cmp_eq_u32 vcc,-1,v26
s_branch L_cf_a_q01
L_cf_a_q023x:
s_mov_b64 exec,vcc
global_load_dwordx4 v[40:43],v1,s[16:17] offset:0 sc1
s_mov_b64 exec,-1
s_waitcnt vmcnt(2)
v_max3_u32 v26,v48,v49,v50
v_max_u32 v26,v26,v51
v_cmp_eq_u32 vcc,-1,v26
s_branch L_cf_a_q230
L_cf_a_q20x:
s_mov_b64 exec,vcc
global_load_dwordx4 v[48:51],v1,s[16:17] offset:2048 sc1
s_mov_b64 exec,-1
s_sub_u32 s40,s40,1
s_cbranch_scc1 L_chain_bail
s_waitcnt vmcnt(1)
v_max3_u32 v26,v40,v41,v42
v_max_u32 v26,v26,v43
v_cmp_eq_u32 vcc,-1,v26
s_branch L_cf_a_q02
L_cf_a_q21x:
s_mov_b64 exec,vcc
global_load_dwordx4 v[48:51],v1,s[16:17] offset:2048 sc1
s_mov_b64 exec,-1
s_sub_u32 s40,s40,1
s_cbranch_scc1 L_chain_bail
s_waitcnt vmcnt(1)
v_max3_u32 v26,v44,v45,v46
v_max_u32 v26,v26,v47
v_cmp_eq_u32 vcc,-1,v26
s_branch L_cf_a_q12
L_cf_a_q120x:
s_mov_b64 exec,vcc
global_load_dwordx4 v[44:47],v1,s[16:17] offset:1024 sc1
s_mov_b64 exec,-1
s_waitcnt vmcnt(2)
v_max3_u32 v26,v48,v49,v50
v_max_u32 v26,v26,v51
v_cmp_eq_u32 vcc,-1,v26
L_cf_a_q201:
s_cbranch_vccnz L_cf_a_q201x
v_smfmac_f32_16x16x64_bf16 v[56:59],v[48:51],a[16:23],v21
s_waitcnt vmcnt(1)
v_max3_u32 v26,v40,v41,v42
v_smfmac_f32_16x16x64_bf16 v[60:63],v[48:51],a[48:55],v21
v_max_u32 v26,v26,v43
v_cmp_eq_u32 vcc,-1,v26
v_smfmac_f32_16x16x64_bf16 v[64:67],v[48:51],a[80:87],v21
v_smfmac_f32_16x16x64_bf16 v[68:71],v[48:51],a[112:119],v21
s_branch L_cf_a_q01
L_cf_a_q130x:
s_mov_b64 exec,vcc
global_load_dwordx4 v[44:47],v1,s[16:17] offset:1024 sc1
s_mov_b64 exec,-1
s_waitcnt vmcnt(2)
v_max3_u32 v26,v52,v53,v54
v_max_u32 v26,v26,v55
v_cmp_eq_u32 vcc,-1,v26
s_branch L_cf_a_q301
L_cf_a_q201x:
s_mov_b64 exec,vcc
global_load_dwordx4 v[48:51],v1,s[16:17] offset:2048 sc1
s_mov_b64 exec,-1
s_sub_u32 s40,s40,1
s_cbranch_scc1 L_chain_bail
s_waitcnt vmcnt(2)
v_max3_u32 v26,v40,v41,v42
v_max_u32 v26,v26,v43
v_cmp_eq_u32 vcc,-1,v26
s_branch L_cf_a_q012
L_cf_b_q0123x:
s_mov_b64 exec,vcc
global_load_dwordx4 v[104:107],v4,s[16:17] offset:0 sc1
s_mov_b64 exec,-1
s_waitcnt vmcnt(3)
v_max3_u32 v26,v108,v109,v110
v_max_u32 v26,v26,v111
v_cmp_eq_u32 vcc,-1,v26
L_cf_b_q1230:
s_cbranch_vccnz L_cf_b_q1230x
v_mfma_f32_16x16x32_bf16 v[120:123],v[164:167],v[108:111],v[120:123]
s_waitcnt vmcnt(2)
v_max3_u32 v26,v112,v113,v114
v_mfma_f32_16x16x32_bf16 v[124:127],v[180:183],v[108:111],v[124:127]
v_max_u32 v26,v26,v115
v_cmp_eq_u32 vcc,-1,v26
v_mfma_f32_16x16x32_bf16 v[128:131],v[108:111],v[108:111],v[128:131]
L_cf_b_q230:
s_cbranch_vccnz L_cf_b_q230x
v_mfma_f32_16x16x32_bf16 v[120:123],v[168:171],v[112:115],v[120:123]
s_waitcnt vmcnt(1)
v_max3_u32 v26,v116,v117,v118
v_mfma_f32_16x16x32_bf16 v[124:127],v[184:187],v[112:115],v[124:127]
v_max_u32 v26,v26,v119
v_cmp_eq_u32 vcc,-1,v26
v_mfma_f32_16x16x32_bf16 v[128:131],v[112:115],v[112:115],v[128:131]
L_cf_b_q30:
s_cbranch_vccnz L_cf_b_q30x
v_mfma_f32_16x16x32_bf16 v[120:123],v[172:175],v[116:119],v[120:123]
s_waitcnt vmcnt(0)
v_max3_u32 v26,v104,v105,v106
v_mfma_f32_16x16x32_bf16 v[124:127],v[188:191],v[116:119],v[124:127]
v_max_u32 v26,v26,v107
v_cmp_eq_u32 vcc,-1,v26
v_mfma_f32_16x16x32_bf16 v[128:131],v[116:119],v[116:119],v[128:131]
L_cf_b_q0:
s_cbranch_vccnz L_cf_b_q0x
v_mfma_f32_16x16x32_bf16 v[120:123],v[160:163],v[104:107],v[120:123]
v_mfma_f32_16x16x32_bf16 v[124:127],v[176:179],v[104:107],v[124:127]
v_mfma_f32_16x16x32_bf16 v[128:131],v[104:107],v[104:107],v[128:131]
s_branch L_cf_b_done
L_cf_b_q123x:
s_mov_b64 exec,vcc
global_load_dwordx4 v[108:111],v4,s[16:17] offset:1024 sc1
s_mov_b64 exec,-1
s_waitcnt vmcnt(2)
v_max3_u32 v26,v112,v113,v114
v_max_u32 v26,v26,v115
v_cmp_eq_u32 vcc,-1,v26
L_cf_b_q231:
s_cbranch_vccnz L_cf_b_q231x
v_mfma_f32_16x16x32_bf16 v[120:123],v[168:171],v[112:115],v[120:123]
s_waitcnt vmcnt(1)
v_max3_u32 v26,v116,v117,v118
v_mfma_f32_16x16x32_bf16 v[124:127],v[184:187],v[112:115],v[124:127]
v_max_u32 v26,v26,v119
v_cmp_eq_u32 vcc,-1,v26
v_mfma_f32_16x16x32_bf16 v[128:131],v[112:115],v[112:115],v[128:131]
L_cf_b_q31:
s_cbranch_vccnz L_cf_b_q31x
v_mfma_f32_16x16x32_bf16 v[120:123],v[172:175],v[116:119],v[120:123]
s_waitcnt vmcnt(0)
v_max3_u32 v26,v108,v109,v110
v_mfma_f32_16x16x32_bf16 v[124:127],v[188:191],v[116:119],v[124:127]
v_max_u32 v26,v26,v111
v_cmp_eq_u32 vcc,-1,v26
v_mfma_f32_16x16x32_bf16 v[128:131],v[116:119],v[116:119],v[128:131]
L_cf_b_q1:
s_cbranch_vccnz L_cf_b_q1x
v_mfma_f32_16x16x32_bf16 v[120:123],v[164:167],v[108:111],v[120:123]
v_mfma_f32_16x16x32_bf16 v[124:127],v[180:183],v[108:111],v[124:127]
v_mfma_f32_16x16x32_bf16 v[128:131],v[108:111],v[108:111],v[128:131]
s_branch L_cf_b_done
L_cf_b_q23x:
s_mov_b64 exec,vcc
global_load_dwordx4 v[112:115],v4,s[16:17] offset:2048 sc1
s_mov_b64 exec,-1
s_waitcnt vmcnt(1)
v_max3_u32 v26,v116,v117,v118
v_max_u32 v26,v26,v119
v_cmp_eq_u32 vcc,-1,v26
L_cf_b_q32:
s_cbranch_vccnz L_cf_b_q32x
v_mfma_f32_16x16x32_bf16 v[120:123],v[172:175],v[116:119],v[120:123]
s_waitcnt vmcnt(0)
v_max3_u32 v26,v112,v113,v114
v_mfma_f32_16x16x32_bf16 v[124:127],v[188:191],v[116:119],v[124:127]
v_max_u32 v26,v26,v115
v_cmp_eq_u32 vcc,-1,v26
v_mfma_f32_16x16x32_bf16 v[128:131],v[116:119],v[116:119],v[128:131]
L_cf_b_q2:
s_cbranch_vccnz L_cf_b_q2x
v_mfma_f32_16x16x32_bf16 v[120:123],v[168:171],v[112:115],v[120:123]
v_mfma_f32_16x16x32_bf16 v[124:127],v[184:187],v[112:115],v[124:127]
v_mfma_f32_16x16x32_bf16 v[128:131],v[112:115],v[112:115],v[128:131]
s_branch L_cf_b_done
L_cf_b_q3x:
s_mov_b64 exec,vcc
global_load_dwordx4 v[116:119],v4,s[16:17] offset:3072 sc1
s_mov_b64 exec,-1
s_sub_u32 s40,s40,1
s_cbranch_scc1 L_chain_bail
s_waitcnt vmcnt(0)
v_max3_u32 v26,v116,v117,v118
v_max_u32 v26,v26,v119
v_cmp_eq_u32 vcc,-1,v26
s_branch L_cf_b_q3
L_cf_b_q1230x:
s_mov_b64 exec,vcc
global_load_dwordx4 v[108:111],v4,s[16:17] offset:1024 sc1
s_mov_b64 exec,-1
s_waitcnt vmcnt(3)
v_max3_u32 v26,v112,v113,v114
v_max_u32 v26,v26,v115
v_cmp_eq_u32 vcc,-1,v26
L_cf_b_q2301:
s_cbranch_vccnz L_cf_b_q2301x
v_mfma_f32_16x16x32_bf16 v[120:123],v[168:171],v[112:115],v[120:123]
s_waitcnt vmcnt(2)
v_max3_u32 v26,v116,v117,v118
v_mfma_f32_16x16x32_bf16 v[124:127],v[184:187],v[112:115],v[124:127]
v_max_u32 v26,v26,v119
v_cmp_eq_u32 vcc,-1,v26
v_mfma_f32_16x16x32_bf16 v[128:131],v[112:115],v[112:115],v[128:131]
L_cf_b_q301:
s_cbranch_vccnz L_cf_b_q301x
v_mfma_f32_16x16x32_bf16 v[120:123],v[172:175],v[116:119],v[120:123]
s_waitcnt vmcnt(1)
v_max3_u32 v26,v104,v105,v106
v_mfma_f32_16x16x32_bf16 v[124:127],v[188:191],v[116:119],v[124:127]
v_max_u32 v26,v26,v107
v_cmp_eq_u32 vcc,-1,v26
v_mfma_f32_16x16x32_bf16 v[128:131],v[116:119],v[116:119],v[128:131]
L_cf_b_q01:
s_cbranch_vccnz L_cf_b_q01x
v_mfma_f32_16x16x32_bf16 v[120:123],v[160:163],v[104:107],v[120:123]
s_waitcnt vmcnt(0)
v_max3_u32 v26,v108,v109,v110
v_mfma_f32_16x16x32_bf16 v[124:127],v[176:179],v[104:107],v[124:127]
v_max_u32 v26,v26,v111
v_cmp_eq_u32 vcc,-1,v26
v_mfma_f32_16x16x32_bf16 v[128:131],v[104:107],v[104:107],v[128:131]
s_branch L_cf_b_q1
L_cf_b_q230x:
s_mov_b64 exec,vcc
global_load_dwordx4 v[112:115],v4,s[16:17] offset:2048 sc1
s_mov_b64 exec,-1
s_waitcnt vmcnt(2)
v_max3_u32 v26,v116,v117,v118
v_max_u32 v26,v26,v119
v_cmp_eq_u32 vcc,-1,v26
L_cf_b_q302:
s_cbranch_vccnz L_cf_b_q302x
v_mfma_f32_16x16x32_bf16 v[120:123],v[172:175],v[116:119],v[120:123]
s_waitcnt vmcnt(1)
v_max3_u32 v26,v104,v105,v106
v_mfma_f32_16x16x32_bf16 v[124:127],v[188:191],v[116:119],v[124:127]
v_max_u32 v26,v26,v107
v_cmp_eq_u32 vcc,-1,v26
v_mfma_f32_16x16x32_bf16 v[128:131],v[116:119],v[116:119],v[128:131]
L_cf_b_q02:
s_cbranch_vccnz L_cf_b_q02x
v_mfma_f32_16x16x32_bf16 v[120:123],v[160:163],v[104:107],v[120:123]
s_waitcnt vmcnt(0)
v_max3_u32 v26,v112,v113,v114
v_mfma_f32_16x16x32_bf16 v[124:127],v[176:179],v[104:107],v[124:127]
v_max_u32 v26,v26,v115
v_cmp_eq_u32 vcc,-1,v26
v_mfma_f32_16x16x32_bf16 v[128:131],v[104:107],v[104:107],v[128:131]
s_branch L_cf_b_q2
L_cf_b_q30x:
s_mov_b64 exec,vcc
global_load_dwordx4 v[116:119],v4,s[16:17] offset:3072 sc1
s_mov_b64 exec,-1
s_sub_u32 s40,s40,1
s_cbranch_scc1 L_chain_bail
s_waitcnt vmcnt(1)
v_max3_u32 v26,v104,v105,v106
v_max_u32 v26,v26,v107
v_cmp_eq_u32 vcc,-1,v26
L_cf_b_q03:
s_cbranch_vccnz L_cf_b_q03x
v_mfma_f32_16x16x32_bf16 v[120:123],v[160:163],v[104:107],v[120:123]
s_waitcnt vmcnt(0)
v_max3_u32 v26,v116,v117,v118
v_mfma_f32_16x16x32_bf16 v[124:127],v[176:179],v[104:107],v[124:127]
v_max_u32 v26,v26,v119
v_cmp_eq_u32 vcc,-1,v26
v_mfma_f32_16x16x32_bf16 v[128:131],v[104:107],v[104:107],v[128:131]
s_branch L_cf_b_q3
L_cf_b_q0x:
s_mov_b64 exec,vcc
global_load_dwordx4 v[104:107],v4,s[16:17] offset:0 sc1
s_mov_b64 exec,-1
s_sub_u32 s40,s40,1
s_cbranch_scc1 L_chain_bail
s_waitcnt vmcnt(0)
v_max3_u32 v26,v104,v105,v106
v_max_u32 v26,v26,v107
v_cmp_eq_u32 vcc,-1,v26
s_branch L_cf_b_q0
L_cf_b_q231x:
s_mov_b64 exec,vcc
global_load_dwordx4 v[112:115],v4,s[16:17] offset:2048 sc1
s_mov_b64 exec,-1
s_waitcnt vmcnt(2)
v_max3_u32 v26,v116,v117,v118
v_max_u32 v26,v26,v119
v_cmp_eq_u32 vcc,-1,v26
L_cf_b_q312:
s_cbranch_vccnz L_cf_b_q312x
v_mfma_f32_16x16x32_bf16 v[120:123],v[172:175],v[116:119],v[120:123]
s_waitcnt vmcnt(1)
v_max3_u32 v26,v108,v109,v110
v_mfma_f32_16x16x32_bf16 v[124:127],v[188:191],v[116:119],v[124:127]
v_max_u32 v26,v26,v111
v_cmp_eq_u32 vcc,-1,v26
v_mfma_f32_16x16x32_bf16 v[128:131],v[116:119],v[116:119],v[128:131]
L_cf_b_q12:
s_cbranch_vccnz L_cf_b_q12x
v_mfma_f32_16x16x32_bf16 v[120:123],v[164:167],v[108:111],v[120:123]
s_waitcnt vmcnt(0)
v_max3_u32 v26,v112,v113,v114
v_mfma_f32_16x16x32_bf16 v[124:127],v[180:183],v[108:111],v[124:127]
v_max_u32 v26,v26,v115
v_cmp_eq_u32 vcc,-1,v26
v_mfma_f32_16x16x32_bf16 v[128:131],v[108:111],v[108:111],v[128:131]
s_branch L_cf_b_q2
L_cf_b_q31x:
s_mov_b64 exec,vcc
global_load_dwordx4 v[116:119],v4,s[16:17] offset:3072 sc1
s_mov_b64 exec,-1
s_sub_u32 s40,s40,1
s_cbranch_scc1 L_chain_bail
s_waitcnt vmcnt(1)
v_max3_u32 v26,v108,v109,v110
v_max_u32 v26,v26,v111
v_cmp_eq_u32 vcc,-1,v26
L_cf_b_q13:
s_cbranch_vccnz L_cf_b_q13x
v_mfma_f32_16x16x32_bf16 v[120:123],v[164:167],v[108:111],v[120:123]
s_waitcnt vmcnt(0)
v_max3_u32 v26,v116,v117,v118
v_mfma_f32_16x16x32_bf16 v[124:127],v[180:183],v[108:111],v[124:127]
v_max_u32 v26,v26,v119
v_cmp_eq_u32 vcc,-1,v26
v_mfma_f32_16x16x32_bf16 v[128:131],v[108:111],v[108:111],v[128:131]
s_branch L_cf_b_q3
L_cf_b_q1x:
s_mov_b64 exec,vcc
global_load_dwordx4 v[108:111],v4,s[16:17] offset:1024 sc1
s_mov_b64 exec,-1
s_sub_u32 s40,s40,1
s_cbranch_scc1 L_chain_bail
s_waitcnt vmcnt(0)
v_max3_u32 v26,v108,v109,v110
v_max_u32 v26,v26,v111
v_cmp_eq_u32 vcc,-1,v26
s_branch L_cf_b_q1
L_cf_b_q32x:
s_mov_b64 exec,vcc
global_load_dwordx4 v[116:119],v4,s[16:17] offset:3072 sc1
s_mov_b64 exec,-1
s_sub_u32 s40,s40,1
s_cbranch_scc1 L_chain_bail
s_waitcnt vmcnt(1)
v_max3_u32 v26,v112,v113,v114
v_max_u32 v26,v26,v115
v_cmp_eq_u32 vcc,-1,v26
s_branch L_cf_b_q23
L_cf_b_q2x:
s_mov_b64 exec,vcc
global_load_dwordx4 v[112:115],v4,s[16:17] offset:2048 sc1
s_mov_b64 exec,-1
s_sub_u32 s40,s40,1
s_cbranch_scc1 L_chain_bail
s_waitcnt vmcnt(0)
v_max3_u32 v26,v112,v113,v114
v_max_u32 v26,v26,v115
v_cmp_eq_u32 vcc,-1,v26
s_branch L_cf_b_q2
L_cf_b_q2301x:
s_mov_b64 exec,vcc
global_load_dwordx4 v[112:115],v4,s[16:17] offset:2048 sc1
s_mov_b64 exec,-1
s_waitcnt vmcnt(3)
v_max3_u32 v26,v116,v117,v118
v_max_u32 v26,v26,v119
v_cmp_eq_u32 vcc,-1,v26
L_cf_b_q3012:
s_cbranch_vccnz L_cf_b_q3012x
v_mfma_f32_16x16x32_bf16 v[120:123],v[172:175],v[116:119],v[120:123]
s_waitcnt vmcnt(2)
v_max3_u32 v26,v104,v105,v106
v_mfma_f32_16x16x32_bf16 v[124:127],v[188:191],v[116:119],v[124:127]
v_max_u32 v26,v26,v107
v_cmp_eq_u32 vcc,-1,v26
v_mfma_f32_16x16x32_bf16 v[128:131],v[116:119],v[116:119],v[128:131]
L_cf_b_q012:
s_cbranch_vccnz L_cf_b_q012x
v_mfma_f32_16x16x32_bf16 v[120:123],v[160:163],v[104:107],v[120:123]
s_waitcnt vmcnt(1)
v_max3_u32 v26,v108,v109,v110
v_mfma_f32_16x16x32_bf16 v[124:127],v[176:179],v[104:107],v[124:127]
v_max_u32 v26,v26,v111
v_cmp_eq_u32 vcc,-1,v26
v_mfma_f32_16x16x32_bf16 v[128:131],v[104:107],v[104:107],v[128:131]
s_branch L_cf_b_q12
L_cf_b_q301x:
s_mov_b64 exec,vcc
global_load_dwordx4 v[116:119],v4,s[16:17] offset:3072 sc1
s_mov_b64 exec,-1
s_sub_u32 s40,s40,1
s_cbranch_scc1 L_chain_bail
s_waitcnt vmcnt(2)
v_max3_u32 v26,v104,v105,v106
v_max_u32 v26,v26,v107
v_cmp_eq_u32 vcc,-1,v26
L_cf_b_q013:
s_cbranch_vccnz L_cf_b_q013x
v_mfma_f32_16x16x32_bf16 v[120:123],v[160:163],v[104:107],v[120:123]
s_waitcnt vmcnt(1)
v_max3_u32 v26,v108,v109,v110
v_mfma_f32_16x16x32_bf16 v[124:127],v[176:179],v[104:107],v[124:127]
v_max_u32 v26,v26,v111
v_cmp_eq_u32 vcc,-1,v26
v_mfma_f32_16x16x32_bf16 v[128:131],v[104:107],v[104:107],v[128:131]
s_branch L_cf_b_q13
L_cf_b_q01x:
s_mov_b64 exec,vcc
global_load_dwordx4 v[104:107],v4,s[16:17] offset:0 sc1
s_mov_b64 exec,-1
s_waitcnt vmcnt(1)
v_max3_u32 v26,v108,v109,v110
v_max_u32 v26,v26,v111
v_cmp_eq_u32 vcc,-1,v26
L_cf_b_q10:
s_cbranch_vccnz L_cf_b_q10x
v_mfma_f32_16x16x32_bf16 v[120:123],v[164:167],v[108:111],v[120:123]
s_waitcnt vmcnt(0)
v_max3_u32 v26,v104,v105,v106
v_mfma_f32_16x16x32_bf16 v[124:127],v[180:183],v[108:111],v[124:127]
v_max_u32 v26,v26,v107
v_cmp_eq_u32 vcc,-1,v26
v_mfma_f32_16x16x32_bf16 v[128:131],v[108:111],v[108:111],v[128:131]
s_branch L_cf_b_q0
L_cf_b_q302x:
s_mov_b64 exec,vcc
global_load_dwordx4 v[116:119],v4,s[16:17] offset:3072 sc1
s_mov_b64 exec,-1
s_sub_u32 s40,s40,1
s_cbranch_scc1 L_chain_bail
s_waitcnt vmcnt(2)
v_max3_u32 v26,v104,v105,v106
v_max_u32 v26,v26,v107
v_cmp_eq_u32 vcc,-1,v26
L_cf_b_q023:
s_cbranch_vccnz L_cf_b_q023x
v_mfma_f32_16x16x32_bf16 v[120:123],v[160:163],v[104:107],v[120:123]
s_waitcnt vmcnt(1)
v_max3_u32 v26,v112,v113,v114
v_mfma_f32_16x16x32_bf16 v[124:127],v[176:179],v[104:107],v[124:127]
v_max_u32 v26,v26,v115
v_cmp_eq_u32 vcc,-1,v26
v_mfma_f32_16x16x32_bf16 v[128:131],v[104:107],v[104:107],v[128:131]
s_branch L_cf_b_q23
L_cf_b_q02x:
s_mov_b64 exec,vcc
global_load_dwordx4 v[104:107],v4,s[16:17] offset:0 sc1
s_mov_b64 exec,-1
s_waitcnt vmcnt(1)
v_max3_u32 v26,v112,v113,v114
v_max_u32 v26,v26,v115
v_cmp_eq_u32 vcc,-1,v26
L_cf_b_q20:
s_cbranch_vccnz L_cf_b_q20x
v_mfma_f32_16x16x32_bf16 v[120:123],v[168:171],v[112:115],v[120:123]
s_waitcnt vmcnt(0)
v_max3_u32 v26,v104,v105,v106
v_mfma_f32_16x16x32_bf16 v[124:127],v[184:187],v[112:115],v[124:127]
v_max_u32 v26,v26,v107
v_cmp_eq_u32 vcc,-1,v26
v_mfma_f32_16x16x32_bf16 v[128:131],v[112:115],v[112:115],v[128:131]
s_branch L_cf_b_q0
L_cf_b_q03x:
s_mov_b64 exec,vcc
global_load_dwordx4 v[104:107],v4,s[16:17] offset:0 sc1
s_mov_b64 exec,-1
s_waitcnt vmcnt(1)
v_max3_u32 v26,v116,v117,v118
v_max_u32 v26,v26,v119
v_cmp_eq_u32 vcc,-1,v26
s_branch L_cf_b_q30
L_cf_b_q312x:
s_mov_b64 exec,vcc
global_load_dwordx4 v[116:119],v4,s[16:17] offset:3072 sc1
s_mov_b64 exec,-1
s_sub_u32 s40,s40,1
s_cbranch_scc1 L_chain_bail
s_waitcnt vmcnt(2)
v_max3_u32 v26,v108,v109,v110
v_max_u32 v26,v26,v111
v_cmp_eq_u32 vcc,-1,v26
s_branch L_cf_b_q123
L_cf_b_q12x:
s_mov_b64 exec,vcc
global_load_dwordx4 v[108:111],v4,s[16:17] offset:1024 sc1
s_mov_b64 exec,-1
s_waitcnt vmcnt(1)
v_max3_u32 v26,v112,v113,v114
v_max_u32 v26,v26,v115
v_cmp_eq_u32 vcc,-1,v26
L_cf_b_q21:
s_cbranch_vccnz L_cf_b_q21x
v_mfma_f32_16x16x32_bf16 v[120:123],v[168:171],v[112:115],v[120:123]
s_waitcnt vmcnt(0)
v_max3_u32 v26,v108,v109,v110
v_mfma_f32_16x16x32_bf16 v[124:127],v[184:187],v[112:115],v[124:127]
v_max_u32 v26,v26,v111
v_cmp_eq_u32 vcc,-1,v26
v_mfma_f32_16x16x32_bf16 v[128:131],v[112:115],v[112:115],v[128:131]
s_branch L_cf_b_q1
L_cf_b_q13x:
s_mov_b64 exec,vcc
global_load_dwordx4 v[108:111],v4,s[16:17] offset:1024 sc1
s_mov_b64 exec,-1
s_waitcnt vmcnt(1)
v_max3_u32 v26,v116,v117,v118
v_max_u32 v26,v26,v119
v_cmp_eq_u32 vcc,-1,v26
s_branch L_cf_b_q31
L_cf_b_q3012x:
s_mov_b64 exec,vcc
global_load_dwordx4 v[116:119],v4,s[16:17] offset:3072 sc1
s_mov_b64 exec,-1
s_sub_u32 s40,s40,1
s_cbranch_scc1 L_chain_bail
s_waitcnt vmcnt(3)
v_max3_u32 v26,v104,v105,v106
v_max_u32 v26,v26,v107
v_cmp_eq_u32 vcc,-1,v26
s_branch L_cf_b_q0123
L_cf_b_q012x:
s_mov_b64 exec,vcc
global_load_dwordx4 v[104:107],v4,s[16:17] offset:0 sc1
s_mov_b64 exec,-1
s_waitcnt vmcnt(2)
v_max3_u32 v26,v108,v109,v110
v_max_u32 v26,v26,v111
v_cmp_eq_u32 vcc,-1,v26
L_cf_b_q120:
s_cbranch_vccnz L_cf_b_q120x
v_mfma_f32_16x16x32_bf16 v[120:123],v[164:167],v[108:111],v[120:123]
s_waitcnt vmcnt(1)
v_max3_u32 v26,v112,v113,v114
v_mfma_f32_16x16x32_bf16 v[124:127],v[180:183],v[108:111],v[124:127]
v_max_u32 v26,v26,v115
v_cmp_eq_u32 vcc,-1,v26
v_mfma_f32_16x16x32_bf16 v[128:131],v[108:111],v[108:111],v[128:131]
s_branch L_cf_b_q20
L_cf_b_q013x:
s_mov_b64 exec,vcc
global_load_dwordx4 v[104:107],v4,s[16:17] offset:0 sc1
s_mov_b64 exec,-1
s_waitcnt vmcnt(2)
v_max3_u32 v26,v108,v109,v110
v_max_u32 v26,v26,v111
v_cmp_eq_u32 vcc,-1,v26
L_cf_b_q130:
s_cbranch_vccnz L_cf_b_q130x
v_mfma_f32_16x16x32_bf16 v[120:123],v[164:167],v[108:111],v[120:123]
s_waitcnt vmcnt(1)
v_max3_u32 v26,v116,v117,v118
v_mfma_f32_16x16x32_bf16 v[124:127],v[180:183],v[108:111],v[124:127]
v_max_u32 v26,v26,v119
v_cmp_eq_u32 vcc,-1,v26
v_mfma_f32_16x16x32_bf16 v[128:131],v[108:111],v[108:111],v[128:131]
s_branch L_cf_b_q30
L_cf_b_q10x:
s_mov_b64 exec,vcc
global_load_dwordx4 v[108:111],v4,s[16:17] offset:1024 sc1
s_mov_b64 exec,-1
s_sub_u32 s40,s40,1
s_cbranch_scc1 L_chain_bail
s_waitcnt vmcnt(1)
v_max3_u32 v26,v104,v105,v106
v_max_u32 v26,v26,v107
v_cmp_eq_u32 vcc,-1,v26
s_branch L_cf_b_q01
L_cf_b_q023x:
s_mov_b64 exec,vcc
global_load_dwordx4 v[104:107],v4,s[16:17] offset:0 sc1
s_mov_b64 exec,-1
s_waitcnt vmcnt(2)
v_max3_u32 v26,v112,v113,v114
v_max_u32 v26,v26,v115
v_cmp_eq_u32 vcc,-1,v26
s_branch L_cf_b_q230
L_cf_b_q20x:
s_mov_b64 exec,vcc
global_load_dwordx4 v[112:115],v4,s[16:17] offset:2048 sc1
s_mov_b64 exec,-1
s_sub_u32 s40,s40,1
s_cbranch_scc1 L_chain_bail
s_waitcnt vmcnt(1)
v_max3_u32 v26,v104,v105,v106
v_max_u32 v26,v26,v107
v_cmp_eq_u32 vcc,-1,v26
s_branch L_cf_b_q02
L_cf_b_q21x:
s_mov_b64 exec,vcc
global_load_dwordx4 v[112:115],v4,s[16:17] offset:2048 sc1
s_mov_b64 exec,-1
s_sub_u32 s40,s40,1
s_cbranch_scc1 L_chain_bail
s_waitcnt vmcnt(1)
v_max3_u32 v26,v108,v109,v110
v_max_u32 v26,v26,v111
v_cmp_eq_u32 vcc,-1,v26
s_branch L_cf_b_q12
L_cf_b_q120x:
s_mov_b64 exec,vcc
global_load_dwordx4 v[108:111],v4,s[16:17] offset:1024 sc1
s_mov_b64 exec,-1
s_waitcnt vmcnt(2)
v_max3_u32 v26,v112,v113,v114
v_max_u32 v26,v26,v115
v_cmp_eq_u32 vcc,-1,v26
L_cf_b_q201:
s_cbranch_vccnz L_cf_b_q201x
v_mfma_f32_16x16x32_bf16 v[120:123],v[168:171],v[112:115],v[120:123]
s_waitcnt vmcnt(1)
v_max3_u32 v26,v104,v105,v106
v_mfma_f32_16x16x32_bf16 v[124:127],v[184:187],v[112:115],v[124:127]
v_max_u32 v26,v26,v107
v_cmp_eq_u32 vcc,-1,v26
v_mfma_f32_16x16x32_bf16 v[128:131],v[112:115],v[112:115],v[128:131]
s_branch L_cf_b_q01
L_cf_b_q130x:
s_mov_b64 exec,vcc
global_load_dwordx4 v[108:111],v4,s[16:17] offset:1024 sc1
s_mov_b64 exec,-1
s_waitcnt vmcnt(2)
v_max3_u32 v26,v116,v117,v118
v_max_u32 v26,v26,v119
v_cmp_eq_u32 vcc,-1,v26
s_branch L_cf_b_q301
L_cf_b_q201x:
s_mov_b64 exec,vcc
global_load_dwordx4 v[112:115],v4,s[16:17] offset:2048 sc1
s_mov_b64 exec,-1
s_sub_u32 s40,s40,1
s_cbranch_scc1 L_chain_bail
s_waitcnt vmcnt(2)
v_max3_u32 v26,v104,v105,v106
v_max_u32 v26,v26,v107
v_cmp_eq_u32 vcc,-1,v26
s_branch L_cf_b_q012
L_cf_o_q0123x:
s_mov_b64 exec,vcc
global_load_dwordx4 v[40:43],v2,s[16:17] offset:0 sc1
s_mov_b64 exec,-1
s_waitcnt vmcnt(3)
v_max3_u32 v26,v44,v45,v46
v_max_u32 v26,v26,v47
v_cmp_eq_u32 vcc,-1,v26
L_cf_o_q1230:
s_cbranch_vccnz L_cf_o_q1230x
v_smfmac_f32_16x16x64_bf16 v[80:83],v[44:47],a[200:207],v21
s_waitcnt vmcnt(2)
v_max3_u32 v26,v48,v49,v50
v_max_u32 v26,v26,v51
v_cmp_eq_u32 vcc,-1,v26
v_smfmac_f32_16x16x64_bf16 v[84:87],v[44:47],a[232:239],v21
L_cf_o_q230:
s_cbranch_vccnz L_cf_o_q230x
v_smfmac_f32_16x16x64_bf16 v[80:83],v[48:51],a[208:215],v21
s_waitcnt vmcnt(1)
v_max3_u32 v26,v52,v53,v54
v_max_u32 v26,v26,v55
v_cmp_eq_u32 vcc,-1,v26
v_smfmac_f32_16x16x64_bf16 v[84:87],v[48:51],a[240:247],v21
L_cf_o_q30:
s_cbranch_vccnz L_cf_o_q30x
v_smfmac_f32_16x16x64_bf16 v[80:83],v[52:55],a[216:223],v21
s_waitcnt vmcnt(0)
v_max3_u32 v26,v40,v41,v42
v_max_u32 v26,v26,v43
v_cmp_eq_u32 vcc,-1,v26
v_smfmac_f32_16x16x64_bf16 v[84:87],v[52:55],a[248:255],v21
L_cf_o_q0:
s_cbranch_vccnz L_cf_o_q0x
v_smfmac_f32_16x16x64_bf16 v[80:83],v[40:43],a[192:199],v21
v_smfmac_f32_16x16x64_bf16 v[84:87],v[40:43],a[224:231],v21
s_branch L_cf_o_done
L_cf_o_q123x:
s_mov_b64 exec,vcc
global_load_dwordx4 v[44:47],v2,s[16:17] offset:1024 sc1
s_mov_b64 exec,-1
s_waitcnt vmcnt(2)
v_max3_u32 v26,v48,v49,v50
v_max_u32 v26,v26,v51
v_cmp_eq_u32 vcc,-1,v26
L_cf_o_q231:
s_cbranch_vccnz L_cf_o_q231x
v_smfmac_f32_16x16x64_bf16 v[80:83],v[48:51],a[208:215],v21
s_waitcnt vmcnt(1)
v_max3_u32 v26,v52,v53,v54
v_max_u32 v26,v26,v55
v_cmp_eq_u32 vcc,-1,v26
v_smfmac_f32_16x16x64_bf16 v[84:87],v[48:51],a[240:247],v21
L_cf_o_q31:
s_cbranch_vccnz L_cf_o_q31x
v_smfmac_f32_16x16x64_bf16 v[80:83],v[52:55],a[216:223],v21
s_waitcnt vmcnt(0)
v_max3_u32 v26,v44,v45,v46
v_max_u32 v26,v26,v47
v_cmp_eq_u32 vcc,-1,v26
v_smfmac_f32_16x16x64_bf16 v[84:87],v[52:55],a[248:255],v21
L_cf_o_q1:
s_cbranch_vccnz L_cf_o_q1x
v_smfmac_f32_16x16x64_bf16 v[80:83],v[44:47],a[200:207],v21
v_smfmac_f32_16x16x64_bf16 v[84:87],v[44:47],a[232:239],v21
s_branch L_cf_o_done
L_cf_o_q23x:
s_mov_b64 exec,vcc
global_load_dwordx4 v[48:51],v2,s[16:17] offset:2048 sc1
s_mov_b64 exec,-1
s_waitcnt vmcnt(1)
v_max3_u32 v26,v52,v53,v54
v_max_u32 v26,v26,v55
v_cmp_eq_u32 vcc,-1,v26
L_cf_o_q32:
s_cbranch_vccnz L_cf_o_q32x
v_smfmac_f32_16x16x64_bf16 v[80:83],v[52:55],a[216:223],v21
s_waitcnt vmcnt(0)
v_max3_u32 v26,v48,v49,v50
v_max_u32 v26,v26,v51
v_cmp_eq_u32 vcc,-1,v26
v_smfmac_f32_16x16x64_bf16 v[84:87],v[52:55],a[248:255],v21
L_cf_o_q2:
s_cbranch_vccnz L_cf_o_q2x
v_smfmac_f32_16x16x64_bf16 v[80:83],v[48:51],a[208:215],v21
v_smfmac_f32_16x16x64_bf16 v[84:87],v[48:51],a[240:247],v21
s_branch L_cf_o_done
L_cf_o_q3x:
s_mov_b64 exec,vcc
global_load_dwordx4 v[52:55],v2,s[16:17] offset:3072 sc1
s_mov_b64 exec,-1
s_sub_u32 s40,s40,1
s_cbranch_scc1 L_chain_bail
s_waitcnt vmcnt(0)
v_max3_u32 v26,v52,v53,v54
v_max_u32 v26,v26,v55
v_cmp_eq_u32 vcc,-1,v26
s_branch L_cf_o_q3
L_cf_o_q1230x:
s_mov_b64 exec,vcc
global_load_dwordx4 v[44:47],v2,s[16:17] offset:1024 sc1
s_mov_b64 exec,-1
s_waitcnt vmcnt(3)
v_max3_u32 v26,v48,v49,v50
v_max_u32 v26,v26,v51
v_cmp_eq_u32 vcc,-1,v26
L_cf_o_q2301:
s_cbranch_vccnz L_cf_o_q2301x
v_smfmac_f32_16x16x64_bf16 v[80:83],v[48:51],a[208:215],v21
s_waitcnt vmcnt(2)
v_max3_u32 v26,v52,v53,v54
v_max_u32 v26,v26,v55
v_cmp_eq_u32 vcc,-1,v26
v_smfmac_f32_16x16x64_bf16 v[84:87],v[48:51],a[240:247],v21
L_cf_o_q301:
s_cbranch_vccnz L_cf_o_q301x
v_smfmac_f32_16x16x64_bf16 v[80:83],v[52:55],a[216:223],v21
s_waitcnt vmcnt(1)
v_max3_u32 v26,v40,v41,v42
v_max_u32 v26,v26,v43
v_cmp_eq_u32 vcc,-1,v26
v_smfmac_f32_16x16x64_bf16 v[84:87],v[52:55],a[248:255],v21
L_cf_o_q01:
s_cbranch_vccnz L_cf_o_q01x
v_smfmac_f32_16x16x64_bf16 v[80:83],v[40:43],a[192:199],v21
s_waitcnt vmcnt(0)
v_max3_u32 v26,v44,v45,v46
v_max_u32 v26,v26,v47
v_cmp_eq_u32 vcc,-1,v26
v_smfmac_f32_16x16x64_bf16 v[84:87],v[40:43],a[224:231],v21
s_branch L_cf_o_q1
L_cf_o_q230x:
s_mov_b64 exec,vcc
global_load_dwordx4 v[48:51],v2,s[16:17] offset:2048 sc1
s_mov_b64 exec,-1
s_waitcnt vmcnt(2)
v_max3_u32 v26,v52,v53,v54
v_max_u32 v26,v26,v55
v_cmp_eq_u32 vcc,-1,v26
L_cf_o_q302:
s_cbranch_vccnz L_cf_o_q302x
v_smfmac_f32_16x16x64_bf16 v[80:83],v[52:55],a[216:223],v21
s_waitcnt vmcnt(1)
v_max3_u32 v26,v40,v41,v42
v_max_u32 v26,v26,v43
v_cmp_eq_u32 vcc,-1,v26
v_smfmac_f32_16x16x64_bf16 v[84:87],v[52:55],a[248:255],v21
L_cf_o_q02:
s_cbranch_vccnz L_cf_o_q02x
v_smfmac_f32_16x16x64_bf16 v[80:83],v[40:43],a[192:199],v21
s_waitcnt vmcnt(0)
v_max3_u32 v26,v48,v49,v50
v_max_u32 v26,v26,v51
v_cmp_eq_u32 vcc,-1,v26
v_smfmac_f32_16x16x64_bf16 v[84:87],v[40:43],a[224:231],v21
s_branch L_cf_o_q2
L_cf_o_q30x:
s_mov_b64 exec,vcc
global_load_dwordx4 v[52:55],v2,s[16:17] offset:3072 sc1
s_mov_b64 exec,-1
s_sub_u32 s40,s40,1
s_cbranch_scc1 L_chain_bail
s_waitcnt vmcnt(1)
v_max3_u32 v26,v40,v41,v42
v_max_u32 v26,v26,v43
v_cmp_eq_u32 vcc,-1,v26
L_cf_o_q03:
s_cbranch_vccnz L_cf_o_q03x
v_smfmac_f32_16x16x64_bf16 v[80:83],v[40:43],a[192:199],v21
s_waitcnt vmcnt(0)
v_max3_u32 v26,v52,v53,v54
v_max_u32 v26,v26,v55
v_cmp_eq_u32 vcc,-1,v26
v_smfmac_f32_16x16x64_bf16 v[84:87],v[40:43],a[224:231],v21
s_branch L_cf_o_q3
L_cf_o_q0x:
s_mov_b64 exec,vcc
global_load_dwordx4 v[40:43],v2,s[16:17] offset:0 sc1
s_mov_b64 exec,-1
s_sub_u32 s40,s40,1
s_cbranch_scc1 L_chain_bail
s_waitcnt vmcnt(0)
v_max3_u32 v26,v40,v41,v42
v_max_u32 v26,v26,v43
v_cmp_eq_u32 vcc,-1,v26
s_branch L_cf_o_q0
L_cf_o_q231x:
s_mov_b64 exec,vcc
global_load_dwordx4 v[48:51],v2,s[16:17] offset:2048 sc1
s_mov_b64 exec,-1
s_waitcnt vmcnt(2)
v_max3_u32 v26,v52,v53,v54
v_max_u32 v26,v26,v55
v_cmp_eq_u32 vcc,-1,v26
L_cf_o_q312:
s_cbranch_vccnz L_cf_o_q312x
v_smfmac_f32_16x16x64_bf16 v[80:83],v[52:55],a[216:223],v21
s_waitcnt vmcnt(1)
v_max3_u32 v26,v44,v45,v46
v_max_u32 v26,v26,v47
v_cmp_eq_u32 vcc,-1,v26
v_smfmac_f32_16x16x64_bf16 v[84:87],v[52:55],a[248:255],v21
L_cf_o_q12:
s_cbranch_vccnz L_cf_o_q12x
v_smfmac_f32_16x16x64_bf16 v[80:83],v[44:47],a[200:207],v21
s_waitcnt vmcnt(0)
v_max3_u32 v26,v48,v49,v50
v_max_u32 v26,v26,v51
v_cmp_eq_u32 vcc,-1,v26
v_smfmac_f32_16x16x64_bf16 v[84:87],v[44:47],a[232:239],v21
s_branch L_cf_o_q2
L_cf_o_q31x:
s_mov_b64 exec,vcc
global_load_dwordx4 v[52:55],v2,s[16:17] offset:3072 sc1
s_mov_b64 exec,-1
s_sub_u32 s40,s40,1
s_cbranch_scc1 L_chain_bail
s_waitcnt vmcnt(1)
v_max3_u32 v26,v44,v45,v46
v_max_u32 v26,v26,v47
v_cmp_eq_u32 vcc,-1,v26
L_cf_o_q13:
s_cbranch_vccnz L_cf_o_q13x
v_smfmac_f32_16x16x64_bf16 v[80:83],v[44:47],a[200:207],v21
s_waitcnt vmcnt(0)
v_max3_u32 v26,v52,v53,v54
v_max_u32 v26,v26,v55
v_cmp_eq_u32 vcc,-1,v26
v_smfmac_f32_16x16x64_bf16 v[84:87],v[44:47],a[232:239],v21
s_branch L_cf_o_q3
L_cf_o_q1x:
s_mov_b64 exec,vcc
global_load_dwordx4 v[44:47],v2,s[16:17] offset:1024 sc1
s_mov_b64 exec,-1
s_sub_u32 s40,s40,1
s_cbranch_scc1 L_chain_bail
s_waitcnt vmcnt(0)
v_max3_u32 v26,v44,v45,v46
v_max_u32 v26,v26,v47
v_cmp_eq_u32 vcc,-1,v26
s_branch L_cf_o_q1
L_cf_o_q32x:
s_mov_b64 exec,vcc
global_load_dwordx4 v[52:55],v2,s[16:17] offset:3072 sc1
s_mov_b64 exec,-1
s_sub_u32 s40,s40,1
s_cbranch_scc1 L_chain_bail
s_waitcnt vmcnt(1)
v_max3_u32 v26,v48,v49,v50
v_max_u32 v26,v26,v51
v_cmp_eq_u32 vcc,-1,v26
s_branch L_cf_o_q23
L_cf_o_q2x:
s_mov_b64 exec,vcc
global_load_dwordx4 v[48:51],v2,s[16:17] offset:2048 sc1
s_mov_b64 exec,-1
s_sub_u32 s40,s40,1
s_cbranch_scc1 L_chain_bail
s_waitcnt vmcnt(0)
v_max3_u32 v26,v48,v49,v50
v_max_u32 v26,v26,v51
v_cmp_eq_u32 vcc,-1,v26
s_branch L_cf_o_q2
L_cf_o_q2301x:
s_mov_b64 exec,vcc
global_load_dwordx4 v[48:51],v2,s[16:17] offset:2048 sc1
s_mov_b64 exec,-1
s_waitcnt vmcnt(3)
v_max3_u32 v26,v52,v53,v54
v_max_u32 v26,v26,v55
v_cmp_eq_u32 vcc,-1,v26
L_cf_o_q3012:
s_cbranch_vccnz L_cf_o_q3012x
v_smfmac_f32_16x16x64_bf16 v[80:83],v[52:55],a[216:223],v21
s_waitcnt vmcnt(2)
v_max3_u32 v26,v40,v41,v42
v_max_u32 v26,v26,v43
v_cmp_eq_u32 vcc,-1,v26
v_smfmac_f32_16x16x64_bf16 v[84:87],v[52:55],a[248:255],v21
L_cf_o_q012:
s_cbranch_vccnz L_cf_o_q012x
v_smfmac_f32_16x16x64_bf16 v[80:83],v[40:43],a[192:199],v21
s_waitcnt vmcnt(1)
v_max3_u32 v26,v44,v45,v46
v_max_u32 v26,v26,v47
v_cmp_eq_u32 vcc,-1,v26
v_smfmac_f32_16x16x64_bf16 v[84:87],v[40:43],a[224:231],v21
s_branch L_cf_o_q12
L_cf_o_q301x:
s_mov_b64 exec,vcc
global_load_dwordx4 v[52:55],v2,s[16:17] offset:3072 sc1
s_mov_b64 exec,-1
s_sub_u32 s40,s40,1
s_cbranch_scc1 L_chain_bail
s_waitcnt vmcnt(2)
v_max3_u32 v26,v40,v41,v42
v_max_u32 v26,v26,v43
v_cmp_eq_u32 vcc,-1,v26
L_cf_o_q013:
s_cbranch_vccnz L_cf_o_q013x
v_smfmac_f32_16x16x64_bf16 v[80:83],v[40:43],a[192:199],v21
s_waitcnt vmcnt(1)
v_max3_u32 v26,v44,v45,v46
v_max_u32 v26,v26,v47
v_cmp_eq_u32 vcc,-1,v26
v_smfmac_f32_16x16x64_bf16 v[84:87],v[40:43],a[224:231],v21
s_branch L_cf_o_q13
L_cf_o_q01x:
s_mov_b64 exec,vcc
global_load_dwordx4 v[40:43],v2,s[16:17] offset:0 sc1
s_mov_b64 exec,-1
s_waitcnt vmcnt(1)
v_max3_u32 v26,v44,v45,v46
v_max_u32 v26,v26,v47
v_cmp_eq_u32 vcc,-1,v26
L_cf_o_q10:
s_cbranch_vccnz L_cf_o_q10x
v_smfmac_f32_16x16x64_bf16 v[80:83],v[44:47],a[200:207],v21
s_waitcnt vmcnt(0)
v_max3_u32 v26,v40,v41,v42
v_max_u32 v26,v26,v43
v_cmp_eq_u32 vcc,-1,v26
v_smfmac_f32_16x16x64_bf16 v[84:87],v[44:47],a[232:239],v21
s_branch L_cf_o_q0
L_cf_o_q302x:
s_mov_b64 exec,vcc
global_load_dwordx4 v[52:55],v2,s[16:17] offset:3072 sc1
s_mov_b64 exec,-1
s_sub_u32 s40,s40,1
s_cbranch_scc1 L_chain_bail
s_waitcnt vmcnt(2)
v_max3_u32 v26,v40,v41,v42
v_max_u32 v26,v26,v43
v_cmp_eq_u32 vcc,-1,v26
L_cf_o_q023:
s_cbranch_vccnz L_cf_o_q023x
v_smfmac_f32_16x16x64_bf16 v[80:83],v[40:43],a[192:199],v21
s_waitcnt vmcnt(1)
v_max3_u32 v26,v48,v49,v50
v_max_u32 v26,v26,v51
v_cmp_eq_u32 vcc,-1,v26
v_smfmac_f32_16x16x64_bf16 v[84:87],v[40:43],a[224:231],v21
s_branch L_cf_o_q23
L_cf_o_q02x:
s_mov_b64 exec,vcc
global_load_dwordx4 v[40:43],v2,s[16:17] offset:0 sc1
s_mov_b64 exec,-1
s_waitcnt vmcnt(1)
v_max3_u32 v26,v48,v49,v50
v_max_u32 v26,v26,v51
v_cmp_eq_u32 vcc,-1,v26
L_cf_o_q20:
s_cbranch_vccnz L_cf_o_q20x
v_smfmac_f32_16x16x64_bf16 v[80:83],v[48:51],a[208:215],v21
s_waitcnt vmcnt(0)
v_max3_u32 v26,v40,v41,v42
v_max_u32 v26,v26,v43
v_cmp_eq_u32 vcc,-1,v26
v_smfmac_f32_16x16x64_bf16 v[84:87],v[48:51],a[240:247],v21
s_branch L_cf_o_q0
L_cf_o_q03x:
s_mov_b64 exec,vcc
global_load_dwordx4 v[40:43],v2,s[16:17] offset:0 sc1
s_mov_b64 exec,-1
s_waitcnt vmcnt(1)
v_max3_u32 v26,v52,v53,v54
v_max_u32 v26,v26,v55
v_cmp_eq_u32 vcc,-1,v26
s_branch L_cf_o_q30
L_cf_o_q312x:
s_mov_b64 exec,vcc
global_load_dwordx4 v[52:55],v2,s[16:17] offset:3072 sc1
s_mov_b64 exec,-1
s_sub_u32 s40,s40,1
s_cbranch_scc1 L_chain_bail
s_waitcnt vmcnt(2)
v_max3_u32 v26,v44,v45,v46
v_max_u32 v26,v26,v47
v_cmp_eq_u32 vcc,-1,v26
s_branch L_cf_o_q123
L_cf_o_q12x:
s_mov_b64 exec,vcc
global_load_dwordx4 v[44:47],v2,s[16:17] offset:1024 sc1
s_mov_b64 exec,-1
s_waitcnt vmcnt(1)
v_max3_u32 v26,v48,v49,v50
v_max_u32 v26,v26,v51
v_cmp_eq_u32 vcc,-1,v26
L_cf_o_q21:
s_cbranch_vccnz L_cf_o_q21x
v_smfmac_f32_16x16x64_bf16 v[80:83],v[48:51],a[208:215],v21
s_waitcnt vmcnt(0)
v_max3_u32 v26,v44,v45,v46
v_max_u32 v26,v26,v47
v_cmp_eq_u32 vcc,-1,v26
v_smfmac_f32_16x16x64_bf16 v[84:87],v[48:51],a[240:247],v21
s_branch L_cf_o_q1
L_cf_o_q13x:
s_mov_b64 exec,vcc
global_load_dwordx4 v[44:47],v2,s[16:17] offset:1024 sc1
s_mov_b64 exec,-1
s_waitcnt vmcnt(1)
v_max3_u32 v26,v52,v53,v54
v_max_u32 v26,v26,v55
v_cmp_eq_u32 vcc,-1,v26
s_branch L_cf_o_q31
L_cf_o_q3012x:
s_mov_b64 exec,vcc
global_load_dwordx4 v[52:55],v2,s[16:17] offset:3072 sc1
s_mov_b64 exec,-1
s_sub_u32 s40,s40,1
s_cbranch_scc1 L_chain_bail
s_waitcnt vmcnt(3)
v_max3_u32 v26,v40,v41,v42
v_max_u32 v26,v26,v43
v_cmp_eq_u32 vcc,-1,v26
s_branch L_cf_o_q0123
L_cf_o_q012x:
s_mov_b64 exec,vcc
global_load_dwordx4 v[40:43],v2,s[16:17] offset:0 sc1
s_mov_b64 exec,-1
s_waitcnt vmcnt(2)
v_max3_u32 v26,v44,v45,v46
v_max_u32 v26,v26,v47
v_cmp_eq_u32 vcc,-1,v26
L_cf_o_q120:
s_cbranch_vccnz L_cf_o_q120x
v_smfmac_f32_16x16x64_bf16 v[80:83],v[44:47],a[200:207],v21
s_waitcnt vmcnt(1)
v_max3_u32 v26,v48,v49,v50
v_max_u32 v26,v26,v51
v_cmp_eq_u32 vcc,-1,v26
v_smfmac_f32_16x16x64_bf16 v[84:87],v[44:47],a[232:239],v21
s_branch L_cf_o_q20
L_cf_o_q013x:
s_mov_b64 exec,vcc
global_load_dwordx4 v[40:43],v2,s[16:17] offset:0 sc1
s_mov_b64 exec,-1
s_waitcnt vmcnt(2)
v_max3_u32 v26,v44,v45,v46
v_max_u32 v26,v26,v47
v_cmp_eq_u32 vcc,-1,v26
L_cf_o_q130:
s_cbranch_vccnz L_cf_o_q130x
v_smfmac_f32_16x16x64_bf16 v[80:83],v[44:47],a[200:207],v21
s_waitcnt vmcnt(1)
v_max3_u32 v26,v52,v53,v54
v_max_u32 v26,v26,v55
v_cmp_eq_u32 vcc,-1,v26
v_smfmac_f32_16x16x64_bf16 v[84:87],v[44:47],a[232:239],v21
s_branch L_cf_o_q30
L_cf_o_q10x:
s_mov_b64 exec,vcc
global_load_dwordx4 v[44:47],v2,s[16:17] offset:1024 sc1
s_mov_b64 exec,-1
s_sub_u32 s40,s40,1
s_cbranch_scc1 L_chain_bail
s_waitcnt vmcnt(1)
v_max3_u32 v26,v40,v41,v42
v_max_u32 v26,v26,v43
v_cmp_eq_u32 vcc,-1,v26
s_branch L_cf_o_q01
L_cf_o_q023x:
s_mov_b64 exec,vcc
global_load_dwordx4 v[40:43],v2,s[16:17] offset:0 sc1
s_mov_b64 exec,-1
s_waitcnt vmcnt(2)
v_max3_u32 v26,v48,v49,v50
v_max_u32 v26,v26,v51
v_cmp_eq_u32 vcc,-1,v26
s_branch L_cf_o_q230
L_cf_o_q20x:
s_mov_b64 exec,vcc
global_load_dwordx4 v[48:51],v2,s[16:17] offset:2048 sc1
s_mov_b64 exec,-1
s_sub_u32 s40,s40,1
s_cbranch_scc1 L_chain_bail
s_waitcnt vmcnt(1)
v_max3_u32 v26,v40,v41,v42
v_max_u32 v26,v26,v43
v_cmp_eq_u32 vcc,-1,v26
s_branch L_cf_o_q02
L_cf_o_q21x:
s_mov_b64 exec,vcc
global_load_dwordx4 v[48:51],v2,s[16:17] offset:2048 sc1
s_mov_b64 exec,-1
s_sub_u32 s40,s40,1
s_cbranch_scc1 L_chain_bail
s_waitcnt vmcnt(1)
v_max3_u32 v26,v44,v45,v46
v_max_u32 v26,v26,v47
v_cmp_eq_u32 vcc,-1,v26
s_branch L_cf_o_q12
L_cf_o_q120x:
s_mov_b64 exec,vcc
global_load_dwordx4 v[44:47],v2,s[16:17] offset:1024 sc1
s_mov_b64 exec,-1
s_waitcnt vmcnt(2)
v_max3_u32 v26,v48,v49,v50
v_max_u32 v26,v26,v51
v_cmp_eq_u32 vcc,-1,v26
L_cf_o_q201:
s_cbranch_vccnz L_cf_o_q201x
v_smfmac_f32_16x16x64_bf16 v[80:83],v[48:51],a[208:215],v21
s_waitcnt vmcnt(1)
v_max3_u32 v26,v40,v41,v42
v_max_u32 v26,v26,v43
v_cmp_eq_u32 vcc,-1,v26
v_smfmac_f32_16x16x64_bf16 v[84:87],v[48:51],a[240:247],v21
s_branch L_cf_o_q01
L_cf_o_q130x:
s_mov_b64 exec,vcc
global_load_dwordx4 v[44:47],v2,s[16:17] offset:1024 sc1
s_mov_b64 exec,-1
s_waitcnt vmcnt(2)
v_max3_u32 v26,v52,v53,v54
v_max_u32 v26,v26,v55
v_cmp_eq_u32 vcc,-1,v26
s_branch L_cf_o_q301
L_cf_o_q201x:
s_mov_b64 exec,vcc
global_load_dwordx4 v[48:51],v2,s[16:17] offset:2048 sc1
s_mov_b64 exec,-1
s_sub_u32 s40,s40,1
s_cbranch_scc1 L_chain_bail
s_waitcnt vmcnt(2)
v_max3_u32 v26,v40,v41,v42
v_max_u32 v26,v26,v43
v_cmp_eq_u32 vcc,-1,v26
s_branch L_cf_o_q012
L_cf_c_q012x:
s_mov_b64 exec,vcc
global_load_dwordx4 v[120:123],v7,s[62:63] sc1
s_mov_b64 exec,-1
s_waitcnt vmcnt(2)
v_max3_u32 v26,v124,v125,v126
v_max_u32 v26,v26,v127
v_cmp_eq_u32 vcc,-1,v26
L_cf_c_q120:
s_cbranch_vccnz L_cf_c_q120x
s_waitcnt vmcnt(1)
v_max3_u32 v26,v128,v129,v130
v_max_u32 v26,v26,v131
v_cmp_eq_u32 vcc,-1,v26
L_cf_c_q20:
s_cbranch_vccnz L_cf_c_q20x
s_waitcnt vmcnt(0)
v_max3_u32 v26,v120,v121,v122
v_max_u32 v26,v26,v123
v_cmp_eq_u32 vcc,-1,v26
L_cf_c_q0:
s_cbranch_vccnz L_cf_c_q0x
v_pk_add_f32 v[88:89],v[88:89],v[120:121]
v_pk_add_f32 v[90:91],v[90:91],v[122:123]
s_branch L_cf_c_done
L_cf_c_q12x:
s_mov_b64 exec,vcc
global_load_dwordx4 v[124:127],v8,s[62:63] sc1
s_mov_b64 exec,-1
s_waitcnt vmcnt(1)
v_max3_u32 v26,v128,v129,v130
v_max_u32 v26,v26,v131
v_cmp_eq_u32 vcc,-1,v26
L_cf_c_q21:
s_cbranch_vccnz L_cf_c_q21x
s_waitcnt vmcnt(0)
v_max3_u32 v26,v124,v125,v126
v_max_u32 v26,v26,v127
v_cmp_eq_u32 vcc,-1,v26
L_cf_c_q1:
s_cbranch_vccnz L_cf_c_q1x
s_branch L_cf_c_done
L_cf_c_q2x:
s_mov_b64 exec,vcc
global_load_dwordx4 v[128:131],v9,s[62:63] sc1
s_mov_b64 exec,-1
s_sub_u32 s40,s40,1
s_cbranch_scc1 L_chain_bail
s_waitcnt vmcnt(0)
v_max3_u32 v26,v128,v129,v130
v_max_u32 v26,v26,v131
v_cmp_eq_u32 vcc,-1,v26
s_branch L_cf_c_q2
L_cf_c_q120x:
s_mov_b64 exec,vcc
global_load_dwordx4 v[124:127],v8,s[62:63] sc1
s_mov_b64 exec,-1
s_waitcnt vmcnt(2)
v_max3_u32 v26,v128,v129,v130
v_max_u32 v26,v26,v131
v_cmp_eq_u32 vcc,-1,v26
L_cf_c_q201:
s_cbranch_vccnz L_cf_c_q201x
s_waitcnt vmcnt(1)
v_max3_u32 v26,v120,v121,v122
v_max_u32 v26,v26,v123
v_cmp_eq_u32 vcc,-1,v26
L_cf_c_q01:
s_cbranch_vccnz L_cf_c_q01x
v_pk_add_f32 v[88:89],v[88:89],v[120:121]
s_waitcnt vmcnt(0)
v_max3_u32 v26,v124,v125,v126
v_max_u32 v26,v26,v127
v_cmp_eq_u32 vcc,-1,v26
v_pk_add_f32 v[90:91],v[90:91],v[122:123]
s_branch L_cf_c_q1
L_cf_c_q20x:
s_mov_b64 exec,vcc
global_load_dwordx4 v[128:131],v9,s[62:63] sc1
s_mov_b64 exec,-1
s_sub_u32 s40,s40,1
s_cbranch_scc1 L_chain_bail
s_waitcnt vmcnt(1)
v_max3_u32 v26,v120,v121,v122
v_max_u32 v26,v26,v123
v_cmp_eq_u32 vcc,-1,v26
L_cf_c_q02:
s_cbranch_vccnz L_cf_c_q02x
v_pk_add_f32 v[88:89],v[88:89],v[120:121]
s_waitcnt vmcnt(0)
v_max3_u32 v26,v128,v129,v130
v_max_u32 v26,v26,v131
v_cmp_eq_u32 vcc,-1,v26
v_pk_add_f32 v[90:91],v[90:91],v[122:123]
s_branch L_cf_c_q2
L_cf_c_q0x:
s_mov_b64 exec,vcc
global_load_dwordx4 v[120:123],v7,s[62:63] sc1
s_mov_b64 exec,-1
s_sub_u32 s40,s40,1
s_cbranch_scc1 L_chain_bail
s_waitcnt vmcnt(0)
v_max3_u32 v26,v120,v121,v122
v_max_u32 v26,v26,v123
v_cmp_eq_u32 vcc,-1,v26
s_branch L_cf_c_q0
L_cf_c_q21x:
s_mov_b64 exec,vcc
global_load_dwordx4 v[128:131],v9,s[62:63] sc1
s_mov_b64 exec,-1
s_sub_u32 s40,s40,1
s_cbranch_scc1 L_chain_bail
s_waitcnt vmcnt(1)
v_max3_u32 v26,v124,v125,v126
v_max_u32 v26,v26,v127
v_cmp_eq_u32 vcc,-1,v26
s_branch L_cf_c_q12
L_cf_c_q1x:
s_mov_b64 exec,vcc
global_load_dwordx4 v[124:127],v8,s[62:63] sc1
s_mov_b64 exec,-1
s_sub_u32 s40,s40,1
s_cbranch_scc1 L_chain_bail
s_waitcnt vmcnt(0)
v_max3_u32 v26,v124,v125,v126
v_max_u32 v26,v26,v127
v_cmp_eq_u32 vcc,-1,v26
s_branch L_cf_c_q1
L_cf_c_q201x:
s_mov_b64 exec,vcc
global_load_dwordx4 v[128:131],v9,s[62:63] sc1
s_mov_b64 exec,-1
s_sub_u32 s40,s40,1
s_cbranch_scc1 L_chain_bail
s_waitcnt vmcnt(2)
v_max3_u32 v26,v120,v121,v122
v_max_u32 v26,v26,v123
v_cmp_eq_u32 vcc,-1,v26
s_branch L_cf_c_q012
L_cf_c_q01x:
s_mov_b64 exec,vcc
global_load_dwordx4 v[120:123],v7,s[62:63] sc1
s_mov_b64 exec,-1
s_waitcnt vmcnt(1)
v_max3_u32 v26,v124,v125,v126
v_max_u32 v26,v26,v127
v_cmp_eq_u32 vcc,-1,v26
L_cf_c_q10:
s_cbranch_vccnz L_cf_c_q10x
s_waitcnt vmcnt(0)
v_max3_u32 v26,v120,v121,v122
v_max_u32 v26,v26,v123
v_cmp_eq_u32 vcc,-1,v26
s_branch L_cf_c_q0
L_cf_c_q02x:
s_mov_b64 exec,vcc
global_load_dwordx4 v[120:123],v7,s[62:63] sc1
s_mov_b64 exec,-1
s_waitcnt vmcnt(1)
v_max3_u32 v26,v128,v129,v130
v_max_u32 v26,v26,v131
v_cmp_eq_u32 vcc,-1,v26
s_branch L_cf_c_q20
L_cf_c_q10x:
s_mov_b64 exec,vcc
global_load_dwordx4 v[124:127],v8,s[62:63] sc1
s_mov_b64 exec,-1
s_sub_u32 s40,s40,1
s_cbranch_scc1 L_chain_bail
s_waitcnt vmcnt(1)
v_max3_u32 v26,v120,v121,v122
v_max_u32 v26,v26,v123
v_cmp_eq_u32 vcc,-1,v26
s_branch L_cf_c_q01
L_cs_top:
s_barrier
s_nop 7
global_load_dwordx4 v[40:43],v1,s[16:17] offset:0 sc1
s_nop 13
global_load_dwordx4 v[44:47],v1,s[16:17] offset:1024 sc1
s_nop 13
global_load_dwordx4 v[48:51],v1,s[16:17] offset:2048 sc1
s_nop 13
global_load_dwordx4 v[52:55],v1,s[16:17] offset:3072 sc1
L_cs_a_go:
s_waitcnt vmcnt(0)
v_max3_u32 v26,v40,v41,v42
v_max3_u32 v26,v26,v43,v44
v_max3_u32 v26,v26,v45,v46
v_max3_u32 v26,v26,v47,v48
v_max3_u32 v26,v26,v49,v50
v_max3_u32 v26,v26,v51,v52
v_max3_u32 v26,v26,v53,v54
v_max_u32 v26,v26,v55
v_cmp_eq_u32 vcc,-1,v26
s_cbranch_vccz L_cs_a_ok
global_load_dwordx4 v[40:43],v1,s[16:17] offset:0 sc1
global_load_dwordx4 v[44:47],v1,s[16:17] offset:1024 sc1
global_load_dwordx4 v[48:51],v1,s[16:17] offset:2048 sc1
global_load_dwordx4 v[52:55],v1,s[16:17] offset:3072 sc1
s_sub_u32 s40,s40,1
s_cbranch_scc0 L_cs_a_go
s_branch L_chain_bail
L_cs_a_ok:
v_smfmac_f32_16x16x64_bf16 v[56:59],v[40:43],a[0:7],v21
v_smfmac_f32_16x16x64_bf16 v[60:63],v[40:43],a[32:39],v21
v_smfmac_f32_16x16x64_bf16 v[64:67],v[40:43],a[64:71],v21
v_smfmac_f32_16x16x64_bf16 v[68:71],v[40:43],a[96:103],v21
v_smfmac_f32_16x16x64_bf16 v[56:59],v[44:47],a[8:15],v21
v_smfmac_f32_16x16x64_bf16 v[60:63],v[44:47],a[40:47],v21
v_smfmac_f32_16x16x64_bf16 v[64:67],v[44:47],a[72:79],v21
v_smfmac_f32_16x16x64_bf16 v[68:71],v[44:47],a[104:111],v21
v_smfmac_f32_16x16x64_bf16 v[56:59],v[48:51],a[16:23],v21
v_smfmac_f32_16x16x64_bf16 v[60:63],v[48:51],a[48:55],v21
v_smfmac_f32_16x16x64_bf16 v[64:67],v[48:51],a[80:87],v21
v_smfmac_f32_16x16x64_bf16 v[68:71],v[48:51],a[112:119],v21
v_smfmac_f32_16x16x64_bf16 v[56:59],v[52:55],a[24:31],v21
v_smfmac_f32_16x16x64_bf16 v[60:63],v[52:55],a[56:63],v21
v_smfmac_f32_16x16x64_bf16 v[64:67],v[52:55],a[88:95],v21
v_smfmac_f32_16x16x64_bf16 v[68:71],v[52:55],a[120:127],v21
v_pk_add_f32 v[56:57],v[56:57],v[58:59]
ds_write2_b32 v11,v56,v57 offset0:0 offset1:36
v_pk_add_f32 v[60:61],v[60:61],v[62:63]
ds_write2_b32 v11,v60,v61 offset0:16 offset1:52
v_pk_add_f32 v[64:65],v[64:65],v[66:67]
ds_write2_b32 v12,v64,v65 offset0:0 offset1:36
s_nop 1
v_pk_add_f32 v[68:69],v[68:69],v[70:71]
ds_write2_b32 v12,v68,v69 offset0:16 offset1:52
v_smfmac_f32_16x16x64_bf16 v[72:75],v[40:43],a[128:135],v21
v_smfmac_f32_16x16x64_bf16 v[76:79],v[40:43],a[160:167],v21
v_smfmac_f32_16x16x64_bf16 v[72:75],v[44:47],a[136:143],v21
s_waitcnt lgkmcnt(0)
s_barrier
ds_read_b64 v[88:89],v13 offset:0
ds_read_b64 v[90:91],v13 offset:2304
ds_read_b64 v[92:93],v13 offset:4608
ds_read_b64 v[94:95],v13 offset:6912
v_smfmac_f32_16x16x64_bf16 v[76:79],v[44:47],a[168:175],v21
v_smfmac_f32_16x16x64_bf16 v[72:75],v[48:51],a[144:151],v21
v_smfmac_f32_16x16x64_bf16 v[76:79],v[48:51],a[176:183],v21
v_smfmac_f32_16x16x64_bf16 v[72:75],v[52:55],a[152:159],v21
v_smfmac_f32_16x16x64_bf16 v[76:79],v[52:55],a[184:191],v21
s_waitcnt lgkmcnt(0)
v_pk_add_f32 v[88:89],v[88:89],v[90:91]
v_pk_add_f32 v[92:93],v[92:93],v[94:95]
v_pk_add_f32 v[88:89],v[88:89],v[92:93]
v_cvt_pk_bf16_f32 v88,v88,v89
v_min_u32 v88,s37,v88
global_store_dword v3,v88,s[16:17] sc1
v_pk_add_f32 v[72:73],v[72:73],v[74:75]
ds_write_b64 v15,v[72:73] offset:0
v_pk_add_f32 v[76:77],v[76:77],v[78:79]
ds_write_b64 v15,v[76:77] offset:512
s_cmp_lt_u32 s14,2
s_cbranch_scc0 L_cs_w23
s_waitcnt lgkmcnt(0)
s_barrier
ds_read_b128 v[160:163],v34 offset:0
ds_read_b128 v[164:167],v34 offset:1024
ds_read_b128 v[168:171],v34 offset:2048
ds_read_b128 v[172:175],v34 offset:3072
ds_read_b128 v[176:179],v34 offset:4096
ds_read_b128 v[180:183],v34 offset:5120
ds_read_b128 v[184:187],v34 offset:6144
ds_read_b128 v[188:191],v34 offset:7168
ds_read_b128 v[152:155],v35
global_load_dwordx4 v[104:107],v4,s[16:17] offset:0 sc1
s_nop 7
global_load_dwordx4 v[108:111],v4,s[16:17] offset:1024 sc1
s_nop 7
global_load_dwordx4 v[112:115],v4,s[16:17] offset:2048 sc1
s_nop 7
global_load_dwordx4 v[116:119],v4,s[16:17] offset:3072 sc1
s_barrier
ds_read_b32 v149,v20
v_mov_b32 v120,0
v_mov_b32 v121,0
v_mov_b32 v122,0
v_mov_b32 v123,0
v_mov_b32 v124,0
v_mov_b32 v125,0
v_mov_b32 v126,0
v_mov_b32 v127,0
v_mov_b32 v128,0
v_mov_b32 v129,0
v_mov_b32 v130,0
v_mov_b32 v131,0
s_cmp_eq_u32 s15,63
s_cbranch_scc1 L_cs_last01
s_waitcnt lgkmcnt(1)
L_cs_b_go:
s_waitcnt vmcnt(0)
v_max3_u32 v26,v104,v105,v106
v_max3_u32 v26,v26,v107,v108
v_max3_u32 v26,v26,v109,v110
v_max3_u32 v26,v26,v111,v112
v_max3_u32 v26,v26,v113,v114
v_max3_u32 v26,v26,v115,v116
v_max3_u32 v26,v26,v117,v118
v_max_u32 v26,v26,v119
v_cmp_eq_u32 vcc,-1,v26
s_cbranch_vccz L_cs_b_ok
global_load_dwordx4 v[104:107],v4,s[16:17] offset:0 sc1
global_load_dwordx4 v[108:111],v4,s[16:17] offset:1024 sc1
global_load_dwordx4 v[112:115],v4,s[16:17] offset:2048 sc1
global_load_dwordx4 v[116:119],v4,s[16:17] offset:3072 sc1
s_sub_u32 s40,s40,1
s_cbranch_scc0 L_cs_b_go
s_branch L_chain_bail
L_cs_b_ok:
v_mfma_f32_16x16x32_bf16 v[120:123],v[160:163],v[104:107],v[120:123]
v_mfma_f32_16x16x32_bf16 v[124:127],v[176:179],v[104:107],v[124:127]
v_mfma_f32_16x16x32_bf16 v[128:131],v[104:107],v[104:107],v[128:131]
v_mfma_f32_16x16x32_bf16 v[120:123],v[164:167],v[108:111],v[120:123]
v_mfma_f32_16x16x32_bf16 v[124:127],v[180:183],v[108:111],v[124:127]
v_mfma_f32_16x16x32_bf16 v[128:131],v[108:111],v[108:111],v[128:131]
v_mfma_f32_16x16x32_bf16 v[120:123],v[168:171],v[112:115],v[120:123]
v_mfma_f32_16x16x32_bf16 v[124:127],v[184:187],v[112:115],v[124:127]
v_mfma_f32_16x16x32_bf16 v[128:131],v[112:115],v[112:115],v[128:131]
v_mfma_f32_16x16x32_bf16 v[120:123],v[172:175],v[116:119],v[120:123]
v_mfma_f32_16x16x32_bf16 v[124:127],v[188:191],v[116:119],v[124:127]
v_mfma_f32_16x16x32_bf16 v[128:131],v[116:119],v[116:119],v[128:131]
v_max3_f32 v24,v120,v121,v122
s_nop 2
v_max3_f32 v24,v24,v123,v124
v_max3_f32 v24,v24,v125,v126
s_nop 1
v_max3_f32 v24,v24,v127,v130
v_max_f32 v24,v24,v131
v_mov_b32 v25,v24
s_nop 1
v_permlane32_swap_b32 v24,v25
v_max_f32 v24,v24,v25
v_mov_b32 v25,v24
s_nop 1
v_permlane16_swap_b32 v24,v25
v_max_f32 v24,v24,v25
v_mul_f32 v24,s36,v24
v_pk_fma_f32 v[120:121],v[120:121],v[138:139],v[24:25] op_sel_hi:[1,1,0] neg_lo:[0,0,1] neg_hi:[0,0,1]
v_pk_fma_f32 v[122:123],v[122:123],v[138:139],v[24:25] op_sel_hi:[1,1,0] neg_lo:[0,0,1] neg_hi:[0,0,1]
v_pk_fma_f32 v[124:125],v[124:125],v[138:139],v[24:25] op_sel_hi:[1,1,0] neg_lo:[0,0,1] neg_hi:[0,0,1]
v_pk_fma_f32 v[126:127],v[126:127],v[138:139],v[24:25] op_sel_hi:[1,1,0] neg_lo:[0,0,1] neg_hi:[0,0,1]
v_pk_fma_f32 v[130:131],v[130:131],v[138:139],v[24:25] op_sel_hi:[1,1,0] neg_lo:[0,0,1] neg_hi:[0,0,1]
v_exp_f32 v120,v120
v_exp_f32 v121,v121
v_exp_f32 v122,v122
v_exp_f32 v123,v123
v_exp_f32 v124,v124
v_exp_f32 v125,v125
v_exp_f32 v126,v126
v_exp_f32 v127,v127
v_cvt_pk_bf16_f32 v132,v120,v121
v_cvt_pk_bf16_f32 v133,v122,v123
v_cvt_pk_bf16_f32 v134,v124,v125
v_cvt_pk_bf16_f32 v135,v126,v127
v_exp_f32 v130,v130
v_exp_f32 v131,v131
v_mfma_f32_16x16x32_bf16 v[144:147],v[36:39],v[132:135],0
v_cvt_pk_bf16_f32 v137,v130,v131
v_mfma_f32_16x16x32_bf16 v[140:143],v[152:155],v[132:135],0
s_waitcnt lgkmcnt(0)
s_nop 0
v_mfma_f32_16x16x16_bf16 v[144:147],v[36:37],v[136:137],v[144:147]
s_nop 1
v_mfma_f32_16x16x16_bf16 v[140:143],v[148:149],v[136:137],v[140:143]
s_mov_b64 exec,s[32:33]
s_nop 2
v_rcp_f32 v24,v144
s_nop 2
v_pk_mul_f32 v[140:141],v[140:141],v[24:25] op_sel_hi:[1,0]
v_pk_mul_f32 v[142:143],v[142:143],v[24:25] op_sel_hi:[1,0]
v_cvt_pk_bf16_f32 v140,v140,v141
v_cvt_pk_bf16_f32 v141,v142,v143
v_min_u32 v140,s37,v140
v_min_u32 v141,s37,v141
global_store_dwordx2 v5,v[140:141],s[16:17] sc1
s_mov_b64 exec,-1
s_branch L_cs_po
L_cs_last01:
L_cs_bl_go:
s_waitcnt vmcnt(0)
v_max3_u32 v26,v104,v105,v106
v_max3_u32 v26,v26,v107,v108
v_max3_u32 v26,v26,v109,v110
v_max3_u32 v26,v26,v111,v112
v_max3_u32 v26,v26,v113,v114
v_max3_u32 v26,v26,v115,v116
v_max3_u32 v26,v26,v117,v118
v_max_u32 v26,v26,v119
v_cmp_eq_u32 vcc,-1,v26
s_cbranch_vccz L_cs_bl_ok
global_load_dwordx4 v[104:107],v4,s[16:17] offset:0 sc1
global_load_dwordx4 v[108:111],v4,s[16:17] offset:1024 sc1
global_load_dwordx4 v[112:115],v4,s[16:17] offset:2048 sc1
global_load_dwordx4 v[116:119],v4,s[16:17] offset:3072 sc1
s_sub_u32 s40,s40,1
s_cbranch_scc0 L_cs_bl_go
s_branch L_chain_bail
L_cs_bl_ok:
global_store_dwordx4 v195,v[240:243],s[26:27] sc1
s_add_u32 s26,s26,262144
s_addc_u32 s27,s27,0
ds_read_b128 v[196:199],v194 offset:0
ds_read_b128 v[200:203],v194 offset:1024
ds_read_b128 v[204:207],v194 offset:2048
ds_read_b128 v[208:211],v194 offset:3072
ds_read_b128 v[212:215],v34 offset:8192
ds_read_b128 v[216:219],v34 offset:9216
ds_read_b32 v221,v29 offset:0
ds_read_b32 v223,v29 offset:256
v_xor_b32 v34,32768,v34
v_xor_b32 v35,32768,v35
v_xor_b32 v194,32768,v194
s_waitcnt lgkmcnt(0)
v_mfma_f32_16x16x32_bf16 v[120:123],v[160:163],v[196:199],v[224:227]
v_mfma_f32_16x16x32_bf16 v[124:127],v[176:179],v[196:199],v[228:231]
v_mfma_f32_16x16x32_bf16 v[128:131],v[104:107],v[196:199],0
v_mfma_f32_16x16x32_bf16 v[120:123],v[164:167],v[200:203],v[120:123]
v_mfma_f32_16x16x32_bf16 v[124:127],v[180:183],v[200:203],v[124:127]
v_mfma_f32_16x16x32_bf16 v[128:131],v[108:111],v[200:203],v[128:131]
v_mfma_f32_16x16x32_bf16 v[120:123],v[168:171],v[204:207],v[120:123]
v_mfma_f32_16x16x32_bf16 v[124:127],v[184:187],v[204:207],v[124:127]
v_mfma_f32_16x16x32_bf16 v[128:131],v[112:115],v[204:207],v[128:131]
v_mfma_f32_16x16x32_bf16 v[120:123],v[172:175],v[208:211],v[120:123]
v_mfma_f32_16x16x32_bf16 v[124:127],v[188:191],v[208:211],v[124:127]
v_mfma_f32_16x16x32_bf16 v[128:131],v[116:119],v[208:211],v[128:131]
v_max3_f32 v24,v120,v121,v122
s_nop 2
v_max3_f32 v24,v24,v123,v124
v_max3_f32 v24,v24,v125,v126
s_nop 1
v_max3_f32 v24,v24,v127,v130
v_max_f32 v24,v24,v131
v_mov_b32 v25,v24
s_nop 1
v_permlane32_swap_b32 v24,v25
v_max_f32 v24,v24,v25
v_mov_b32 v25,v24
s_nop 1
v_permlane16_swap_b32 v24,v25
v_max_f32 v24,v24,v25
v_mul_f32 v24,s36,v24
v_pk_fma_f32 v[120:121],v[120:121],v[138:139],v[24:25] op_sel_hi:[1,1,0] neg_lo:[0,0,1] neg_hi:[0,0,1]
v_pk_fma_f32 v[122:123],v[122:123],v[138:139],v[24:25] op_sel_hi:[1,1,0] neg_lo:[0,0,1] neg_hi:[0,0,1]
v_pk_fma_f32 v[124:125],v[124:125],v[138:139],v[24:25] op_sel_hi:[1,1,0] neg_lo:[0,0,1] neg_hi:[0,0,1]
v_pk_fma_f32 v[126:127],v[126:127],v[138:139],v[24:25] op_sel_hi:[1,1,0] neg_lo:[0,0,1] neg_hi:[0,0,1]
v_pk_fma_f32 v[130:131],v[130:131],v[138:139],v[24:25] op_sel_hi:[1,1,0] neg_lo:[0,0,1] neg_hi:[0,0,1]
v_exp_f32 v120,v120
v_exp_f32 v121,v121
v_exp_f32 v122,v122
v_exp_f32 v123,v123
v_exp_f32 v124,v124
v_exp_f32 v125,v125
v_exp_f32 v126,v126
v_exp_f32 v127,v127
v_exp_f32 v130,v130
v_exp_f32 v131,v131
v_cvt_pk_bf16_f32 v244,v120,v121
v_cvt_pk_bf16_f32 v245,v122,v123
v_cvt_pk_bf16_f32 v246,v124,v125
v_cvt_pk_bf16_f32 v247,v126,v127
v_cvt_pk_bf16_f32 v249,v130,v131
s_nop 0
v_mfma_f32_16x16x32_bf16 v[144:147],v[36:39],v[244:247],0
v_mfma_f32_16x16x32_bf16 v[232:235],v[212:215],v[244:247],0
v_mfma_f32_16x16x32_bf16 v[236:239],v[216:219],v[244:247],0
v_mfma_f32_16x16x16_bf16 v[144:147],v[36:37],v[248:249],v[144:147]
v_mfma_f32_16x16x16_bf16 v[232:235],v[220:221],v[248:249],v[232:235]
v_mfma_f32_16x16x16_bf16 v[236:239],v[222:223],v[248:249],v[236:239]
v_rcp_f32 v24,v144
s_nop 2
v_pk_mul_f32 v[232:233],v[232:233],v[24:25] op_sel_hi:[1,0]
v_pk_mul_f32 v[234:235],v[234:235],v[24:25] op_sel_hi:[1,0]
s_nop 1
v_pk_mul_f32 v[236:237],v[236:237],v[24:25] op_sel_hi:[1,0]
v_pk_mul_f32 v[238:239],v[238:239],v[24:25] op_sel_hi:[1,0]
v_cvt_pk_bf16_f32 v240,v232,v233
v_cvt_pk_bf16_f32 v241,v234,v235
v_cvt_pk_bf16_f32 v242,v236,v237
v_cvt_pk_bf16_f32 v243,v238,v239
global_store_dwordx4 v195,v[240:243],s[26:27] sc1
s_add_u32 s26,s26,262144
s_addc_u32 s27,s27,0
s_waitcnt vmcnt(0)
s_barrier
s_branch L_chain_done
L_cs_w23:
s_waitcnt lgkmcnt(0)
s_barrier
ds_read_b64 v[88:89],v16 offset:0
ds_read_b64 v[90:91],v16 offset:1024
ds_read_b64 v[92:93],v16 offset:2048
ds_read_b64 v[94:95],v16 offset:3072
s_waitcnt lgkmcnt(0)
v_pk_add_f32 v[88:89],v[88:89],v[90:91]
v_pk_add_f32 v[92:93],v[92:93],v[94:95]
v_pk_add_f32 v[88:89],v[88:89],v[92:93]
v_cvt_pk_bf16_f32 v149,v88,v89
ds_write_b32 v20,v149
s_waitcnt lgkmcnt(0)
s_barrier
v_mov_b32 v56,0
v_mov_b32 v57,0
v_mov_b32 v58,0
v_mov_b32 v59,0
v_mov_b32 v60,0
v_mov_b32 v61,0
v_mov_b32 v62,0
v_mov_b32 v63,0
v_mov_b32 v64,0
v_mov_b32 v65,0
v_mov_b32 v66,0
v_mov_b32 v67,0
v_mov_b32 v68,0
v_mov_b32 v69,0
v_mov_b32 v70,0
v_mov_b32 v71,0
v_mov_b32 v72,0
v_mov_b32 v73,0
v_mov_b32 v74,0
v_mov_b32 v75,0
v_mov_b32 v76,0
v_mov_b32 v77,0
v_mov_b32 v78,0
v_mov_b32 v79,0
s_cmp_eq_u32 s15,63
s_cbranch_scc1 L_cs_last23
s_cmp_eq_u32 s14,2
s_cbranch_scc0 L_cs_po
s_cmp_eq_u32 s15,61
s_cbranch_scc0 L_cs_ncw
s_getpc_b64 s[56:57]
L_cs_pc:
s_add_u32 s56,s56,L_chain_done-L_cs_pc
s_addc_u32 s57,s57,0
s_and_b32 s54,s11,1
s_lshl_b32 s54,s54,13
v_bfe_u32 v31,v0,0,6
v_lshlrev_b32 v24,7,v31
v_add_u32 v24,s54,v24
v_min_u32 v24,L_code_end-L_chain_done-4,v24
global_load_dword v25,v24,s[56:57]
L_cs_ncw:
s_add_u32 s54,s15,1
s_and_b32 s55,s54,7
s_cbranch_scc1 L_cs_po
s_cmp_ge_u32 s54,64
s_cbranch_scc1 L_cs_po
v_cmp_gt_u32 vcc,0x60,v192
s_cbranch_vccz L_cs_po
s_lshl_b32 s54,s54,4
s_add_u32 s54,s54,94437376
v_mov_b32 v24,s54
L_cs_kvw:
global_load_dword v25,v24,s[4:5] sc1
s_sub_u32 s40,s40,1
s_cbranch_scc1 L_chain_bail
s_waitcnt vmcnt(0)
v_cmp_gt_u32 vcc,0x60,v25
s_cbranch_vccnz L_cs_kvw
L_cs_po:
s_barrier
v_mov_b32 v80,0
v_mov_b32 v81,0
v_mov_b32 v82,0
v_mov_b32 v83,0
v_mov_b32 v84,0
v_mov_b32 v85,0
v_mov_b32 v86,0
v_mov_b32 v87,0
s_add_u32 s15,s15,1
s_mov_b32 m0,s52
global_load_dwordx4 v[40:43],v2,s[16:17] offset:0 sc1
s_nop 13
global_load_dwordx4 v[44:47],v2,s[16:17] offset:1024 sc1
s_nop 13
global_load_dwordx4 v[48:51],v2,s[16:17] offset:2048 sc1
s_nop 13
global_load_dwordx4 v[52:55],v2,s[16:17] offset:3072 sc1
L_cs_o_go:
s_waitcnt vmcnt(0)
v_max3_u32 v26,v40,v41,v42
v_max3_u32 v26,v26,v43,v44
v_max3_u32 v26,v26,v45,v46
v_max3_u32 v26,v26,v47,v48
v_max3_u32 v26,v26,v49,v50
v_max3_u32 v26,v26,v51,v52
v_max3_u32 v26,v26,v53,v54
v_max_u32 v26,v26,v55
v_cmp_eq_u32 vcc,-1,v26
s_cbranch_vccz L_cs_o_ok
global_load_dwordx4 v[40:43],v2,s[16:17] offset:0 sc1
global_load_dwordx4 v[44:47],v2,s[16:17] offset:1024 sc1
global_load_dwordx4 v[48:51],v2,s[16:17] offset:2048 sc1
global_load_dwordx4 v[52:55],v2,s[16:17] offset:3072 sc1
s_sub_u32 s40,s40,1
s_cbranch_scc0 L_cs_o_go
s_branch L_chain_bail
L_cs_o_ok:
v_smfmac_f32_16x16x64_bf16 v[80:83],v[40:43],a[192:199],v21
v_smfmac_f32_16x16x64_bf16 v[84:87],v[40:43],a[224:231],v21
v_smfmac_f32_16x16x64_bf16 v[80:83],v[44:47],a[200:207],v21
v_smfmac_f32_16x16x64_bf16 v[84:87],v[44:47],a[232:239],v21
v_smfmac_f32_16x16x64_bf16 v[80:83],v[48:51],a[208:215],v21
v_smfmac_f32_16x16x64_bf16 v[84:87],v[48:51],a[240:247],v21
v_smfmac_f32_16x16x64_bf16 v[80:83],v[52:55],a[216:223],v21
v_smfmac_f32_16x16x64_bf16 v[84:87],v[52:55],a[248:255],v21
s_nop 3
v_pk_add_f32 v[80:81],v[80:81],v[82:83]
ds_write2_b32 v17,v80,v81 offset0:0 offset1:36
s_nop 1
v_pk_add_f32 v[84:85],v[84:85],v[86:87]
ds_write2_b32 v17,v84,v85 offset0:16 offset1:52
global_load_lds_dwordx4 v157,s[22:23] offset:0 sc1
global_load_lds_dwordx4 v157,s[22:23] offset:1024 sc1
s_mov_b32 m0,s53
s_add_u32 s54,s52,10240
global_load_lds_dwordx4 v158,s[22:23] sc1
s_mov_b32 m0,s54
s_nop 0
global_load_lds_dwordx4 v193,s[22:23] offset:0 sc1
global_load_lds_dwordx4 v193,s[22:23] offset:1024 sc1
s_waitcnt lgkmcnt(0)
s_barrier
ds_read2st64_b32 v[80:81],v22 offset0:0 offset1:5
ds_read2st64_b32 v[82:83],v22 offset0:10 offset1:15
s_cmp_lt_u32 s14,2
s_waitcnt lgkmcnt(0)
v_add_f32 v80,v80,v81
v_add_f32 v82,v82,v83
v_add_f32 v80,v80,v82
v_min_u32 v80,s37,v80
global_store_dword v6,v80,s[16:17] sc1
global_store_dword v3,v32,s[20:21] sc1
global_store_dword v6,v32,s[20:21] sc1
s_cbranch_scc0 L_cs_w23c
s_mov_b64 exec,s[32:33]
global_store_dwordx2 v5,v[32:33],s[20:21] sc1
s_mov_b64 exec,-1
s_cmp_eq_u32 s15,1
s_cbranch_scc1 L_cs_nos
global_store_dwordx4 v195,v[240:243],s[26:27] sc1
s_add_u32 s26,s26,262144
s_addc_u32 s27,s27,0
L_cs_nos:
ds_read_b128 v[196:199],v194 offset:0
ds_read_b128 v[200:203],v194 offset:1024
ds_read_b128 v[204:207],v194 offset:2048
ds_read_b128 v[208:211],v194 offset:3072
ds_read_b128 v[212:215],v34 offset:8192
ds_read_b128 v[216:219],v34 offset:9216
ds_read_b32 v221,v29 offset:0
ds_read_b32 v223,v29 offset:256
v_xor_b32 v34,32768,v34
v_xor_b32 v35,32768,v35
v_xor_b32 v194,32768,v194
s_waitcnt lgkmcnt(0)
v_mfma_f32_16x16x32_bf16 v[120:123],v[160:163],v[196:199],v[224:227]
v_mfma_f32_16x16x32_bf16 v[124:127],v[176:179],v[196:199],v[228:231]
v_mfma_f32_16x16x32_bf16 v[128:131],v[104:107],v[196:199],0
v_mfma_f32_16x16x32_bf16 v[120:123],v[164:167],v[200:203],v[120:123]
v_mfma_f32_16x16x32_bf16 v[124:127],v[180:183],v[200:203],v[124:127]
v_mfma_f32_16x16x32_bf16 v[128:131],v[108:111],v[200:203],v[128:131]
v_mfma_f32_16x16x32_bf16 v[120:123],v[168:171],v[204:207],v[120:123]
v_mfma_f32_16x16x32_bf16 v[124:127],v[184:187],v[204:207],v[124:127]
v_mfma_f32_16x16x32_bf16 v[128:131],v[112:115],v[204:207],v[128:131]
v_mfma_f32_16x16x32_bf16 v[120:123],v[172:175],v[208:211],v[120:123]
v_mfma_f32_16x16x32_bf16 v[124:127],v[188:191],v[208:211],v[124:127]
v_mfma_f32_16x16x32_bf16 v[128:131],v[116:119],v[208:211],v[128:131]
v_max3_f32 v24,v120,v121,v122
s_nop 2
v_max3_f32 v24,v24,v123,v124
v_max3_f32 v24,v24,v125,v126
s_nop 1
v_max3_f32 v24,v24,v127,v130
v_max_f32 v24,v24,v131
v_mov_b32 v25,v24
s_nop 1
v_permlane32_swap_b32 v24,v25
v_max_f32 v24,v24,v25
v_mov_b32 v25,v24
s_nop 1
v_permlane16_swap_b32 v24,v25
v_max_f32 v24,v24,v25
v_mul_f32 v24,s36,v24
v_pk_fma_f32 v[120:121],v[120:121],v[138:139],v[24:25] op_sel_hi:[1,1,0] neg_lo:[0,0,1] neg_hi:[0,0,1]
v_pk_fma_f32 v[122:123],v[122:123],v[138:139],v[24:25] op_sel_hi:[1,1,0] neg_lo:[0,0,1] neg_hi:[0,0,1]
v_pk_fma_f32 v[124:125],v[124:125],v[138:139],v[24:25] op_sel_hi:[1,1,0] neg_lo:[0,0,1] neg_hi:[0,0,1]
v_pk_fma_f32 v[126:127],v[126:127],v[138:139],v[24:25] op_sel_hi:[1,1,0] neg_lo:[0,0,1] neg_hi:[0,0,1]
v_pk_fma_f32 v[130:131],v[130:131],v[138:139],v[24:25] op_sel_hi:[1,1,0] neg_lo:[0,0,1] neg_hi:[0,0,1]
v_exp_f32 v120,v120
v_exp_f32 v121,v121
v_exp_f32 v122,v122
v_exp_f32 v123,v123
v_exp_f32 v124,v124
v_exp_f32 v125,v125
v_exp_f32 v126,v126
v_exp_f32 v127,v127
v_exp_f32 v130,v130
v_exp_f32 v131,v131
v_cvt_pk_bf16_f32 v244,v120,v121
v_cvt_pk_bf16_f32 v245,v122,v123
v_cvt_pk_bf16_f32 v246,v124,v125
v_cvt_pk_bf16_f32 v247,v126,v127
v_cvt_pk_bf16_f32 v249,v130,v131
s_nop 0
v_mfma_f32_16x16x32_bf16 v[144:147],v[36:39],v[244:247],0
v_mfma_f32_16x16x32_bf16 v[232:235],v[212:215],v[244:247],0
v_mfma_f32_16x16x32_bf16 v[236:239],v[216:219],v[244:247],0
v_mfma_f32_16x16x16_bf16 v[144:147],v[36:37],v[248:249],v[144:147]
v_mfma_f32_16x16x16_bf16 v[232:235],v[220:221],v[248:249],v[232:235]
v_mfma_f32_16x16x16_bf16 v[236:239],v[222:223],v[248:249],v[236:239]
v_rcp_f32 v24,v144
s_nop 2
v_pk_mul_f32 v[232:233],v[232:233],v[24:25] op_sel_hi:[1,0]
v_pk_mul_f32 v[234:235],v[234:235],v[24:25] op_sel_hi:[1,0]
s_nop 1
v_pk_mul_f32 v[236:237],v[236:237],v[24:25] op_sel_hi:[1,0]
v_pk_mul_f32 v[238:239],v[238:239],v[24:25] op_sel_hi:[1,0]
v_cvt_pk_bf16_f32 v240,v232,v233
v_cvt_pk_bf16_f32 v241,v234,v235
v_cvt_pk_bf16_f32 v242,v236,v237
v_cvt_pk_bf16_f32 v243,v238,v239
v_mov_b32 v56,0
v_mov_b32 v57,0
v_mov_b32 v58,0
v_mov_b32 v59,0
v_mov_b32 v60,0
v_mov_b32 v61,0
v_mov_b32 v62,0
v_mov_b32 v63,0
v_mov_b32 v64,0
v_mov_b32 v65,0
v_mov_b32 v66,0
v_mov_b32 v67,0
v_mov_b32 v68,0
v_mov_b32 v69,0
v_mov_b32 v70,0
v_mov_b32 v71,0
v_mov_b32 v72,0
v_mov_b32 v73,0
v_mov_b32 v74,0
v_mov_b32 v75,0
v_mov_b32 v76,0
v_mov_b32 v77,0
v_mov_b32 v78,0
v_mov_b32 v79,0
s_mov_b64 s[16:17],s[18:19]
s_mov_b64 s[18:19],s[20:21]
s_add_u32 s54,s15,2
s_and_b32 s54,s54,3
s_lshl_b32 s54,s54,19
s_add_u32 s20,s42,s54
s_addc_u32 s21,s43,0
s_add_u32 s22,s22,8192
s_addc_u32 s23,s23,0
s_xor_b32 s52,s52,32768
s_xor_b32 s53,s53,32768
s_branch L_cs_top
L_cs_w23c:
s_cmp_eq_u32 s14,3
s_cbranch_scc0 L_cs_w2c
s_sub_i32 s54,s15,2
s_max_i32 s54,s54,0
v_mov_b32 v24,s54
s_mov_b64 exec,1
global_store_dword v28,v24,s[4:5] sc1
s_mov_b64 exec,-1
s_cmp_gt_u32 s15,32
s_cbranch_scc1 L_cs_ni
global_store_dwordx4 v250,v[252:255],s[4:5] sc1
v_add_u32 v250,1024,v250
L_cs_ni:
s_mov_b64 s[16:17],s[18:19]
s_mov_b64 s[18:19],s[20:21]
s_add_u32 s54,s15,2
s_and_b32 s54,s54,3
s_lshl_b32 s54,s54,19
s_add_u32 s20,s42,s54
s_addc_u32 s21,s43,0
s_add_u32 s22,s22,8192
s_addc_u32 s23,s23,0
s_xor_b32 s52,s52,32768
s_xor_b32 s53,s53,32768
s_branch L_cs_top
L_cs_last23:
s_barrier
s_cmp_eq_u32 s14,3
s_cbranch_scc0 L_chain_done
v_mov_b32 v24,64
s_mov_b64 exec,1
global_store_dword v28,v24,s[4:5] sc1
s_mov_b64 exec,-1
s_branch L_chain_done
L_cs_w2c:
ds_read2_b64 v[88:91],v18 offset0:0 offset1:2
ds_read2_b64 v[92:95],v18 offset0:160 offset1:162
ds_read2_b64 v[96:99],v19 offset0:0 offset1:2
ds_read2_b64 v[100:103],v19 offset0:160 offset1:162
global_store_dwordx2 v10,v[32:33],s[20:21] sc1
s_mov_b64 s[62:63],s[16:17]
s_mov_b64 s[16:17],s[18:19]
s_mov_b64 s[18:19],s[20:21]
s_add_u32 s54,s15,2
s_and_b32 s54,s54,3
s_lshl_b32 s54,s54,19
s_add_u32 s20,s42,s54
s_addc_u32 s21,s43,0
s_add_u32 s22,s22,8192
s_addc_u32 s23,s23,0
s_xor_b32 s52,s52,32768
s_xor_b32 s53,s53,32768
s_waitcnt lgkmcnt(0)
v_pk_add_f32 v[88:89],v[88:89],v[92:93]
v_pk_add_f32 v[96:97],v[96:97],v[100:101]
v_pk_add_f32 v[90:91],v[90:91],v[94:95]
v_pk_add_f32 v[98:99],v[98:99],v[102:103]
v_pk_add_f32 v[88:89],v[88:89],v[96:97]
v_pk_add_f32 v[90:91],v[90:91],v[98:99]
s_add_u32 s54,s15,1
s_and_b32 s55,s54,7
s_cbranch_scc1 L_cs_nf
s_lshl_b32 s54,s54,4
s_add_u32 s54,s54,94437376
v_mov_b32 v159,s54
global_load_dword v192,v159,s[4:5] sc1
L_cs_nf:
s_nop 15
s_nop 15
s_nop 15
s_nop 15
s_nop 15
s_nop 15
s_nop 15
s_nop 15
global_load_dwordx4 v[120:123],v7,s[62:63] sc1
global_load_dwordx4 v[124:127],v8,s[62:63] sc1
global_load_dwordx4 v[128:131],v9,s[62:63] sc1
L_cs_c_go:
s_waitcnt vmcnt(0)
v_max3_u32 v26,v120,v121,v122
v_max3_u32 v26,v26,v123,v124
v_max3_u32 v26,v26,v125,v126
v_max3_u32 v26,v26,v127,v128
v_max3_u32 v26,v26,v129,v130
v_max_u32 v26,v26,v131
v_cmp_eq_u32 vcc,-1,v26
s_cbranch_vccz L_cs_c_ok
global_load_dwordx4 v[120:123],v7,s[62:63] sc1
global_load_dwordx4 v[124:127],v8,s[62:63] sc1
global_load_dwordx4 v[128:131],v9,s[62:63] sc1
s_sub_u32 s40,s40,1
s_cbranch_scc0 L_cs_c_go
s_branch L_chain_bail
L_cs_c_ok:
v_pk_add_f32 v[88:89],v[88:89],v[120:121]
v_pk_add_f32 v[90:91],v[90:91],v[122:123]
v_pk_add_f32 v[124:125],v[124:125],v[128:129]
v_pk_add_f32 v[126:127],v[126:127],v[130:131]
v_pk_add_f32 v[88:89],v[88:89],v[124:125]
v_pk_add_f32 v[90:91],v[90:91],v[126:127]
v_cvt_pk_bf16_f32 v88,v88,v89
v_cvt_pk_bf16_f32 v89,v90,v91
v_min_u32 v88,s37,v88
v_min_u32 v89,s37,v89
global_store_dwordx2 v10,v[88:89],s[16:17] sc1
s_branch L_cs_top
L_chain_bail:
v_mov_b32 v24,1
v_mov_b32 v25,0
global_atomic_add v25,v24,s[6:7] offset:64
s_endpgm
L_chain_done:
s_load_dwordx2 s[16:17],s[0:1],96
s_cmp_eq_u32 s14,s10
s_cbranch_scc0 L_fin_a
v_mov_b32 v24,94443392
global_load_dword v27,v24,s[4:5] sc1
s_lshl_b32 s54,s10,8
s_add_u32 s54,s54,95435776
v_bfe_u32 v31,v0,0,4
v_lshlrev_b32 v24,3,v31
v_add_u32 v24,s54,v24
global_load_dwordx2 v[56:57],v24,s[4:5] offset:0 sc1
global_load_dwordx2 v[58:59],v24,s[4:5] offset:128 sc1
L_fin_a:
s_lshl_b32 s54,s10,12
s_add_u32 s54,s54,94371840
v_bfe_u32 v31,v0,0,5
v_lshlrev_b32 v24,7,v31
v_add_u32 v24,s54,v24
s_lshl_b32 s54,s10,15
s_lshl_b32 s59,s14,13
s_add_u32 s54,s54,s59
s_add_u32 s54,s54,82837504
s_add_u32 s18,s4,s54
s_addc_u32 s19,s5,0
v_add_u32 v26,4096,v30
L_fin_p0:
global_load_dword v25,v24,s[4:5] sc1
s_sub_u32 s40,s40,1
s_cbranch_scc1 L_chain_bail
s_waitcnt vmcnt(0)
v_cmp_gt_u32 vcc,64,v25
s_cbranch_vccnz L_fin_p0
global_load_dwordx4 v[64:67],v30,s[18:19] offset:0 sc1
global_load_dwordx4 v[68:71],v30,s[18:19] offset:1024 sc1
global_load_dwordx4 v[72:75],v30,s[18:19] offset:2048 sc1
global_load_dwordx4 v[76:79],v30,s[18:19] offset:3072 sc1
global_load_dwordx4 v[80:83],v26,s[18:19] offset:0 sc1
global_load_dwordx4 v[84:87],v26,s[18:19] offset:1024 sc1
global_load_dwordx4 v[88:91],v26,s[18:19] offset:2048 sc1
global_load_dwordx4 v[92:95],v26,s[18:19] offset:3072 sc1
s_add_u32 s18,s18,131072
s_addc_u32 s19,s19,0
global_load_dwordx4 v[96:99],v30,s[18:19] offset:0 sc1
global_load_dwordx4 v[100:103],v30,s[18:19] offset:1024 sc1
global_load_dwordx4 v[104:107],v30,s[18:19] offset:2048 sc1
global_load_dwordx4 v[108:111],v30,s[18:19] offset:3072 sc1
global_load_dwordx4 v[112:115],v26,s[18:19] offset:0 sc1
global_load_dwordx4 v[116:119],v26,s[18:19] offset:1024 sc1
global_load_dwordx4 v[120:123],v26,s[18:19] offset:2048 sc1
global_load_dwordx4 v[124:127],v26,s[18:19] offset:3072 sc1
s_add_u32 s18,s18,131072
s_addc_u32 s19,s19,0
global_load_dwordx4 v[128:131],v30,s[18:19] offset:0 sc1
global_load_dwordx4 v[132:135],v30,s[18:19] offset:1024 sc1
global_load_dwordx4 v[136:139],v30,s[18:19] offset:2048 sc1
global_load_dwordx4 v[140:143],v30,s[18:19] offset:3072 sc1
global_load_dwordx4 v[144:147],v26,s[18:19] offset:0 sc1
global_load_dwordx4 v[148:151],v26,s[18:19] offset:1024 sc1
global_load_dwordx4 v[152:155],v26,s[18:19] offset:2048 sc1
global_load_dwordx4 v[156:159],v26,s[18:19] offset:3072 sc1
s_add_u32 s18,s18,131072
s_addc_u32 s19,s19,0
global_load_dwordx4 v[160:163],v30,s[18:19] offset:0 sc1
global_load_dwordx4 v[164:167],v30,s[18:19] offset:1024 sc1
global_load_dwordx4 v[168:171],v30,s[18:19] offset:2048 sc1
global_load_dwordx4 v[172:175],v30,s[18:19] offset:3072 sc1
global_load_dwordx4 v[176:179],v26,s[18:19] offset:0 sc1
global_load_dwordx4 v[180:183],v26,s[18:19] offset:1024 sc1
global_load_dwordx4 v[184:187],v26,s[18:19] offset:2048 sc1
global_load_dwordx4 v[188:191],v26,s[18:19] offset:3072 sc1
s_add_u32 s18,s18,131072
s_addc_u32 s19,s19,0
s_waitcnt vmcnt(31)
v_mfma_f32_16x16x32_bf16 v[192:195],a[192:195],v[64:67],0
v_mfma_f32_16x16x32_bf16 v[196:199],a[224:227],v[64:67],0
global_load_dwordx4 v[64:67],v30,s[18:19] offset:0 sc1
s_waitcnt vmcnt(31)
v_mfma_f32_16x16x32_bf16 v[192:195],a[196:199],v[68:71],v[192:195]
v_mfma_f32_16x16x32_bf16 v[196:199],a[228:231],v[68:71],v[196:199]
global_load_dwordx4 v[68:71],v30,s[18:19] offset:1024 sc1
s_waitcnt vmcnt(31)
v_mfma_f32_16x16x32_bf16 v[192:195],a[200:203],v[72:75],v[192:195]
v_mfma_f32_16x16x32_bf16 v[196:199],a[232:235],v[72:75],v[196:199]
global_load_dwordx4 v[72:75],v30,s[18:19] offset:2048 sc1
s_waitcnt vmcnt(31)
v_mfma_f32_16x16x32_bf16 v[192:195],a[204:207],v[76:79],v[192:195]
v_mfma_f32_16x16x32_bf16 v[196:199],a[236:239],v[76:79],v[196:199]
global_load_dwordx4 v[76:79],v30,s[18:19] offset:3072 sc1
s_waitcnt vmcnt(31)
v_mfma_f32_16x16x32_bf16 v[192:195],a[208:211],v[80:83],v[192:195]
v_mfma_f32_16x16x32_bf16 v[196:199],a[240:243],v[80:83],v[196:199]
global_load_dwordx4 v[80:83],v26,s[18:19] offset:0 sc1
s_waitcnt vmcnt(31)
v_mfma_f32_16x16x32_bf16 v[192:195],a[212:215],v[84:87],v[192:195]
v_mfma_f32_16x16x32_bf16 v[196:199],a[244:247],v[84:87],v[196:199]
global_load_dwordx4 v[84:87],v26,s[18:19] offset:1024 sc1
s_waitcnt vmcnt(31)
v_mfma_f32_16x16x32_bf16 v[192:195],a[216:219],v[88:91],v[192:195]
v_mfma_f32_16x16x32_bf16 v[196:199],a[248:251],v[88:91],v[196:199]
global_load_dwordx4 v[88:91],v26,s[18:19] offset:2048 sc1
s_waitcnt vmcnt(31)
v_mfma_f32_16x16x32_bf16 v[192:195],a[220:223],v[92:95],v[192:195]
v_mfma_f32_16x16x32_bf16 v[196:199],a[252:255],v[92:95],v[196:199]
global_load_dwordx4 v[92:95],v26,s[18:19] offset:3072 sc1
s_add_u32 s18,s18,131072
s_addc_u32 s19,s19,0
s_waitcnt vmcnt(31)
v_mfma_f32_16x16x32_bf16 v[200:203],a[192:195],v[96:99],0
v_mfma_f32_16x16x32_bf16 v[204:207],a[224:227],v[96:99],0
global_load_dwordx4 v[96:99],v30,s[18:19] offset:0 sc1
s_waitcnt vmcnt(31)
v_mfma_f32_16x16x32_bf16 v[200:203],a[196:199],v[100:103],v[200:203]
v_mfma_f32_16x16x32_bf16 v[204:207],a[228:231],v[100:103],v[204:207]
global_load_dwordx4 v[100:103],v30,s[18:19] offset:1024 sc1
s_waitcnt vmcnt(31)
v_mfma_f32_16x16x32_bf16 v[200:203],a[200:203],v[104:107],v[200:203]
v_mfma_f32_16x16x32_bf16 v[204:207],a[232:235],v[104:107],v[204:207]
global_load_dwordx4 v[104:107],v30,s[18:19] offset:2048 sc1
s_waitcnt vmcnt(31)
v_mfma_f32_16x16x32_bf16 v[200:203],a[204:207],v[108:111],v[200:203]
v_mfma_f32_16x16x32_bf16 v[204:207],a[236:239],v[108:111],v[204:207]
global_load_dwordx4 v[108:111],v30,s[18:19] offset:3072 sc1
s_waitcnt vmcnt(31)
v_mfma_f32_16x16x32_bf16 v[200:203],a[208:211],v[112:115],v[200:203]
v_mfma_f32_16x16x32_bf16 v[204:207],a[240:243],v[112:115],v[204:207]
global_load_dwordx4 v[112:115],v26,s[18:19] offset:0 sc1
s_waitcnt vmcnt(31)
v_mfma_f32_16x16x32_bf16 v[200:203],a[212:215],v[116:119],v[200:203]
v_mfma_f32_16x16x32_bf16 v[204:207],a[244:247],v[116:119],v[204:207]
global_load_dwordx4 v[116:119],v26,s[18:19] offset:1024 sc1
s_waitcnt vmcnt(31)
v_mfma_f32_16x16x32_bf16 v[200:203],a[216:219],v[120:123],v[200:203]
v_mfma_f32_16x16x32_bf16 v[204:207],a[248:251],v[120:123],v[204:207]
global_load_dwordx4 v[120:123],v26,s[18:19] offset:2048 sc1
s_waitcnt vmcnt(31)
v_mfma_f32_16x16x32_bf16 v[200:203],a[220:223],v[124:127],v[200:203]
v_mfma_f32_16x16x32_bf16 v[204:207],a[252:255],v[124:127],v[204:207]
global_load_dwordx4 v[124:127],v26,s[18:19] offset:3072 sc1
s_add_u32 s18,s18,131072
s_addc_u32 s19,s19,0
s_waitcnt vmcnt(31)
v_mfma_f32_16x16x32_bf16 v[208:211],a[192:195],v[128:131],0
v_mfma_f32_16x16x32_bf16 v[212:215],a[224:227],v[128:131],0
global_load_dwordx4 v[128:131],v30,s[18:19] offset:0 sc1
s_waitcnt vmcnt(31)
v_mfma_f32_16x16x32_bf16 v[208:211],a[196:199],v[132:135],v[208:211]
v_mfma_f32_16x16x32_bf16 v[212:215],a[228:231],v[132:135],v[212:215]
global_load_dwordx4 v[132:135],v30,s[18:19] offset:1024 sc1
s_waitcnt vmcnt(31)
v_mfma_f32_16x16x32_bf16 v[208:211],a[200:203],v[136:139],v[208:211]
v_mfma_f32_16x16x32_bf16 v[212:215],a[232:235],v[136:139],v[212:215]
global_load_dwordx4 v[136:139],v30,s[18:19] offset:2048 sc1
s_waitcnt vmcnt(31)
v_mfma_f32_16x16x32_bf16 v[208:211],a[204:207],v[140:143],v[208:211]
v_mfma_f32_16x16x32_bf16 v[212:215],a[236:239],v[140:143],v[212:215]
global_load_dwordx4 v[140:143],v30,s[18:19] offset:3072 sc1
s_waitcnt vmcnt(31)
v_mfma_f32_16x16x32_bf16 v[208:211],a[208:211],v[144:147],v[208:211]
v_mfma_f32_16x16x32_bf16 v[212:215],a[240:243],v[144:147],v[212:215]
global_load_dwordx4 v[144:147],v26,s[18:19] offset:0 sc1
s_waitcnt vmcnt(31)
v_mfma_f32_16x16x32_bf16 v[208:211],a[212:215],v[148:151],v[208:211]
v_mfma_f32_16x16x32_bf16 v[212:215],a[244:247],v[148:151],v[212:215]
global_load_dwordx4 v[148:151],v26,s[18:19] offset:1024 sc1
s_waitcnt vmcnt(31)
v_mfma_f32_16x16x32_bf16 v[208:211],a[216:219],v[152:155],v[208:211]
v_mfma_f32_16x16x32_bf16 v[212:215],a[248:251],v[152:155],v[212:215]
global_load_dwordx4 v[152:155],v26,s[18:19] offset:2048 sc1
s_waitcnt vmcnt(31)
v_mfma_f32_16x16x32_bf16 v[208:211],a[220:223],v[156:159],v[208:211]
v_mfma_f32_16x16x32_bf16 v[212:215],a[252:255],v[156:159],v[212:215]
global_load_dwordx4 v[156:159],v26,s[18:19] offset:3072 sc1
s_add_u32 s18,s18,131072
s_addc_u32 s19,s19,0
s_waitcnt vmcnt(31)
v_mfma_f32_16x16x32_bf16 v[216:219],a[192:195],v[160:163],0
v_mfma_f32_16x16x32_bf16 v[220:223],a[224:227],v[160:163],0
global_load_dwordx4 v[160:163],v30,s[18:19] offset:0 sc1
s_waitcnt vmcnt(31)
v_mfma_f32_16x16x32_bf16 v[216:219],a[196:199],v[164:167],v[216:219]
v_mfma_f32_16x16x32_bf16 v[220:223],a[228:231],v[164:167],v[220:223]
global_load_dwordx4 v[164:167],v30,s[18:19] offset:1024 sc1
s_waitcnt vmcnt(31)
v_mfma_f32_16x16x32_bf16 v[216:219],a[200:203],v[168:171],v[216:219]
v_mfma_f32_16x16x32_bf16 v[220:223],a[232:235],v[168:171],v[220:223]
global_load_dwordx4 v[168:171],v30,s[18:19] offset:2048 sc1
s_waitcnt vmcnt(31)
v_mfma_f32_16x16x32_bf16 v[216:219],a[204:207],v[172:175],v[216:219]
v_mfma_f32_16x16x32_bf16 v[220:223],a[236:239],v[172:175],v[220:223]
global_load_dwordx4 v[172:175],v30,s[18:19] offset:3072 sc1
s_waitcnt vmcnt(31)
v_mfma_f32_16x16x32_bf16 v[216:219],a[208:211],v[176:179],v[216:219]
v_mfma_f32_16x16x32_bf16 v[220:223],a[240:243],v[176:179],v[220:223]
global_load_dwordx4 v[176:179],v26,s[18:19] offset:0 sc1
s_waitcnt vmcnt(31)
v_mfma_f32_16x16x32_bf16 v[216:219],a[212:215],v[180:183],v[216:219]
v_mfma_f32_16x16x32_bf16 v[220:223],a[244:247],v[180:183],v[220:223]
global_load_dwordx4 v[180:183],v26,s[18:19] offset:1024 sc1
s_waitcnt vmcnt(31)
v_mfma_f32_16x16x32_bf16 v[216:219],a[216:219],v[184:187],v[216:219]
v_mfma_f32_16x16x32_bf16 v[220:223],a[248:251],v[184:187],v[220:223]
global_load_dwordx4 v[184:187],v26,s[18:19] offset:2048 sc1
s_waitcnt vmcnt(31)
v_mfma_f32_16x16x32_bf16 v[216:219],a[220:223],v[188:191],v[216:219]
v_mfma_f32_16x16x32_bf16 v[220:223],a[252:255],v[188:191],v[220:223]
global_load_dwordx4 v[188:191],v26,s[18:19] offset:3072 sc1
s_waitcnt vmcnt(31)
v_mfma_f32_16x16x32_bf16 v[224:227],a[192:195],v[64:67],0
v_mfma_f32_16x16x32_bf16 v[228:231],a[224:227],v[64:67],0
s_waitcnt vmcnt(30)
v_mfma_f32_16x16x32_bf16 v[224:227],a[196:199],v[68:71],v[224:227]
v_mfma_f32_16x16x32_bf16 v[228:231],a[228:231],v[68:71],v[228:231]
s_waitcnt vmcnt(29)
v_mfma_f32_16x16x32_bf16 v[224:227],a[200:203],v[72:75],v[224:227]
v_mfma_f32_16x16x32_bf16 v[228:231],a[232:235],v[72:75],v[228:231]
s_waitcnt vmcnt(28)
v_mfma_f32_16x16x32_bf16 v[224:227],a[204:207],v[76:79],v[224:227]
v_mfma_f32_16x16x32_bf16 v[228:231],a[236:239],v[76:79],v[228:231]
s_waitcnt vmcnt(27)
v_mfma_f32_16x16x32_bf16 v[224:227],a[208:211],v[80:83],v[224:227]
v_mfma_f32_16x16x32_bf16 v[228:231],a[240:243],v[80:83],v[228:231]
s_waitcnt vmcnt(26)
v_mfma_f32_16x16x32_bf16 v[224:227],a[212:215],v[84:87],v[224:227]
v_mfma_f32_16x16x32_bf16 v[228:231],a[244:247],v[84:87],v[228:231]
s_waitcnt vmcnt(25)
v_mfma_f32_16x16x32_bf16 v[224:227],a[216:219],v[88:91],v[224:227]
v_mfma_f32_16x16x32_bf16 v[228:231],a[248:251],v[88:91],v[228:231]
s_waitcnt vmcnt(24)
v_mfma_f32_16x16x32_bf16 v[224:227],a[220:223],v[92:95],v[224:227]
v_mfma_f32_16x16x32_bf16 v[228:231],a[252:255],v[92:95],v[228:231]
s_waitcnt vmcnt(23)
v_mfma_f32_16x16x32_bf16 v[232:235],a[192:195],v[96:99],0
v_mfma_f32_16x16x32_bf16 v[236:239],a[224:227],v[96:99],0
s_waitcnt vmcnt(22)
v_mfma_f32_16x16x32_bf16 v[232:235],a[196:199],v[100:103],v[232:235]
v_mfma_f32_16x16x32_bf16 v[236:239],a[228:231],v[100:103],v[236:239]
s_waitcnt vmcnt(21)
v_mfma_f32_16x16x32_bf16 v[232:235],a[200:203],v[104:107],v[232:235]
v_mfma_f32_16x16x32_bf16 v[236:239],a[232:235],v[104:107],v[236:239]
s_waitcnt vmcnt(20)
v_mfma_f32_16x16x32_bf16 v[232:235],a[204:207],v[108:111],v[232:235]
v_mfma_f32_16x16x32_bf16 v[236:239],a[236:239],v[108:111],v[236:239]
s_waitcnt vmcnt(19)
v_mfma_f32_16x16x32_bf16 v[232:235],a[208:211],v[112:115],v[232:235]
v_mfma_f32_16x16x32_bf16 v[236:239],a[240:243],v[112:115],v[236:239]
s_waitcnt vmcnt(18)
v_mfma_f32_16x16x32_bf16 v[232:235],a[212:215],v[116:119],v[232:235]
v_mfma_f32_16x16x32_bf16 v[236:239],a[244:247],v[116:119],v[236:239]
s_waitcnt vmcnt(17)
v_mfma_f32_16x16x32_bf16 v[232:235],a[216:219],v[120:123],v[232:235]
v_mfma_f32_16x16x32_bf16 v[236:239],a[248:251],v[120:123],v[236:239]
s_waitcnt vmcnt(16)
v_mfma_f32_16x16x32_bf16 v[232:235],a[220:223],v[124:127],v[232:235]
v_mfma_f32_16x16x32_bf16 v[236:239],a[252:255],v[124:127],v[236:239]
s_waitcnt vmcnt(15)
v_mfma_f32_16x16x32_bf16 v[240:243],a[192:195],v[128:131],0
v_mfma_f32_16x16x32_bf16 v[244:247],a[224:227],v[128:131],0
s_waitcnt vmcnt(14)
v_mfma_f32_16x16x32_bf16 v[240:243],a[196:199],v[132:135],v[240:243]
v_mfma_f32_16x16x32_bf16 v[244:247],a[228:231],v[132:135],v[244:247]
s_waitcnt vmcnt(13)
v_mfma_f32_16x16x32_bf16 v[240:243],a[200:203],v[136:139],v[240:243]
v_mfma_f32_16x16x32_bf16 v[244:247],a[232:235],v[136:139],v[244:247]
s_waitcnt vmcnt(12)
v_mfma_f32_16x16x32_bf16 v[240:243],a[204:207],v[140:143],v[240:243]
v_mfma_f32_16x16x32_bf16 v[244:247],a[236:239],v[140:143],v[244:247]
s_waitcnt vmcnt(11)
v_mfma_f32_16x16x32_bf16 v[240:243],a[208:211],v[144:147],v[240:243]
v_mfma_f32_16x16x32_bf16 v[244:247],a[240:243],v[144:147],v[244:247]
s_waitcnt vmcnt(10)
v_mfma_f32_16x16x32_bf16 v[240:243],a[212:215],v[148:151],v[240:243]
v_mfma_f32_16x16x32_bf16 v[244:247],a[244:247],v[148:151],v[244:247]
s_waitcnt vmcnt(9)
v_mfma_f32_16x16x32_bf16 v[240:243],a[216:219],v[152:155],v[240:243]
v_mfma_f32_16x16x32_bf16 v[244:247],a[248:251],v[152:155],v[244:247]
s_waitcnt vmcnt(8)
v_mfma_f32_16x16x32_bf16 v[240:243],a[220:223],v[156:159],v[240:243]
v_mfma_f32_16x16x32_bf16 v[244:247],a[252:255],v[156:159],v[244:247]
s_waitcnt vmcnt(7)
v_mfma_f32_16x16x32_bf16 v[248:251],a[192:195],v[160:163],0
v_mfma_f32_16x16x32_bf16 v[252:255],a[224:227],v[160:163],0
s_waitcnt vmcnt(6)
v_mfma_f32_16x16x32_bf16 v[248:251],a[196:199],v[164:167],v[248:251]
v_mfma_f32_16x16x32_bf16 v[252:255],a[228:231],v[164:167],v[252:255]
s_waitcnt vmcnt(5)
v_mfma_f32_16x16x32_bf16 v[248:251],a[200:203],v[168:171],v[248:251]
v_mfma_f32_16x16x32_bf16 v[252:255],a[232:235],v[168:171],v[252:255]
s_waitcnt vmcnt(4)
v_mfma_f32_16x16x32_bf16 v[248:251],a[204:207],v[172:175],v[248:251]
v_mfma_f32_16x16x32_bf16 v[252:255],a[236:239],v[172:175],v[252:255]
s_waitcnt vmcnt(3)
v_mfma_f32_16x16x32_bf16 v[248:251],a[208:211],v[176:179],v[248:251]
v_mfma_f32_16x16x32_bf16 v[252:255],a[240:243],v[176:179],v[252:255]
s_waitcnt vmcnt(2)
v_mfma_f32_16x16x32_bf16 v[248:251],a[212:215],v[180:183],v[248:251]
v_mfma_f32_16x16x32_bf16 v[252:255],a[244:247],v[180:183],v[252:255]
s_waitcnt vmcnt(1)
v_mfma_f32_16x16x32_bf16 v[248:251],a[216:219],v[184:187],v[248:251]
v_mfma_f32_16x16x32_bf16 v[252:255],a[248:251],v[184:187],v[252:255]
s_waitcnt vmcnt(0)
v_mfma_f32_16x16x32_bf16 v[248:251],a[220:223],v[188:191],v[248:251]
v_mfma_f32_16x16x32_bf16 v[252:255],a[252:255],v[188:191],v[252:255]
s_cmp_eq_u32 s14,s10
s_cbranch_scc0 L_fin_d
v_cmp_gt_u32 vcc,8,v27
s_cbranch_vccz L_fin_e
v_mov_b32 v24,94443392
L_fin_b:
global_load_dword v25,v24,s[4:5] sc1
s_sub_u32 s40,s40,1
s_cbranch_scc1 L_chain_bail
s_waitcnt vmcnt(0)
v_cmp_gt_u32 vcc,8,v25
s_cbranch_vccnz L_fin_b
L_fin_e:
s_lshl_b32 s54,s10,16
s_lshl_b32 s59,s46,10
s_add_u32 s54,s54,s59
s_add_u32 s54,s54,104595456
s_add_u32 s56,s4,s54
s_addc_u32 s57,s5,0
global_load_dwordx4 v[40:43],v30,s[56:57] sc1
s_add_u32 s56,s56,32768
s_addc_u32 s57,s57,0
global_load_dwordx4 v[44:47],v30,s[56:57] sc1
L_fin_d:
v_bfe_u32 v31,v0,6,2
v_lshlrev_b32 v24,15,v31
v_bfe_u32 v31,v0,0,6
v_lshl_add_u32 v24,v31,4,v24
s_barrier
ds_write_b128 v24,v[192:195] offset:0
ds_write_b128 v24,v[196:199] offset:1024
ds_write_b128 v24,v[200:203] offset:2048
ds_write_b128 v24,v[204:207] offset:3072
ds_write_b128 v24,v[208:211] offset:4096
ds_write_b128 v24,v[212:215] offset:5120
ds_write_b128 v24,v[216:219] offset:6144
ds_write_b128 v24,v[220:223] offset:7168
ds_write_b128 v24,v[224:227] offset:8192
ds_write_b128 v24,v[228:231] offset:9216
ds_write_b128 v24,v[232:235] offset:10240
ds_write_b128 v24,v[236:239] offset:11264
ds_write_b128 v24,v[240:243] offset:12288
ds_write_b128 v24,v[244:247] offset:13312
ds_write_b128 v24,v[248:251] offset:14336
ds_write_b128 v24,v[252:255] offset:15360
v_bfe_u32 v31,v0,6,2
v_lshlrev_b32 v24,12,v31
v_bfe_u32 v31,v0,0,6
v_lshl_add_u32 v24,v31,4,v24
v_add_u32 v25,65536,v24
s_waitcnt lgkmcnt(0)
s_barrier
ds_read_b128 v[128:131],v24 offset:0
ds_read_b128 v[132:135],v24 offset:32768
ds_read_b128 v[136:139],v25 offset:0
ds_read_b128 v[140:143],v25 offset:32768
ds_read_b128 v[144:147],v24 offset:1024
ds_read_b128 v[148:151],v24 offset:33792
ds_read_b128 v[152:155],v25 offset:1024
ds_read_b128 v[156:159],v25 offset:33792
ds_read_b128 v[160:163],v24 offset:2048
ds_read_b128 v[164:167],v24 offset:34816
ds_read_b128 v[168:171],v25 offset:2048
ds_read_b128 v[172:175],v25 offset:34816
s_waitcnt lgkmcnt(8)
v_pk_add_f32 v[128:129],v[128:129],v[132:133]
v_pk_add_f32 v[136:137],v[136:137],v[140:141]
v_pk_add_f32 v[130:131],v[130:131],v[134:135]
v_pk_add_f32 v[138:139],v[138:139],v[142:143]
v_pk_add_f32 v[128:129],v[128:129],v[136:137]
v_pk_add_f32 v[130:131],v[130:131],v[138:139]
ds_read_b128 v[176:179],v24 offset:3072
ds_read_b128 v[180:183],v24 offset:35840
ds_read_b128 v[184:187],v25 offset:3072
ds_read_b128 v[188:191],v25 offset:35840
s_waitcnt lgkmcnt(8)
v_pk_add_f32 v[144:145],v[144:145],v[148:149]
v_pk_add_f32 v[152:153],v[152:153],v[156:157]
v_pk_add_f32 v[146:147],v[146:147],v[150:151]
v_pk_add_f32 v[154:155],v[154:155],v[158:159]
v_pk_add_f32 v[144:145],v[144:145],v[152:153]
v_pk_add_f32 v[146:147],v[146:147],v[154:155]
s_waitcnt lgkmcnt(0)
v_pk_add_f32 v[160:161],v[160:161],v[164:165]
v_pk_add_f32 v[168:169],v[168:169],v[172:173]
v_pk_add_f32 v[162:163],v[162:163],v[166:167]
v_pk_add_f32 v[170:171],v[170:171],v[174:175]
v_pk_add_f32 v[160:161],v[160:161],v[168:169]
v_pk_add_f32 v[162:163],v[162:163],v[170:171]
v_pk_add_f32 v[176:177],v[176:177],v[180:181]
v_pk_add_f32 v[184:185],v[184:185],v[188:189]
v_pk_add_f32 v[178:179],v[178:179],v[182:183]
v_pk_add_f32 v[186:187],v[186:187],v[190:191]
v_pk_add_f32 v[176:177],v[176:177],v[184:185]
v_pk_add_f32 v[178:179],v[178:179],v[186:187]
s_lshl_b32 s54,s11,17
s_lshl_b32 s59,s14,15
s_add_u32 s54,s54,s59
s_add_u32 s54,s54,83886080
s_add_u32 s18,s4,s54
s_addc_u32 s19,s5,0
s_cmp_eq_u32 s14,s10
s_cbranch_scc1 L_fin_c
s_lshl_b32 s54,s10,13
s_add_u32 s18,s18,s54
s_addc_u32 s19,s19,0
v_min_u32 v128,s37,v128
v_min_u32 v129,s37,v129
v_min_u32 v130,s37,v130
v_min_u32 v131,s37,v131
global_store_dwordx4 v30,v[128:131],s[18:19] offset:0 sc1
v_min_u32 v144,s37,v144
v_min_u32 v145,s37,v145
v_min_u32 v146,s37,v146
v_min_u32 v147,s37,v147
global_store_dwordx4 v30,v[144:147],s[18:19] offset:1024 sc1
v_min_u32 v160,s37,v160
v_min_u32 v161,s37,v161
v_min_u32 v162,s37,v162
v_min_u32 v163,s37,v163
global_store_dwordx4 v30,v[160:163],s[18:19] offset:2048 sc1
v_min_u32 v176,s37,v176
v_min_u32 v177,s37,v177
v_min_u32 v178,s37,v178
v_min_u32 v179,s37,v179
global_store_dwordx4 v30,v[176:179],s[18:19] offset:3072 sc1
s_endpgm
L_fin_c:
s_xor_b32 s54,s10,1
s_lshl_b32 s54,s54,13
v_add_u32 v2,s54,v30
v_add_u32 v3,s54,v26
s_xor_b32 s54,s10,2
s_lshl_b32 s54,s54,13
v_add_u32 v4,s54,v30
v_add_u32 v5,s54,v26
s_xor_b32 s54,s10,3
s_lshl_b32 s54,s54,13
v_add_u32 v6,s54,v30
v_add_u32 v7,s54,v26
v_bfe_u32 v31,v0,0,4
v_lshlrev_b32 v24,11,v31
v_bfe_u32 v31,v0,4,1
v_lshl_add_u32 v24,v31,5,v24
v_bfe_u32 v31,v0,5,1
v_lshl_add_u32 v24,v31,4,v24
s_lshl_b32 s54,s10,16
s_lshl_b32 s59,s46,6
s_add_u32 s54,s54,s59
s_add_u32 s54,s54,3932160
s_add_u32 s16,s16,s54
s_addc_u32 s17,s17,0
L_fin_g:
global_load_dwordx4 v[132:135],v2,s[18:19] offset:0 sc1
global_load_dwordx4 v[148:151],v2,s[18:19] offset:1024 sc1
global_load_dwordx4 v[164:167],v2,s[18:19] offset:2048 sc1
global_load_dwordx4 v[180:183],v2,s[18:19] offset:3072 sc1
global_load_dwordx4 v[136:139],v4,s[18:19] offset:0 sc1
global_load_dwordx4 v[152:155],v4,s[18:19] offset:1024 sc1
global_load_dwordx4 v[168:171],v4,s[18:19] offset:2048 sc1
global_load_dwordx4 v[184:187],v4,s[18:19] offset:3072 sc1
global_load_dwordx4 v[140:143],v6,s[18:19] offset:0 sc1
global_load_dwordx4 v[156:159],v6,s[18:19] offset:1024 sc1
global_load_dwordx4 v[172:175],v6,s[18:19] offset:2048 sc1
global_load_dwordx4 v[188:191],v6,s[18:19] offset:3072 sc1
s_sub_u32 s40,s40,1
s_cbranch_scc1 L_chain_bail
s_waitcnt vmcnt(0)
v_mov_b32 v25,0
v_max3_u32 v25,v25,v132,v133
v_max3_u32 v25,v25,v134,v135
v_max3_u32 v25,v25,v136,v137
v_max3_u32 v25,v25,v138,v139
v_max3_u32 v25,v25,v140,v141
v_max3_u32 v25,v25,v142,v143
v_max3_u32 v25,v25,v148,v149
v_max3_u32 v25,v25,v150,v151
v_max3_u32 v25,v25,v152,v153
v_max3_u32 v25,v25,v154,v155
v_max3_u32 v25,v25,v156,v157
v_max3_u32 v25,v25,v158,v159
v_max3_u32 v25,v25,v164,v165
v_max3_u32 v25,v25,v166,v167
v_max3_u32 v25,v25,v168,v169
v_max3_u32 v25,v25,v170,v171
v_max3_u32 v25,v25,v172,v173
v_max3_u32 v25,v25,v174,v175
v_max3_u32 v25,v25,v180,v181
v_max3_u32 v25,v25,v182,v183
v_max3_u32 v25,v25,v184,v185
v_max3_u32 v25,v25,v186,v187
v_max3_u32 v25,v25,v188,v189
v_max3_u32 v25,v25,v190,v191
v_cmp_eq_u32 vcc,-1,v25
s_cbranch_vccnz L_fin_g
v_pk_add_f32 v[128:129],v[128:129],v[132:133]
v_pk_add_f32 v[136:137],v[136:137],v[140:141]
v_pk_add_f32 v[130:131],v[130:131],v[134:135]
v_pk_add_f32 v[138:139],v[138:139],v[142:143]
v_pk_add_f32 v[128:129],v[128:129],v[136:137]
v_pk_add_f32 v[130:131],v[130:131],v[138:139]
v_pk_add_f32 v[144:145],v[144:145],v[148:149]
v_pk_add_f32 v[152:153],v[152:153],v[156:157]
v_pk_add_f32 v[146:147],v[146:147],v[150:151]
v_pk_add_f32 v[154:155],v[154:155],v[158:159]
v_pk_add_f32 v[144:145],v[144:145],v[152:153]
v_pk_add_f32 v[146:147],v[146:147],v[154:155]
v_cvt_pk_bf16_f32 v72,v128,v129
v_cvt_pk_bf16_f32 v73,v130,v131
v_cvt_pk_bf16_f32 v74,v144,v145
v_cvt_pk_bf16_f32 v75,v146,v147
v_lshlrev_b32 v64,16,v72
v_and_b32 v65,0xffff0000,v72
v_lshlrev_b32 v66,16,v73
v_and_b32 v67,0xffff0000,v73
v_lshlrev_b32 v68,16,v74
v_and_b32 v69,0xffff0000,v74
v_lshlrev_b32 v70,16,v75
v_and_b32 v71,0xffff0000,v75
v_pk_mul_f32 v[64:65],v[64:65],v[56:57] op_sel_hi:[1,0]
v_pk_mul_f32 v[66:67],v[66:67],v[56:57] op_sel_hi:[1,0]
v_pk_mul_f32 v[68:69],v[68:69],v[56:57] op_sel_hi:[1,0]
v_pk_mul_f32 v[70:71],v[70:71],v[56:57] op_sel_hi:[1,0]
v_cvt_pk_bf16_f32 v72,v64,v65
v_cvt_pk_bf16_f32 v73,v66,v67
v_cvt_pk_bf16_f32 v74,v68,v69
v_cvt_pk_bf16_f32 v75,v70,v71
v_lshlrev_b32 v64,16,v72
v_and_b32 v65,0xffff0000,v72
v_lshlrev_b32 v66,16,v73
v_and_b32 v67,0xffff0000,v73
v_lshlrev_b32 v68,16,v74
v_and_b32 v69,0xffff0000,v74
v_lshlrev_b32 v70,16,v75
v_and_b32 v71,0xffff0000,v75
v_lshlrev_b32 v80,16,v40
v_and_b32 v81,0xffff0000,v40
v_lshlrev_b32 v82,16,v41
v_and_b32 v83,0xffff0000,v41
v_lshlrev_b32 v84,16,v42
v_and_b32 v85,0xffff0000,v42
v_lshlrev_b32 v86,16,v43
v_and_b32 v87,0xffff0000,v43
v_pk_add_f32 v[64:65],v[64:65],v[80:81]
v_pk_add_f32 v[66:67],v[66:67],v[82:83]
v_pk_add_f32 v[68:69],v[68:69],v[84:85]
v_pk_add_f32 v[70:71],v[70:71],v[86:87]
v_cvt_pk_bf16_f32 v96,v64,v65
v_cvt_pk_bf16_f32 v97,v66,v67
v_cvt_pk_bf16_f32 v98,v68,v69
v_cvt_pk_bf16_f32 v99,v70,v71
s_nop 0
v_permlane16_swap_b32 v96,v98
v_permlane16_swap_b32 v97,v99
global_store_dwordx4 v24,v[96:99],s[16:17] sc1
s_add_u32 s16,s16,32768
s_addc_u32 s17,s17,0
v_pk_add_f32 v[160:161],v[160:161],v[164:165]
v_pk_add_f32 v[168:169],v[168:169],v[172:173]
v_pk_add_f32 v[162:163],v[162:163],v[166:167]
v_pk_add_f32 v[170:171],v[170:171],v[174:175]
v_pk_add_f32 v[160:161],v[160:161],v[168:169]
v_pk_add_f32 v[162:163],v[162:163],v[170:171]
v_pk_add_f32 v[176:177],v[176:177],v[180:181]
v_pk_add_f32 v[184:185],v[184:185],v[188:189]
v_pk_add_f32 v[178:179],v[178:179],v[182:183]
v_pk_add_f32 v[186:187],v[186:187],v[190:191]
v_pk_add_f32 v[176:177],v[176:177],v[184:185]
v_pk_add_f32 v[178:179],v[178:179],v[186:187]
v_cvt_pk_bf16_f32 v72,v160,v161
v_cvt_pk_bf16_f32 v73,v162,v163
v_cvt_pk_bf16_f32 v74,v176,v177
v_cvt_pk_bf16_f32 v75,v178,v179
v_lshlrev_b32 v64,16,v72
v_and_b32 v65,0xffff0000,v72
v_lshlrev_b32 v66,16,v73
v_and_b32 v67,0xffff0000,v73
v_lshlrev_b32 v68,16,v74
v_and_b32 v69,0xffff0000,v74
v_lshlrev_b32 v70,16,v75
v_and_b32 v71,0xffff0000,v75
v_pk_mul_f32 v[64:65],v[64:65],v[58:59] op_sel_hi:[1,0]
v_pk_mul_f32 v[66:67],v[66:67],v[58:59] op_sel_hi:[1,0]
v_pk_mul_f32 v[68:69],v[68:69],v[58:59] op_sel_hi:[1,0]
v_pk_mul_f32 v[70:71],v[70:71],v[58:59] op_sel_hi:[1,0]
v_cvt_pk_bf16_f32 v72,v64,v65
v_cvt_pk_bf16_f32 v73,v66,v67
v_cvt_pk_bf16_f32 v74,v68,v69
v_cvt_pk_bf16_f32 v75,v70,v71
v_lshlrev_b32 v64,16,v72
v_and_b32 v65,0xffff0000,v72
v_lshlrev_b32 v66,16,v73
v_and_b32 v67,0xffff0000,v73
v_lshlrev_b32 v68,16,v74
v_and_b32 v69,0xffff0000,v74
v_lshlrev_b32 v70,16,v75
v_and_b32 v71,0xffff0000,v75
v_lshlrev_b32 v80,16,v44
v_and_b32 v81,0xffff0000,v44
v_lshlrev_b32 v82,16,v45
v_and_b32 v83,0xffff0000,v45
v_lshlrev_b32 v84,16,v46
v_and_b32 v85,0xffff0000,v46
v_lshlrev_b32 v86,16,v47
v_and_b32 v87,0xffff0000,v47
v_pk_add_f32 v[64:65],v[64:65],v[80:81]
v_pk_add_f32 v[66:67],v[66:67],v[82:83]
v_pk_add_f32 v[68:69],v[68:69],v[84:85]
v_pk_add_f32 v[70:71],v[70:71],v[86:87]
v_cvt_pk_bf16_f32 v100,v64,v65
v_cvt_pk_bf16_f32 v101,v66,v67
v_cvt_pk_bf16_f32 v102,v68,v69
v_cvt_pk_bf16_f32 v103,v70,v71
s_nop 0
v_permlane16_swap_b32 v100,v102
v_permlane16_swap_b32 v101,v103
global_store_dwordx4 v24,v[100:103],s[16:17] sc1
s_endpgm
L_code_end:
.p2align 4
.type L_table,@object
L_table:
.long 0xe10c000a,0x90c8022,0x410c2004,0x150d4052,0x510d0044,0x1d0dc071,0xfc0f8006,0xfc0f80e7,0xfc0f8000,0xfc0f8000
.long 0xe10c001a,0xd0cc032,0x450c6014,0x150d4152,0x550d4054,0x1d0dc171,0xfc0f8106,0xfc0f81e7,0xfc0f8000,0xfc0f8000
.long 0xe10c010a,0x90c8122,0x490ca024,0x150d4252,0x590d8064,0x1d0dc271,0xfc0f8206,0xfc0f82e7,0xfc0f8000,0xfc0f8000
.long 0xe10c011a,0xd0cc132,0x4d0ce034,0x150d4352,0x5d0dc074,0x1d0dc371,0xfc0f8306,0xfc0f83e7,0xfc0f8000,0xfc0f8000
.long 0xe10c020a,0x90c8222,0x410c2104,0x150d4452,0x510d0144,0x1d0dc471,0xfc0f8406,0xfc0f84e7,0xfc0f8000,0xfc0f8000
.long 0xe10c021a,0xd0cc232,0x450c6114,0x150d4552,0x550d4154,0x1d0dc571,0xfc0f8506,0xfc0f85e7,0xfc0f8000,0xfc0f8000
.long 0xe10c030a,0x90c8322,0x490ca124,0x150d4652,0x590d8164,0x1d0dc671,0xfc0f8606,0xfc0f86e7,0xfc0f8000,0xfc0f8000
.long 0xe10c031a,0xd0cc332,0x4d0ce134,0x150d4752,0x5d0dc174,0x1d0dc771,0xfc0f8706,0xfc0f87e7,0xfc0f8000,0xfc0f8000
.long 0xe50c040a,0x90c8422,0x410c2204,0x150d4852,0x510d0244,0x1d0dc871,0xfc0f8016,0xfc0f88e7,0xfc0f8000,0xfc0f8000
.long 0xe50c041a,0xd0cc432,0x450c6214,0x150d4952,0x550d4254,0x1d0dc971,0xfc0f8116,0xfc0f89e7,0xfc0f8000,0xfc0f8000
.long 0xe50c050a,0x90c8522,0x490ca224,0x150d4a52,0x590d8264,0x1d0dca71,0xfc0f8216,0xfc0f8ae7,0xfc0f8000,0xfc0f8000
.long 0xe50c051a,0xd0cc532,0x4d0ce234,0x150d4b52,0x5d0dc274,0x1d0dcb71,0xfc0f8316,0xfc0f8be7,0xfc0f8000,0xfc0f8000
.long 0xe50c060a,0x90c8622,0x410c2304,0x150d4c52,0x510d0344,0x1d0dcc71,0xfc0f8416,0xfc0f8ce7,0xfc0f8000,0xfc0f8000
.long 0xe50c061a,0xd0cc632,0x450c6314,0x150d4d52,0x550d4354,0x1d0dcd71,0xfc0f8516,0xfc0f8de7,0xfc0f8000,0xfc0f8000
.long 0xe50c070a,0x90c8722,0x490ca324,0x150d4e52,0x590d8364,0x1d0dce71,0xfc0f8616,0xfc0f8ee7,0xfc0f8000,0xfc0f8000
.long 0xe50c071a,0xd0cc732,0x4d0ce334,0x150d4f52,0x5d0dc374,0x1d0dcf71,0xfc0f8716,0xfc0f8fe7,0xfc0f8000,0xfc0f8000
.long 0xe10c0009,0x50c4029,0x410c3004,0x110d0042,0x510d1044,0x190d80c9,0xb1c5008c,0xfc0f80c7,0xfc0f8000,0xfc0f8000
.long 0xe10c0019,0x50c4039,0x450c7014,0x110d0142,0x550d5054,0x190d80d9,0xb1c5018c,0xfc0f81c7,0xfc0f8000,0xfc0f8000
.long 0xe10c0109,0x50c4129,0x490cb024,0x110d0242,0x590d9064,0x190d81c9,0xb1c5028c,0xfc0f82c7,0xfc0f8000,0xfc0f8000
.long 0xe10c0119,0x50c4139,0x4d0cf034,0x110d0342,0x5d0dd074,0x190d81d9,0xb1c5038c,0xfc0f83c7,0xfc0f8000,0xfc0f8000
.long 0xe10c0209,0x50c4229,0x410c3104,0x110d0442,0x510d1144,0x190d82c9,0xb1c5009c,0xfc0f84c7,0xfc0f8000,0xfc0f8000
.long 0xe10c0219,0x50c4239,0x450c7114,0x110d0542,0x550d5154,0x190d82d9,0xb1c5019c,0xfc0f85c7,0xfc0f8000,0xfc0f8000
.long 0xe10c0309,0x50c4329,0x490cb124,0x110d0642,0x590d9164,0x190d83c9,0xb1c5029c,0xfc0f86c7,0xfc0f8000,0xfc0f8000
.long 0xe10c0319,0x50c4339,0x4d0cf134,0x110d0742,0x5d0dd174,0x190d83d9,0xb1c5039c,0xfc0f87c7,0xfc0f8000,0xfc0f8000
.long 0xe50c0409,0x50c4429,0x410c3204,0x110d0842,0x510d1244,0x190d84c9,0xb5c540ac,0xfc0f80d7,0xfc0f8000,0xfc0f8000
.long 0xe50c0419,0x50c4439,0x450c7214,0x110d0942,0x550d5254,0x190d84d9,0xb5c541ac,0xfc0f81d7,0xfc0f8000,0xfc0f8000
.long 0xe50c0509,0x50c4529,0x490cb224,0x110d0a42,0x590d9264,0x190d85c9,0xb5c542ac,0xfc0f82d7,0xfc0f8000,0xfc0f8000
.long 0xe50c0519,0x50c4539,0x4d0cf234,0x110d0b42,0x5d0dd274,0x190d85d9,0xb5c543ac,0xfc0f83d7,0xfc0f8000,0xfc0f8000
.long 0xe50c0609,0x50c4629,0x410c3304,0x110d0c42,0x510d1344,0x190d86c9,0xb5c540bc,0xfc0f84d7,0xfc0f8000,0xfc0f8000
.long 0xe50c0619,0x50c4639,0x450c7314,0x110d0d42,0x550d5354,0x190d86d9,0xb5c541bc,0xfc0f85d7,0xfc0f8000,0xfc0f8000
.long 0xe50c0709,0x50c4729,0x490cb324,0x110d0e42,0x590d9364,0x190d87c9,0xb5c542bc,0xfc0f86d7,0xfc0f8000,0xfc0f8000
.long 0xe50c0719,0x50c4739,0x4d0cf334,0x110d0f42,0x5d0dd374,0x190d87d9,0xb5c543bc,0xfc0f87d7,0xfc0f8000,0xfc0f8000
.long 0xe90c080a,0x90c8822,0x410c2404,0x150d4053,0x510d0444,0xfc0f8048,0xfc0f8000,0xfc0f8000,0xfc0f8000,0xfc0f8000
.long 0xe90c081a,0xd0cc832,0x450c6414,0x150d4153,0x550d4454,0xfc0f8148,0xfc0f8000,0xfc0f8000,0xfc0f8000,0xfc0f8000
.long 0xe90c090a,0x90c8922,0x490ca424,0x150d4253,0x590d8464,0xfc0f8248,0xfc0f8000,0xfc0f8000,0xfc0f8000,0xfc0f8000
.long 0xe90c091a,0xd0cc932,0x4d0ce434,0x150d4353,0x5d0dc474,0xfc0f8348,0xfc0f8000,0xfc0f8000,0xfc0f8000,0xfc0f8000
.long 0xe90c0a0a,0x90c8a22,0x410c2504,0x150d4453,0x510d0544,0xfc0f8058,0xfc0f8000,0xfc0f8000,0xfc0f8000,0xfc0f8000
.long 0xe90c0a1a,0xd0cca32,0x450c6514,0x150d4553,0x550d4554,0xfc0f8158,0xfc0f8000,0xfc0f8000,0xfc0f8000,0xfc0f8000
.long 0xe90c0b0a,0x90c8b22,0x490ca524,0x150d4653,0x590d8564,0xfc0f8258,0xfc0f8000,0xfc0f8000,0xfc0f8000,0xfc0f8000
.long 0xe90c0b1a,0xd0ccb32,0x4d0ce534,0x150d4753,0x5d0dc574,0xfc0f8358,0xfc0f8000,0xfc0f8000,0xfc0f8000,0xfc0f8000
.long 0xed0c0c0a,0x90c8c22,0x410c2604,0x150d4853,0x510d0644,0xfc0f8068,0xfc0f8000,0xfc0f8000,0xfc0f8000,0xfc0f8000
.long 0xed0c0c1a,0xd0ccc32,0x450c6614,0x150d4953,0x550d4654,0xfc0f8168,0xfc0f8000,0xfc0f8000,0xfc0f8000,0xfc0f8000
.long 0xed0c0d0a,0x90c8d22,0x490ca624,0x150d4a53,0x590d8664,0xfc0f8268,0xfc0f8000,0xfc0f8000,0xfc0f8000,0xfc0f8000
.long 0xed0c0d1a,0xd0ccd32,0x4d0ce634,0x150d4b53,0x5d0dc674,0xfc0f8368,0xfc0f8000,0xfc0f8000,0xfc0f8000,0xfc0f8000
.long 0xed0c0e0a,0x90c8e22,0x410c2704,0x150d4c53,0x510d0744,0xfc0f8078,0xfc0f8000,0xfc0f8000,0xfc0f8000,0xfc0f8000
.long 0xed0c0e1a,0xd0cce32,0x450c6714,0x150d4d53,0x550d4754,0xfc0f8178,0xfc0f8000,0xfc0f8000,0xfc0f8000,0xfc0f8000
.long 0xed0c0f0a,0x90c8f22,0x490ca724,0x150d4e53,0x590d8764,0xfc0f8278,0xfc0f8000,0xfc0f8000,0xfc0f8000,0xfc0f8000
.long 0xed0c0f1a,0xd0ccf32,0x4d0ce734,0x150d4f53,0x5d0dc774,0xfc0f8378,0xfc0f8000,0xfc0f8000,0xfc0f8000,0xfc0f8000
.long 0xe90c0809,0x50c4829,0x410c3404,0x110d0043,0x510d1444,0x190d88c9,0xb9c580cc,0xfc0f88c7,0xfc0f8000,0xfc0f8000
.long 0xe90c0819,0x50c4839,0x450c7414,0x110d0143,0x550d5454,0x190d88d9,0xb9c581cc,0xfc0f89c7,0xfc0f8000,0xfc0f8000
.long 0xe90c0909,0x50c4929,0x490cb424,0x110d0243,0x590d9464,0x190d89c9,0xb9c582cc,0xfc0f8ac7,0xfc0f8000,0xfc0f8000
.long 0xe90c0919,0x50c4939,0x4d0cf434,0x110d0343,0x5d0dd474,0x190d89d9,0xb9c583cc,0xfc0f8bc7,0xfc0f8000,0xfc0f8000
.long 0xe90c0a09,0x50c4a29,0x410c3504,0x110d0443,0x510d1544,0x190d8ac9,0xb9c580dc,0xfc0f8cc7,0xfc0f8000,0xfc0f8000
.long 0xe90c0a19,0x50c4a39,0x450c7514,0x110d0543,0x550d5554,0x190d8ad9,0xb9c581dc,0xfc0f8dc7,0xfc0f8000,0xfc0f8000
.long 0xe90c0b09,0x50c4b29,0x490cb524,0x110d0643,0x590d9564,0x190d8bc9,0xb9c582dc,0xfc0f8ec7,0xfc0f8000,0xfc0f8000
.long 0xe90c0b19,0x50c4b39,0x4d0cf534,0x110d0743,0x5d0dd574,0x190d8bd9,0xb9c583dc,0xfc0f8fc7,0xfc0f8000,0xfc0f8000
.long 0xed0c0c09,0x50c4c29,0x410c3604,0x110d0843,0x510d1644,0x190d8cc9,0xbdc5c0ec,0xfc0f88d7,0xfc0f8000,0xfc0f8000
.long 0xed0c0c19,0x50c4c39,0x450c7614,0x110d0943,0x550d5654,0x190d8cd9,0xbdc5c1ec,0xfc0f89d7,0xfc0f8000,0xfc0f8000
.long 0xed0c0d09,0x50c4d29,0x490cb624,0x110d0a43,0x590d9664,0x190d8dc9,0xbdc5c2ec,0xfc0f8ad7,0xfc0f8000,0xfc0f8000
.long 0xed0c0d19,0x50c4d39,0x4d0cf634,0x110d0b43,0x5d0dd674,0x190d8dd9,0xbdc5c3ec,0xfc0f8bd7,0xfc0f8000,0xfc0f8000
.long 0xed0c0e09,0x50c4e29,0x410c3704,0x110d0c43,0x510d1744,0x190d8ec9,0xbdc5c0fc,0xfc0f8cd7,0xfc0f8000,0xfc0f8000
.long 0xed0c0e19,0x50c4e39,0x450c7714,0x110d0d43,0x550d5754,0x190d8ed9,0xbdc5c1fc,0xfc0f8dd7,0xfc0f8000,0xfc0f8000
.long 0xed0c0f09,0x50c4f29,0x490cb724,0x110d0e43,0x590d9764,0x190d8fc9,0xbdc5c2fc,0xfc0f8ed7,0xfc0f8000,0xfc0f8000
.long 0xed0c0f19,0x50c4f39,0x4d0cf734,0x110d0f43,0x5d0dd774,0x190d8fd9,0xbdc5c3fc,0xfc0f8fd7,0xfc0f8000,0xfc0f8000
.long 0xe10c000b,0x90c8023,0x410c2804,0x150d4051,0x510d0844,0x1d0dc072,0xfc0f8086,0xfc0f90e7,0xfc0f8000,0xfc0f8000
.long 0xe10c001b,0xd0cc033,0x450c6814,0x150d4151,0x550d4854,0x1d0dc172,0xfc0f8186,0xfc0f91e7,0xfc0f8000,0xfc0f8000
.long 0xe10c010b,0x90c8123,0x490ca824,0x150d4251,0x590d8864,0x1d0dc272,0xfc0f8286,0xfc0f92e7,0xfc0f8000,0xfc0f8000
.long 0xe10c011b,0xd0cc133,0x4d0ce834,0x150d4351,0x5d0dc874,0x1d0dc372,0xfc0f8386,0xfc0f93e7,0xfc0f8000,0xfc0f8000
.long 0xe10c020b,0x90c8223,0x410c2904,0x150d4451,0x510d0944,0x1d0dc472,0xfc0f8486,0xfc0f94e7,0xfc0f8000,0xfc0f8000
.long 0xe10c021b,0xd0cc233,0x450c6914,0x150d4551,0x550d4954,0x1d0dc572,0xfc0f8586,0xfc0f95e7,0xfc0f8000,0xfc0f8000
.long 0xe10c030b,0x90c8323,0x490ca924,0x150d4651,0x590d8964,0x1d0dc672,0xfc0f8686,0xfc0f96e7,0xfc0f8000,0xfc0f8000
.long 0xe10c031b,0xd0cc333,0x4d0ce934,0x150d4751,0x5d0dc974,0x1d0dc772,0xfc0f8786,0xfc0f97e7,0xfc0f8000,0xfc0f8000
.long 0xe50c040b,0x90c8423,0x410c2a04,0x150d4851,0x510d0a44,0x1d0dc872,0xfc0f8096,0xfc0f98e7,0xfc0f8000,0xfc0f8000
.long 0xe50c041b,0xd0cc433,0x450c6a14,0x150d4951,0x550d4a54,0x1d0dc972,0xfc0f8196,0xfc0f99e7,0xfc0f8000,0xfc0f8000
.long 0xe50c050b,0x90c8523,0x490caa24,0x150d4a51,0x590d8a64,0x1d0dca72,0xfc0f8296,0xfc0f9ae7,0xfc0f8000,0xfc0f8000
.long 0xe50c051b,0xd0cc533,0x4d0cea34,0x150d4b51,0x5d0dca74,0x1d0dcb72,0xfc0f8396,0xfc0f9be7,0xfc0f8000,0xfc0f8000
.long 0xe50c060b,0x90c8623,0x410c2b04,0x150d4c51,0x510d0b44,0x1d0dcc72,0xfc0f8496,0xfc0f9ce7,0xfc0f8000,0xfc0f8000
.long 0xe50c061b,0xd0cc633,0x450c6b14,0x150d4d51,0x550d4b54,0x1d0dcd72,0xfc0f8596,0xfc0f9de7,0xfc0f8000,0xfc0f8000
.long 0xe50c070b,0x90c8723,0x490cab24,0x150d4e51,0x590d8b64,0x1d0dce72,0xfc0f8696,0xfc0f9ee7,0xfc0f8000,0xfc0f8000
.long 0xe50c071b,0xd0cc733,0x4d0ceb34,0x150d4f51,0x5d0dcb74,0x1d0dcf72,0xfc0f8796,0xfc0f9fe7,0xfc0f8000,0xfc0f8000
.long 0x50c4012,0x90c8021,0x410c3804,0xa1c42005,0xfc0f98c7,0xfc0f8000,0xfc0f8000,0xfc0f8000,0xfc0f8000,0xfc0f8000
.long 0x50c4112,0xd0cc031,0x450c7814,0xa1c42105,0xfc0f99c7,0xfc0f8000,0xfc0f8000,0xfc0f8000,0xfc0f8000,0xfc0f8000
.long 0x50c4212,0x90c8121,0x490cb824,0xa1c42205,0xfc0f9ac7,0xfc0f8000,0xfc0f8000,0xfc0f8000,0xfc0f8000,0xfc0f8000
.long 0x50c4312,0xd0cc131,0x4d0cf834,0xa1c42305,0xfc0f9bc7,0xfc0f8000,0xfc0f8000,0xfc0f8000,0xfc0f8000,0xfc0f8000
.long 0x50c4412,0x90c8221,0x410c3904,0xa5c46015,0xfc0f9cc7,0xfc0f8000,0xfc0f8000,0xfc0f8000,0xfc0f8000,0xfc0f8000
.long 0x50c4512,0xd0cc231,0x450c7914,0xa5c46115,0xfc0f9dc7,0xfc0f8000,0xfc0f8000,0xfc0f8000,0xfc0f8000,0xfc0f8000
.long 0x50c4612,0x90c8321,0x490cb924,0xa5c46215,0xfc0f9ec7,0xfc0f8000,0xfc0f8000,0xfc0f8000,0xfc0f8000,0xfc0f8000
.long 0x50c4712,0xd0cc331,0x4d0cf934,0xa5c46315,0xfc0f9fc7,0xfc0f8000,0xfc0f8000,0xfc0f8000,0xfc0f8000,0xfc0f8000
.long 0x50c4812,0x90c8421,0x410c3a04,0xa9c4a025,0xfc0f98d7,0xfc0f8000,0xfc0f8000,0xfc0f8000,0xfc0f8000,0xfc0f8000
.long 0x50c4912,0xd0cc431,0x450c7a14,0xa9c4a125,0xfc0f99d7,0xfc0f8000,0xfc0f8000,0xfc0f8000,0xfc0f8000,0xfc0f8000
.long 0x50c4a12,0x90c8521,0x490cba24,0xa9c4a225,0xfc0f9ad7,0xfc0f8000,0xfc0f8000,0xfc0f8000,0xfc0f8000,0xfc0f8000
.long 0x50c4b12,0xd0cc531,0x4d0cfa34,0xa9c4a325,0xfc0f9bd7,0xfc0f8000,0xfc0f8000,0xfc0f8000,0xfc0f8000,0xfc0f8000
.long 0x50c4c12,0x90c8621,0x410c3b04,0xadc4e035,0xfc0f9cd7,0xfc0f8000,0xfc0f8000,0xfc0f8000,0xfc0f8000,0xfc0f8000
.long 0x50c4d12,0xd0cc631,0x450c7b14,0xadc4e135,0xfc0f9dd7,0xfc0f8000,0xfc0f8000,0xfc0f8000,0xfc0f8000,0xfc0f8000
.long 0x50c4e12,0x90c8721,0x490cbb24,0xadc4e235,0xfc0f9ed7,0xfc0f8000,0xfc0f8000,0xfc0f8000,0xfc0f8000,0xfc0f8000
.long 0x50c4f12,0xd0cc731,0x4d0cfb34,0xadc4e335,0xfc0f9fd7,0xfc0f8000,0xfc0f8000,0xfc0f8000,0xfc0f8000,0xfc0f8000
.long 0xe90c080b,0x90c8823,0x410c2c04,0x510d1844,0x510d0c44,0x1d0dc073,0xfc0f80a6,0xfc0f8000,0xfc0f8000,0xfc0f8000
.long 0xe90c081b,0xd0cc833,0x450c6c14,0x550d5854,0x550d4c54,0x1d0dc173,0xfc0f81a6,0xfc0f8000,0xfc0f8000,0xfc0f8000
.long 0xe90c090b,0x90c8923,0x490cac24,0x590d9864,0x590d8c64,0x1d0dc273,0xfc0f82a6,0xfc0f8000,0xfc0f8000,0xfc0f8000
.long 0xe90c091b,0xd0cc933,0x4d0cec34,0x5d0dd874,0x5d0dcc74,0x1d0dc373,0xfc0f83a6,0xfc0f8000,0xfc0f8000,0xfc0f8000
.long 0xe90c0a0b,0x90c8a23,0x410c2d04,0x510d1944,0x510d0d44,0x1d0dc473,0xfc0f84a6,0xfc0f8000,0xfc0f8000,0xfc0f8000
.long 0xe90c0a1b,0xd0cca33,0x450c6d14,0x550d5954,0x550d4d54,0x1d0dc573,0xfc0f85a6,0xfc0f8000,0xfc0f8000,0xfc0f8000
.long 0xe90c0b0b,0x90c8b23,0x490cad24,0x590d9964,0x590d8d64,0x1d0dc673,0xfc0f86a6,0xfc0f8000,0xfc0f8000,0xfc0f8000
.long 0xe90c0b1b,0xd0ccb33,0x4d0ced34,0x5d0dd974,0x5d0dcd74,0x1d0dc773,0xfc0f87a6,0xfc0f8000,0xfc0f8000,0xfc0f8000
.long 0xed0c0c0b,0x90c8c23,0x410c2e04,0x510d1a44,0x510d0e44,0x1d0dc873,0xfc0f80b6,0xfc0f8000,0xfc0f8000,0xfc0f8000
.long 0xed0c0c1b,0xd0ccc33,0x450c6e14,0x550d5a54,0x550d4e54,0x1d0dc973,0xfc0f81b6,0xfc0f8000,0xfc0f8000,0xfc0f8000
.long 0xed0c0d0b,0x90c8d23,0x490cae24,0x590d9a64,0x590d8e64,0x1d0dca73,0xfc0f82b6,0xfc0f8000,0xfc0f8000,0xfc0f8000
.long 0xed0c0d1b,0xd0ccd33,0x4d0cee34,0x5d0dda74,0x5d0dce74,0x1d0dcb73,0xfc0f83b6,0xfc0f8000,0xfc0f8000,0xfc0f8000
.long 0xed0c0e0b,0x90c8e23,0x410c2f04,0x510d1b44,0x510d0f44,0x1d0dcc73,0xfc0f84b6,0xfc0f8000,0xfc0f8000,0xfc0f8000
.long 0xed0c0e1b,0xd0cce33,0x450c6f14,0x550d5b54,0x550d4f54,0x1d0dcd73,0xfc0f85b6,0xfc0f8000,0xfc0f8000,0xfc0f8000
.long 0xed0c0f0b,0x90c8f23,0x490caf24,0x590d9b64,0x590d8f64,0x1d0dce73,0xfc0f86b6,0xfc0f8000,0xfc0f8000,0xfc0f8000
.long 0xed0c0f1b,0xd0ccf33,0x4d0cef34,0x5d0ddb74,0x5d0dcf74,0x1d0dcf73,0xfc0f87b6,0xfc0f8000,0xfc0f8000,0xfc0f8000
.long 0x50c4013,0x90c8821,0x110d0041,0x190d8062,0x190d8063,0xfc0f8026,0xfc0f90c7,0xfc0f8000,0xfc0f8000,0xfc0f8000
.long 0x50c4113,0xd0cc831,0x110d0141,0x190d8162,0x190d8163,0xfc0f8126,0xfc0f91c7,0xfc0f8000,0xfc0f8000,0xfc0f8000
.long 0x50c4213,0x90c8921,0x110d0241,0x190d8262,0x190d8263,0xfc0f8226,0xfc0f92c7,0xfc0f8000,0xfc0f8000,0xfc0f8000
.long 0x50c4313,0xd0cc931,0x110d0341,0x190d8362,0x190d8363,0xfc0f8326,0xfc0f93c7,0xfc0f8000,0xfc0f8000,0xfc0f8000
.long 0x50c4413,0x90c8a21,0x110d0441,0x190d8462,0x190d8463,0xfc0f8426,0xfc0f94c7,0xfc0f8000,0xfc0f8000,0xfc0f8000
.long 0x50c4513,0xd0cca31,0x110d0541,0x190d8562,0x190d8563,0xfc0f8526,0xfc0f95c7,0xfc0f8000,0xfc0f8000,0xfc0f8000
.long 0x50c4613,0x90c8b21,0x110d0641,0x190d8662,0x190d8663,0xfc0f8626,0xfc0f96c7,0xfc0f8000,0xfc0f8000,0xfc0f8000
.long 0x50c4713,0xd0ccb31,0x110d0741,0x190d8762,0x190d8763,0xfc0f8726,0xfc0f97c7,0xfc0f8000,0xfc0f8000,0xfc0f8000
.long 0x50c4813,0x90c8c21,0x110d0841,0x190d8862,0x190d8863,0xfc0f8036,0xfc0f90d7,0xfc0f8000,0xfc0f8000,0xfc0f8000
.long 0x50c4913,0xd0ccc31,0x110d0941,0x190d8962,0x190d8963,0xfc0f8136,0xfc0f91d7,0xfc0f8000,0xfc0f8000,0xfc0f8000
.long 0x50c4a13,0x90c8d21,0x110d0a41,0x190d8a62,0x190d8a63,0xfc0f8236,0xfc0f92d7,0xfc0f8000,0xfc0f8000,0xfc0f8000
.long 0x50c4b13,0xd0ccd31,0x110d0b41,0x190d8b62,0x190d8b63,0xfc0f8336,0xfc0f93d7,0xfc0f8000,0xfc0f8000,0xfc0f8000
.long 0x50c4c13,0x90c8e21,0x110d0c41,0x190d8c62,0x190d8c63,0xfc0f8436,0xfc0f94d7,0xfc0f8000,0xfc0f8000,0xfc0f8000
.long 0x50c4d13,0xd0cce31,0x110d0d41,0x190d8d62,0x190d8d63,0xfc0f8536,0xfc0f95d7,0xfc0f8000,0xfc0f8000,0xfc0f8000
.long 0x50c4e13,0x90c8f21,0x110d0e41,0x190d8e62,0x190d8e63,0xfc0f8636,0xfc0f96d7,0xfc0f8000,0xfc0f8000,0xfc0f8000
.long 0x50c4f13,0xd0ccf31,0x110d0f41,0x190d8f62,0x190d8f63,0xfc0f8736,0xfc0f97d7,0xfc0f8000,0xfc0f8000,0xfc0f8000
.section .rodata,"a"
.p2align 6
.amdhsa_kernel gated_mix__memory_aug_recurrent_mem_tr__glu_gated_swiglu__prompt_kernel
  .amdhsa_next_free_vgpr 512
  .amdhsa_next_free_sgpr 102
  .amdhsa_accum_offset 256
  .amdhsa_group_segment_fixed_size 0
  .amdhsa_kernarg_size 120
  .amdhsa_user_sgpr_count 2
  .amdhsa_user_sgpr_kernarg_segment_ptr 1
  .amdhsa_system_sgpr_workgroup_id_x 1
.end_amdhsa_kernel
```
